```python
import torch

def _softmax(x, axis=-1):
    return torch.softmax(x, dim=axis)
def _gelu(x):
    return torch.nn.functional.gelu(x, approximate="tanh")
def _silu(x):
    return torch.nn.functional.silu(x)
def _sigmoid(x):
    return torch.sigmoid(x)
def _layernorm(x, axis=-1, eps=1e-5):
    m = x.mean(dim=axis, keepdim=True)
    v = x.var(dim=axis, keepdim=True, unbiased=False)
    return (x - m) / torch.sqrt(v + eps)
def _scatter_add(tgt, idx, src, axis=0):
    return tgt.clone().index_add_(axis, idx, src)
def _segment_sum(src, seg, n):
    out = torch.zeros((n,) + src.shape[1:], dtype=src.dtype)
    return out.index_add_(0, seg, src)
def _pad(x, pw):
    flat = tuple(v for pair in reversed(pw) for v in pair)
    return torch.nn.functional.pad(x, flat)

kernel_name = 'recurrent_scan__gqa_block_cached__dense_activation_gelu__prompt'

def setup_inputs():

    _w = (lambda a: (lambda t: t.to(torch.bfloat16) if t.is_floating_point() else t)(torch.as_tensor(a)))
    def _A_setup():
        B, Sq, D = 1, 2048, 512
        Hq, Hkv, Sk, Dh = 32, 8, 2048, 128
        assert Hq % Hkv == 0, (Hq, Hkv)
        return {
            "x": _w((lambda *s: torch.randn(*s, dtype=torch.bfloat16) * 0.1)(B, Sq, D)),
            "k_cache": _w((lambda *s: torch.randn(*s, dtype=torch.bfloat16) * 0.8)(B, Hkv, Sk, Dh)),
            "v_cache": _w((lambda *s: torch.randn(*s, dtype=torch.bfloat16) * 3.2)(B, Hkv, Sk, Dh)),
            "wq": _w((lambda *s: torch.randn(*s, dtype=torch.bfloat16) * 0.8)(D, Hq * Dh) * (D ** -0.5)),
            "wo": _w((lambda *s: torch.randn(*s, dtype=torch.bfloat16) * 3.2)(Hq * Dh, D) * ((Hq * Dh) ** -0.5)),
        }
    _A_in = _A_setup()

    def _B_setup():
        B, S, D, F = 1, 2048, 512, 1792
        return {
            "x": _w((lambda *s: torch.randn(*s, dtype=torch.bfloat16) * 0.1)(B, S, D)),
            "w1": _w((lambda *s: torch.randn(*s, dtype=torch.bfloat16) * 3.2)(D, F) * (D ** -0.5)),
            "b1": _w((lambda *s: torch.randn(*s, dtype=torch.bfloat16) * 3.2)(F) * 0.01),
            "w2": _w((lambda *s: torch.randn(*s, dtype=torch.bfloat16) * 3.2)(F, D) * (F ** -0.5)),
            "b2": _w((lambda *s: torch.randn(*s, dtype=torch.bfloat16) * 3.2)(D) * 0.01),
        }
    _B_in = _B_setup()

    return {
        "A_x": _A_in["x"],
        "A_k_cache": _A_in["k_cache"],
        "A_v_cache": _A_in["v_cache"],
        "A_wq": _A_in["wq"],
        "A_wo": _A_in["wo"],
        "B_x": _B_in["x"],
        "B_w1": _B_in["w1"],
        "B_b1": _B_in["b1"],
        "B_w2": _B_in["w2"],
        "B_b2": _B_in["b2"],
    }

def reference(A_x, A_k_cache, A_v_cache, A_wq, A_wo, B_x, B_w1, B_b1, B_w2, B_b2):
    def _A_ref(x, k_cache, v_cache, wq, wo):
        B, Sq, D = x.shape
        Hq, Dh = 32, 128
        Hkv = k_cache.shape[1]
        rep = Hq // Hkv
        q = (lambda x, *d: x.permute(*d))((x @ wq).reshape(B, Sq, Hq, Dh), 0, 2, 1, 3)
        k = (lambda x, n, axis: torch.repeat_interleave(x, n, dim=axis))(k_cache, rep, axis=1)
        v = (lambda x, n, axis: torch.repeat_interleave(x, n, dim=axis))(v_cache, rep, axis=1)
        scores = torch.einsum("bhqd,bhkd->bhqk", q, k) * (Dh ** -0.5)
        p = _softmax(scores, axis=-1)
        o = torch.einsum("bhqk,bhkd->bhqd", p, v)
        return (lambda x, *d: x.permute(*d))(o, 0, 2, 1, 3).reshape(B, Sq, Hq * Dh) @ wo

    def _B_ref(x, w1, b1, w2, b2):
        h = torch.einsum("bsd,df->bsf", x, w1) + b1
        h = _gelu(h)
        return torch.einsum("bsf,fd->bsd", h, w2) + b2

    x = A_x
    xn = _layernorm(x, axis=-1)
    s = _A_ref(xn, A_k_cache, A_v_cache, A_wq, A_wo)
    g = _silu(_B_ref(xn, B_w1, B_b1, B_w2, B_b2))
    return x + s * g
```

```asm
; @launch grid=(256,1,1) block=(256,1,1) lds=163840
.amdgcn_target "amdgcn-amd-amdhsa--gfx950"
.text
.globl recurrent_scan__gqa_block_cached__dense_activation_gelu__prompt_kernel
.p2align 12
.p2align 8
.type recurrent_scan__gqa_block_cached__dense_activation_gelu__prompt_kernel,@function
recurrent_scan__gqa_block_cached__dense_activation_gelu__prompt_kernel:
    s_load_dwordx2 s[4:5], s[0:1], 0
    s_load_dwordx16 s[64:79], s[0:1], 0
    s_load_dwordx8 s[80:87], s[0:1], 64
    s_load_dwordx2 s[88:89], s[0:1], 96
    s_cmp_ge_u32 s2, 256
    s_cbranch_scc1 L_END
    s_getpc_b64 s[90:91]
L_PC1:
    v_lshlrev_b32 v58, 4, v0
    global_load_dword v60, v58, s[90:91]
    s_lshr_b32 s94, s2, 3
    s_and_b32 s53, s2, 1
    s_lshl_b32 s53, s53, 4
    s_lshr_b32 s95, s94, 1
    s_add_u32 s53, s53, s95
    s_lshl_b32 s59, s53, 16
    v_lshrrev_b32 v33, 2, v0
    v_lshlrev_b32 v33, 10, v33
    v_and_b32 v34, 3, v0
    v_lshl_add_u32 v33, v34, 4, v33
    s_mov_b32 s6, 0x200000
    s_mov_b32 s7, 0x20000
    s_waitcnt lgkmcnt(0)
    buffer_load_dwordx4 v[64:67], v33, s[4:7], s59 offen offset:0
    buffer_load_dwordx4 v[68:71], v33, s[4:7], s59 offen offset:64
    v_lshrrev_b32 v34, 6, v0
    v_and_b32 v37, 63, v0
    v_readfirstlane_b32 s3, v34
    s_and_b32 s49, s94, 3
    s_lshl_b32 s50, s3, 2
    s_add_u32 s49, s49, s50
    s_lshl_b32 s49, s49, 2
    s_mov_b32 s44, 0x86307b97
    s_mov_b32 s45, 0xcccca421
    s_lshr_b64 s[44:45], s[44:45], s49
    s_and_b32 s44, s44, 15
    s_lshl_b32 m0, s44, 1
    s_nop 0
    s_movrels_b64 s[46:47], s[64:65]
    s_mov_b32 s40, 0x66f70000
    s_mov_b32 s41, 0x7fff
    s_lshr_b64 s[40:41], s[40:41], s49
    s_and_b32 s40, s40, 15
    s_lshr_b32 s41, s94, 2
    s_lshl_b32 s41, s41, 1
    s_min_u32 s40, s40, s41
    s_lshl_b32 s40, s40, 18
    s_lshl_b32 s41, s94, 20
    s_cmp_eq_u32 s3, 3
    s_cselect_b32 s40, s41, s40
    s_load_dword s98, s[46:47], s40
    s_lshl_b32 s93, s94, 11
    v_lshlrev_b32 v57, 3, v0
    v_add_u32 v57, s93, v57
    v_min_u32 v57, L_END-L_PC1, v57
    global_load_dword v60, v57, s[90:91]
    buffer_load_dwordx4 v[72:75], v33, s[4:7], s59 offen offset:128
    buffer_load_dwordx4 v[76:79], v33, s[4:7], s59 offen offset:192
    buffer_load_dwordx4 v[80:83], v33, s[4:7], s59 offen offset:256
    buffer_load_dwordx4 v[84:87], v33, s[4:7], s59 offen offset:320
    buffer_load_dwordx4 v[88:91], v33, s[4:7], s59 offen offset:384
    buffer_load_dwordx4 v[92:95], v33, s[4:7], s59 offen offset:448
    s_and_b32 s52, s2, 6
    s_and_b32 s93, s94, 1
    s_or_b32 s52, s52, s93
    s_lshl_b32 s94, s95, 2
    s_add_u32 s94, s94, s3
    s_lshl_b32 s63, s3, 14
    v_and_b32 v38, 15, v37
    v_lshrrev_b32 v39, 4, v37
    v_lshlrev_b32 v15, 4, v37
    s_mov_b32 s24, s76
    s_mov_b32 s25, s77
    s_mov_b32 s26, 0x1c0000
    s_mov_b32 s27, 0x20000
    s_mul_i32 s58, s94, 28672
    s_mul_i32 s93, s52, 448
    s_and_b32 s93, s93, 0xffffff80
    s_add_u32 s58, s58, s93
    v_lshrrev_b32 v59, 2, v37
    v_min_u32 v59, 7, v59
    v_mul_u32_u24 v59, 3584, v59
    v_and_b32 v32, 3, v37
    v_lshl_add_u32 v59, v32, 7, v59
    s_mov_b32 s16, s70
    s_mov_b32 s17, s71
    s_mov_b32 s18, 0x400000
    s_mov_b32 s19, 0x20000
    s_mov_b32 s40, s78
    s_mov_b32 s41, s79
    s_mov_b32 s42, 0xe00
    s_mov_b32 s43, 0x20000
    v_and_b32 v34, 7, v37
    v_lshlrev_b32 v35, 1, v39
    v_xor_b32 v34, v34, v35
    v_lshlrev_b32 v34, 4, v34
    v_lshrrev_b32 v35, 5, v37
    v_bfe_u32 v36, v37, 3, 2
    v_lshl_add_u32 v35, v35, 3, v36
    s_mul_i32 s92, s52, 448
    s_and_b32 s92, s92, 0xffffff80
    s_lshl_b32 s93, s3, 7
    s_add_u32 s92, s92, s93
    v_mul_u32_u24 v48, 3584, v35
    v_add3_u32 v48, v48, v34, s92
    s_mul_i32 s93, s52, 448
    s_sub_u32 s93, s92, s93
    v_add_u32 v36, s93, v34
    v_cmp_lt_u32 vcc, 447, v36
    v_mov_b32 v36, 0x10000000
    s_nop 0
    v_cndmask_b32 v48, v48, v36, vcc
    v_lshlrev_b32 v57, 3, v39
    s_mov_b32 s95, s92
    s_lshl_b32 s93, s52, 19
    s_add_u32 s66, s66, s93
    s_addc_u32 s67, s67, 0
    s_add_u32 s68, s68, s93
    s_addc_u32 s69, s69, 0
    s_mov_b32 s8, s66
    s_mov_b32 s9, s67
    s_mov_b32 s10, 0x80000
    s_mov_b32 s11, 0x20000
    s_mov_b32 s12, s68
    s_mov_b32 s13, s69
    s_mov_b32 s14, 0x80000
    s_mov_b32 s15, 0x20000
    s_mov_b32 s20, s72
    s_mov_b32 s21, s73
    s_mov_b32 s22, 0x400000
    s_mov_b32 s23, 0x20000
    s_mov_b32 s28, s80
    s_mov_b32 s29, s81
    s_mov_b32 s30, 0x1c0000
    s_mov_b32 s31, 0x20000
    s_mov_b32 s44, s82
    s_mov_b32 s45, s83
    s_mov_b32 s46, 0x400
    s_mov_b32 s47, 0x20000
    s_mov_b32 s36, s84
    s_mov_b32 s37, s85
    s_mov_b32 s38, 0x200000
    s_mov_b32 s39, 0x20000
    s_mov_b32 s48, s86
    s_mov_b32 s49, s87
    s_mov_b32 s50, 0x100
    s_mov_b32 s51, 0x20000
    s_mov_b32 s32, s88
    s_mov_b32 s33, s89
    s_mov_b32 s34, 0x10000000
    s_mov_b32 s35, 0x20000
    s_mov_b32 s80, s88
    s_mov_b32 s81, s89
    s_mov_b32 s82, 0x10000000
    s_mov_b32 s83, 0x20000
    s_mul_i32 s99, s94, 8192
    v_and_b32 v61, 15, v37
    v_lshlrev_b32 v61, 7, v61
    s_lshl_b32 s93, s52, 19
    s_add_u32 s99, s99, s93
    s_mul_i32 s77, s94, 65536
    s_lshl_b32 s93, s52, 10
    s_add_u32 s77, s77, s93
    v_lshrrev_b32 v58, 3, v37
    v_mul_u32_u24 v58, 8192, v58
    v_and_b32 v32, 7, v37
    v_lshl_add_u32 v58, v32, 7, v58
    s_mul_i32 s78, s94, 4096
    s_mul_i32 s93, s52, 229376
    s_add_u32 s78, s78, s93
    v_lshrrev_b32 v14, 3, v37
    v_min_u32 v14, 3, v14
    v_mul_u32_u24 v14, 1024, v14
    v_and_b32 v32, 7, v37
    v_lshl_add_u32 v14, v32, 7, v14
    s_mul_i32 s79, s94, 1024
    v_lshrrev_b32 v55, 1, v37
    v_min_u32 v55, 3, v55
    v_mul_u32_u24 v55, 256, v55
    v_and_b32 v32, 1, v37
    v_lshl_add_u32 v55, v32, 7, v55
    s_lshl_b32 s92, s52, 10
    s_lshl_b32 s93, s3, 8
    s_add_u32 s92, s92, s93
    v_lshlrev_b32 v49, 13, v35
    v_add3_u32 v49, v49, v34, s92
    s_mul_i32 s92, s52, 229376
    s_lshl_b32 s93, s3, 7
    s_add_u32 s92, s92, s93
    v_lshrrev_b32 v35, 3, v37
    v_lshlrev_b32 v62, 10, v35
    v_add3_u32 v50, v62, v34, s92
    s_lshl_b32 s92, s52, 19
    s_lshl_b32 s93, s3, 17
    s_add_u32 s92, s92, s93
    v_add3_u32 v62, v62, v34, s92
    v_lshrrev_b32 v34, 2, v37
    v_lshlrev_b32 v34, 7, v34
    v_and_b32 v35, 3, v37
    v_lshl_add_u32 v34, v35, 3, v34
    v_add_u32 v34, s63, v34
    v_bfe_u32 v35, v37, 3, 2
    v_xor_b32 v36, 0, v35
    v_lshl_add_u32 v4, v36, 5, v34
    v_add_u32 v8, 0x10000, v4
    v_xor_b32 v36, 1, v35
    v_lshl_add_u32 v5, v36, 5, v34
    v_add_u32 v9, 0x10000, v5
    v_xor_b32 v36, 2, v35
    v_lshl_add_u32 v6, v36, 5, v34
    v_add_u32 v10, 0x10000, v6
    v_xor_b32 v36, 3, v35
    v_lshl_add_u32 v7, v36, 5, v34
    v_add_u32 v11, 0x10000, v7
    v_and_b32 v34, 7, v37
    v_lshlrev_b32 v34, 1, v34
    v_xor_b32 v34, v34, v39
    v_lshlrev_b32 v35, 8, v38
    v_add_u32 v35, 0x20000, v35
    v_xor_b32 v36, 0, v34
    v_lshl_add_u32 v0, v36, 4, v35
    v_xor_b32 v36, 4, v34
    v_lshl_add_u32 v1, v36, 4, v35
    v_xor_b32 v36, 8, v34
    v_lshl_add_u32 v2, v36, 4, v35
    v_xor_b32 v36, 12, v34
    v_lshl_add_u32 v3, v36, 4, v35
    v_lshlrev_b32 v34, 1, v39
    v_xor_b32 v34, v34, v38
    v_lshlrev_b32 v35, 8, v39
    v_lshl_add_u32 v12, v34, 4, v35
    v_xor_b32 v13, 0x80, v12
    v_add_u32 v54, 0x20000, v12
    v_add_u32 v53, 0x12000, v12
    v_and_b32 v34, 3, v37
    v_lshrrev_b32 v35, 2, v37
    v_lshlrev_b32 v36, 1, v34
    v_xor_b32 v35, v35, v36
    v_lshlrev_b32 v34, 8, v34
    v_lshl_add_u32 v34, v35, 4, v34
    s_lshl_b32 s92, s3, 13
    s_add_u32 s92, s92, 0x20000
    s_add_u32 s93, s63, 0x12000
    s_and_b32 s85, s52, 0
    s_cselect_b32 s85, s92, s93
    s_cselect_b32 s86, s93, s92
    v_add_u32 v35, s85, v34
    v_add_u32 v56, s86, v34
    v_and_b32 v52, 1, v37
    v_bfe_u32 v34, v37, 1, 1
    v_sub_u32 v52, v52, v34
    v_lshlrev_b32 v52, 3, v52
    s_mov_b32 s70, 0x3e0293ee
    s_mov_b32 s71, 0xc2469614
    v_mov_b32 v51, 0xc1906ebb
    s_lshr_b32 s92, s53, 5
    s_lshl_b32 s92, s92, 24
    s_add_u32 s61, s92, 0xe00000
    s_and_b32 s93, s53, 31
    s_lshl_b32 s60, s93, 12
    s_add_u32 s60, s60, s92
    s_lshl_b32 s62, s93, 15
    s_add_u32 s62, s62, s92
    s_add_u32 s62, s62, 0x1000000
    s_lshl_b32 s92, s3, 13
    s_lshl_b32 s93, s52, 10
    s_add_u32 s92, s92, s93
    s_add_u32 s72, s92, s62
    s_lshl_b32 s92, s3, 10
    s_lshl_b32 s93, s52, 17
    s_add_u32 s92, s92, s93
    s_add_u32 s84, s92, s60
    s_mov_b32 s69, 0
    s_lshl_b32 s64, s3, 13
    s_add_u32 s65, s64, 4096
    s_mov_b32 s66, s64
    s_mov_b32 s67, s65
    s_waitcnt vmcnt(8)
    buffer_load_dwordx4 v[96:99], v33, s[4:7], s59 offen offset:512
    buffer_load_dwordx4 v[100:103], v33, s[4:7], s59 offen offset:576
    buffer_load_dwordx4 v[104:107], v33, s[4:7], s59 offen offset:640
    v_lshlrev_b32 v128, 16, v64
    v_and_b32 v129, 0xffff0000, v64
    v_lshlrev_b32 v130, 16, v65
    v_and_b32 v131, 0xffff0000, v65
    v_lshlrev_b32 v132, 16, v66
    v_and_b32 v133, 0xffff0000, v66
    v_lshlrev_b32 v134, 16, v67
    v_and_b32 v135, 0xffff0000, v67
    v_pk_mul_f32 v[24:25], v[128:129], v[128:129]
    v_pk_mul_f32 v[26:27], v[130:131], v[130:131]
    v_pk_mul_f32 v[28:29], v[132:133], v[132:133]
    v_pk_mul_f32 v[30:31], v[134:135], v[134:135]
    s_waitcnt vmcnt(10)
    buffer_load_dwordx4 v[108:111], v33, s[4:7], s59 offen offset:704
    v_lshlrev_b32 v136, 16, v68
    v_and_b32 v137, 0xffff0000, v68
    v_lshlrev_b32 v138, 16, v69
    v_and_b32 v139, 0xffff0000, v69
    v_lshlrev_b32 v140, 16, v70
    v_and_b32 v141, 0xffff0000, v70
    v_lshlrev_b32 v142, 16, v71
    v_and_b32 v143, 0xffff0000, v71
    v_pk_add_f32 v[16:17], v[128:129], v[136:137]
    v_pk_fma_f32 v[24:25], v[136:137], v[136:137], v[24:25]
    v_pk_add_f32 v[18:19], v[130:131], v[138:139]
    v_pk_fma_f32 v[26:27], v[138:139], v[138:139], v[26:27]
    v_pk_add_f32 v[20:21], v[132:133], v[140:141]
    v_pk_fma_f32 v[28:29], v[140:141], v[140:141], v[28:29]
    v_pk_add_f32 v[22:23], v[134:135], v[142:143]
    v_pk_fma_f32 v[30:31], v[142:143], v[142:143], v[30:31]
    s_waitcnt vmcnt(9)
    buffer_load_dwordx4 v[112:115], v33, s[4:7], s59 offen offset:768
    v_lshlrev_b32 v144, 16, v72
    v_and_b32 v145, 0xffff0000, v72
    v_lshlrev_b32 v146, 16, v73
    v_and_b32 v147, 0xffff0000, v73
    v_lshlrev_b32 v148, 16, v74
    v_and_b32 v149, 0xffff0000, v74
    v_lshlrev_b32 v150, 16, v75
    v_and_b32 v151, 0xffff0000, v75
    v_pk_add_f32 v[16:17], v[16:17], v[144:145]
    v_pk_fma_f32 v[24:25], v[144:145], v[144:145], v[24:25]
    v_pk_add_f32 v[18:19], v[18:19], v[146:147]
    v_pk_fma_f32 v[26:27], v[146:147], v[146:147], v[26:27]
    v_pk_add_f32 v[20:21], v[20:21], v[148:149]
    v_pk_fma_f32 v[28:29], v[148:149], v[148:149], v[28:29]
    v_pk_add_f32 v[22:23], v[22:23], v[150:151]
    v_pk_fma_f32 v[30:31], v[150:151], v[150:151], v[30:31]
    s_waitcnt vmcnt(9)
    buffer_load_dwordx4 v[116:119], v33, s[4:7], s59 offen offset:832
    v_lshlrev_b32 v152, 16, v76
    v_and_b32 v153, 0xffff0000, v76
    v_lshlrev_b32 v154, 16, v77
    v_and_b32 v155, 0xffff0000, v77
    v_lshlrev_b32 v156, 16, v78
    v_and_b32 v157, 0xffff0000, v78
    v_lshlrev_b32 v158, 16, v79
    v_and_b32 v159, 0xffff0000, v79
    v_pk_add_f32 v[16:17], v[16:17], v[152:153]
    v_pk_fma_f32 v[24:25], v[152:153], v[152:153], v[24:25]
    v_pk_add_f32 v[18:19], v[18:19], v[154:155]
    v_pk_fma_f32 v[26:27], v[154:155], v[154:155], v[26:27]
    v_pk_add_f32 v[20:21], v[20:21], v[156:157]
    v_pk_fma_f32 v[28:29], v[156:157], v[156:157], v[28:29]
    v_pk_add_f32 v[22:23], v[22:23], v[158:159]
    v_pk_fma_f32 v[30:31], v[158:159], v[158:159], v[30:31]
    s_waitcnt vmcnt(9)
    buffer_load_dwordx4 v[120:123], v33, s[4:7], s59 offen offset:896
    v_lshlrev_b32 v160, 16, v80
    v_and_b32 v161, 0xffff0000, v80
    v_lshlrev_b32 v162, 16, v81
    v_and_b32 v163, 0xffff0000, v81
    v_lshlrev_b32 v164, 16, v82
    v_and_b32 v165, 0xffff0000, v82
    v_lshlrev_b32 v166, 16, v83
    v_and_b32 v167, 0xffff0000, v83
    v_pk_add_f32 v[16:17], v[16:17], v[160:161]
    v_pk_fma_f32 v[24:25], v[160:161], v[160:161], v[24:25]
    v_pk_add_f32 v[18:19], v[18:19], v[162:163]
    v_pk_fma_f32 v[26:27], v[162:163], v[162:163], v[26:27]
    v_pk_add_f32 v[20:21], v[20:21], v[164:165]
    v_pk_fma_f32 v[28:29], v[164:165], v[164:165], v[28:29]
    v_pk_add_f32 v[22:23], v[22:23], v[166:167]
    v_pk_fma_f32 v[30:31], v[166:167], v[166:167], v[30:31]
    s_waitcnt vmcnt(9)
    buffer_load_dwordx4 v[124:127], v33, s[4:7], s59 offen offset:960
    v_lshlrev_b32 v168, 16, v84
    v_and_b32 v169, 0xffff0000, v84
    v_lshlrev_b32 v170, 16, v85
    v_and_b32 v171, 0xffff0000, v85
    v_lshlrev_b32 v172, 16, v86
    v_and_b32 v173, 0xffff0000, v86
    v_lshlrev_b32 v174, 16, v87
    v_and_b32 v175, 0xffff0000, v87
    v_pk_add_f32 v[16:17], v[16:17], v[168:169]
    v_pk_fma_f32 v[24:25], v[168:169], v[168:169], v[24:25]
    v_pk_add_f32 v[18:19], v[18:19], v[170:171]
    v_pk_fma_f32 v[26:27], v[170:171], v[170:171], v[26:27]
    v_pk_add_f32 v[20:21], v[20:21], v[172:173]
    v_pk_fma_f32 v[28:29], v[172:173], v[172:173], v[28:29]
    v_pk_add_f32 v[22:23], v[22:23], v[174:175]
    v_pk_fma_f32 v[30:31], v[174:175], v[174:175], v[30:31]
    s_waitcnt vmcnt(9)
    buffer_load_dword v60, v59, s[24:27], s58 offen
    v_lshlrev_b32 v176, 16, v88
    v_and_b32 v177, 0xffff0000, v88
    v_lshlrev_b32 v178, 16, v89
    v_and_b32 v179, 0xffff0000, v89
    v_lshlrev_b32 v180, 16, v90
    v_and_b32 v181, 0xffff0000, v90
    v_lshlrev_b32 v182, 16, v91
    v_and_b32 v183, 0xffff0000, v91
    v_pk_add_f32 v[16:17], v[16:17], v[176:177]
    v_pk_fma_f32 v[24:25], v[176:177], v[176:177], v[24:25]
    v_pk_add_f32 v[18:19], v[18:19], v[178:179]
    v_pk_fma_f32 v[26:27], v[178:179], v[178:179], v[26:27]
    v_pk_add_f32 v[20:21], v[20:21], v[180:181]
    v_pk_fma_f32 v[28:29], v[180:181], v[180:181], v[28:29]
    v_pk_add_f32 v[22:23], v[22:23], v[182:183]
    v_pk_fma_f32 v[30:31], v[182:183], v[182:183], v[30:31]
    s_waitcnt vmcnt(9)
    buffer_load_dwordx2 v[40:41], v57, s[40:43], s95 offen offset:0
    v_lshlrev_b32 v184, 16, v92
    v_and_b32 v185, 0xffff0000, v92
    v_lshlrev_b32 v186, 16, v93
    v_and_b32 v187, 0xffff0000, v93
    v_lshlrev_b32 v188, 16, v94
    v_and_b32 v189, 0xffff0000, v94
    v_lshlrev_b32 v190, 16, v95
    v_and_b32 v191, 0xffff0000, v95
    v_pk_add_f32 v[16:17], v[16:17], v[184:185]
    v_pk_fma_f32 v[24:25], v[184:185], v[184:185], v[24:25]
    v_pk_add_f32 v[18:19], v[18:19], v[186:187]
    v_pk_fma_f32 v[26:27], v[186:187], v[186:187], v[26:27]
    v_pk_add_f32 v[20:21], v[20:21], v[188:189]
    v_pk_fma_f32 v[28:29], v[188:189], v[188:189], v[28:29]
    v_pk_add_f32 v[22:23], v[22:23], v[190:191]
    v_pk_fma_f32 v[30:31], v[190:191], v[190:191], v[30:31]
    s_waitcnt vmcnt(9)
    buffer_load_dwordx2 v[42:43], v57, s[40:43], s95 offen offset:32
    v_lshlrev_b32 v192, 16, v96
    v_and_b32 v193, 0xffff0000, v96
    v_lshlrev_b32 v194, 16, v97
    v_and_b32 v195, 0xffff0000, v97
    v_lshlrev_b32 v196, 16, v98
    v_and_b32 v197, 0xffff0000, v98
    v_lshlrev_b32 v198, 16, v99
    v_and_b32 v199, 0xffff0000, v99
    v_pk_add_f32 v[16:17], v[16:17], v[192:193]
    v_pk_fma_f32 v[24:25], v[192:193], v[192:193], v[24:25]
    v_pk_add_f32 v[18:19], v[18:19], v[194:195]
    v_pk_fma_f32 v[26:27], v[194:195], v[194:195], v[26:27]
    v_pk_add_f32 v[20:21], v[20:21], v[196:197]
    v_pk_fma_f32 v[28:29], v[196:197], v[196:197], v[28:29]
    v_pk_add_f32 v[22:23], v[22:23], v[198:199]
    v_pk_fma_f32 v[30:31], v[198:199], v[198:199], v[30:31]
    s_waitcnt vmcnt(9)
    buffer_load_dwordx2 v[44:45], v57, s[40:43], s95 offen offset:64
    v_lshlrev_b32 v200, 16, v100
    v_and_b32 v201, 0xffff0000, v100
    v_lshlrev_b32 v202, 16, v101
    v_and_b32 v203, 0xffff0000, v101
    v_lshlrev_b32 v204, 16, v102
    v_and_b32 v205, 0xffff0000, v102
    v_lshlrev_b32 v206, 16, v103
    v_and_b32 v207, 0xffff0000, v103
    v_pk_add_f32 v[16:17], v[16:17], v[200:201]
    v_pk_fma_f32 v[24:25], v[200:201], v[200:201], v[24:25]
    v_pk_add_f32 v[18:19], v[18:19], v[202:203]
    v_pk_fma_f32 v[26:27], v[202:203], v[202:203], v[26:27]
    v_pk_add_f32 v[20:21], v[20:21], v[204:205]
    v_pk_fma_f32 v[28:29], v[204:205], v[204:205], v[28:29]
    v_pk_add_f32 v[22:23], v[22:23], v[206:207]
    v_pk_fma_f32 v[30:31], v[206:207], v[206:207], v[30:31]
    s_waitcnt vmcnt(9)
    buffer_load_dwordx2 v[46:47], v57, s[40:43], s95 offen offset:96
    v_lshlrev_b32 v208, 16, v104
    v_and_b32 v209, 0xffff0000, v104
    v_lshlrev_b32 v210, 16, v105
    v_and_b32 v211, 0xffff0000, v105
    v_lshlrev_b32 v212, 16, v106
    v_and_b32 v213, 0xffff0000, v106
    v_lshlrev_b32 v214, 16, v107
    v_and_b32 v215, 0xffff0000, v107
    v_pk_add_f32 v[16:17], v[16:17], v[208:209]
    v_pk_fma_f32 v[24:25], v[208:209], v[208:209], v[24:25]
    v_pk_add_f32 v[18:19], v[18:19], v[210:211]
    v_pk_fma_f32 v[26:27], v[210:211], v[210:211], v[26:27]
    v_pk_add_f32 v[20:21], v[20:21], v[212:213]
    v_pk_fma_f32 v[28:29], v[212:213], v[212:213], v[28:29]
    v_pk_add_f32 v[22:23], v[22:23], v[214:215]
    v_pk_fma_f32 v[30:31], v[214:215], v[214:215], v[30:31]
    s_waitcnt vmcnt(9)
    s_mov_b32 s54, 0x0
    s_add_u32 m0, s63, 0x2000
    s_nop 0
    buffer_load_dwordx4 v48, s[24:27], s54 offen lds
    v_lshlrev_b32 v216, 16, v108
    v_and_b32 v217, 0xffff0000, v108
    v_lshlrev_b32 v218, 16, v109
    v_and_b32 v219, 0xffff0000, v109
    v_lshlrev_b32 v220, 16, v110
    v_and_b32 v221, 0xffff0000, v110
    v_lshlrev_b32 v222, 16, v111
    v_and_b32 v223, 0xffff0000, v111
    v_pk_add_f32 v[16:17], v[16:17], v[216:217]
    v_pk_fma_f32 v[24:25], v[216:217], v[216:217], v[24:25]
    v_pk_add_f32 v[18:19], v[18:19], v[218:219]
    v_pk_fma_f32 v[26:27], v[218:219], v[218:219], v[26:27]
    v_pk_add_f32 v[20:21], v[20:21], v[220:221]
    v_pk_fma_f32 v[28:29], v[220:221], v[220:221], v[28:29]
    v_pk_add_f32 v[22:23], v[22:23], v[222:223]
    v_pk_fma_f32 v[30:31], v[222:223], v[222:223], v[30:31]
    s_waitcnt vmcnt(9)
    s_mov_b32 s55, 0xdc00
    buffer_load_dwordx4 v48, s[24:27], s55 offen offset:1024 lds
    v_lshlrev_b32 v224, 16, v112
    v_and_b32 v225, 0xffff0000, v112
    v_lshlrev_b32 v226, 16, v113
    v_and_b32 v227, 0xffff0000, v113
    v_lshlrev_b32 v228, 16, v114
    v_and_b32 v229, 0xffff0000, v114
    v_lshlrev_b32 v230, 16, v115
    v_and_b32 v231, 0xffff0000, v115
    v_pk_add_f32 v[16:17], v[16:17], v[224:225]
    v_pk_fma_f32 v[24:25], v[224:225], v[224:225], v[24:25]
    v_pk_add_f32 v[18:19], v[18:19], v[226:227]
    v_pk_fma_f32 v[26:27], v[226:227], v[226:227], v[26:27]
    v_pk_add_f32 v[20:21], v[20:21], v[228:229]
    v_pk_fma_f32 v[28:29], v[228:229], v[228:229], v[28:29]
    v_pk_add_f32 v[22:23], v[22:23], v[230:231]
    v_pk_fma_f32 v[30:31], v[230:231], v[230:231], v[30:31]
    s_waitcnt vmcnt(9)
    s_mov_b32 s56, 0x3000
    buffer_load_dwordx4 v48, s[24:27], s56 offen offset:2048 lds
    v_lshlrev_b32 v232, 16, v116
    v_and_b32 v233, 0xffff0000, v116
    v_lshlrev_b32 v234, 16, v117
    v_and_b32 v235, 0xffff0000, v117
    v_lshlrev_b32 v236, 16, v118
    v_and_b32 v237, 0xffff0000, v118
    v_lshlrev_b32 v238, 16, v119
    v_and_b32 v239, 0xffff0000, v119
    v_pk_add_f32 v[16:17], v[16:17], v[232:233]
    v_pk_fma_f32 v[24:25], v[232:233], v[232:233], v[24:25]
    v_pk_add_f32 v[18:19], v[18:19], v[234:235]
    v_pk_fma_f32 v[26:27], v[234:235], v[234:235], v[26:27]
    v_pk_add_f32 v[20:21], v[20:21], v[236:237]
    v_pk_fma_f32 v[28:29], v[236:237], v[236:237], v[28:29]
    v_pk_add_f32 v[22:23], v[22:23], v[238:239]
    v_pk_fma_f32 v[30:31], v[238:239], v[238:239], v[30:31]
    s_waitcnt vmcnt(9)
    s_mov_b32 s57, 0x10c00
    buffer_load_dwordx4 v48, s[24:27], s57 offen offset:3072 lds
    v_lshlrev_b32 v240, 16, v120
    v_and_b32 v241, 0xffff0000, v120
    v_lshlrev_b32 v242, 16, v121
    v_and_b32 v243, 0xffff0000, v121
    v_lshlrev_b32 v244, 16, v122
    v_and_b32 v245, 0xffff0000, v122
    v_lshlrev_b32 v246, 16, v123
    v_and_b32 v247, 0xffff0000, v123
    v_pk_add_f32 v[16:17], v[16:17], v[240:241]
    v_pk_fma_f32 v[24:25], v[240:241], v[240:241], v[24:25]
    v_pk_add_f32 v[18:19], v[18:19], v[242:243]
    v_pk_fma_f32 v[26:27], v[242:243], v[242:243], v[26:27]
    v_pk_add_f32 v[20:21], v[20:21], v[244:245]
    v_pk_fma_f32 v[28:29], v[244:245], v[244:245], v[28:29]
    v_pk_add_f32 v[22:23], v[22:23], v[246:247]
    v_pk_fma_f32 v[30:31], v[246:247], v[246:247], v[30:31]
    s_waitcnt vmcnt(9)
    s_mov_b32 s54, 0x1c000
    s_add_u32 m0, s63, 0x3000
    s_nop 0
    buffer_load_dwordx4 v48, s[24:27], s54 offen lds
    v_lshlrev_b32 v248, 16, v124
    v_and_b32 v249, 0xffff0000, v124
    v_lshlrev_b32 v250, 16, v125
    v_and_b32 v251, 0xffff0000, v125
    v_lshlrev_b32 v252, 16, v126
    v_and_b32 v253, 0xffff0000, v126
    v_lshlrev_b32 v254, 16, v127
    v_and_b32 v255, 0xffff0000, v127
    v_pk_add_f32 v[16:17], v[16:17], v[248:249]
    v_pk_fma_f32 v[24:25], v[248:249], v[248:249], v[24:25]
    v_pk_add_f32 v[18:19], v[18:19], v[250:251]
    v_pk_fma_f32 v[26:27], v[250:251], v[250:251], v[26:27]
    v_pk_add_f32 v[20:21], v[20:21], v[252:253]
    v_pk_fma_f32 v[28:29], v[252:253], v[252:253], v[28:29]
    v_pk_add_f32 v[22:23], v[22:23], v[254:255]
    v_pk_fma_f32 v[30:31], v[254:255], v[254:255], v[30:31]
    s_waitcnt lgkmcnt(0)
    v_pk_add_f32 v[16:17], v[16:17], v[18:19]
    v_pk_add_f32 v[20:21], v[20:21], v[22:23]
    v_pk_add_f32 v[24:25], v[24:25], v[26:27]
    v_pk_add_f32 v[28:29], v[28:29], v[30:31]
    s_mov_b32 s55, 0x29c00
    v_pk_add_f32 v[16:17], v[16:17], v[20:21]
    v_pk_add_f32 v[24:25], v[24:25], v[28:29]
    v_add_f32 v16, v16, v17
    v_add_f32 v24, v24, v25
    buffer_load_dwordx4 v48, s[24:27], s55 offen offset:1024 lds
    s_nop 1
    v_add_f32_dpp v16, v16, v16 quad_perm:[1,0,3,2] row_mask:0xf bank_mask:0xf
    v_add_f32_dpp v24, v24, v24 quad_perm:[1,0,3,2] row_mask:0xf bank_mask:0xf
    s_nop 1
    s_mov_b32 s56, 0x1f000
    v_add_f32_dpp v16, v16, v16 quad_perm:[2,3,0,1] row_mask:0xf bank_mask:0xf
    v_add_f32_dpp v24, v24, v24 quad_perm:[2,3,0,1] row_mask:0xf bank_mask:0xf
    v_mul_f32 v16, 0x3b000000, v16
    v_mul_f32 v24, 0x3b000000, v24
    buffer_load_dwordx4 v48, s[24:27], s56 offen offset:2048 lds
    v_fma_f32 v24, -v16, v16, v24
    v_max_f32 v24, 0, v24
    v_cvt_pk_bf16_f32 v17, v16, v24
    v_lshlrev_b32 v16, 16, v17
    s_mov_b32 s57, 0x2cc00
    v_and_b32 v24, 0xffff0000, v17
    v_add_f32 v24, 0x3727c5ac, v24
    v_cvt_pk_bf16_f32 v24, v24, v24
    v_and_b32 v24, 0xffff0000, v24
    buffer_load_dwordx4 v48, s[24:27], s57 offen offset:3072 lds
    v_sqrt_f32 v24, v24
    s_nop 0
    v_cvt_pk_bf16_f32 v24, v24, v24
    v_and_b32 v24, 0xffff0000, v24
    s_mov_b32 s54, 0x38000
    v_rcp_f32 v24, v24
    s_nop 0
    v_mul_f32 v24, s70, v24
    v_mul_f32 v16, v16, v24
    s_add_u32 m0, s63, 0x10000
    v_sub_f32 v16, 0, v16
    v_mov_b32 v25, v24
    v_mov_b32 v17, v16
    buffer_load_dwordx4 v48, s[24:27], s54 offen lds
    v_pk_fma_f32 v[128:129], v[128:129], v[24:25], v[16:17]
    v_pk_fma_f32 v[130:131], v[130:131], v[24:25], v[16:17]
    v_pk_fma_f32 v[132:133], v[132:133], v[24:25], v[16:17]
    v_pk_fma_f32 v[134:135], v[134:135], v[24:25], v[16:17]
    s_mov_b32 s55, 0x45c00
    v_cvt_pk_bf16_f32 v64, v128, v129
    v_cvt_pk_bf16_f32 v65, v130, v131
    v_cvt_pk_bf16_f32 v66, v132, v133
    v_cvt_pk_bf16_f32 v67, v134, v135
    buffer_load_dwordx4 v48, s[24:27], s55 offen offset:1024 lds
    v_pk_fma_f32 v[136:137], v[136:137], v[24:25], v[16:17]
    v_pk_fma_f32 v[138:139], v[138:139], v[24:25], v[16:17]
    v_pk_fma_f32 v[140:141], v[140:141], v[24:25], v[16:17]
    v_pk_fma_f32 v[142:143], v[142:143], v[24:25], v[16:17]
    s_mov_b32 s56, 0x3b000
    v_cvt_pk_bf16_f32 v68, v136, v137
    v_cvt_pk_bf16_f32 v69, v138, v139
    v_cvt_pk_bf16_f32 v70, v140, v141
    v_cvt_pk_bf16_f32 v71, v142, v143
    buffer_load_dwordx4 v48, s[24:27], s56 offen offset:2048 lds
    v_pk_fma_f32 v[144:145], v[144:145], v[24:25], v[16:17]
    v_pk_fma_f32 v[146:147], v[146:147], v[24:25], v[16:17]
    v_pk_fma_f32 v[148:149], v[148:149], v[24:25], v[16:17]
    v_pk_fma_f32 v[150:151], v[150:151], v[24:25], v[16:17]
    s_mov_b32 s57, 0x48c00
    v_cvt_pk_bf16_f32 v72, v144, v145
    v_cvt_pk_bf16_f32 v73, v146, v147
    v_cvt_pk_bf16_f32 v74, v148, v149
    v_cvt_pk_bf16_f32 v75, v150, v151
    buffer_load_dwordx4 v48, s[24:27], s57 offen offset:3072 lds
    v_pk_fma_f32 v[152:153], v[152:153], v[24:25], v[16:17]
    v_pk_fma_f32 v[154:155], v[154:155], v[24:25], v[16:17]
    v_pk_fma_f32 v[156:157], v[156:157], v[24:25], v[16:17]
    v_pk_fma_f32 v[158:159], v[158:159], v[24:25], v[16:17]
    s_mov_b32 s54, 0x54000
    v_cvt_pk_bf16_f32 v76, v152, v153
    v_cvt_pk_bf16_f32 v77, v154, v155
    v_cvt_pk_bf16_f32 v78, v156, v157
    s_add_u32 m0, s63, 0x11000
    v_cvt_pk_bf16_f32 v79, v158, v159
    v_pk_fma_f32 v[160:161], v[160:161], v[24:25], v[16:17]
    v_pk_fma_f32 v[162:163], v[162:163], v[24:25], v[16:17]
    v_pk_fma_f32 v[164:165], v[164:165], v[24:25], v[16:17]
    buffer_load_dwordx4 v48, s[24:27], s54 offen lds
    v_pk_fma_f32 v[166:167], v[166:167], v[24:25], v[16:17]
    v_cvt_pk_bf16_f32 v80, v160, v161
    v_cvt_pk_bf16_f32 v81, v162, v163
    v_cvt_pk_bf16_f32 v82, v164, v165
    s_mov_b32 s55, 0x61c00
    v_cvt_pk_bf16_f32 v83, v166, v167
    v_pk_fma_f32 v[168:169], v[168:169], v[24:25], v[16:17]
    v_pk_fma_f32 v[170:171], v[170:171], v[24:25], v[16:17]
    v_pk_fma_f32 v[172:173], v[172:173], v[24:25], v[16:17]
    buffer_load_dwordx4 v48, s[24:27], s55 offen offset:1024 lds
    v_pk_fma_f32 v[174:175], v[174:175], v[24:25], v[16:17]
    v_cvt_pk_bf16_f32 v84, v168, v169
    v_cvt_pk_bf16_f32 v85, v170, v171
    v_cvt_pk_bf16_f32 v86, v172, v173
    s_mov_b32 s56, 0x57000
    v_cvt_pk_bf16_f32 v87, v174, v175
    v_pk_fma_f32 v[176:177], v[176:177], v[24:25], v[16:17]
    v_pk_fma_f32 v[178:179], v[178:179], v[24:25], v[16:17]
    v_pk_fma_f32 v[180:181], v[180:181], v[24:25], v[16:17]
    buffer_load_dwordx4 v48, s[24:27], s56 offen offset:2048 lds
    v_pk_fma_f32 v[182:183], v[182:183], v[24:25], v[16:17]
    v_cvt_pk_bf16_f32 v88, v176, v177
    v_cvt_pk_bf16_f32 v89, v178, v179
    v_cvt_pk_bf16_f32 v90, v180, v181
    s_mov_b32 s57, 0x64c00
    v_cvt_pk_bf16_f32 v91, v182, v183
    v_pk_fma_f32 v[184:185], v[184:185], v[24:25], v[16:17]
    v_pk_fma_f32 v[186:187], v[186:187], v[24:25], v[16:17]
    v_pk_fma_f32 v[188:189], v[188:189], v[24:25], v[16:17]
    buffer_load_dwordx4 v48, s[24:27], s57 offen offset:3072 lds
    v_pk_fma_f32 v[190:191], v[190:191], v[24:25], v[16:17]
    v_cvt_pk_bf16_f32 v92, v184, v185
    v_cvt_pk_bf16_f32 v93, v186, v187
    v_cvt_pk_bf16_f32 v94, v188, v189
    s_mov_b32 s54, 0x70000
    v_cvt_pk_bf16_f32 v95, v190, v191
    v_pk_fma_f32 v[192:193], v[192:193], v[24:25], v[16:17]
    v_pk_fma_f32 v[194:195], v[194:195], v[24:25], v[16:17]
    s_add_u32 m0, s63, 0x0
    v_pk_fma_f32 v[196:197], v[196:197], v[24:25], v[16:17]
    v_pk_fma_f32 v[198:199], v[198:199], v[24:25], v[16:17]
    v_cvt_pk_bf16_f32 v96, v192, v193
    v_cvt_pk_bf16_f32 v97, v194, v195
    buffer_load_dwordx4 v48, s[24:27], s54 offen lds
    v_cvt_pk_bf16_f32 v98, v196, v197
    v_cvt_pk_bf16_f32 v99, v198, v199
    v_pk_fma_f32 v[200:201], v[200:201], v[24:25], v[16:17]
    v_pk_fma_f32 v[202:203], v[202:203], v[24:25], v[16:17]
    s_mov_b32 s55, 0x7dc00
    v_pk_fma_f32 v[204:205], v[204:205], v[24:25], v[16:17]
    v_pk_fma_f32 v[206:207], v[206:207], v[24:25], v[16:17]
    v_cvt_pk_bf16_f32 v100, v200, v201
    v_cvt_pk_bf16_f32 v101, v202, v203
    buffer_load_dwordx4 v48, s[24:27], s55 offen offset:1024 lds
    v_cvt_pk_bf16_f32 v102, v204, v205
    v_cvt_pk_bf16_f32 v103, v206, v207
    v_pk_fma_f32 v[208:209], v[208:209], v[24:25], v[16:17]
    v_pk_fma_f32 v[210:211], v[210:211], v[24:25], v[16:17]
    s_mov_b32 s56, 0x73000
    v_pk_fma_f32 v[212:213], v[212:213], v[24:25], v[16:17]
    v_pk_fma_f32 v[214:215], v[214:215], v[24:25], v[16:17]
    v_cvt_pk_bf16_f32 v104, v208, v209
    v_cvt_pk_bf16_f32 v105, v210, v211
    buffer_load_dwordx4 v48, s[24:27], s56 offen offset:2048 lds
    v_cvt_pk_bf16_f32 v106, v212, v213
    v_cvt_pk_bf16_f32 v107, v214, v215
    v_pk_fma_f32 v[216:217], v[216:217], v[24:25], v[16:17]
    v_pk_fma_f32 v[218:219], v[218:219], v[24:25], v[16:17]
    s_mov_b32 s57, 0x80c00
    v_pk_fma_f32 v[220:221], v[220:221], v[24:25], v[16:17]
    v_pk_fma_f32 v[222:223], v[222:223], v[24:25], v[16:17]
    v_cvt_pk_bf16_f32 v108, v216, v217
    v_cvt_pk_bf16_f32 v109, v218, v219
    buffer_load_dwordx4 v48, s[24:27], s57 offen offset:3072 lds
    v_cvt_pk_bf16_f32 v110, v220, v221
    v_cvt_pk_bf16_f32 v111, v222, v223
    v_pk_fma_f32 v[224:225], v[224:225], v[24:25], v[16:17]
    s_mov_b32 s54, 0x8c000
    v_pk_fma_f32 v[226:227], v[226:227], v[24:25], v[16:17]
    v_pk_fma_f32 v[228:229], v[228:229], v[24:25], v[16:17]
    v_pk_fma_f32 v[230:231], v[230:231], v[24:25], v[16:17]
    v_cvt_pk_bf16_f32 v112, v224, v225
    s_add_u32 m0, s63, 0x1000
    v_cvt_pk_bf16_f32 v113, v226, v227
    v_cvt_pk_bf16_f32 v114, v228, v229
    v_cvt_pk_bf16_f32 v115, v230, v231
    v_pk_fma_f32 v[232:233], v[232:233], v[24:25], v[16:17]
    buffer_load_dwordx4 v48, s[24:27], s54 offen lds
    v_pk_fma_f32 v[234:235], v[234:235], v[24:25], v[16:17]
    v_pk_fma_f32 v[236:237], v[236:237], v[24:25], v[16:17]
    v_pk_fma_f32 v[238:239], v[238:239], v[24:25], v[16:17]
    v_cvt_pk_bf16_f32 v116, v232, v233
    s_mov_b32 s55, 0x99c00
    v_cvt_pk_bf16_f32 v117, v234, v235
    v_cvt_pk_bf16_f32 v118, v236, v237
    v_cvt_pk_bf16_f32 v119, v238, v239
    v_pk_fma_f32 v[240:241], v[240:241], v[24:25], v[16:17]
    buffer_load_dwordx4 v48, s[24:27], s55 offen offset:1024 lds
    v_pk_fma_f32 v[242:243], v[242:243], v[24:25], v[16:17]
    v_pk_fma_f32 v[244:245], v[244:245], v[24:25], v[16:17]
    v_pk_fma_f32 v[246:247], v[246:247], v[24:25], v[16:17]
    v_cvt_pk_bf16_f32 v120, v240, v241
    s_mov_b32 s56, 0x8f000
    v_cvt_pk_bf16_f32 v121, v242, v243
    v_cvt_pk_bf16_f32 v122, v244, v245
    v_cvt_pk_bf16_f32 v123, v246, v247
    v_pk_fma_f32 v[248:249], v[248:249], v[24:25], v[16:17]
    buffer_load_dwordx4 v48, s[24:27], s56 offen offset:2048 lds
    v_pk_fma_f32 v[250:251], v[250:251], v[24:25], v[16:17]
    v_pk_fma_f32 v[252:253], v[252:253], v[24:25], v[16:17]
    v_pk_fma_f32 v[254:255], v[254:255], v[24:25], v[16:17]
    v_cvt_pk_bf16_f32 v124, v248, v249
    s_mov_b32 s57, 0x9cc00
    v_cvt_pk_bf16_f32 v125, v250, v251
    v_cvt_pk_bf16_f32 v126, v252, v253
    v_cvt_pk_bf16_f32 v127, v254, v255
    buffer_load_dwordx4 v48, s[24:27], s57 offen offset:3072 lds
    buffer_load_dword v60, v58, s[16:19], s77 offen
    s_mov_b64 exec, 0
    s_cmp_eq_u32 s3, 0
    s_cbranch_scc1 L_PAD0
    s_cmp_eq_u32 s3, 1
    s_cbranch_scc1 L_PAD1
    s_cmp_eq_u32 s3, 2
    s_cbranch_scc1 L_PAD2
    s_branch L_PAD3
L_PADX:
    s_mov_b64 exec, -1
    ds_write_b128 v35, v[64:67] offset:0
    ds_write_b128 v35, v[68:71] offset:1024
    ds_write_b128 v35, v[72:75] offset:2048
    ds_write_b128 v35, v[76:79] offset:3072
    ds_write_b128 v35, v[80:83] offset:4096
    ds_write_b128 v35, v[84:87] offset:5120
    ds_write_b128 v35, v[88:91] offset:6144
    s_waitcnt vmcnt(25)
    v_lshlrev_b32 v64, 16, v40
    v_and_b32 v65, 0xffff0000, v40
    v_lshlrev_b32 v66, 16, v41
    v_and_b32 v67, 0xffff0000, v41
    v_lshlrev_b32 v68, 16, v42
    v_and_b32 v69, 0xffff0000, v42
    v_lshlrev_b32 v70, 16, v43
    v_and_b32 v71, 0xffff0000, v43
    v_lshlrev_b32 v72, 16, v44
    v_and_b32 v73, 0xffff0000, v44
    v_lshlrev_b32 v74, 16, v45
    v_and_b32 v75, 0xffff0000, v45
    v_lshlrev_b32 v76, 16, v46
    v_and_b32 v77, 0xffff0000, v46
    v_lshlrev_b32 v78, 16, v47
    ds_write_b128 v35, v[92:95] offset:7168
    v_and_b32 v79, 0xffff0000, v47
    v_mul_f32 v64, s70, v64
    v_mul_f32 v65, s70, v65
    v_mul_f32 v66, s70, v66
    v_mul_f32 v67, s70, v67
    v_mul_f32 v68, s70, v68
    v_mul_f32 v69, s70, v69
    v_mul_f32 v70, s70, v70
    v_mul_f32 v71, s70, v71
    v_mul_f32 v72, s70, v72
    v_mul_f32 v73, s70, v73
    v_mul_f32 v74, s70, v74
    v_mul_f32 v75, s70, v75
    v_mul_f32 v76, s70, v76
    v_mul_f32 v77, s70, v77
    v_mul_f32 v78, s70, v78
    v_mul_f32 v79, s70, v79
    s_waitcnt vmcnt(17)
    ds_read_b64_tr_b16 v[16:17], v4 offset:8192
    ds_read_b64_tr_b16 v[18:19], v4 offset:10240
    ds_read_b64_tr_b16 v[20:21], v4 offset:12288
    ds_read_b64_tr_b16 v[22:23], v4 offset:14336
    ds_read_b64_tr_b16 v[24:25], v5 offset:8192
    ds_read_b64_tr_b16 v[26:27], v5 offset:10240
    ds_read_b64_tr_b16 v[28:29], v5 offset:12288
    ds_read_b64_tr_b16 v[30:31], v5 offset:14336
    s_waitcnt lgkmcnt(8)
    s_barrier
    ds_read_b128 a[240:243], v53 offset:0
    ds_read_b128 a[224:227], v53 offset:1024
    ds_read_b128 a[244:247], v53 offset:16384
    ds_read_b128 a[228:231], v53 offset:17408
    ds_read_b128 a[248:251], v53 offset:32768
    ds_read_b128 a[232:235], v53 offset:33792
    ds_read_b128 a[252:255], v53 offset:49152
    ds_read_b128 a[236:239], v53 offset:50176
    s_waitcnt lgkmcnt(0)
    v_mfma_f32_16x16x32_bf16 v[128:131], v[16:19], a[240:243], v[64:67]
    ds_write_b128 v56, v[96:99] offset:0
    v_mfma_f32_16x16x32_bf16 v[128:131], v[20:23], a[224:227], v[128:131]
    s_nop 0
    ds_read_b64_tr_b16 v[32:33], v6 offset:8192
    ds_read_b64_tr_b16 v[34:35], v6 offset:10240
    v_mfma_f32_16x16x32_bf16 v[132:135], v[20:23], a[228:231], v[64:67]
    ds_write_b128 v56, v[100:103] offset:1024
    v_mfma_f32_16x16x32_bf16 v[132:135], v[16:19], a[244:247], v[132:135]
    s_nop 0
    ds_read_b64_tr_b16 v[36:37], v6 offset:12288
    ds_read_b64_tr_b16 v[38:39], v6 offset:14336
    v_mfma_f32_16x16x32_bf16 v[136:139], v[16:19], a[248:251], v[64:67]
    ds_write_b128 v56, v[104:107] offset:2048
    v_mfma_f32_16x16x32_bf16 v[136:139], v[20:23], a[232:235], v[136:139]
    s_nop 0
    ds_read_b64_tr_b16 v[40:41], v7 offset:8192
    ds_read_b64_tr_b16 v[42:43], v7 offset:10240
    v_mfma_f32_16x16x32_bf16 v[140:143], v[20:23], a[236:239], v[64:67]
    ds_write_b128 v56, v[108:111] offset:3072
    v_mfma_f32_16x16x32_bf16 v[140:143], v[16:19], a[252:255], v[140:143]
    s_nop 0
    ds_read_b64_tr_b16 v[44:45], v7 offset:12288
    ds_read_b64_tr_b16 v[46:47], v7 offset:14336
    v_mfma_f32_16x16x32_bf16 v[144:147], v[24:27], a[240:243], v[68:71]
    ds_write_b128 v56, v[112:115] offset:4096
    v_mfma_f32_16x16x32_bf16 v[144:147], v[28:31], a[224:227], v[144:147]
    v_mfma_f32_16x16x32_bf16 v[148:151], v[28:31], a[228:231], v[68:71]
    ds_write_b128 v56, v[116:119] offset:5120
    v_mfma_f32_16x16x32_bf16 v[148:151], v[24:27], a[244:247], v[148:151]
    v_mfma_f32_16x16x32_bf16 v[152:155], v[24:27], a[248:251], v[68:71]
    ds_write_b128 v56, v[120:123] offset:6144
    v_mfma_f32_16x16x32_bf16 v[152:155], v[28:31], a[232:235], v[152:155]
    s_mov_b32 s54, 0xe0000
    v_mfma_f32_16x16x32_bf16 v[156:159], v[28:31], a[236:239], v[68:71]
    s_add_u32 m0, s63, 0x2000
    ds_write_b128 v56, v[124:127] offset:7168
    v_mfma_f32_16x16x32_bf16 v[156:159], v[24:27], a[252:255], v[156:159]
    s_waitcnt vmcnt(9) lgkmcnt(4)
    v_mfma_f32_16x16x32_bf16 v[160:163], v[32:35], a[240:243], v[72:75]
    ds_read_b128 a[208:211], v53 offset:2048
    buffer_load_dwordx4 v48, s[24:27], s54 offen lds
    v_mfma_f32_16x16x32_bf16 v[160:163], v[36:39], a[224:227], v[160:163]
    s_mov_b32 s55, 0xedc00
    ds_read_b64_tr_b16 v[16:17], v8 offset:0
    ds_read_b64_tr_b16 v[18:19], v8 offset:2048
    ds_read_b128 a[212:215], v53 offset:18432
    v_mfma_f32_16x16x32_bf16 v[164:167], v[36:39], a[228:231], v[72:75]
    ds_read_b128 a[216:219], v53 offset:34816
    v_mfma_f32_16x16x32_bf16 v[164:167], v[32:35], a[244:247], v[164:167]
    s_nop 0
    ds_read_b64_tr_b16 v[20:21], v8 offset:4096
    ds_read_b64_tr_b16 v[22:23], v8 offset:6144
    ds_read_b128 a[220:223], v53 offset:51200
    v_mfma_f32_16x16x32_bf16 v[168:171], v[32:35], a[248:251], v[72:75]
    ds_read_b128 a[192:195], v53 offset:3072
    buffer_load_dwordx4 v48, s[24:27], s55 offen offset:1024 lds
    v_mfma_f32_16x16x32_bf16 v[168:171], v[36:39], a[232:235], v[168:171]
    s_mov_b32 s56, 0xe3000
    ds_read_b64_tr_b16 v[24:25], v9 offset:0
    ds_read_b64_tr_b16 v[26:27], v9 offset:2048
    ds_read_b128 a[196:199], v53 offset:19456
    v_mfma_f32_16x16x32_bf16 v[172:175], v[36:39], a[236:239], v[72:75]
    ds_read_b128 a[200:203], v53 offset:35840
    v_mfma_f32_16x16x32_bf16 v[172:175], v[32:35], a[252:255], v[172:175]
    s_nop 0
    ds_read_b64_tr_b16 v[28:29], v9 offset:4096
    ds_read_b64_tr_b16 v[30:31], v9 offset:6144
    ds_read_b128 a[204:207], v53 offset:52224
    v_mfma_f32_16x16x32_bf16 v[176:179], v[40:43], a[240:243], v[76:79]
    ds_read_b128 a[176:179], v53 offset:4096
    buffer_load_dwordx4 v48, s[24:27], s56 offen offset:2048 lds
    v_mfma_f32_16x16x32_bf16 v[176:179], v[44:47], a[224:227], v[176:179]
    s_mov_b32 s57, 0xf0c00
    ds_read_b128 a[180:183], v53 offset:20480
    v_mfma_f32_16x16x32_bf16 v[180:183], v[44:47], a[228:231], v[76:79]
    ds_read_b128 a[184:187], v53 offset:36864
    v_mfma_f32_16x16x32_bf16 v[180:183], v[40:43], a[244:247], v[180:183]
    ds_read_b128 a[188:191], v53 offset:53248
    v_mfma_f32_16x16x32_bf16 v[184:187], v[40:43], a[248:251], v[76:79]
    ds_read_b128 a[160:163], v53 offset:5120
    buffer_load_dwordx4 v48, s[24:27], s57 offen offset:3072 lds
    v_mfma_f32_16x16x32_bf16 v[184:187], v[44:47], a[232:235], v[184:187]
    s_mov_b32 s54, 0xfc000
    ds_read_b128 a[164:167], v53 offset:21504
    v_mfma_f32_16x16x32_bf16 v[188:191], v[44:47], a[236:239], v[76:79]
    s_add_u32 m0, s63, 0x3000
    ds_read_b128 a[168:171], v53 offset:37888
    v_mfma_f32_16x16x32_bf16 v[188:191], v[40:43], a[252:255], v[188:191]
    s_waitcnt lgkmcnt(7)
    ds_read_b128 a[172:175], v53 offset:54272
    v_mfma_f32_16x16x32_bf16 v[128:131], v[16:19], a[208:211], v[128:131]
    ds_read_b128 a[144:147], v53 offset:6144
    buffer_load_dwordx4 v48, s[24:27], s54 offen lds
    v_mfma_f32_16x16x32_bf16 v[128:131], v[20:23], a[192:195], v[128:131]
    s_mov_b32 s55, 0x109c00
    ds_read_b64_tr_b16 v[32:33], v10 offset:0
    ds_read_b64_tr_b16 v[34:35], v10 offset:2048
    ds_read_b128 a[148:151], v53 offset:22528
    v_mfma_f32_16x16x32_bf16 v[132:135], v[20:23], a[196:199], v[132:135]
    ds_read_b128 a[152:155], v53 offset:38912
    v_mfma_f32_16x16x32_bf16 v[132:135], v[16:19], a[212:215], v[132:135]
    s_nop 0
    ds_read_b64_tr_b16 v[36:37], v10 offset:4096
    ds_read_b64_tr_b16 v[38:39], v10 offset:6144
    ds_read_b128 a[156:159], v53 offset:55296
    v_mfma_f32_16x16x32_bf16 v[136:139], v[16:19], a[216:219], v[136:139]
    ds_read_b128 a[128:131], v53 offset:7168
    buffer_load_dwordx4 v48, s[24:27], s55 offen offset:1024 lds
    v_mfma_f32_16x16x32_bf16 v[136:139], v[20:23], a[200:203], v[136:139]
    s_mov_b32 s56, 0xff000
    ds_read_b64_tr_b16 v[40:41], v11 offset:0
    ds_read_b64_tr_b16 v[42:43], v11 offset:2048
    ds_read_b128 a[132:135], v53 offset:23552
    v_mfma_f32_16x16x32_bf16 v[140:143], v[20:23], a[204:207], v[140:143]
    ds_read_b128 a[136:139], v53 offset:39936
    v_mfma_f32_16x16x32_bf16 v[140:143], v[16:19], a[220:223], v[140:143]
    s_nop 0
    ds_read_b64_tr_b16 v[44:45], v11 offset:4096
    ds_read_b64_tr_b16 v[46:47], v11 offset:6144
    ds_read_b128 a[140:143], v53 offset:56320
    v_mfma_f32_16x16x32_bf16 v[144:147], v[24:27], a[208:211], v[144:147]
    buffer_load_dwordx4 v48, s[24:27], s56 offen offset:2048 lds
    v_mfma_f32_16x16x32_bf16 v[144:147], v[28:31], a[192:195], v[144:147]
    s_mov_b32 s57, 0x10cc00
    v_mfma_f32_16x16x32_bf16 v[148:151], v[28:31], a[196:199], v[148:151]
    v_mfma_f32_16x16x32_bf16 v[148:151], v[24:27], a[212:215], v[148:151]
    v_mfma_f32_16x16x32_bf16 v[152:155], v[24:27], a[216:219], v[152:155]
    buffer_load_dwordx4 v48, s[24:27], s57 offen offset:3072 lds
    v_mfma_f32_16x16x32_bf16 v[152:155], v[28:31], a[200:203], v[152:155]
    s_mov_b32 s54, 0xa8000
    v_mfma_f32_16x16x32_bf16 v[156:159], v[28:31], a[204:207], v[156:159]
    s_add_u32 m0, s63, 0x12000
    v_mfma_f32_16x16x32_bf16 v[156:159], v[24:27], a[220:223], v[156:159]
    s_waitcnt vmcnt(9) lgkmcnt(1)
    s_waitcnt lgkmcnt(0)
    s_barrier
    v_mfma_f32_16x16x32_bf16 v[160:163], v[32:35], a[208:211], v[160:163]
    ds_read_b128 a[112:115], v54 offset:0
    buffer_load_dwordx4 v48, s[24:27], s54 offen lds
    v_mfma_f32_16x16x32_bf16 v[160:163], v[36:39], a[192:195], v[160:163]
    s_mov_b32 s55, 0xb5c00
    ds_read_b64_tr_b16 v[16:17], v4 offset:0
    ds_read_b64_tr_b16 v[18:19], v4 offset:2048
    v_mfma_f32_16x16x32_bf16 v[164:167], v[36:39], a[196:199], v[164:167]
    ds_read_b128 a[116:119], v54 offset:8192
    buffer_load_dwordx4 v48, s[24:27], s55 offen offset:1024 lds
    v_mfma_f32_16x16x32_bf16 v[164:167], v[32:35], a[212:215], v[164:167]
    s_mov_b32 s56, 0xab000
    ds_read_b64_tr_b16 v[20:21], v4 offset:4096
    ds_read_b64_tr_b16 v[22:23], v4 offset:6144
    v_mfma_f32_16x16x32_bf16 v[168:171], v[32:35], a[216:219], v[168:171]
    ds_read_b128 a[120:123], v54 offset:16384
    buffer_load_dwordx4 v48, s[24:27], s56 offen offset:2048 lds
    v_mfma_f32_16x16x32_bf16 v[168:171], v[36:39], a[200:203], v[168:171]
    s_mov_b32 s57, 0xb8c00
    ds_read_b64_tr_b16 v[24:25], v5 offset:0
    ds_read_b64_tr_b16 v[26:27], v5 offset:2048
    v_mfma_f32_16x16x32_bf16 v[172:175], v[36:39], a[204:207], v[172:175]
    ds_read_b128 a[124:127], v54 offset:24576
    buffer_load_dwordx4 v48, s[24:27], s57 offen offset:3072 lds
    v_mfma_f32_16x16x32_bf16 v[172:175], v[32:35], a[220:223], v[172:175]
    s_mov_b32 s54, 0xc4000
    s_add_u32 m0, s63, 0x13000
    ds_read_b64_tr_b16 v[28:29], v5 offset:4096
    ds_read_b64_tr_b16 v[30:31], v5 offset:6144
    v_mfma_f32_16x16x32_bf16 v[176:179], v[40:43], a[208:211], v[176:179]
    ds_read_b128 a[96:99], v54 offset:1024
    v_mfma_f32_16x16x32_bf16 v[176:179], v[44:47], a[192:195], v[176:179]
    buffer_load_dwordx4 v48, s[24:27], s54 offen lds
    s_mov_b32 s55, 0xd1c00
    v_mfma_f32_16x16x32_bf16 v[180:183], v[44:47], a[196:199], v[180:183]
    ds_read_b128 a[100:103], v54 offset:9216
    v_mfma_f32_16x16x32_bf16 v[180:183], v[40:43], a[212:215], v[180:183]
    buffer_load_dwordx4 v48, s[24:27], s55 offen offset:1024 lds
    s_mov_b32 s56, 0xc7000
    v_mfma_f32_16x16x32_bf16 v[184:187], v[40:43], a[216:219], v[184:187]
    buffer_load_dwordx4 v48, s[24:27], s56 offen offset:2048 lds
    v_mfma_f32_16x16x32_bf16 v[184:187], v[44:47], a[200:203], v[184:187]
    s_mov_b32 s57, 0xd4c00
    ds_read_b128 a[104:107], v54 offset:17408
    v_mfma_f32_16x16x32_bf16 v[188:191], v[44:47], a[204:207], v[188:191]
    buffer_load_dwordx4 v48, s[24:27], s57 offen offset:3072 lds
    v_mfma_f32_16x16x32_bf16 v[188:191], v[40:43], a[220:223], v[188:191]
    s_waitcnt lgkmcnt(3)
    ds_read_b128 a[108:111], v54 offset:25600
    v_mfma_f32_16x16x32_bf16 v[128:131], v[16:19], a[176:179], v[128:131]
    s_mov_b32 s54, 0x118000
    v_mfma_f32_16x16x32_bf16 v[128:131], v[20:23], a[160:163], v[128:131]
    s_add_u32 m0, s63, 0x10000
    ds_read_b64_tr_b16 v[32:33], v6 offset:0
    ds_read_b64_tr_b16 v[34:35], v6 offset:2048
    v_mfma_f32_16x16x32_bf16 v[132:135], v[20:23], a[164:167], v[132:135]
    ds_read_b128 a[80:83], v54 offset:2048
    v_mfma_f32_16x16x32_bf16 v[132:135], v[16:19], a[180:183], v[132:135]
    s_nop 0
    ds_read_b64_tr_b16 v[36:37], v6 offset:4096
    ds_read_b64_tr_b16 v[38:39], v6 offset:6144
    v_mfma_f32_16x16x32_bf16 v[136:139], v[16:19], a[184:187], v[136:139]
    ds_read_b128 a[84:87], v54 offset:10240
    v_mfma_f32_16x16x32_bf16 v[136:139], v[20:23], a[168:171], v[136:139]
    s_nop 0
    ds_read_b64_tr_b16 v[40:41], v7 offset:0
    ds_read_b64_tr_b16 v[42:43], v7 offset:2048
    v_mfma_f32_16x16x32_bf16 v[140:143], v[20:23], a[172:175], v[140:143]
    ds_read_b128 a[88:91], v54 offset:18432
    v_mfma_f32_16x16x32_bf16 v[140:143], v[16:19], a[188:191], v[140:143]
    s_nop 0
    ds_read_b64_tr_b16 v[44:45], v7 offset:4096
    ds_read_b64_tr_b16 v[46:47], v7 offset:6144
    v_mfma_f32_16x16x32_bf16 v[144:147], v[24:27], a[176:179], v[144:147]
    ds_read_b128 a[92:95], v54 offset:26624
    v_mfma_f32_16x16x32_bf16 v[144:147], v[28:31], a[160:163], v[144:147]
    v_mfma_f32_16x16x32_bf16 v[148:151], v[28:31], a[164:167], v[148:151]
    ds_read_b128 a[64:67], v54 offset:3072
    v_mfma_f32_16x16x32_bf16 v[148:151], v[24:27], a[180:183], v[148:151]
    v_mfma_f32_16x16x32_bf16 v[152:155], v[24:27], a[184:187], v[152:155]
    ds_read_b128 a[68:71], v54 offset:11264
    v_mfma_f32_16x16x32_bf16 v[152:155], v[28:31], a[168:171], v[152:155]
    v_mfma_f32_16x16x32_bf16 v[156:159], v[28:31], a[172:175], v[156:159]
    ds_read_b128 a[72:75], v54 offset:19456
    v_mfma_f32_16x16x32_bf16 v[156:159], v[24:27], a[188:191], v[156:159]
    s_waitcnt vmcnt(0) lgkmcnt(4)
    buffer_load_dwordx4 v48, s[24:27], s54 offen lds
    v_mfma_f32_16x16x32_bf16 v[160:163], v[32:35], a[176:179], v[160:163]
    s_mov_b32 s55, 0x125c00
    ds_read_b128 a[76:79], v54 offset:27648
    v_mfma_f32_16x16x32_bf16 v[160:163], v[36:39], a[160:163], v[160:163]
    s_nop 0
    ds_read_b64_tr_b16 v[16:17], v8 offset:8192
    ds_read_b64_tr_b16 v[18:19], v8 offset:10240
    v_mfma_f32_16x16x32_bf16 v[164:167], v[36:39], a[164:167], v[164:167]
    v_mfma_f32_16x16x32_bf16 v[164:167], v[32:35], a[180:183], v[164:167]
    s_nop 0
    ds_read_b64_tr_b16 v[20:21], v8 offset:12288
    ds_read_b64_tr_b16 v[22:23], v8 offset:14336
    v_mfma_f32_16x16x32_bf16 v[168:171], v[32:35], a[184:187], v[168:171]
    ds_read_b128 a[48:51], v54 offset:4096
    buffer_load_dwordx4 v48, s[24:27], s55 offen offset:1024 lds
    v_mfma_f32_16x16x32_bf16 v[168:171], v[36:39], a[168:171], v[168:171]
    s_mov_b32 s56, 0x11b000
    ds_read_b64_tr_b16 v[24:25], v9 offset:8192
    ds_read_b64_tr_b16 v[26:27], v9 offset:10240
    v_mfma_f32_16x16x32_bf16 v[172:175], v[36:39], a[172:175], v[172:175]
    ds_read_b128 a[52:55], v54 offset:12288
    buffer_load_dwordx4 v48, s[24:27], s56 offen offset:2048 lds
    v_mfma_f32_16x16x32_bf16 v[172:175], v[32:35], a[188:191], v[172:175]
    s_mov_b32 s57, 0x128c00
    ds_read_b64_tr_b16 v[28:29], v9 offset:12288
    ds_read_b64_tr_b16 v[30:31], v9 offset:14336
    v_mfma_f32_16x16x32_bf16 v[176:179], v[40:43], a[176:179], v[176:179]
    ds_read_b128 a[56:59], v54 offset:20480
    v_mfma_f32_16x16x32_bf16 v[176:179], v[44:47], a[160:163], v[176:179]
    ds_read_b128 a[60:63], v54 offset:28672
    v_mfma_f32_16x16x32_bf16 v[180:183], v[44:47], a[164:167], v[180:183]
    buffer_load_dwordx4 v48, s[24:27], s57 offen offset:3072 lds
    v_mfma_f32_16x16x32_bf16 v[180:183], v[40:43], a[180:183], v[180:183]
    s_mov_b32 s54, 0x134000
    ds_read_b128 a[32:35], v54 offset:5120
    v_mfma_f32_16x16x32_bf16 v[184:187], v[40:43], a[184:187], v[184:187]
    s_add_u32 m0, s63, 0x11000
    v_mfma_f32_16x16x32_bf16 v[184:187], v[44:47], a[168:171], v[184:187]
    ds_read_b128 a[36:39], v54 offset:13312
    v_mfma_f32_16x16x32_bf16 v[188:191], v[44:47], a[172:175], v[188:191]
    buffer_load_dwordx4 v48, s[24:27], s54 offen lds
    v_mfma_f32_16x16x32_bf16 v[188:191], v[40:43], a[188:191], v[188:191]
    s_waitcnt lgkmcnt(4)
    v_mfma_f32_16x16x32_bf16 v[128:131], v[16:19], a[144:147], v[128:131]
    s_mov_b32 s55, 0x141c00
    ds_read_b128 a[40:43], v54 offset:21504
    v_mfma_f32_16x16x32_bf16 v[128:131], v[20:23], a[128:131], v[128:131]
    s_nop 0
    ds_read_b64_tr_b16 v[32:33], v10 offset:8192
    ds_read_b64_tr_b16 v[34:35], v10 offset:10240
    v_mfma_f32_16x16x32_bf16 v[132:135], v[20:23], a[132:135], v[132:135]
    ds_read_b128 a[44:47], v54 offset:29696
    buffer_load_dwordx4 v48, s[24:27], s55 offen offset:1024 lds
    v_mfma_f32_16x16x32_bf16 v[132:135], v[16:19], a[148:151], v[132:135]
    s_mov_b32 s56, 0x137000
    ds_read_b64_tr_b16 v[36:37], v10 offset:12288
    ds_read_b64_tr_b16 v[38:39], v10 offset:14336
    v_mfma_f32_16x16x32_bf16 v[136:139], v[16:19], a[152:155], v[136:139]
    ds_read_b128 a[16:19], v54 offset:6144
    buffer_load_dwordx4 v48, s[24:27], s56 offen offset:2048 lds
    v_mfma_f32_16x16x32_bf16 v[136:139], v[20:23], a[136:139], v[136:139]
    s_mov_b32 s57, 0x144c00
    ds_read_b64_tr_b16 v[40:41], v11 offset:8192
    ds_read_b64_tr_b16 v[42:43], v11 offset:10240
    v_mfma_f32_16x16x32_bf16 v[140:143], v[20:23], a[140:143], v[140:143]
    ds_read_b128 a[20:23], v54 offset:14336
    v_mfma_f32_16x16x32_bf16 v[140:143], v[16:19], a[156:159], v[140:143]
    s_nop 0
    ds_read_b64_tr_b16 v[44:45], v11 offset:12288
    ds_read_b64_tr_b16 v[46:47], v11 offset:14336
    v_mfma_f32_16x16x32_bf16 v[144:147], v[24:27], a[144:147], v[144:147]
    ds_read_b128 a[24:27], v54 offset:22528
    v_mfma_f32_16x16x32_bf16 v[144:147], v[28:31], a[128:131], v[144:147]
    buffer_load_dwordx4 v48, s[24:27], s57 offen offset:3072 lds
    v_mfma_f32_16x16x32_bf16 v[148:151], v[28:31], a[132:135], v[148:151]
    s_mov_b32 s54, 0x150000
    s_add_u32 m0, s63, 0x0
    v_mfma_f32_16x16x32_bf16 v[148:151], v[24:27], a[148:151], v[148:151]
    ds_read_b128 a[28:31], v54 offset:30720
    v_mfma_f32_16x16x32_bf16 v[152:155], v[24:27], a[152:155], v[152:155]
    buffer_load_dwordx4 v48, s[24:27], s54 offen lds
    v_mfma_f32_16x16x32_bf16 v[152:155], v[28:31], a[136:139], v[152:155]
    s_mov_b32 s55, 0x15dc00
    ds_read_b128 a[0:3], v54 offset:7168
    v_mfma_f32_16x16x32_bf16 v[156:159], v[28:31], a[140:143], v[156:159]
    v_mfma_f32_16x16x32_bf16 v[156:159], v[24:27], a[156:159], v[156:159]
    s_waitcnt vmcnt(17) lgkmcnt(3)
    ds_read_b128 a[4:7], v54 offset:15360
    v_mfma_f32_16x16x32_bf16 v[160:163], v[32:35], a[144:147], v[160:163]
    buffer_load_dwordx4 v48, s[24:27], s55 offen offset:1024 lds
    v_mfma_f32_16x16x32_bf16 v[160:163], v[36:39], a[128:131], v[160:163]
    s_mov_b32 s56, 0x153000
    ds_read_b64_tr_b16 v[16:17], v4 offset:8192
    ds_read_b64_tr_b16 v[18:19], v4 offset:10240
    v_mfma_f32_16x16x32_bf16 v[164:167], v[36:39], a[132:135], v[164:167]
    ds_read_b128 a[8:11], v54 offset:23552
    buffer_load_dwordx4 v48, s[24:27], s56 offen offset:2048 lds
    v_mfma_f32_16x16x32_bf16 v[164:167], v[32:35], a[148:151], v[164:167]
    s_mov_b32 s57, 0x160c00
    ds_read_b64_tr_b16 v[20:21], v4 offset:12288
    ds_read_b64_tr_b16 v[22:23], v4 offset:14336
    v_mfma_f32_16x16x32_bf16 v[168:171], v[32:35], a[152:155], v[168:171]
    ds_read_b128 a[12:15], v54 offset:31744
    v_mfma_f32_16x16x32_bf16 v[168:171], v[36:39], a[136:139], v[168:171]
    s_nop 0
    ds_read_b64_tr_b16 v[24:25], v5 offset:8192
    ds_read_b64_tr_b16 v[26:27], v5 offset:10240
    v_mfma_f32_16x16x32_bf16 v[172:175], v[36:39], a[140:143], v[172:175]
    buffer_load_dwordx4 v48, s[24:27], s57 offen offset:3072 lds
    v_mfma_f32_16x16x32_bf16 v[172:175], v[32:35], a[156:159], v[172:175]
    s_mov_b32 s54, 0x16c000
    ds_read_b64_tr_b16 v[28:29], v5 offset:12288
    ds_read_b64_tr_b16 v[30:31], v5 offset:14336
    v_mfma_f32_16x16x32_bf16 v[176:179], v[40:43], a[144:147], v[176:179]
    s_add_u32 m0, s63, 0x1000
    v_mfma_f32_16x16x32_bf16 v[176:179], v[44:47], a[128:131], v[176:179]
    buffer_load_dwordx4 v48, s[24:27], s54 offen lds
    v_mfma_f32_16x16x32_bf16 v[180:183], v[44:47], a[132:135], v[180:183]
    s_mov_b32 s55, 0x179c00
    v_mfma_f32_16x16x32_bf16 v[180:183], v[40:43], a[148:151], v[180:183]
    v_mfma_f32_16x16x32_bf16 v[184:187], v[40:43], a[152:155], v[184:187]
    v_mfma_f32_16x16x32_bf16 v[184:187], v[44:47], a[136:139], v[184:187]
    buffer_load_dwordx4 v48, s[24:27], s55 offen offset:1024 lds
    v_mfma_f32_16x16x32_bf16 v[188:191], v[44:47], a[140:143], v[188:191]
    s_mov_b32 s56, 0x16f000
    v_mfma_f32_16x16x32_bf16 v[188:191], v[40:43], a[156:159], v[188:191]
    s_waitcnt lgkmcnt(0)
    v_mfma_f32_16x16x32_bf16 v[128:131], v[16:19], a[112:115], v[128:131]
    buffer_load_dwordx4 v48, s[24:27], s56 offen offset:2048 lds
    v_mfma_f32_16x16x32_bf16 v[128:131], v[20:23], a[96:99], v[128:131]
    s_mov_b32 s57, 0x17cc00
    ds_read_b64_tr_b16 v[32:33], v6 offset:8192
    ds_read_b64_tr_b16 v[34:35], v6 offset:10240
    v_mfma_f32_16x16x32_bf16 v[132:135], v[20:23], a[100:103], v[132:135]
    v_mfma_f32_16x16x32_bf16 v[132:135], v[16:19], a[116:119], v[132:135]
    s_nop 0
    ds_read_b64_tr_b16 v[36:37], v6 offset:12288
    ds_read_b64_tr_b16 v[38:39], v6 offset:14336
    v_mfma_f32_16x16x32_bf16 v[136:139], v[16:19], a[120:123], v[136:139]
    buffer_load_dwordx4 v48, s[24:27], s57 offen offset:3072 lds
    v_mfma_f32_16x16x32_bf16 v[136:139], v[20:23], a[104:107], v[136:139]
    s_mov_b32 s54, 0x188000
    ds_read_b64_tr_b16 v[40:41], v7 offset:8192
    ds_read_b64_tr_b16 v[42:43], v7 offset:10240
    v_mfma_f32_16x16x32_bf16 v[140:143], v[20:23], a[108:111], v[140:143]
    s_add_u32 m0, s63, 0x12000
    v_mfma_f32_16x16x32_bf16 v[140:143], v[16:19], a[124:127], v[140:143]
    s_nop 0
    ds_read_b64_tr_b16 v[44:45], v7 offset:12288
    ds_read_b64_tr_b16 v[46:47], v7 offset:14336
    v_mfma_f32_16x16x32_bf16 v[144:147], v[24:27], a[112:115], v[144:147]
    buffer_load_dwordx4 v48, s[24:27], s54 offen lds
    v_mfma_f32_16x16x32_bf16 v[144:147], v[28:31], a[96:99], v[144:147]
    s_mov_b32 s55, 0x195c00
    v_mfma_f32_16x16x32_bf16 v[148:151], v[28:31], a[100:103], v[148:151]
    v_mfma_f32_16x16x32_bf16 v[148:151], v[24:27], a[116:119], v[148:151]
    buffer_load_dwordx4 v48, s[24:27], s55 offen offset:1024 lds
    v_mfma_f32_16x16x32_bf16 v[152:155], v[24:27], a[120:123], v[152:155]
    s_mov_b32 s56, 0x18b000
    v_mfma_f32_16x16x32_bf16 v[152:155], v[28:31], a[104:107], v[152:155]
    v_mfma_f32_16x16x32_bf16 v[156:159], v[28:31], a[108:111], v[156:159]
    buffer_load_dwordx4 v48, s[24:27], s56 offen offset:2048 lds
    v_mfma_f32_16x16x32_bf16 v[156:159], v[24:27], a[124:127], v[156:159]
    s_waitcnt vmcnt(11) lgkmcnt(0)
    v_mfma_f32_16x16x32_bf16 v[160:163], v[32:35], a[112:115], v[160:163]
    s_mov_b32 s57, 0x198c00
    v_mfma_f32_16x16x32_bf16 v[160:163], v[36:39], a[96:99], v[160:163]
    s_nop 0
    ds_read_b64_tr_b16 v[16:17], v8 offset:0
    ds_read_b64_tr_b16 v[18:19], v8 offset:2048
    v_mfma_f32_16x16x32_bf16 v[164:167], v[36:39], a[100:103], v[164:167]
    buffer_load_dwordx4 v48, s[24:27], s57 offen offset:3072 lds
    v_mfma_f32_16x16x32_bf16 v[164:167], v[32:35], a[116:119], v[164:167]
    s_mov_b32 s54, 0x1a4000
    ds_read_b64_tr_b16 v[20:21], v8 offset:4096
    ds_read_b64_tr_b16 v[22:23], v8 offset:6144
    v_mfma_f32_16x16x32_bf16 v[168:171], v[32:35], a[120:123], v[168:171]
    s_add_u32 m0, s63, 0x13000
    v_mfma_f32_16x16x32_bf16 v[168:171], v[36:39], a[104:107], v[168:171]
    s_nop 0
    ds_read_b64_tr_b16 v[24:25], v9 offset:0
    ds_read_b64_tr_b16 v[26:27], v9 offset:2048
    v_mfma_f32_16x16x32_bf16 v[172:175], v[36:39], a[108:111], v[172:175]
    buffer_load_dwordx4 v48, s[24:27], s54 offen lds
    v_mfma_f32_16x16x32_bf16 v[172:175], v[32:35], a[124:127], v[172:175]
    s_mov_b32 s55, 0x1b1c00
    ds_read_b64_tr_b16 v[28:29], v9 offset:4096
    ds_read_b64_tr_b16 v[30:31], v9 offset:6144
    v_mfma_f32_16x16x32_bf16 v[176:179], v[40:43], a[112:115], v[176:179]
    v_mfma_f32_16x16x32_bf16 v[176:179], v[44:47], a[96:99], v[176:179]
    buffer_load_dwordx4 v48, s[24:27], s55 offen offset:1024 lds
    v_mfma_f32_16x16x32_bf16 v[180:183], v[44:47], a[100:103], v[180:183]
    s_mov_b32 s56, 0x1a7000
    v_mfma_f32_16x16x32_bf16 v[180:183], v[40:43], a[116:119], v[180:183]
    v_mfma_f32_16x16x32_bf16 v[184:187], v[40:43], a[120:123], v[184:187]
    buffer_load_dwordx4 v48, s[24:27], s56 offen offset:2048 lds
    v_mfma_f32_16x16x32_bf16 v[184:187], v[44:47], a[104:107], v[184:187]
    s_mov_b32 s57, 0x1b4c00
    v_mfma_f32_16x16x32_bf16 v[188:191], v[44:47], a[108:111], v[188:191]
    v_mfma_f32_16x16x32_bf16 v[188:191], v[40:43], a[124:127], v[188:191]
    s_waitcnt lgkmcnt(0)
    v_mfma_f32_16x16x32_bf16 v[128:131], v[16:19], a[80:83], v[128:131]
    buffer_load_dwordx4 v48, s[24:27], s57 offen offset:3072 lds
    v_mfma_f32_16x16x32_bf16 v[128:131], v[20:23], a[64:67], v[128:131]
    s_mov_b32 s54, 0x0
    ds_read_b64_tr_b16 v[32:33], v10 offset:0
    ds_read_b64_tr_b16 v[34:35], v10 offset:2048
    v_mfma_f32_16x16x32_bf16 v[132:135], v[20:23], a[68:71], v[132:135]
    s_add_u32 m0, s63, 0x2000
    v_mfma_f32_16x16x32_bf16 v[132:135], v[16:19], a[84:87], v[132:135]
    s_lshl_b32 s76, s3, 13
    ds_read_b64_tr_b16 v[36:37], v10 offset:4096
    ds_read_b64_tr_b16 v[38:39], v10 offset:6144
    v_mfma_f32_16x16x32_bf16 v[136:139], v[16:19], a[88:91], v[136:139]
    buffer_load_dwordx4 v49, s[16:19], s54 offen lds
    v_mfma_f32_16x16x32_bf16 v[136:139], v[20:23], a[72:75], v[136:139]
    s_mov_b32 s55, 0x1fc00
    ds_read_b64_tr_b16 v[40:41], v11 offset:0
    ds_read_b64_tr_b16 v[42:43], v11 offset:2048
    v_mfma_f32_16x16x32_bf16 v[140:143], v[20:23], a[76:79], v[140:143]
    s_add_u32 s76, s76, 0x20000
    v_add_u32 v53, s76, v15
    v_mfma_f32_16x16x32_bf16 v[140:143], v[16:19], a[92:95], v[140:143]
    s_and_b32 s76, s52, 1
    ds_read_b64_tr_b16 v[44:45], v11 offset:4096
    ds_read_b64_tr_b16 v[46:47], v11 offset:6144
    v_mfma_f32_16x16x32_bf16 v[144:147], v[24:27], a[80:83], v[144:147]
    buffer_load_dwordx4 v49, s[16:19], s55 offen offset:1024 lds
    v_mfma_f32_16x16x32_bf16 v[144:147], v[28:31], a[64:67], v[144:147]
    s_mov_b32 s56, 0x7800
    s_lshl_b32 s76, s76, 12
    v_mfma_f32_16x16x32_bf16 v[148:151], v[28:31], a[68:71], v[148:151]
    buffer_load_dwordx4 v49, s[16:19], s56 offen offset:2048 lds
    v_mfma_f32_16x16x32_bf16 v[148:151], v[24:27], a[84:87], v[148:151]
    s_mov_b32 s57, 0x27400
    v_mfma_f32_16x16x32_bf16 v[152:155], v[24:27], a[88:91], v[152:155]
    s_add_u32 s76, s76, 0x20000
    v_add_u32 v54, s76, v15
    v_mfma_f32_16x16x32_bf16 v[152:155], v[28:31], a[72:75], v[152:155]
    v_mfma_f32_16x16x32_bf16 v[156:159], v[28:31], a[76:79], v[156:159]
    buffer_load_dwordx4 v49, s[16:19], s57 offen offset:3072 lds
    v_mfma_f32_16x16x32_bf16 v[156:159], v[24:27], a[92:95], v[156:159]
    s_waitcnt vmcnt(12) lgkmcnt(0)
    v_mfma_f32_16x16x32_bf16 v[160:163], v[32:35], a[80:83], v[160:163]
    s_mov_b32 s54, 0x40000
    s_add_u32 m0, s63, 0x3000
    v_mfma_f32_16x16x32_bf16 v[160:163], v[36:39], a[64:67], v[160:163]
    s_nop 0
    ds_read_b64_tr_b16 v[16:17], v4 offset:0
    ds_read_b64_tr_b16 v[18:19], v4 offset:2048
    v_mfma_f32_16x16x32_bf16 v[164:167], v[36:39], a[68:71], v[164:167]
    buffer_load_dwordx4 v49, s[16:19], s54 offen lds
    v_mfma_f32_16x16x32_bf16 v[164:167], v[32:35], a[84:87], v[164:167]
    s_mov_b32 s55, 0x5fc00
    ds_read_b64_tr_b16 v[20:21], v4 offset:4096
    ds_read_b64_tr_b16 v[22:23], v4 offset:6144
    v_mfma_f32_16x16x32_bf16 v[168:171], v[32:35], a[88:91], v[168:171]
    v_mfma_f32_16x16x32_bf16 v[168:171], v[36:39], a[72:75], v[168:171]
    s_nop 0
    ds_read_b64_tr_b16 v[24:25], v5 offset:0
    ds_read_b64_tr_b16 v[26:27], v5 offset:2048
    v_mfma_f32_16x16x32_bf16 v[172:175], v[36:39], a[76:79], v[172:175]
    buffer_load_dwordx4 v49, s[16:19], s55 offen offset:1024 lds
    v_mfma_f32_16x16x32_bf16 v[172:175], v[32:35], a[92:95], v[172:175]
    s_mov_b32 s56, 0x47800
    ds_read_b64_tr_b16 v[28:29], v5 offset:4096
    ds_read_b64_tr_b16 v[30:31], v5 offset:6144
    v_mfma_f32_16x16x32_bf16 v[176:179], v[40:43], a[80:83], v[176:179]
    buffer_load_dwordx4 v49, s[16:19], s56 offen offset:2048 lds
    v_mfma_f32_16x16x32_bf16 v[176:179], v[44:47], a[64:67], v[176:179]
    s_mov_b32 s57, 0x67400
    v_mfma_f32_16x16x32_bf16 v[180:183], v[44:47], a[68:71], v[180:183]
    v_mfma_f32_16x16x32_bf16 v[180:183], v[40:43], a[84:87], v[180:183]
    v_mfma_f32_16x16x32_bf16 v[184:187], v[40:43], a[88:91], v[184:187]
    buffer_load_dwordx4 v49, s[16:19], s57 offen offset:3072 lds
    v_mfma_f32_16x16x32_bf16 v[184:187], v[44:47], a[72:75], v[184:187]
    s_mov_b32 s54, 0x80000
    v_mfma_f32_16x16x32_bf16 v[188:191], v[44:47], a[76:79], v[188:191]
    s_add_u32 m0, s63, 0x10000
    v_mfma_f32_16x16x32_bf16 v[188:191], v[40:43], a[92:95], v[188:191]
    s_waitcnt lgkmcnt(0)
    v_mfma_f32_16x16x32_bf16 v[128:131], v[16:19], a[48:51], v[128:131]
    buffer_load_dwordx4 v49, s[16:19], s54 offen lds
    v_mfma_f32_16x16x32_bf16 v[128:131], v[20:23], a[32:35], v[128:131]
    s_mov_b32 s55, 0x9fc00
    ds_read_b64_tr_b16 v[32:33], v6 offset:0
    ds_read_b64_tr_b16 v[34:35], v6 offset:2048
    v_mfma_f32_16x16x32_bf16 v[132:135], v[20:23], a[36:39], v[132:135]
    v_mfma_f32_16x16x32_bf16 v[132:135], v[16:19], a[52:55], v[132:135]
    s_nop 0
    ds_read_b64_tr_b16 v[36:37], v6 offset:4096
    ds_read_b64_tr_b16 v[38:39], v6 offset:6144
    v_mfma_f32_16x16x32_bf16 v[136:139], v[16:19], a[56:59], v[136:139]
    buffer_load_dwordx4 v49, s[16:19], s55 offen offset:1024 lds
    v_mfma_f32_16x16x32_bf16 v[136:139], v[20:23], a[40:43], v[136:139]
    s_mov_b32 s56, 0x87800
    ds_read_b64_tr_b16 v[40:41], v7 offset:0
    ds_read_b64_tr_b16 v[42:43], v7 offset:2048
    v_mfma_f32_16x16x32_bf16 v[140:143], v[20:23], a[44:47], v[140:143]
    buffer_load_dwordx4 v49, s[16:19], s56 offen offset:2048 lds
    v_mfma_f32_16x16x32_bf16 v[140:143], v[16:19], a[60:63], v[140:143]
    s_mov_b32 s57, 0xa7400
    ds_read_b64_tr_b16 v[44:45], v7 offset:4096
    ds_read_b64_tr_b16 v[46:47], v7 offset:6144
    v_mfma_f32_16x16x32_bf16 v[144:147], v[24:27], a[48:51], v[144:147]
    v_mfma_f32_16x16x32_bf16 v[144:147], v[28:31], a[32:35], v[144:147]
    v_mfma_f32_16x16x32_bf16 v[148:151], v[28:31], a[36:39], v[148:151]
    buffer_load_dwordx4 v49, s[16:19], s57 offen offset:3072 lds
    v_mfma_f32_16x16x32_bf16 v[148:151], v[24:27], a[52:55], v[148:151]
    s_mov_b32 s54, 0xc0000
    v_mfma_f32_16x16x32_bf16 v[152:155], v[24:27], a[56:59], v[152:155]
    s_add_u32 m0, s63, 0x11000
    v_mfma_f32_16x16x32_bf16 v[152:155], v[28:31], a[40:43], v[152:155]
    buffer_load_dwordx4 v49, s[16:19], s54 offen lds
    v_mfma_f32_16x16x32_bf16 v[156:159], v[28:31], a[44:47], v[156:159]
    s_mov_b32 s55, 0xdfc00
    v_mfma_f32_16x16x32_bf16 v[156:159], v[24:27], a[60:63], v[156:159]
    s_waitcnt vmcnt(13) lgkmcnt(0)
    v_mfma_f32_16x16x32_bf16 v[160:163], v[32:35], a[48:51], v[160:163]
    v_add_u32 v4, v4, v52
    v_add_u32 v5, v5, v52
    v_mfma_f32_16x16x32_bf16 v[160:163], v[36:39], a[32:35], v[160:163]
    ds_read_b64_tr_b16 v[16:17], v8 offset:8192
    ds_read_b64_tr_b16 v[18:19], v8 offset:10240
    v_mfma_f32_16x16x32_bf16 v[164:167], v[36:39], a[36:39], v[164:167]
    buffer_load_dwordx4 v49, s[16:19], s55 offen offset:1024 lds
    v_mfma_f32_16x16x32_bf16 v[164:167], v[32:35], a[52:55], v[164:167]
    s_mov_b32 s56, 0xc7800
    ds_read_b64_tr_b16 v[20:21], v8 offset:12288
    ds_read_b64_tr_b16 v[22:23], v8 offset:14336
    v_mfma_f32_16x16x32_bf16 v[168:171], v[32:35], a[56:59], v[168:171]
    buffer_load_dwordx4 v49, s[16:19], s56 offen offset:2048 lds
    v_mfma_f32_16x16x32_bf16 v[168:171], v[36:39], a[40:43], v[168:171]
    s_mov_b32 s57, 0xe7400
    ds_read_b64_tr_b16 v[24:25], v9 offset:8192
    ds_read_b64_tr_b16 v[26:27], v9 offset:10240
    v_mfma_f32_16x16x32_bf16 v[172:175], v[36:39], a[44:47], v[172:175]
    v_add_u32 v6, v6, v52
    v_add_u32 v7, v7, v52
    v_mfma_f32_16x16x32_bf16 v[172:175], v[32:35], a[60:63], v[172:175]
    ds_read_b64_tr_b16 v[28:29], v9 offset:12288
    ds_read_b64_tr_b16 v[30:31], v9 offset:14336
    v_mfma_f32_16x16x32_bf16 v[176:179], v[40:43], a[48:51], v[176:179]
    buffer_load_dwordx4 v49, s[16:19], s57 offen offset:3072 lds
    v_mfma_f32_16x16x32_bf16 v[176:179], v[44:47], a[32:35], v[176:179]
    s_mov_b32 s54, 0x100000
    v_mfma_f32_16x16x32_bf16 v[180:183], v[44:47], a[36:39], v[180:183]
    s_add_u32 m0, s63, 0x0
    v_mfma_f32_16x16x32_bf16 v[180:183], v[40:43], a[52:55], v[180:183]
    buffer_load_dwordx4 v49, s[16:19], s54 offen lds
    v_mfma_f32_16x16x32_bf16 v[184:187], v[40:43], a[56:59], v[184:187]
    s_mov_b32 s55, 0x11fc00
    v_mfma_f32_16x16x32_bf16 v[184:187], v[44:47], a[40:43], v[184:187]
    v_mfma_f32_16x16x32_bf16 v[188:191], v[44:47], a[44:47], v[188:191]
    v_mfma_f32_16x16x32_bf16 v[188:191], v[40:43], a[60:63], v[188:191]
    s_waitcnt lgkmcnt(0)
    v_mfma_f32_16x16x32_bf16 v[128:131], v[16:19], a[16:19], v[128:131]
    buffer_load_dwordx4 v49, s[16:19], s55 offen offset:1024 lds
    v_mfma_f32_16x16x32_bf16 v[128:131], v[20:23], a[0:3], v[128:131]
    s_mov_b32 s56, 0x107800
    ds_read_b64_tr_b16 v[32:33], v10 offset:8192
    ds_read_b64_tr_b16 v[34:35], v10 offset:10240
    v_mfma_f32_16x16x32_bf16 v[132:135], v[20:23], a[4:7], v[132:135]
    buffer_load_dwordx4 v49, s[16:19], s56 offen offset:2048 lds
    v_mfma_f32_16x16x32_bf16 v[132:135], v[16:19], a[20:23], v[132:135]
    s_mov_b32 s57, 0x127400
    ds_read_b64_tr_b16 v[36:37], v10 offset:12288
    ds_read_b64_tr_b16 v[38:39], v10 offset:14336
    v_mfma_f32_16x16x32_bf16 v[136:139], v[16:19], a[24:27], v[136:139]
    v_mfma_f32_16x16x32_bf16 v[136:139], v[20:23], a[8:11], v[136:139]
    s_nop 0
    ds_read_b64_tr_b16 v[40:41], v11 offset:8192
    ds_read_b64_tr_b16 v[42:43], v11 offset:10240
    v_mfma_f32_16x16x32_bf16 v[140:143], v[20:23], a[12:15], v[140:143]
    buffer_load_dwordx4 v49, s[16:19], s57 offen offset:3072 lds
    v_mfma_f32_16x16x32_bf16 v[140:143], v[16:19], a[28:31], v[140:143]
    s_mov_b32 s54, 0x140000
    ds_read_b64_tr_b16 v[44:45], v11 offset:12288
    ds_read_b64_tr_b16 v[46:47], v11 offset:14336
    v_mul_f32 v56, v128, v128
    v_mul_f32 v57, v129, v129
    v_mfma_f32_16x16x32_bf16 v[144:147], v[24:27], a[16:19], v[144:147]
    s_add_u32 m0, s63, 0x1000
    v_mul_f32 v58, v130, v130
    v_mul_f32 v59, v131, v131
    v_fma_f32 v56, v56, s71, v51
    v_mfma_f32_16x16x32_bf16 v[144:147], v[28:31], a[0:3], v[144:147]
    buffer_load_dwordx4 v49, s[16:19], s54 offen lds
    v_fma_f32 v57, v57, s71, v51
    v_mfma_f32_16x16x32_bf16 v[148:151], v[28:31], a[4:7], v[148:151]
    s_mov_b32 s55, 0x15fc00
    v_fma_f32 v58, v58, s71, v51
    v_fma_f32 v59, v59, s71, v51
    v_mul_f32 v56, v56, v128
    v_mfma_f32_16x16x32_bf16 v[148:151], v[24:27], a[20:23], v[148:151]
    v_mul_f32 v57, v57, v129
    v_mul_f32 v58, v58, v130
    v_mul_f32 v59, v59, v131
    v_mfma_f32_16x16x32_bf16 v[152:155], v[24:27], a[24:27], v[152:155]
    v_exp_f32 v56, v56
    v_mfma_f32_16x16x32_bf16 v[152:155], v[28:31], a[8:11], v[152:155]
    buffer_load_dwordx4 v49, s[16:19], s55 offen offset:1024 lds
    v_mfma_f32_16x16x32_bf16 v[156:159], v[28:31], a[12:15], v[156:159]
    s_mov_b32 s56, 0x147800
    v_exp_f32 v57, v57
    v_mfma_f32_16x16x32_bf16 v[156:159], v[24:27], a[28:31], v[156:159]
    s_waitcnt vmcnt(14) lgkmcnt(0)
    v_exp_f32 v58, v58
    v_mfma_f32_16x16x32_bf16 v[160:163], v[32:35], a[16:19], v[160:163]
    buffer_load_dwordx4 v49, s[16:19], s56 offen offset:2048 lds
    v_mfma_f32_16x16x32_bf16 v[160:163], v[36:39], a[0:3], v[160:163]
    s_mov_b32 s57, 0x167400
    ds_read_b64_tr_b16 v[16:17], v4 offset:8192
    ds_read_b64_tr_b16 v[18:19], v4 offset:10240
    v_mfma_f32_16x16x32_bf16 v[164:167], v[36:39], a[4:7], v[164:167]
    v_add_u32 v8, v8, v52
    v_add_u32 v9, v9, v52
    v_mfma_f32_16x16x32_bf16 v[164:167], v[32:35], a[20:23], v[164:167]
    ds_read_b64_tr_b16 v[20:21], v4 offset:12288
    ds_read_b64_tr_b16 v[22:23], v4 offset:14336
    v_mfma_f32_16x16x32_bf16 v[168:171], v[32:35], a[24:27], v[168:171]
    buffer_load_dwordx4 v49, s[16:19], s57 offen offset:3072 lds
    v_mfma_f32_16x16x32_bf16 v[168:171], v[36:39], a[8:11], v[168:171]
    s_mov_b32 s54, 0x180000
    ds_read_b64_tr_b16 v[24:25], v5 offset:8192
    ds_read_b64_tr_b16 v[26:27], v5 offset:10240
    v_mfma_f32_16x16x32_bf16 v[172:175], v[36:39], a[12:15], v[172:175]
    s_add_u32 m0, s63, 0x12000
    v_add_u32 v10, v10, v52
    v_add_u32 v11, v11, v52
    v_mfma_f32_16x16x32_bf16 v[172:175], v[32:35], a[28:31], v[172:175]
    s_nop 0
    ds_read_b64_tr_b16 v[28:29], v5 offset:12288
    ds_read_b64_tr_b16 v[30:31], v5 offset:14336
    v_exp_f32 v59, v59
    v_mfma_f32_16x16x32_bf16 v[176:179], v[40:43], a[16:19], v[176:179]
    buffer_load_dwordx4 v49, s[16:19], s54 offen lds
    v_add_f32 v56, 1.0, v56
    v_mfma_f32_16x16x32_bf16 v[176:179], v[44:47], a[0:3], v[176:179]
    s_mov_b32 s55, 0x19fc00
    v_add_f32 v57, 1.0, v57
    v_add_f32 v58, 1.0, v58
    v_add_f32 v59, 1.0, v59
    v_mfma_f32_16x16x32_bf16 v[180:183], v[44:47], a[4:7], v[180:183]
    v_rcp_f32 v56, v56
    v_mfma_f32_16x16x32_bf16 v[180:183], v[40:43], a[20:23], v[180:183]
    buffer_load_dwordx4 v49, s[16:19], s55 offen offset:1024 lds
    v_mfma_f32_16x16x32_bf16 v[184:187], v[40:43], a[24:27], v[184:187]
    s_mov_b32 s56, 0x187800
    v_rcp_f32 v57, v57
    v_mfma_f32_16x16x32_bf16 v[184:187], v[44:47], a[8:11], v[184:187]
    v_rcp_f32 v58, v58
    v_mfma_f32_16x16x32_bf16 v[188:191], v[44:47], a[12:15], v[188:191]
    buffer_load_dwordx4 v49, s[16:19], s56 offen offset:2048 lds
    v_mfma_f32_16x16x32_bf16 v[188:191], v[40:43], a[28:31], v[188:191]
    s_waitcnt lgkmcnt(0)
    v_rcp_f32 v59, v59
    v_mul_f32 v56, v56, v128
    v_mfma_f32_16x16x32_bf16 v[192:195], v[16:19], a[240:243], 0
    s_mov_b32 s57, 0x1a7400
    v_mul_f32 v57, v57, v129
    v_mul_f32 v58, v58, v130
    v_mul_f32 v59, v59, v131
    v_mfma_f32_16x16x32_bf16 v[192:195], v[20:23], a[224:227], v[192:195]
    s_nop 0
    ds_read_b64_tr_b16 v[32:33], v6 offset:8192
    ds_read_b64_tr_b16 v[34:35], v6 offset:10240
    v_cvt_pk_bf16_f32 v128, v56, v57
    v_mfma_f32_16x16x32_bf16 v[196:199], v[20:23], a[228:231], 0
    buffer_load_dwordx4 v49, s[16:19], s57 offen offset:3072 lds
    v_cvt_pk_bf16_f32 v129, v58, v59
    v_mfma_f32_16x16x32_bf16 v[196:199], v[16:19], a[244:247], v[196:199]
    s_mov_b32 s54, 0x1c0000
    ds_read_b64_tr_b16 v[36:37], v6 offset:12288
    ds_read_b64_tr_b16 v[38:39], v6 offset:14336
    v_mul_f32 v56, v144, v144
    v_mfma_f32_16x16x32_bf16 v[200:203], v[16:19], a[248:251], 0
    s_add_u32 m0, s63, 0x13000
    v_mul_f32 v57, v145, v145
    v_mul_f32 v58, v146, v146
    v_mul_f32 v59, v147, v147
    v_mfma_f32_16x16x32_bf16 v[200:203], v[20:23], a[232:235], v[200:203]
    s_nop 0
    ds_read_b64_tr_b16 v[40:41], v7 offset:8192
    ds_read_b64_tr_b16 v[42:43], v7 offset:10240
    v_fma_f32 v56, v56, s71, v51
    v_mfma_f32_16x16x32_bf16 v[204:207], v[20:23], a[236:239], 0
    buffer_load_dwordx4 v49, s[16:19], s54 offen lds
    v_fma_f32 v57, v57, s71, v51
    v_mfma_f32_16x16x32_bf16 v[204:207], v[16:19], a[252:255], v[204:207]
    s_mov_b32 s55, 0x1dfc00
    ds_read_b64_tr_b16 v[44:45], v7 offset:12288
    ds_read_b64_tr_b16 v[46:47], v7 offset:14336
    v_fma_f32 v58, v58, s71, v51
    v_fma_f32 v59, v59, s71, v51
    v_mfma_f32_16x16x32_bf16 v[208:211], v[24:27], a[240:243], 0
    v_mul_f32 v56, v56, v144
    v_mul_f32 v57, v57, v145
    v_mul_f32 v58, v58, v146
    v_mfma_f32_16x16x32_bf16 v[208:211], v[28:31], a[224:227], v[208:211]
    buffer_load_dwordx4 v49, s[16:19], s55 offen offset:1024 lds
    v_mul_f32 v59, v59, v147
    v_mfma_f32_16x16x32_bf16 v[212:215], v[28:31], a[228:231], 0
    s_mov_b32 s56, 0x1c7800
    v_exp_f32 v56, v56
    v_mfma_f32_16x16x32_bf16 v[212:215], v[24:27], a[244:247], v[212:215]
    v_exp_f32 v57, v57
    v_mfma_f32_16x16x32_bf16 v[216:219], v[24:27], a[248:251], 0
    buffer_load_dwordx4 v49, s[16:19], s56 offen offset:2048 lds
    v_mfma_f32_16x16x32_bf16 v[216:219], v[28:31], a[232:235], v[216:219]
    s_mov_b32 s57, 0x1e7400
    v_exp_f32 v58, v58
    v_mfma_f32_16x16x32_bf16 v[220:223], v[28:31], a[236:239], 0
    v_exp_f32 v59, v59
    v_add_f32 v56, 1.0, v56
    v_mfma_f32_16x16x32_bf16 v[220:223], v[24:27], a[252:255], v[220:223]
    s_waitcnt vmcnt(15) lgkmcnt(0)
    v_add_f32 v57, 1.0, v57
    v_add_f32 v58, 1.0, v58
    v_add_f32 v59, 1.0, v59
    v_mfma_f32_16x16x32_bf16 v[224:227], v[32:35], a[240:243], 0
    buffer_load_dwordx4 v49, s[16:19], s57 offen offset:3072 lds
    v_mfma_f32_16x16x32_bf16 v[224:227], v[36:39], a[224:227], v[224:227]
    s_mov_b32 s54, 0x200000
    ds_read_b64_tr_b16 v[16:17], v8 offset:0
    ds_read_b64_tr_b16 v[18:19], v8 offset:2048
    v_mfma_f32_16x16x32_bf16 v[228:231], v[36:39], a[228:231], 0
    s_add_u32 m0, s63, 0x2000
    v_rcp_f32 v56, v56
    v_mfma_f32_16x16x32_bf16 v[228:231], v[32:35], a[244:247], v[228:231]
    s_nop 0
    ds_read_b64_tr_b16 v[20:21], v8 offset:4096
    ds_read_b64_tr_b16 v[22:23], v8 offset:6144
    v_mfma_f32_16x16x32_bf16 v[232:235], v[32:35], a[248:251], 0
    buffer_load_dwordx4 v49, s[16:19], s54 offen lds
    v_mfma_f32_16x16x32_bf16 v[232:235], v[36:39], a[232:235], v[232:235]
    s_mov_b32 s55, 0x21fc00
    ds_read_b64_tr_b16 v[24:25], v9 offset:0
    ds_read_b64_tr_b16 v[26:27], v9 offset:2048
    v_mfma_f32_16x16x32_bf16 v[236:239], v[36:39], a[236:239], 0
    v_rcp_f32 v57, v57
    v_mfma_f32_16x16x32_bf16 v[236:239], v[32:35], a[252:255], v[236:239]
    ds_read_b64_tr_b16 v[28:29], v9 offset:4096
    ds_read_b64_tr_b16 v[30:31], v9 offset:6144
    v_rcp_f32 v58, v58
    v_mfma_f32_16x16x32_bf16 v[240:243], v[40:43], a[240:243], 0
    buffer_load_dwordx4 v49, s[16:19], s55 offen offset:1024 lds
    v_mfma_f32_16x16x32_bf16 v[240:243], v[44:47], a[224:227], v[240:243]
    s_mov_b32 s56, 0x207800
    v_rcp_f32 v59, v59
    v_mul_f32 v56, v56, v144
    v_mfma_f32_16x16x32_bf16 v[244:247], v[44:47], a[228:231], 0
    buffer_load_dwordx4 v49, s[16:19], s56 offen offset:2048 lds
    v_mul_f32 v57, v57, v145
    v_mfma_f32_16x16x32_bf16 v[244:247], v[40:43], a[244:247], v[244:247]
    s_mov_b32 s57, 0x227400
    v_mul_f32 v58, v58, v146
    v_mul_f32 v59, v59, v147
    v_cvt_pk_bf16_f32 v130, v56, v57
    v_mfma_f32_16x16x32_bf16 v[248:251], v[40:43], a[248:251], 0
    v_cvt_pk_bf16_f32 v131, v58, v59
    v_mul_f32 v56, v132, v132
    v_mul_f32 v57, v133, v133
    v_mfma_f32_16x16x32_bf16 v[248:251], v[44:47], a[232:235], v[248:251]
    v_mul_f32 v58, v134, v134
    v_mul_f32 v59, v135, v135
    v_fma_f32 v56, v56, s71, v51
    v_mfma_f32_16x16x32_bf16 v[252:255], v[44:47], a[236:239], 0
    buffer_load_dwordx4 v49, s[16:19], s57 offen offset:3072 lds
    v_fma_f32 v57, v57, s71, v51
    v_mfma_f32_16x16x32_bf16 v[252:255], v[40:43], a[252:255], v[252:255]
    s_waitcnt lgkmcnt(0)
    v_fma_f32 v58, v58, s71, v51
    v_fma_f32 v59, v59, s71, v51
    v_mul_f32 v56, v56, v132
    v_mfma_f32_16x16x32_bf16 v[192:195], v[16:19], a[208:211], v[192:195]
    s_mov_b32 s54, 0x240000
    s_add_u32 m0, s63, 0x3000
    v_mul_f32 v57, v57, v133
    v_mul_f32 v58, v58, v134
    v_mfma_f32_16x16x32_bf16 v[192:195], v[20:23], a[192:195], v[192:195]
    s_nop 0
    ds_read_b64_tr_b16 v[32:33], v10 offset:0
    ds_read_b64_tr_b16 v[34:35], v10 offset:2048
    v_mul_f32 v59, v59, v135
    v_mfma_f32_16x16x32_bf16 v[196:199], v[20:23], a[196:199], v[196:199]
L_PAD0:
    s_cbranch_execz L_PAD4
    buffer_load_dwordx4 v49, s[16:19], s54 offen lds
    v_mfma_f32_16x16x32_bf16 v[196:199], v[16:19], a[212:215], v[196:199]
    s_mov_b32 s55, 0x25fc00
    ds_read_b64_tr_b16 v[36:37], v10 offset:4096
    ds_read_b64_tr_b16 v[38:39], v10 offset:6144
    v_mfma_f32_16x16x32_bf16 v[200:203], v[16:19], a[216:219], v[200:203]
    v_exp_f32 v56, v56
    v_mfma_f32_16x16x32_bf16 v[200:203], v[20:23], a[200:203], v[200:203]
    ds_read_b64_tr_b16 v[40:41], v11 offset:0
    ds_read_b64_tr_b16 v[42:43], v11 offset:2048
    v_mfma_f32_16x16x32_bf16 v[204:207], v[20:23], a[204:207], v[204:207]
    buffer_load_dwordx4 v49, s[16:19], s55 offen offset:1024 lds
    v_mfma_f32_16x16x32_bf16 v[204:207], v[16:19], a[220:223], v[204:207]
    s_mov_b32 s56, 0x247800
    ds_read_b64_tr_b16 v[44:45], v11 offset:4096
    ds_read_b64_tr_b16 v[46:47], v11 offset:6144
    v_exp_f32 v57, v57
    v_mfma_f32_16x16x32_bf16 v[208:211], v[24:27], a[208:211], v[208:211]
    buffer_load_dwordx4 v49, s[16:19], s56 offen offset:2048 lds
    v_mfma_f32_16x16x32_bf16 v[208:211], v[28:31], a[192:195], v[208:211]
    s_mov_b32 s57, 0x267400
    v_exp_f32 v58, v58
    v_mfma_f32_16x16x32_bf16 v[212:215], v[28:31], a[196:199], v[212:215]
    v_exp_f32 v59, v59
    v_add_f32 v56, 1.0, v56
    v_mfma_f32_16x16x32_bf16 v[212:215], v[24:27], a[212:215], v[212:215]
    v_add_f32 v57, 1.0, v57
    v_add_f32 v58, 1.0, v58
    v_add_f32 v59, 1.0, v59
    v_mfma_f32_16x16x32_bf16 v[216:219], v[24:27], a[216:219], v[216:219]
    buffer_load_dwordx4 v49, s[16:19], s57 offen offset:3072 lds
    v_mfma_f32_16x16x32_bf16 v[216:219], v[28:31], a[200:203], v[216:219]
    s_mov_b32 s54, 0x280000
    v_rcp_f32 v56, v56
    v_mfma_f32_16x16x32_bf16 v[220:223], v[28:31], a[204:207], v[220:223]
    s_add_u32 m0, s63, 0x10000
    v_rcp_f32 v57, v57
    v_mfma_f32_16x16x32_bf16 v[220:223], v[24:27], a[220:223], v[220:223]
    s_waitcnt vmcnt(16) lgkmcnt(0)
    v_rcp_f32 v58, v58
    v_mfma_f32_16x16x32_bf16 v[224:227], v[32:35], a[208:211], v[224:227]
    buffer_load_dwordx4 v49, s[16:19], s54 offen lds
    v_mfma_f32_16x16x32_bf16 v[224:227], v[36:39], a[192:195], v[224:227]
    s_mov_b32 s55, 0x29fc00
    ds_read_b64_tr_b16 v[16:17], v4 offset:0
    ds_read_b64_tr_b16 v[18:19], v4 offset:2048
    v_mfma_f32_16x16x32_bf16 v[228:231], v[36:39], a[196:199], v[228:231]
    v_rcp_f32 v59, v59
    v_mul_f32 v56, v56, v132
    v_mfma_f32_16x16x32_bf16 v[228:231], v[32:35], a[212:215], v[228:231]
    ds_read_b64_tr_b16 v[20:21], v4 offset:4096
    ds_read_b64_tr_b16 v[22:23], v4 offset:6144
    v_mul_f32 v57, v57, v133
    v_mfma_f32_16x16x32_bf16 v[232:235], v[32:35], a[216:219], v[232:235]
    buffer_load_dwordx4 v49, s[16:19], s55 offen offset:1024 lds
    v_mul_f32 v58, v58, v134
    v_mfma_f32_16x16x32_bf16 v[232:235], v[36:39], a[200:203], v[232:235]
    s_mov_b32 s56, 0x287800
    ds_read_b64_tr_b16 v[24:25], v5 offset:0
    ds_read_b64_tr_b16 v[26:27], v5 offset:2048
    v_mul_f32 v59, v59, v135
    v_mfma_f32_16x16x32_bf16 v[236:239], v[36:39], a[204:207], v[236:239]
    v_cvt_pk_bf16_f32 v132, v56, v57
    v_cvt_pk_bf16_f32 v133, v58, v59
    v_mul_f32 v56, v148, v148
    v_mfma_f32_16x16x32_bf16 v[236:239], v[32:35], a[220:223], v[236:239]
    ds_read_b64_tr_b16 v[28:29], v5 offset:4096
    ds_read_b64_tr_b16 v[30:31], v5 offset:6144
    v_mul_f32 v57, v149, v149
    v_mul_f32 v58, v150, v150
    v_mfma_f32_16x16x32_bf16 v[240:243], v[40:43], a[208:211], v[240:243]
    buffer_load_dwordx4 v49, s[16:19], s56 offen offset:2048 lds
    v_mul_f32 v59, v151, v151
    v_mfma_f32_16x16x32_bf16 v[240:243], v[44:47], a[192:195], v[240:243]
    s_mov_b32 s57, 0x2a7400
    v_fma_f32 v56, v56, s71, v51
    v_fma_f32 v57, v57, s71, v51
    v_fma_f32 v58, v58, s71, v51
    v_mfma_f32_16x16x32_bf16 v[244:247], v[44:47], a[196:199], v[244:247]
    v_fma_f32 v59, v59, s71, v51
    v_mul_f32 v56, v56, v148
    v_mul_f32 v57, v57, v149
    v_mfma_f32_16x16x32_bf16 v[244:247], v[40:43], a[212:215], v[244:247]
    v_mul_f32 v58, v58, v150
    v_mul_f32 v59, v59, v151
    v_mfma_f32_16x16x32_bf16 v[248:251], v[40:43], a[216:219], v[248:251]
    buffer_load_dwordx4 v49, s[16:19], s57 offen offset:3072 lds
    v_mfma_f32_16x16x32_bf16 v[248:251], v[44:47], a[200:203], v[248:251]
    s_mov_b32 s54, 0x2c0000
    v_exp_f32 v56, v56
    v_mfma_f32_16x16x32_bf16 v[252:255], v[44:47], a[204:207], v[252:255]
    s_add_u32 m0, s63, 0x11000
    v_exp_f32 v57, v57
    v_mfma_f32_16x16x32_bf16 v[252:255], v[40:43], a[220:223], v[252:255]
    s_waitcnt lgkmcnt(0)
    v_exp_f32 v58, v58
    v_mfma_f32_16x16x32_bf16 v[192:195], v[16:19], a[176:179], v[192:195]
    buffer_load_dwordx4 v49, s[16:19], s54 offen lds
    v_mfma_f32_16x16x32_bf16 v[192:195], v[20:23], a[160:163], v[192:195]
    s_mov_b32 s55, 0x2dfc00
    ds_read_b64_tr_b16 v[32:33], v6 offset:0
    ds_read_b64_tr_b16 v[34:35], v6 offset:2048
    v_mfma_f32_16x16x32_bf16 v[196:199], v[20:23], a[164:167], v[196:199]
    v_exp_f32 v59, v59
    v_add_f32 v56, 1.0, v56
    v_mfma_f32_16x16x32_bf16 v[196:199], v[16:19], a[180:183], v[196:199]
    ds_read_b64_tr_b16 v[36:37], v6 offset:4096
    ds_read_b64_tr_b16 v[38:39], v6 offset:6144
    v_add_f32 v57, 1.0, v57
    v_mfma_f32_16x16x32_bf16 v[200:203], v[16:19], a[184:187], v[200:203]
    buffer_load_dwordx4 v49, s[16:19], s55 offen offset:1024 lds
    v_add_f32 v58, 1.0, v58
    v_mfma_f32_16x16x32_bf16 v[200:203], v[20:23], a[168:171], v[200:203]
    s_mov_b32 s56, 0x2c7800
    ds_read_b64_tr_b16 v[40:41], v7 offset:0
    ds_read_b64_tr_b16 v[42:43], v7 offset:2048
    v_add_f32 v59, 1.0, v59
    v_mfma_f32_16x16x32_bf16 v[204:207], v[20:23], a[172:175], v[204:207]
    v_rcp_f32 v56, v56
    v_mfma_f32_16x16x32_bf16 v[204:207], v[16:19], a[188:191], v[204:207]
    ds_read_b64_tr_b16 v[44:45], v7 offset:4096
    ds_read_b64_tr_b16 v[46:47], v7 offset:6144
    v_rcp_f32 v57, v57
    v_mfma_f32_16x16x32_bf16 v[208:211], v[24:27], a[176:179], v[208:211]
    buffer_load_dwordx4 v49, s[16:19], s56 offen offset:2048 lds
    v_mfma_f32_16x16x32_bf16 v[208:211], v[28:31], a[160:163], v[208:211]
    s_mov_b32 s57, 0x2e7400
    v_rcp_f32 v58, v58
    v_mfma_f32_16x16x32_bf16 v[212:215], v[28:31], a[164:167], v[212:215]
    v_rcp_f32 v59, v59
    v_mul_f32 v56, v56, v148
    v_mfma_f32_16x16x32_bf16 v[212:215], v[24:27], a[180:183], v[212:215]
    v_mul_f32 v57, v57, v149
    v_mul_f32 v58, v58, v150
    v_mul_f32 v59, v59, v151
    v_mfma_f32_16x16x32_bf16 v[216:219], v[24:27], a[184:187], v[216:219]
    buffer_load_dwordx4 v49, s[16:19], s57 offen offset:3072 lds
    v_cvt_pk_bf16_f32 v134, v56, v57
    v_mfma_f32_16x16x32_bf16 v[216:219], v[28:31], a[168:171], v[216:219]
    s_mov_b32 s54, 0x300000
    v_cvt_pk_bf16_f32 v135, v58, v59
    v_mul_f32 v56, v136, v136
    v_mul_f32 v57, v137, v137
    v_mfma_f32_16x16x32_bf16 v[220:223], v[28:31], a[172:175], v[220:223]
    s_add_u32 m0, s63, 0x0
    v_mul_f32 v58, v138, v138
    v_mul_f32 v59, v139, v139
    v_fma_f32 v56, v56, s71, v51
    v_mfma_f32_16x16x32_bf16 v[220:223], v[24:27], a[188:191], v[220:223]
    s_waitcnt vmcnt(16) lgkmcnt(0)
    v_fma_f32 v57, v57, s71, v51
    v_fma_f32 v58, v58, s71, v51
    v_fma_f32 v59, v59, s71, v51
    v_mfma_f32_16x16x32_bf16 v[224:227], v[32:35], a[176:179], v[224:227]
    buffer_load_dwordx4 v49, s[16:19], s54 offen lds
    v_mul_f32 v56, v56, v136
    v_mfma_f32_16x16x32_bf16 v[224:227], v[36:39], a[160:163], v[224:227]
    s_mov_b32 s55, 0x31fc00
    ds_read_b64_tr_b16 v[16:17], v8 offset:8192
    ds_read_b64_tr_b16 v[18:19], v8 offset:10240
    v_mul_f32 v57, v57, v137
    v_mfma_f32_16x16x32_bf16 v[228:231], v[36:39], a[164:167], v[228:231]
    v_mul_f32 v58, v58, v138
    v_mul_f32 v59, v59, v139
    v_mfma_f32_16x16x32_bf16 v[228:231], v[32:35], a[180:183], v[228:231]
    ds_read_b64_tr_b16 v[20:21], v8 offset:12288
    ds_read_b64_tr_b16 v[22:23], v8 offset:14336
    v_mfma_f32_16x16x32_bf16 v[232:235], v[32:35], a[184:187], v[232:235]
    buffer_load_dwordx4 v49, s[16:19], s55 offen offset:1024 lds
    v_mfma_f32_16x16x32_bf16 v[232:235], v[36:39], a[168:171], v[232:235]
    s_mov_b32 s56, 0x307800
    ds_read_b64_tr_b16 v[24:25], v9 offset:8192
    ds_read_b64_tr_b16 v[26:27], v9 offset:10240
    v_mfma_f32_16x16x32_bf16 v[236:239], v[36:39], a[172:175], v[236:239]
    v_exp_f32 v56, v56
    v_mfma_f32_16x16x32_bf16 v[236:239], v[32:35], a[188:191], v[236:239]
    ds_read_b64_tr_b16 v[28:29], v9 offset:12288
    ds_read_b64_tr_b16 v[30:31], v9 offset:14336
    v_mfma_f32_16x16x32_bf16 v[240:243], v[40:43], a[176:179], v[240:243]
    buffer_load_dwordx4 v49, s[16:19], s56 offen offset:2048 lds
    v_exp_f32 v57, v57
    v_mfma_f32_16x16x32_bf16 v[240:243], v[44:47], a[160:163], v[240:243]
    s_mov_b32 s57, 0x327400
    v_exp_f32 v58, v58
    v_mfma_f32_16x16x32_bf16 v[244:247], v[44:47], a[164:167], v[244:247]
    v_exp_f32 v59, v59
    v_add_f32 v56, 1.0, v56
    v_mfma_f32_16x16x32_bf16 v[244:247], v[40:43], a[180:183], v[244:247]
    v_add_f32 v57, 1.0, v57
    v_add_f32 v58, 1.0, v58
    v_add_f32 v59, 1.0, v59
    v_mfma_f32_16x16x32_bf16 v[248:251], v[40:43], a[184:187], v[248:251]
    buffer_load_dwordx4 v49, s[16:19], s57 offen offset:3072 lds
    v_mfma_f32_16x16x32_bf16 v[248:251], v[44:47], a[168:171], v[248:251]
    s_mov_b32 s54, 0x340000
    v_rcp_f32 v56, v56
    v_mfma_f32_16x16x32_bf16 v[252:255], v[44:47], a[172:175], v[252:255]
    s_add_u32 m0, s63, 0x1000
    v_rcp_f32 v57, v57
    v_mfma_f32_16x16x32_bf16 v[252:255], v[40:43], a[188:191], v[252:255]
    s_waitcnt lgkmcnt(0)
    v_rcp_f32 v58, v58
    v_mfma_f32_16x16x32_bf16 v[192:195], v[16:19], a[144:147], v[192:195]
    buffer_load_dwordx4 v49, s[16:19], s54 offen lds
    v_mfma_f32_16x16x32_bf16 v[192:195], v[20:23], a[128:131], v[192:195]
    s_mov_b32 s55, 0x35fc00
    ds_read_b64_tr_b16 v[32:33], v10 offset:8192
    ds_read_b64_tr_b16 v[34:35], v10 offset:10240
    v_mfma_f32_16x16x32_bf16 v[196:199], v[20:23], a[132:135], v[196:199]
    v_rcp_f32 v59, v59
    v_mul_f32 v56, v56, v136
    v_mfma_f32_16x16x32_bf16 v[196:199], v[16:19], a[148:151], v[196:199]
    ds_read_b64_tr_b16 v[36:37], v10 offset:12288
    ds_read_b64_tr_b16 v[38:39], v10 offset:14336
    v_mul_f32 v57, v57, v137
    v_mfma_f32_16x16x32_bf16 v[200:203], v[16:19], a[152:155], v[200:203]
    buffer_load_dwordx4 v49, s[16:19], s55 offen offset:1024 lds
    v_mul_f32 v58, v58, v138
    v_mfma_f32_16x16x32_bf16 v[200:203], v[20:23], a[136:139], v[200:203]
    s_mov_b32 s56, 0x347800
    ds_read_b64_tr_b16 v[40:41], v11 offset:8192
    ds_read_b64_tr_b16 v[42:43], v11 offset:10240
    v_mul_f32 v59, v59, v139
    v_mfma_f32_16x16x32_bf16 v[204:207], v[20:23], a[140:143], v[204:207]
    v_cvt_pk_bf16_f32 v136, v56, v57
    v_cvt_pk_bf16_f32 v137, v58, v59
    v_mul_f32 v56, v152, v152
    v_mfma_f32_16x16x32_bf16 v[204:207], v[16:19], a[156:159], v[204:207]
    ds_read_b64_tr_b16 v[44:45], v11 offset:12288
    ds_read_b64_tr_b16 v[46:47], v11 offset:14336
    v_mul_f32 v57, v153, v153
    v_mfma_f32_16x16x32_bf16 v[208:211], v[24:27], a[144:147], v[208:211]
    buffer_load_dwordx4 v49, s[16:19], s56 offen offset:2048 lds
    v_mul_f32 v58, v154, v154
    v_mul_f32 v59, v155, v155
    v_mfma_f32_16x16x32_bf16 v[208:211], v[28:31], a[128:131], v[208:211]
    s_mov_b32 s57, 0x367400
    v_fma_f32 v56, v56, s71, v51
    v_fma_f32 v57, v57, s71, v51
    v_fma_f32 v58, v58, s71, v51
    v_mfma_f32_16x16x32_bf16 v[212:215], v[28:31], a[132:135], v[212:215]
    v_fma_f32 v59, v59, s71, v51
    v_mul_f32 v56, v56, v152
    v_mul_f32 v57, v57, v153
    v_mfma_f32_16x16x32_bf16 v[212:215], v[24:27], a[148:151], v[212:215]
    v_mul_f32 v58, v58, v154
    v_mul_f32 v59, v59, v155
    v_mfma_f32_16x16x32_bf16 v[216:219], v[24:27], a[152:155], v[216:219]
    buffer_load_dwordx4 v49, s[16:19], s57 offen offset:3072 lds
    v_mfma_f32_16x16x32_bf16 v[216:219], v[28:31], a[136:139], v[216:219]
    s_mov_b32 s54, 0x380000
    v_exp_f32 v56, v56
    v_mfma_f32_16x16x32_bf16 v[220:223], v[28:31], a[140:143], v[220:223]
    s_add_u32 m0, s63, 0x12000
    v_exp_f32 v57, v57
    v_mfma_f32_16x16x32_bf16 v[220:223], v[24:27], a[156:159], v[220:223]
    s_waitcnt vmcnt(16) lgkmcnt(0)
    v_exp_f32 v58, v58
    v_mfma_f32_16x16x32_bf16 v[224:227], v[32:35], a[144:147], v[224:227]
    buffer_load_dwordx4 v49, s[16:19], s54 offen lds
    v_mfma_f32_16x16x32_bf16 v[224:227], v[36:39], a[128:131], v[224:227]
    s_mov_b32 s55, 0x39fc00
    ds_read_b64_tr_b16 v[16:17], v4 offset:8192
    ds_read_b64_tr_b16 v[18:19], v4 offset:10240
    v_mfma_f32_16x16x32_bf16 v[228:231], v[36:39], a[132:135], v[228:231]
    v_exp_f32 v59, v59
    v_add_f32 v56, 1.0, v56
    v_mfma_f32_16x16x32_bf16 v[228:231], v[32:35], a[148:151], v[228:231]
    ds_read_b64_tr_b16 v[20:21], v4 offset:12288
    ds_read_b64_tr_b16 v[22:23], v4 offset:14336
    v_add_f32 v57, 1.0, v57
    v_mfma_f32_16x16x32_bf16 v[232:235], v[32:35], a[152:155], v[232:235]
    buffer_load_dwordx4 v49, s[16:19], s55 offen offset:1024 lds
    v_add_f32 v58, 1.0, v58
    v_mfma_f32_16x16x32_bf16 v[232:235], v[36:39], a[136:139], v[232:235]
    s_mov_b32 s56, 0x387800
    ds_read_b64_tr_b16 v[24:25], v5 offset:8192
    ds_read_b64_tr_b16 v[26:27], v5 offset:10240
    v_add_f32 v59, 1.0, v59
    v_mfma_f32_16x16x32_bf16 v[236:239], v[36:39], a[140:143], v[236:239]
    v_rcp_f32 v56, v56
    v_mfma_f32_16x16x32_bf16 v[236:239], v[32:35], a[156:159], v[236:239]
    ds_read_b64_tr_b16 v[28:29], v5 offset:12288
    ds_read_b64_tr_b16 v[30:31], v5 offset:14336
    v_mfma_f32_16x16x32_bf16 v[240:243], v[40:43], a[144:147], v[240:243]
    buffer_load_dwordx4 v49, s[16:19], s56 offen offset:2048 lds
    v_rcp_f32 v57, v57
    v_mfma_f32_16x16x32_bf16 v[240:243], v[44:47], a[128:131], v[240:243]
    s_mov_b32 s57, 0x3a7400
    v_rcp_f32 v58, v58
    v_mfma_f32_16x16x32_bf16 v[244:247], v[44:47], a[132:135], v[244:247]
    v_rcp_f32 v59, v59
    v_mul_f32 v56, v56, v152
    v_mfma_f32_16x16x32_bf16 v[244:247], v[40:43], a[148:151], v[244:247]
    v_mul_f32 v57, v57, v153
    v_mul_f32 v58, v58, v154
    v_mul_f32 v59, v59, v155
    v_mfma_f32_16x16x32_bf16 v[248:251], v[40:43], a[152:155], v[248:251]
    buffer_load_dwordx4 v49, s[16:19], s57 offen offset:3072 lds
    v_cvt_pk_bf16_f32 v138, v56, v57
    v_mfma_f32_16x16x32_bf16 v[248:251], v[44:47], a[136:139], v[248:251]
    s_mov_b32 s54, 0x3c0000
    v_cvt_pk_bf16_f32 v139, v58, v59
    v_mul_f32 v56, v140, v140
    v_mul_f32 v57, v141, v141
    v_mfma_f32_16x16x32_bf16 v[252:255], v[44:47], a[140:143], v[252:255]
    s_add_u32 m0, s63, 0x13000
    v_mul_f32 v58, v142, v142
    v_mul_f32 v59, v143, v143
    v_fma_f32 v56, v56, s71, v51
    v_mfma_f32_16x16x32_bf16 v[252:255], v[40:43], a[156:159], v[252:255]
    s_waitcnt lgkmcnt(0)
    v_fma_f32 v57, v57, s71, v51
    v_fma_f32 v58, v58, s71, v51
    v_fma_f32 v59, v59, s71, v51
    v_mfma_f32_16x16x32_bf16 v[192:195], v[16:19], a[112:115], v[192:195]
    buffer_load_dwordx4 v49, s[16:19], s54 offen lds
    v_mul_f32 v56, v56, v140
    v_mfma_f32_16x16x32_bf16 v[192:195], v[20:23], a[96:99], v[192:195]
    s_mov_b32 s55, 0x3dfc00
    ds_read_b64_tr_b16 v[32:33], v6 offset:8192
    ds_read_b64_tr_b16 v[34:35], v6 offset:10240
    v_mul_f32 v57, v57, v141
    v_mfma_f32_16x16x32_bf16 v[196:199], v[20:23], a[100:103], v[196:199]
    v_mul_f32 v58, v58, v142
    v_mul_f32 v59, v59, v143
    v_mfma_f32_16x16x32_bf16 v[196:199], v[16:19], a[116:119], v[196:199]
    ds_read_b64_tr_b16 v[36:37], v6 offset:12288
    ds_read_b64_tr_b16 v[38:39], v6 offset:14336
    v_mfma_f32_16x16x32_bf16 v[200:203], v[16:19], a[120:123], v[200:203]
    buffer_load_dwordx4 v49, s[16:19], s55 offen offset:1024 lds
    v_mfma_f32_16x16x32_bf16 v[200:203], v[20:23], a[104:107], v[200:203]
    s_mov_b32 s56, 0x3c7800
    ds_read_b64_tr_b16 v[40:41], v7 offset:8192
    ds_read_b64_tr_b16 v[42:43], v7 offset:10240
    v_mfma_f32_16x16x32_bf16 v[204:207], v[20:23], a[108:111], v[204:207]
    v_exp_f32 v56, v56
    v_mfma_f32_16x16x32_bf16 v[204:207], v[16:19], a[124:127], v[204:207]
    ds_read_b64_tr_b16 v[44:45], v7 offset:12288
    ds_read_b64_tr_b16 v[46:47], v7 offset:14336
    v_mfma_f32_16x16x32_bf16 v[208:211], v[24:27], a[112:115], v[208:211]
    buffer_load_dwordx4 v49, s[16:19], s56 offen offset:2048 lds
    v_exp_f32 v57, v57
    v_mfma_f32_16x16x32_bf16 v[208:211], v[28:31], a[96:99], v[208:211]
    s_mov_b32 s57, 0x3e7400
    v_exp_f32 v58, v58
    v_mfma_f32_16x16x32_bf16 v[212:215], v[28:31], a[100:103], v[212:215]
    v_exp_f32 v59, v59
    v_add_f32 v56, 1.0, v56
    v_mfma_f32_16x16x32_bf16 v[212:215], v[24:27], a[116:119], v[212:215]
    v_add_f32 v57, 1.0, v57
    v_add_f32 v58, 1.0, v58
    v_add_f32 v59, 1.0, v59
    v_mfma_f32_16x16x32_bf16 v[216:219], v[24:27], a[120:123], v[216:219]
    buffer_load_dwordx4 v49, s[16:19], s57 offen offset:3072 lds
    v_mfma_f32_16x16x32_bf16 v[216:219], v[28:31], a[104:107], v[216:219]
    s_mov_b32 s54, 0x80
    v_rcp_f32 v56, v56
    v_mfma_f32_16x16x32_bf16 v[220:223], v[28:31], a[108:111], v[220:223]
    s_add_u32 m0, s63, 0x2000
    v_rcp_f32 v57, v57
    v_mfma_f32_16x16x32_bf16 v[220:223], v[24:27], a[124:127], v[220:223]
    s_waitcnt vmcnt(16) lgkmcnt(0)
    v_rcp_f32 v58, v58
    v_mfma_f32_16x16x32_bf16 v[224:227], v[32:35], a[112:115], v[224:227]
    buffer_load_dwordx4 v49, s[16:19], s54 offen lds
    v_mfma_f32_16x16x32_bf16 v[224:227], v[36:39], a[96:99], v[224:227]
    s_mov_b32 s55, 0x1fc80
    ds_read_b64_tr_b16 v[16:17], v8 offset:0
    ds_read_b64_tr_b16 v[18:19], v8 offset:2048
    v_mfma_f32_16x16x32_bf16 v[228:231], v[36:39], a[100:103], v[228:231]
    v_rcp_f32 v59, v59
    v_mul_f32 v56, v56, v140
    v_mfma_f32_16x16x32_bf16 v[228:231], v[32:35], a[116:119], v[228:231]
    ds_read_b64_tr_b16 v[20:21], v8 offset:4096
    ds_read_b64_tr_b16 v[22:23], v8 offset:6144
    v_mul_f32 v57, v57, v141
    v_mfma_f32_16x16x32_bf16 v[232:235], v[32:35], a[120:123], v[232:235]
    buffer_load_dwordx4 v49, s[16:19], s55 offen offset:1024 lds
    v_mul_f32 v58, v58, v142
    v_mfma_f32_16x16x32_bf16 v[232:235], v[36:39], a[104:107], v[232:235]
    s_mov_b32 s56, 0x7880
    ds_read_b64_tr_b16 v[24:25], v9 offset:0
    ds_read_b64_tr_b16 v[26:27], v9 offset:2048
    v_mul_f32 v59, v59, v143
    v_mfma_f32_16x16x32_bf16 v[236:239], v[36:39], a[108:111], v[236:239]
    v_cvt_pk_bf16_f32 v140, v56, v57
    v_cvt_pk_bf16_f32 v141, v58, v59
    v_mul_f32 v56, v156, v156
    v_mfma_f32_16x16x32_bf16 v[236:239], v[32:35], a[124:127], v[236:239]
    ds_read_b64_tr_b16 v[28:29], v9 offset:4096
    ds_read_b64_tr_b16 v[30:31], v9 offset:6144
    v_mul_f32 v57, v157, v157
    v_mfma_f32_16x16x32_bf16 v[240:243], v[40:43], a[112:115], v[240:243]
    buffer_load_dwordx4 v49, s[16:19], s56 offen offset:2048 lds
    v_mul_f32 v58, v158, v158
    v_mul_f32 v59, v159, v159
    v_mfma_f32_16x16x32_bf16 v[240:243], v[44:47], a[96:99], v[240:243]
    s_mov_b32 s57, 0x27480
    v_fma_f32 v56, v56, s71, v51
    v_fma_f32 v57, v57, s71, v51
    v_fma_f32 v58, v58, s71, v51
    v_mfma_f32_16x16x32_bf16 v[244:247], v[44:47], a[100:103], v[244:247]
    v_fma_f32 v59, v59, s71, v51
    v_mul_f32 v56, v56, v156
    v_mul_f32 v57, v57, v157
    v_mfma_f32_16x16x32_bf16 v[244:247], v[40:43], a[116:119], v[244:247]
    v_mul_f32 v58, v58, v158
    v_mul_f32 v59, v59, v159
    v_mfma_f32_16x16x32_bf16 v[248:251], v[40:43], a[120:123], v[248:251]
    buffer_load_dwordx4 v49, s[16:19], s57 offen offset:3072 lds
    v_mfma_f32_16x16x32_bf16 v[248:251], v[44:47], a[104:107], v[248:251]
    s_mov_b32 s54, 0x40080
    v_exp_f32 v56, v56
    v_mfma_f32_16x16x32_bf16 v[252:255], v[44:47], a[108:111], v[252:255]
    s_add_u32 m0, s63, 0x3000
    v_exp_f32 v57, v57
    v_mfma_f32_16x16x32_bf16 v[252:255], v[40:43], a[124:127], v[252:255]
    s_waitcnt lgkmcnt(0)
    v_exp_f32 v58, v58
    v_mfma_f32_16x16x32_bf16 v[192:195], v[16:19], a[80:83], v[192:195]
    buffer_load_dwordx4 v49, s[16:19], s54 offen lds
    v_mfma_f32_16x16x32_bf16 v[192:195], v[20:23], a[64:67], v[192:195]
    s_mov_b32 s55, 0x5fc80
    ds_read_b64_tr_b16 v[32:33], v10 offset:0
    ds_read_b64_tr_b16 v[34:35], v10 offset:2048
    v_mfma_f32_16x16x32_bf16 v[196:199], v[20:23], a[68:71], v[196:199]
    v_exp_f32 v59, v59
    v_add_f32 v56, 1.0, v56
    v_mfma_f32_16x16x32_bf16 v[196:199], v[16:19], a[84:87], v[196:199]
    ds_read_b64_tr_b16 v[36:37], v10 offset:4096
    ds_read_b64_tr_b16 v[38:39], v10 offset:6144
    v_add_f32 v57, 1.0, v57
    v_mfma_f32_16x16x32_bf16 v[200:203], v[16:19], a[88:91], v[200:203]
    buffer_load_dwordx4 v49, s[16:19], s55 offen offset:1024 lds
    v_add_f32 v58, 1.0, v58
    v_mfma_f32_16x16x32_bf16 v[200:203], v[20:23], a[72:75], v[200:203]
    s_mov_b32 s56, 0x47880
    ds_read_b64_tr_b16 v[40:41], v11 offset:0
    ds_read_b64_tr_b16 v[42:43], v11 offset:2048
    v_add_f32 v59, 1.0, v59
    v_mfma_f32_16x16x32_bf16 v[204:207], v[20:23], a[76:79], v[204:207]
    v_rcp_f32 v56, v56
    v_mfma_f32_16x16x32_bf16 v[204:207], v[16:19], a[92:95], v[204:207]
    ds_read_b64_tr_b16 v[44:45], v11 offset:4096
    ds_read_b64_tr_b16 v[46:47], v11 offset:6144
    v_mfma_f32_16x16x32_bf16 v[208:211], v[24:27], a[80:83], v[208:211]
    buffer_load_dwordx4 v49, s[16:19], s56 offen offset:2048 lds
    v_rcp_f32 v57, v57
    v_mfma_f32_16x16x32_bf16 v[208:211], v[28:31], a[64:67], v[208:211]
    s_mov_b32 s57, 0x67480
    v_rcp_f32 v58, v58
    v_mfma_f32_16x16x32_bf16 v[212:215], v[28:31], a[68:71], v[212:215]
    v_rcp_f32 v59, v59
    v_mul_f32 v56, v56, v156
    v_mfma_f32_16x16x32_bf16 v[212:215], v[24:27], a[84:87], v[212:215]
    v_mul_f32 v57, v57, v157
    v_mul_f32 v58, v58, v158
    v_mul_f32 v59, v59, v159
    v_mfma_f32_16x16x32_bf16 v[216:219], v[24:27], a[88:91], v[216:219]
    buffer_load_dwordx4 v49, s[16:19], s57 offen offset:3072 lds
    v_cvt_pk_bf16_f32 v142, v56, v57
    v_mfma_f32_16x16x32_bf16 v[216:219], v[28:31], a[72:75], v[216:219]
    s_mov_b32 s54, 0x80080
    v_cvt_pk_bf16_f32 v143, v58, v59
    v_mul_f32 v56, v160, v160
    v_mul_f32 v57, v161, v161
    v_mfma_f32_16x16x32_bf16 v[220:223], v[28:31], a[76:79], v[220:223]
    s_add_u32 m0, s63, 0x10000
    v_mul_f32 v58, v162, v162
    v_mul_f32 v59, v163, v163
    v_fma_f32 v56, v56, s71, v51
    v_mfma_f32_16x16x32_bf16 v[220:223], v[24:27], a[92:95], v[220:223]
    s_waitcnt vmcnt(16) lgkmcnt(0)
    v_fma_f32 v57, v57, s71, v51
    v_fma_f32 v58, v58, s71, v51
    v_fma_f32 v59, v59, s71, v51
    v_mfma_f32_16x16x32_bf16 v[224:227], v[32:35], a[80:83], v[224:227]
    buffer_load_dwordx4 v49, s[16:19], s54 offen lds
    v_mul_f32 v56, v56, v160
    v_mfma_f32_16x16x32_bf16 v[224:227], v[36:39], a[64:67], v[224:227]
    s_mov_b32 s55, 0x9fc80
    ds_read_b64_tr_b16 v[16:17], v4 offset:0
    ds_read_b64_tr_b16 v[18:19], v4 offset:2048
    v_mul_f32 v57, v57, v161
    v_mfma_f32_16x16x32_bf16 v[228:231], v[36:39], a[68:71], v[228:231]
    v_mul_f32 v58, v58, v162
    v_mul_f32 v59, v59, v163
    v_mfma_f32_16x16x32_bf16 v[228:231], v[32:35], a[84:87], v[228:231]
    ds_read_b64_tr_b16 v[20:21], v4 offset:4096
    ds_read_b64_tr_b16 v[22:23], v4 offset:6144
    v_mfma_f32_16x16x32_bf16 v[232:235], v[32:35], a[88:91], v[232:235]
    buffer_load_dwordx4 v49, s[16:19], s55 offen offset:1024 lds
    v_mfma_f32_16x16x32_bf16 v[232:235], v[36:39], a[72:75], v[232:235]
    s_mov_b32 s56, 0x87880
    ds_read_b64_tr_b16 v[24:25], v5 offset:0
    ds_read_b64_tr_b16 v[26:27], v5 offset:2048
    v_mfma_f32_16x16x32_bf16 v[236:239], v[36:39], a[76:79], v[236:239]
    v_exp_f32 v56, v56
    v_mfma_f32_16x16x32_bf16 v[236:239], v[32:35], a[92:95], v[236:239]
    ds_read_b64_tr_b16 v[28:29], v5 offset:4096
    ds_read_b64_tr_b16 v[30:31], v5 offset:6144
    v_mfma_f32_16x16x32_bf16 v[240:243], v[40:43], a[80:83], v[240:243]
    buffer_load_dwordx4 v49, s[16:19], s56 offen offset:2048 lds
    v_exp_f32 v57, v57
    v_mfma_f32_16x16x32_bf16 v[240:243], v[44:47], a[64:67], v[240:243]
    s_mov_b32 s57, 0xa7480
    v_exp_f32 v58, v58
    v_mfma_f32_16x16x32_bf16 v[244:247], v[44:47], a[68:71], v[244:247]
    v_exp_f32 v59, v59
    v_add_f32 v56, 1.0, v56
    v_mfma_f32_16x16x32_bf16 v[244:247], v[40:43], a[84:87], v[244:247]
    v_add_f32 v57, 1.0, v57
    v_add_f32 v58, 1.0, v58
    v_add_f32 v59, 1.0, v59
    v_mfma_f32_16x16x32_bf16 v[248:251], v[40:43], a[88:91], v[248:251]
    buffer_load_dwordx4 v49, s[16:19], s57 offen offset:3072 lds
    v_mfma_f32_16x16x32_bf16 v[248:251], v[44:47], a[72:75], v[248:251]
    s_mov_b32 s54, 0xc0080
    v_rcp_f32 v56, v56
    v_mfma_f32_16x16x32_bf16 v[252:255], v[44:47], a[76:79], v[252:255]
    s_add_u32 m0, s63, 0x11000
    v_rcp_f32 v57, v57
    v_mfma_f32_16x16x32_bf16 v[252:255], v[40:43], a[92:95], v[252:255]
    s_waitcnt lgkmcnt(0)
    v_rcp_f32 v58, v58
    v_mfma_f32_16x16x32_bf16 v[192:195], v[16:19], a[48:51], v[192:195]
    buffer_load_dwordx4 v49, s[16:19], s54 offen lds
    v_mfma_f32_16x16x32_bf16 v[192:195], v[20:23], a[32:35], v[192:195]
    s_mov_b32 s55, 0xdfc80
    ds_read_b64_tr_b16 v[32:33], v6 offset:0
    ds_read_b64_tr_b16 v[34:35], v6 offset:2048
    v_mfma_f32_16x16x32_bf16 v[196:199], v[20:23], a[36:39], v[196:199]
    v_rcp_f32 v59, v59
    v_mul_f32 v56, v56, v160
    v_mfma_f32_16x16x32_bf16 v[196:199], v[16:19], a[52:55], v[196:199]
    ds_read_b64_tr_b16 v[36:37], v6 offset:4096
    ds_read_b64_tr_b16 v[38:39], v6 offset:6144
    v_mul_f32 v57, v57, v161
    v_mfma_f32_16x16x32_bf16 v[200:203], v[16:19], a[56:59], v[200:203]
    buffer_load_dwordx4 v49, s[16:19], s55 offen offset:1024 lds
    v_mul_f32 v58, v58, v162
    v_mfma_f32_16x16x32_bf16 v[200:203], v[20:23], a[40:43], v[200:203]
    s_mov_b32 s56, 0xc7880
    ds_read_b64_tr_b16 v[40:41], v7 offset:0
    ds_read_b64_tr_b16 v[42:43], v7 offset:2048
    v_mul_f32 v59, v59, v163
    v_mfma_f32_16x16x32_bf16 v[204:207], v[20:23], a[44:47], v[204:207]
    v_cvt_pk_bf16_f32 v160, v56, v57
    v_cvt_pk_bf16_f32 v161, v58, v59
    v_mul_f32 v56, v176, v176
    v_mfma_f32_16x16x32_bf16 v[204:207], v[16:19], a[60:63], v[204:207]
    ds_read_b64_tr_b16 v[44:45], v7 offset:4096
    ds_read_b64_tr_b16 v[46:47], v7 offset:6144
    v_mul_f32 v57, v177, v177
    v_mfma_f32_16x16x32_bf16 v[208:211], v[24:27], a[48:51], v[208:211]
    buffer_load_dwordx4 v49, s[16:19], s56 offen offset:2048 lds
    v_mul_f32 v58, v178, v178
    v_mul_f32 v59, v179, v179
    v_mfma_f32_16x16x32_bf16 v[208:211], v[28:31], a[32:35], v[208:211]
    s_mov_b32 s57, 0xe7480
    v_fma_f32 v56, v56, s71, v51
    v_fma_f32 v57, v57, s71, v51
    v_fma_f32 v58, v58, s71, v51
    v_mfma_f32_16x16x32_bf16 v[212:215], v[28:31], a[36:39], v[212:215]
    v_fma_f32 v59, v59, s71, v51
    v_mul_f32 v56, v56, v176
    v_mul_f32 v57, v57, v177
    v_mfma_f32_16x16x32_bf16 v[212:215], v[24:27], a[52:55], v[212:215]
    v_mul_f32 v58, v58, v178
    v_mul_f32 v59, v59, v179
    v_mfma_f32_16x16x32_bf16 v[216:219], v[24:27], a[56:59], v[216:219]
    buffer_load_dwordx4 v49, s[16:19], s57 offen offset:3072 lds
    v_mfma_f32_16x16x32_bf16 v[216:219], v[28:31], a[40:43], v[216:219]
    s_mov_b32 s54, 0x100080
    v_exp_f32 v56, v56
    v_mfma_f32_16x16x32_bf16 v[220:223], v[28:31], a[44:47], v[220:223]
    s_add_u32 m0, s63, 0x0
    v_exp_f32 v57, v57
    v_mfma_f32_16x16x32_bf16 v[220:223], v[24:27], a[60:63], v[220:223]
    s_waitcnt vmcnt(16) lgkmcnt(0)
    v_exp_f32 v58, v58
    v_mfma_f32_16x16x32_bf16 v[224:227], v[32:35], a[48:51], v[224:227]
    buffer_load_dwordx4 v49, s[16:19], s54 offen lds
    v_mfma_f32_16x16x32_bf16 v[224:227], v[36:39], a[32:35], v[224:227]
    s_mov_b32 s55, 0x11fc80
    ds_read_b64_tr_b16 v[16:17], v8 offset:8192
    ds_read_b64_tr_b16 v[18:19], v8 offset:10240
    v_mfma_f32_16x16x32_bf16 v[228:231], v[36:39], a[36:39], v[228:231]
    v_exp_f32 v59, v59
    v_add_f32 v56, 1.0, v56
    v_mfma_f32_16x16x32_bf16 v[228:231], v[32:35], a[52:55], v[228:231]
    ds_read_b64_tr_b16 v[20:21], v8 offset:12288
    ds_read_b64_tr_b16 v[22:23], v8 offset:14336
    v_add_f32 v57, 1.0, v57
    v_mfma_f32_16x16x32_bf16 v[232:235], v[32:35], a[56:59], v[232:235]
    buffer_load_dwordx4 v49, s[16:19], s55 offen offset:1024 lds
    v_add_f32 v58, 1.0, v58
    v_mfma_f32_16x16x32_bf16 v[232:235], v[36:39], a[40:43], v[232:235]
    s_mov_b32 s56, 0x107880
    ds_read_b64_tr_b16 v[24:25], v9 offset:8192
    ds_read_b64_tr_b16 v[26:27], v9 offset:10240
    v_add_f32 v59, 1.0, v59
    v_mfma_f32_16x16x32_bf16 v[236:239], v[36:39], a[44:47], v[236:239]
L_PAD1:
    s_cbranch_execz L_PAD5
    v_rcp_f32 v56, v56
    v_mfma_f32_16x16x32_bf16 v[236:239], v[32:35], a[60:63], v[236:239]
    ds_read_b64_tr_b16 v[28:29], v9 offset:12288
    ds_read_b64_tr_b16 v[30:31], v9 offset:14336
    v_mfma_f32_16x16x32_bf16 v[240:243], v[40:43], a[48:51], v[240:243]
    buffer_load_dwordx4 v49, s[16:19], s56 offen offset:2048 lds
    v_rcp_f32 v57, v57
    v_mfma_f32_16x16x32_bf16 v[240:243], v[44:47], a[32:35], v[240:243]
    s_mov_b32 s57, 0x127480
    v_rcp_f32 v58, v58
    v_mfma_f32_16x16x32_bf16 v[244:247], v[44:47], a[36:39], v[244:247]
    v_rcp_f32 v59, v59
    v_mul_f32 v56, v56, v176
    v_mfma_f32_16x16x32_bf16 v[244:247], v[40:43], a[52:55], v[244:247]
    v_mul_f32 v57, v57, v177
    v_mul_f32 v58, v58, v178
    v_mul_f32 v59, v59, v179
    v_mfma_f32_16x16x32_bf16 v[248:251], v[40:43], a[56:59], v[248:251]
    buffer_load_dwordx4 v49, s[16:19], s57 offen offset:3072 lds
    v_cvt_pk_bf16_f32 v162, v56, v57
    v_mfma_f32_16x16x32_bf16 v[248:251], v[44:47], a[40:43], v[248:251]
    s_mov_b32 s54, 0x140080
    v_cvt_pk_bf16_f32 v163, v58, v59
    v_mul_f32 v56, v164, v164
    v_mul_f32 v57, v165, v165
    v_mfma_f32_16x16x32_bf16 v[252:255], v[44:47], a[44:47], v[252:255]
    s_add_u32 m0, s63, 0x1000
    v_mul_f32 v58, v166, v166
    v_mul_f32 v59, v167, v167
    v_fma_f32 v56, v56, s71, v51
    v_mfma_f32_16x16x32_bf16 v[252:255], v[40:43], a[60:63], v[252:255]
    s_waitcnt lgkmcnt(0)
    v_fma_f32 v57, v57, s71, v51
    v_fma_f32 v58, v58, s71, v51
    v_fma_f32 v59, v59, s71, v51
    v_mfma_f32_16x16x32_bf16 v[192:195], v[16:19], a[16:19], v[192:195]
    buffer_load_dwordx4 v49, s[16:19], s54 offen lds
    v_mul_f32 v56, v56, v164
    v_mfma_f32_16x16x32_bf16 v[192:195], v[20:23], a[0:3], v[192:195]
    s_mov_b32 s55, 0x15fc80
    ds_read_b64_tr_b16 v[32:33], v10 offset:8192
    ds_read_b64_tr_b16 v[34:35], v10 offset:10240
    v_mul_f32 v57, v57, v165
    v_mfma_f32_16x16x32_bf16 v[196:199], v[20:23], a[4:7], v[196:199]
    v_mul_f32 v58, v58, v166
    v_mul_f32 v59, v59, v167
    v_mfma_f32_16x16x32_bf16 v[196:199], v[16:19], a[20:23], v[196:199]
    ds_read_b64_tr_b16 v[36:37], v10 offset:12288
    ds_read_b64_tr_b16 v[38:39], v10 offset:14336
    v_mfma_f32_16x16x32_bf16 v[200:203], v[16:19], a[24:27], v[200:203]
    buffer_load_dwordx4 v49, s[16:19], s55 offen offset:1024 lds
    v_mfma_f32_16x16x32_bf16 v[200:203], v[20:23], a[8:11], v[200:203]
    s_mov_b32 s56, 0x147880
    ds_read_b64_tr_b16 v[40:41], v11 offset:8192
    ds_read_b64_tr_b16 v[42:43], v11 offset:10240
    v_mfma_f32_16x16x32_bf16 v[204:207], v[20:23], a[12:15], v[204:207]
    v_exp_f32 v56, v56
    v_mfma_f32_16x16x32_bf16 v[204:207], v[16:19], a[28:31], v[204:207]
    ds_read_b64_tr_b16 v[44:45], v11 offset:12288
    ds_read_b64_tr_b16 v[46:47], v11 offset:14336
    v_mfma_f32_16x16x32_bf16 v[208:211], v[24:27], a[16:19], v[208:211]
    buffer_load_dwordx4 v49, s[16:19], s56 offen offset:2048 lds
    v_exp_f32 v57, v57
    v_mfma_f32_16x16x32_bf16 v[208:211], v[28:31], a[0:3], v[208:211]
    s_mov_b32 s57, 0x167480
    v_cvt_pk_bf16_f32 v64, v192, v193
    v_cvt_pk_bf16_f32 v65, v194, v195
    v_mfma_f32_16x16x32_bf16 v[212:215], v[28:31], a[4:7], v[212:215]
    v_cvt_pk_bf16_f32 v80, v196, v197
    v_cvt_pk_bf16_f32 v81, v198, v199
    v_mfma_f32_16x16x32_bf16 v[212:215], v[24:27], a[20:23], v[212:215]
    v_cvt_pk_bf16_f32 v96, v200, v201
    v_cvt_pk_bf16_f32 v97, v202, v203
    v_mfma_f32_16x16x32_bf16 v[216:219], v[24:27], a[24:27], v[216:219]
    buffer_load_dwordx4 v49, s[16:19], s57 offen offset:3072 lds
    v_mfma_f32_16x16x32_bf16 v[216:219], v[28:31], a[8:11], v[216:219]
    s_mov_b32 s54, 0x180080
    v_cvt_pk_bf16_f32 v112, v204, v205
    v_cvt_pk_bf16_f32 v113, v206, v207
    v_mfma_f32_16x16x32_bf16 v[220:223], v[28:31], a[12:15], v[220:223]
    s_add_u32 m0, s63, 0x12000
    v_exp_f32 v58, v58
    v_mfma_f32_16x16x32_bf16 v[220:223], v[24:27], a[28:31], v[220:223]
    s_waitcnt vmcnt(16) lgkmcnt(0)
    v_cvt_pk_bf16_f32 v66, v208, v209
    v_cvt_pk_bf16_f32 v67, v210, v211
    v_mfma_f32_16x16x32_bf16 v[224:227], v[32:35], a[16:19], v[224:227]
    buffer_load_dwordx4 v49, s[16:19], s54 offen lds
    v_mfma_f32_16x16x32_bf16 v[224:227], v[36:39], a[0:3], v[224:227]
    s_mov_b32 s55, 0x19fc80
    ds_read_b64_tr_b16 v[16:17], v4 offset:8192
    ds_read_b64_tr_b16 v[18:19], v4 offset:10240
    v_mfma_f32_16x16x32_bf16 v[228:231], v[36:39], a[4:7], v[228:231]
    v_cvt_pk_bf16_f32 v82, v212, v213
    v_cvt_pk_bf16_f32 v83, v214, v215
    v_mfma_f32_16x16x32_bf16 v[228:231], v[32:35], a[20:23], v[228:231]
    ds_read_b64_tr_b16 v[20:21], v4 offset:12288
    ds_read_b64_tr_b16 v[22:23], v4 offset:14336
    v_mfma_f32_16x16x32_bf16 v[232:235], v[32:35], a[24:27], v[232:235]
    buffer_load_dwordx4 v49, s[16:19], s55 offen offset:1024 lds
    v_mfma_f32_16x16x32_bf16 v[232:235], v[36:39], a[8:11], v[232:235]
    s_mov_b32 s56, 0x187880
    ds_read_b64_tr_b16 v[24:25], v5 offset:8192
    ds_read_b64_tr_b16 v[26:27], v5 offset:10240
    v_mfma_f32_16x16x32_bf16 v[236:239], v[36:39], a[12:15], v[236:239]
    v_cvt_pk_bf16_f32 v98, v216, v217
    v_cvt_pk_bf16_f32 v99, v218, v219
    v_mfma_f32_16x16x32_bf16 v[236:239], v[32:35], a[28:31], v[236:239]
    ds_read_b64_tr_b16 v[28:29], v5 offset:12288
    ds_read_b64_tr_b16 v[30:31], v5 offset:14336
    v_mfma_f32_16x16x32_bf16 v[240:243], v[40:43], a[16:19], v[240:243]
    buffer_load_dwordx4 v49, s[16:19], s56 offen offset:2048 lds
    v_exp_f32 v59, v59
    v_mfma_f32_16x16x32_bf16 v[240:243], v[44:47], a[0:3], v[240:243]
    s_mov_b32 s57, 0x1a7480
    v_cvt_pk_bf16_f32 v114, v220, v221
    v_cvt_pk_bf16_f32 v115, v222, v223
    v_add_f32 v56, 1.0, v56
    v_mfma_f32_16x16x32_bf16 v[244:247], v[44:47], a[4:7], v[244:247]
    v_cvt_pk_bf16_f32 v68, v224, v225
    v_cvt_pk_bf16_f32 v69, v226, v227
    v_add_f32 v57, 1.0, v57
    v_mfma_f32_16x16x32_bf16 v[244:247], v[40:43], a[20:23], v[244:247]
    v_permlane32_swap_b32 v64, v66
    v_add_f32 v58, 1.0, v58
    v_mfma_f32_16x16x32_bf16 v[248:251], v[40:43], a[24:27], v[248:251]
    buffer_load_dwordx4 v49, s[16:19], s57 offen offset:3072 lds
    v_add_f32 v59, 1.0, v59
    v_mfma_f32_16x16x32_bf16 v[248:251], v[44:47], a[8:11], v[248:251]
    s_mov_b32 s54, 0x1c0080
    v_permlane32_swap_b32 v65, v67
    v_mfma_f32_16x16x32_bf16 v[252:255], v[44:47], a[12:15], v[252:255]
    s_add_u32 m0, s63, 0x13000
    v_permlane32_swap_b32 v80, v82
    v_mfma_f32_16x16x32_bf16 v[252:255], v[40:43], a[28:31], v[252:255]
    s_waitcnt lgkmcnt(0)
    v_permlane32_swap_b32 v81, v83
    v_mfma_f32_16x16x32_bf16 v[192:195], v[16:19], a[240:243], 0
    buffer_load_dwordx4 v49, s[16:19], s54 offen lds
    v_mfma_f32_16x16x32_bf16 v[192:195], v[20:23], a[224:227], v[192:195]
    s_mov_b32 s55, 0x1dfc80
    ds_read_b64_tr_b16 v[32:33], v6 offset:8192
    ds_read_b64_tr_b16 v[34:35], v6 offset:10240
    v_mfma_f32_16x16x32_bf16 v[196:199], v[20:23], a[228:231], 0
    v_permlane32_swap_b32 v96, v98
    v_mfma_f32_16x16x32_bf16 v[196:199], v[16:19], a[244:247], v[196:199]
    ds_read_b64_tr_b16 v[36:37], v6 offset:12288
    ds_read_b64_tr_b16 v[38:39], v6 offset:14336
    v_mfma_f32_16x16x32_bf16 v[200:203], v[16:19], a[248:251], 0
    buffer_load_dwordx4 v49, s[16:19], s55 offen offset:1024 lds
    v_mfma_f32_16x16x32_bf16 v[200:203], v[20:23], a[232:235], v[200:203]
    s_mov_b32 s56, 0x1c7880
    ds_read_b64_tr_b16 v[40:41], v7 offset:8192
    ds_read_b64_tr_b16 v[42:43], v7 offset:10240
    v_mfma_f32_16x16x32_bf16 v[204:207], v[20:23], a[236:239], 0
    v_permlane32_swap_b32 v97, v99
    v_mfma_f32_16x16x32_bf16 v[204:207], v[16:19], a[252:255], v[204:207]
    ds_read_b64_tr_b16 v[44:45], v7 offset:12288
    ds_read_b64_tr_b16 v[46:47], v7 offset:14336
    v_mfma_f32_16x16x32_bf16 v[208:211], v[24:27], a[240:243], 0
    buffer_load_dwordx4 v49, s[16:19], s56 offen offset:2048 lds
    v_rcp_f32 v56, v56
    v_mfma_f32_16x16x32_bf16 v[208:211], v[28:31], a[224:227], v[208:211]
    s_mov_b32 s57, 0x1e7480
    v_permlane32_swap_b32 v112, v114
    v_mfma_f32_16x16x32_bf16 v[212:215], v[28:31], a[228:231], 0
    v_permlane32_swap_b32 v113, v115
    v_mfma_f32_16x16x32_bf16 v[212:215], v[24:27], a[244:247], v[212:215]
    v_cvt_pk_bf16_f32 v84, v228, v229
    v_cvt_pk_bf16_f32 v85, v230, v231
    v_mfma_f32_16x16x32_bf16 v[216:219], v[24:27], a[248:251], 0
    buffer_load_dwordx4 v49, s[16:19], s57 offen offset:3072 lds
    v_mfma_f32_16x16x32_bf16 v[216:219], v[28:31], a[232:235], v[216:219]
    s_mov_b32 s54, 0x200080
    v_cvt_pk_bf16_f32 v100, v232, v233
    v_cvt_pk_bf16_f32 v101, v234, v235
    v_mfma_f32_16x16x32_bf16 v[220:223], v[28:31], a[236:239], 0
    s_add_u32 m0, s63, 0x2000
    v_cvt_pk_bf16_f32 v116, v236, v237
    v_cvt_pk_bf16_f32 v117, v238, v239
    v_mfma_f32_16x16x32_bf16 v[220:223], v[24:27], a[252:255], v[220:223]
    s_waitcnt vmcnt(16) lgkmcnt(0)
    v_cvt_pk_bf16_f32 v70, v240, v241
    v_cvt_pk_bf16_f32 v71, v242, v243
    v_mfma_f32_16x16x32_bf16 v[224:227], v[32:35], a[240:243], 0
    buffer_load_dwordx4 v49, s[16:19], s54 offen lds
    v_mfma_f32_16x16x32_bf16 v[224:227], v[36:39], a[224:227], v[224:227]
    s_mov_b32 s55, 0x21fc80
    ds_read_b64_tr_b16 v[16:17], v8 offset:0
    ds_read_b64_tr_b16 v[18:19], v8 offset:2048
    v_mfma_f32_16x16x32_bf16 v[228:231], v[36:39], a[228:231], 0
    v_cvt_pk_bf16_f32 v86, v244, v245
    v_cvt_pk_bf16_f32 v87, v246, v247
    v_mfma_f32_16x16x32_bf16 v[228:231], v[32:35], a[244:247], v[228:231]
    ds_read_b64_tr_b16 v[20:21], v8 offset:4096
    ds_read_b64_tr_b16 v[22:23], v8 offset:6144
    v_mfma_f32_16x16x32_bf16 v[232:235], v[32:35], a[248:251], 0
    buffer_load_dwordx4 v49, s[16:19], s55 offen offset:1024 lds
    v_mfma_f32_16x16x32_bf16 v[232:235], v[36:39], a[232:235], v[232:235]
    s_mov_b32 s56, 0x207880
    ds_read_b64_tr_b16 v[24:25], v9 offset:0
    ds_read_b64_tr_b16 v[26:27], v9 offset:2048
    v_mfma_f32_16x16x32_bf16 v[236:239], v[36:39], a[236:239], 0
    v_cvt_pk_bf16_f32 v102, v248, v249
    v_cvt_pk_bf16_f32 v103, v250, v251
    v_mfma_f32_16x16x32_bf16 v[236:239], v[32:35], a[252:255], v[236:239]
    ds_read_b64_tr_b16 v[28:29], v9 offset:4096
    ds_read_b64_tr_b16 v[30:31], v9 offset:6144
    v_mfma_f32_16x16x32_bf16 v[240:243], v[40:43], a[240:243], 0
    buffer_load_dwordx4 v49, s[16:19], s56 offen offset:2048 lds
    v_rcp_f32 v57, v57
    v_mfma_f32_16x16x32_bf16 v[240:243], v[44:47], a[224:227], v[240:243]
    s_mov_b32 s57, 0x227480
    v_cvt_pk_bf16_f32 v118, v252, v253
    v_cvt_pk_bf16_f32 v119, v254, v255
    v_mfma_f32_16x16x32_bf16 v[244:247], v[44:47], a[228:231], 0
    v_rcp_f32 v58, v58
    v_mfma_f32_16x16x32_bf16 v[244:247], v[40:43], a[244:247], v[244:247]
    v_permlane32_swap_b32 v68, v70
    v_mfma_f32_16x16x32_bf16 v[248:251], v[40:43], a[248:251], 0
    buffer_load_dwordx4 v49, s[16:19], s57 offen offset:3072 lds
    v_mfma_f32_16x16x32_bf16 v[248:251], v[44:47], a[232:235], v[248:251]
    s_mov_b32 s54, 0x240080
    v_permlane32_swap_b32 v69, v71
    v_mfma_f32_16x16x32_bf16 v[252:255], v[44:47], a[236:239], 0
    s_add_u32 m0, s63, 0x3000
    v_permlane32_swap_b32 v84, v86
    v_mfma_f32_16x16x32_bf16 v[252:255], v[40:43], a[252:255], v[252:255]
    s_waitcnt lgkmcnt(0)
    v_permlane32_swap_b32 v85, v87
    v_mfma_f32_16x16x32_bf16 v[192:195], v[16:19], a[208:211], v[192:195]
    buffer_load_dwordx4 v49, s[16:19], s54 offen lds
    v_mfma_f32_16x16x32_bf16 v[192:195], v[20:23], a[192:195], v[192:195]
    s_mov_b32 s55, 0x25fc80
    ds_read_b64_tr_b16 v[32:33], v10 offset:0
    ds_read_b64_tr_b16 v[34:35], v10 offset:2048
    v_mfma_f32_16x16x32_bf16 v[196:199], v[20:23], a[196:199], v[196:199]
    v_permlane32_swap_b32 v100, v102
    v_mfma_f32_16x16x32_bf16 v[196:199], v[16:19], a[212:215], v[196:199]
    ds_read_b64_tr_b16 v[36:37], v10 offset:4096
    ds_read_b64_tr_b16 v[38:39], v10 offset:6144
    v_mfma_f32_16x16x32_bf16 v[200:203], v[16:19], a[216:219], v[200:203]
    buffer_load_dwordx4 v49, s[16:19], s55 offen offset:1024 lds
    v_mfma_f32_16x16x32_bf16 v[200:203], v[20:23], a[200:203], v[200:203]
    s_mov_b32 s56, 0x247880
    ds_read_b64_tr_b16 v[40:41], v11 offset:0
    ds_read_b64_tr_b16 v[42:43], v11 offset:2048
    v_mfma_f32_16x16x32_bf16 v[204:207], v[20:23], a[204:207], v[204:207]
    v_permlane32_swap_b32 v101, v103
    v_mfma_f32_16x16x32_bf16 v[204:207], v[16:19], a[220:223], v[204:207]
    ds_read_b64_tr_b16 v[44:45], v11 offset:4096
    ds_read_b64_tr_b16 v[46:47], v11 offset:6144
    v_mfma_f32_16x16x32_bf16 v[208:211], v[24:27], a[208:211], v[208:211]
    buffer_load_dwordx4 v49, s[16:19], s56 offen offset:2048 lds
    v_mfma_f32_16x16x32_bf16 v[208:211], v[28:31], a[192:195], v[208:211]
    s_mov_b32 s57, 0x267480
    v_permlane32_swap_b32 v116, v118
    v_rcp_f32 v59, v59
    v_mfma_f32_16x16x32_bf16 v[212:215], v[28:31], a[196:199], v[212:215]
    v_permlane32_swap_b32 v117, v119
    v_mul_f32 v56, v56, v164
    v_mfma_f32_16x16x32_bf16 v[212:215], v[24:27], a[212:215], v[212:215]
    v_mul_f32 v57, v57, v165
    v_mul_f32 v58, v58, v166
    v_mul_f32 v59, v59, v167
    v_mfma_f32_16x16x32_bf16 v[216:219], v[24:27], a[216:219], v[216:219]
    buffer_load_dwordx4 v49, s[16:19], s57 offen offset:3072 lds
    v_cvt_pk_bf16_f32 v164, v56, v57
    v_mfma_f32_16x16x32_bf16 v[216:219], v[28:31], a[200:203], v[216:219]
    s_mov_b32 s54, 0x280080
    v_cvt_pk_bf16_f32 v165, v58, v59
    v_mul_f32 v56, v180, v180
    v_mul_f32 v57, v181, v181
    v_mfma_f32_16x16x32_bf16 v[220:223], v[28:31], a[204:207], v[220:223]
    s_add_u32 m0, s63, 0x10000
    v_mul_f32 v58, v182, v182
    v_mul_f32 v59, v183, v183
    v_fma_f32 v56, v56, s71, v51
    v_mfma_f32_16x16x32_bf16 v[220:223], v[24:27], a[220:223], v[220:223]
    s_waitcnt vmcnt(16) lgkmcnt(0)
    v_fma_f32 v57, v57, s71, v51
    v_fma_f32 v58, v58, s71, v51
    v_fma_f32 v59, v59, s71, v51
    v_mfma_f32_16x16x32_bf16 v[224:227], v[32:35], a[208:211], v[224:227]
    buffer_load_dwordx4 v49, s[16:19], s54 offen lds
    v_mul_f32 v56, v56, v180
    v_mfma_f32_16x16x32_bf16 v[224:227], v[36:39], a[192:195], v[224:227]
    s_mov_b32 s55, 0x29fc80
    ds_read_b64_tr_b16 v[16:17], v4 offset:0
    ds_read_b64_tr_b16 v[18:19], v4 offset:2048
    v_mul_f32 v57, v57, v181
    v_mfma_f32_16x16x32_bf16 v[228:231], v[36:39], a[196:199], v[228:231]
    v_mul_f32 v58, v58, v182
    v_mul_f32 v59, v59, v183
    v_mfma_f32_16x16x32_bf16 v[228:231], v[32:35], a[212:215], v[228:231]
    ds_read_b64_tr_b16 v[20:21], v4 offset:4096
    ds_read_b64_tr_b16 v[22:23], v4 offset:6144
    v_mfma_f32_16x16x32_bf16 v[232:235], v[32:35], a[216:219], v[232:235]
    buffer_load_dwordx4 v49, s[16:19], s55 offen offset:1024 lds
    v_mfma_f32_16x16x32_bf16 v[232:235], v[36:39], a[200:203], v[232:235]
    s_mov_b32 s56, 0x287880
    ds_read_b64_tr_b16 v[24:25], v5 offset:0
    ds_read_b64_tr_b16 v[26:27], v5 offset:2048
    v_mfma_f32_16x16x32_bf16 v[236:239], v[36:39], a[204:207], v[236:239]
    v_exp_f32 v56, v56
    v_mfma_f32_16x16x32_bf16 v[236:239], v[32:35], a[220:223], v[236:239]
    ds_read_b64_tr_b16 v[28:29], v5 offset:4096
    ds_read_b64_tr_b16 v[30:31], v5 offset:6144
    v_mfma_f32_16x16x32_bf16 v[240:243], v[40:43], a[208:211], v[240:243]
    buffer_load_dwordx4 v49, s[16:19], s56 offen offset:2048 lds
    v_mfma_f32_16x16x32_bf16 v[240:243], v[44:47], a[192:195], v[240:243]
    s_mov_b32 s57, 0x2a7480
    v_exp_f32 v57, v57
    v_exp_f32 v58, v58
    v_mfma_f32_16x16x32_bf16 v[244:247], v[44:47], a[196:199], v[244:247]
    v_exp_f32 v59, v59
    v_add_f32 v56, 1.0, v56
    v_mfma_f32_16x16x32_bf16 v[244:247], v[40:43], a[212:215], v[244:247]
    v_add_f32 v57, 1.0, v57
    v_add_f32 v58, 1.0, v58
    v_add_f32 v59, 1.0, v59
    v_mfma_f32_16x16x32_bf16 v[248:251], v[40:43], a[216:219], v[248:251]
    buffer_load_dwordx4 v49, s[16:19], s57 offen offset:3072 lds
    v_mfma_f32_16x16x32_bf16 v[248:251], v[44:47], a[200:203], v[248:251]
    s_mov_b32 s54, 0x2c0080
    v_rcp_f32 v56, v56
    v_mfma_f32_16x16x32_bf16 v[252:255], v[44:47], a[204:207], v[252:255]
    s_add_u32 m0, s63, 0x11000
    v_rcp_f32 v57, v57
    v_mfma_f32_16x16x32_bf16 v[252:255], v[40:43], a[220:223], v[252:255]
    s_waitcnt lgkmcnt(0)
    v_rcp_f32 v58, v58
    v_mfma_f32_16x16x32_bf16 v[192:195], v[16:19], a[176:179], v[192:195]
    buffer_load_dwordx4 v49, s[16:19], s54 offen lds
    v_mfma_f32_16x16x32_bf16 v[192:195], v[20:23], a[160:163], v[192:195]
    s_mov_b32 s55, 0x2dfc80
    ds_read_b64_tr_b16 v[32:33], v6 offset:0
    ds_read_b64_tr_b16 v[34:35], v6 offset:2048
    v_mfma_f32_16x16x32_bf16 v[196:199], v[20:23], a[164:167], v[196:199]
    v_rcp_f32 v59, v59
    v_mul_f32 v56, v56, v180
    v_mfma_f32_16x16x32_bf16 v[196:199], v[16:19], a[180:183], v[196:199]
    ds_read_b64_tr_b16 v[36:37], v6 offset:4096
    ds_read_b64_tr_b16 v[38:39], v6 offset:6144
    v_mul_f32 v57, v57, v181
    v_mfma_f32_16x16x32_bf16 v[200:203], v[16:19], a[184:187], v[200:203]
    buffer_load_dwordx4 v49, s[16:19], s55 offen offset:1024 lds
    v_mul_f32 v58, v58, v182
    v_mfma_f32_16x16x32_bf16 v[200:203], v[20:23], a[168:171], v[200:203]
    s_mov_b32 s56, 0x2c7880
    ds_read_b64_tr_b16 v[40:41], v7 offset:0
    ds_read_b64_tr_b16 v[42:43], v7 offset:2048
    v_mul_f32 v59, v59, v183
    v_mfma_f32_16x16x32_bf16 v[204:207], v[20:23], a[172:175], v[204:207]
    v_cvt_pk_bf16_f32 v166, v56, v57
    v_cvt_pk_bf16_f32 v167, v58, v59
    v_mul_f32 v56, v168, v168
    v_mfma_f32_16x16x32_bf16 v[204:207], v[16:19], a[188:191], v[204:207]
    ds_read_b64_tr_b16 v[44:45], v7 offset:4096
    ds_read_b64_tr_b16 v[46:47], v7 offset:6144
    v_mul_f32 v57, v169, v169
    v_mfma_f32_16x16x32_bf16 v[208:211], v[24:27], a[176:179], v[208:211]
    buffer_load_dwordx4 v49, s[16:19], s56 offen offset:2048 lds
    v_mul_f32 v58, v170, v170
    v_mfma_f32_16x16x32_bf16 v[208:211], v[28:31], a[160:163], v[208:211]
    s_mov_b32 s57, 0x2e7480
    v_mul_f32 v59, v171, v171
    v_fma_f32 v56, v56, s71, v51
    v_fma_f32 v57, v57, s71, v51
    v_fma_f32 v58, v58, s71, v51
    v_mfma_f32_16x16x32_bf16 v[212:215], v[28:31], a[164:167], v[212:215]
    v_fma_f32 v59, v59, s71, v51
    v_mul_f32 v56, v56, v168
    v_mul_f32 v57, v57, v169
    v_mfma_f32_16x16x32_bf16 v[212:215], v[24:27], a[180:183], v[212:215]
    v_mul_f32 v58, v58, v170
    v_mul_f32 v59, v59, v171
    v_mfma_f32_16x16x32_bf16 v[216:219], v[24:27], a[184:187], v[216:219]
    buffer_load_dwordx4 v49, s[16:19], s57 offen offset:3072 lds
    v_mfma_f32_16x16x32_bf16 v[216:219], v[28:31], a[168:171], v[216:219]
    s_mov_b32 s54, 0x300080
    v_exp_f32 v56, v56
    v_mfma_f32_16x16x32_bf16 v[220:223], v[28:31], a[172:175], v[220:223]
    s_add_u32 m0, s63, 0x0
    v_exp_f32 v57, v57
    v_mfma_f32_16x16x32_bf16 v[220:223], v[24:27], a[188:191], v[220:223]
    s_waitcnt vmcnt(16) lgkmcnt(0)
    v_exp_f32 v58, v58
    v_mfma_f32_16x16x32_bf16 v[224:227], v[32:35], a[176:179], v[224:227]
    buffer_load_dwordx4 v49, s[16:19], s54 offen lds
    v_mfma_f32_16x16x32_bf16 v[224:227], v[36:39], a[160:163], v[224:227]
    s_mov_b32 s55, 0x31fc80
    ds_read_b64_tr_b16 v[16:17], v8 offset:8192
    ds_read_b64_tr_b16 v[18:19], v8 offset:10240
    v_mfma_f32_16x16x32_bf16 v[228:231], v[36:39], a[164:167], v[228:231]
    v_exp_f32 v59, v59
    v_add_f32 v56, 1.0, v56
    v_mfma_f32_16x16x32_bf16 v[228:231], v[32:35], a[180:183], v[228:231]
    ds_read_b64_tr_b16 v[20:21], v8 offset:12288
    ds_read_b64_tr_b16 v[22:23], v8 offset:14336
    v_add_f32 v57, 1.0, v57
    v_mfma_f32_16x16x32_bf16 v[232:235], v[32:35], a[184:187], v[232:235]
    buffer_load_dwordx4 v49, s[16:19], s55 offen offset:1024 lds
    v_add_f32 v58, 1.0, v58
    v_mfma_f32_16x16x32_bf16 v[232:235], v[36:39], a[168:171], v[232:235]
    s_mov_b32 s56, 0x307880
    ds_read_b64_tr_b16 v[24:25], v9 offset:8192
    ds_read_b64_tr_b16 v[26:27], v9 offset:10240
    v_add_f32 v59, 1.0, v59
    v_mfma_f32_16x16x32_bf16 v[236:239], v[36:39], a[172:175], v[236:239]
    v_rcp_f32 v56, v56
    v_mfma_f32_16x16x32_bf16 v[236:239], v[32:35], a[188:191], v[236:239]
    ds_read_b64_tr_b16 v[28:29], v9 offset:12288
    ds_read_b64_tr_b16 v[30:31], v9 offset:14336
    v_mfma_f32_16x16x32_bf16 v[240:243], v[40:43], a[176:179], v[240:243]
    buffer_load_dwordx4 v49, s[16:19], s56 offen offset:2048 lds
    v_mfma_f32_16x16x32_bf16 v[240:243], v[44:47], a[160:163], v[240:243]
    s_mov_b32 s57, 0x327480
    v_rcp_f32 v57, v57
    v_rcp_f32 v58, v58
    v_mfma_f32_16x16x32_bf16 v[244:247], v[44:47], a[164:167], v[244:247]
    v_rcp_f32 v59, v59
    v_mul_f32 v56, v56, v168
    v_mfma_f32_16x16x32_bf16 v[244:247], v[40:43], a[180:183], v[244:247]
    v_mul_f32 v57, v57, v169
    v_mul_f32 v58, v58, v170
    v_mul_f32 v59, v59, v171
    v_mfma_f32_16x16x32_bf16 v[248:251], v[40:43], a[184:187], v[248:251]
    buffer_load_dwordx4 v49, s[16:19], s57 offen offset:3072 lds
    v_cvt_pk_bf16_f32 v168, v56, v57
    v_mfma_f32_16x16x32_bf16 v[248:251], v[44:47], a[168:171], v[248:251]
    s_mov_b32 s54, 0x340080
    v_cvt_pk_bf16_f32 v169, v58, v59
    v_mul_f32 v56, v184, v184
    v_mul_f32 v57, v185, v185
    v_mfma_f32_16x16x32_bf16 v[252:255], v[44:47], a[172:175], v[252:255]
    s_add_u32 m0, s63, 0x1000
    v_mul_f32 v58, v186, v186
    v_mul_f32 v59, v187, v187
    v_fma_f32 v56, v56, s71, v51
    v_mfma_f32_16x16x32_bf16 v[252:255], v[40:43], a[188:191], v[252:255]
    s_waitcnt lgkmcnt(0)
    v_fma_f32 v57, v57, s71, v51
    v_fma_f32 v58, v58, s71, v51
    v_fma_f32 v59, v59, s71, v51
    v_mfma_f32_16x16x32_bf16 v[192:195], v[16:19], a[144:147], v[192:195]
    buffer_load_dwordx4 v49, s[16:19], s54 offen lds
    v_mul_f32 v56, v56, v184
    v_mfma_f32_16x16x32_bf16 v[192:195], v[20:23], a[128:131], v[192:195]
    s_mov_b32 s55, 0x35fc80
    ds_read_b64_tr_b16 v[32:33], v10 offset:8192
    ds_read_b64_tr_b16 v[34:35], v10 offset:10240
    v_mul_f32 v57, v57, v185
    v_mfma_f32_16x16x32_bf16 v[196:199], v[20:23], a[132:135], v[196:199]
    v_mul_f32 v58, v58, v186
    v_mul_f32 v59, v59, v187
    v_mfma_f32_16x16x32_bf16 v[196:199], v[16:19], a[148:151], v[196:199]
    ds_read_b64_tr_b16 v[36:37], v10 offset:12288
    ds_read_b64_tr_b16 v[38:39], v10 offset:14336
    v_mfma_f32_16x16x32_bf16 v[200:203], v[16:19], a[152:155], v[200:203]
    buffer_load_dwordx4 v49, s[16:19], s55 offen offset:1024 lds
    v_mfma_f32_16x16x32_bf16 v[200:203], v[20:23], a[136:139], v[200:203]
    s_mov_b32 s56, 0x347880
    ds_read_b64_tr_b16 v[40:41], v11 offset:8192
    ds_read_b64_tr_b16 v[42:43], v11 offset:10240
    v_mfma_f32_16x16x32_bf16 v[204:207], v[20:23], a[140:143], v[204:207]
    v_exp_f32 v56, v56
    v_mfma_f32_16x16x32_bf16 v[204:207], v[16:19], a[156:159], v[204:207]
    ds_read_b64_tr_b16 v[44:45], v11 offset:12288
    ds_read_b64_tr_b16 v[46:47], v11 offset:14336
    v_mfma_f32_16x16x32_bf16 v[208:211], v[24:27], a[144:147], v[208:211]
    buffer_load_dwordx4 v49, s[16:19], s56 offen offset:2048 lds
    v_mfma_f32_16x16x32_bf16 v[208:211], v[28:31], a[128:131], v[208:211]
    s_mov_b32 s57, 0x367480
    v_exp_f32 v57, v57
    v_exp_f32 v58, v58
    v_mfma_f32_16x16x32_bf16 v[212:215], v[28:31], a[132:135], v[212:215]
    v_exp_f32 v59, v59
    v_add_f32 v56, 1.0, v56
    v_mfma_f32_16x16x32_bf16 v[212:215], v[24:27], a[148:151], v[212:215]
    v_add_f32 v57, 1.0, v57
    v_add_f32 v58, 1.0, v58
    v_add_f32 v59, 1.0, v59
    v_mfma_f32_16x16x32_bf16 v[216:219], v[24:27], a[152:155], v[216:219]
    buffer_load_dwordx4 v49, s[16:19], s57 offen offset:3072 lds
    v_mfma_f32_16x16x32_bf16 v[216:219], v[28:31], a[136:139], v[216:219]
    s_mov_b32 s54, 0x380080
    v_rcp_f32 v56, v56
    v_mfma_f32_16x16x32_bf16 v[220:223], v[28:31], a[140:143], v[220:223]
    s_add_u32 m0, s63, 0x12000
    v_rcp_f32 v57, v57
    v_mfma_f32_16x16x32_bf16 v[220:223], v[24:27], a[156:159], v[220:223]
    s_waitcnt vmcnt(16) lgkmcnt(0)
    v_rcp_f32 v58, v58
    v_mfma_f32_16x16x32_bf16 v[224:227], v[32:35], a[144:147], v[224:227]
    buffer_load_dwordx4 v49, s[16:19], s54 offen lds
    v_mfma_f32_16x16x32_bf16 v[224:227], v[36:39], a[128:131], v[224:227]
    s_mov_b32 s55, 0x39fc80
    ds_read_b64_tr_b16 v[16:17], v4 offset:8192
    ds_read_b64_tr_b16 v[18:19], v4 offset:10240
    v_mfma_f32_16x16x32_bf16 v[228:231], v[36:39], a[132:135], v[228:231]
    v_rcp_f32 v59, v59
    v_mul_f32 v56, v56, v184
    v_mfma_f32_16x16x32_bf16 v[228:231], v[32:35], a[148:151], v[228:231]
    ds_read_b64_tr_b16 v[20:21], v4 offset:12288
    ds_read_b64_tr_b16 v[22:23], v4 offset:14336
    v_mul_f32 v57, v57, v185
    v_mfma_f32_16x16x32_bf16 v[232:235], v[32:35], a[152:155], v[232:235]
    buffer_load_dwordx4 v49, s[16:19], s55 offen offset:1024 lds
    v_mul_f32 v58, v58, v186
    v_mfma_f32_16x16x32_bf16 v[232:235], v[36:39], a[136:139], v[232:235]
    s_mov_b32 s56, 0x387880
    ds_read_b64_tr_b16 v[24:25], v5 offset:8192
    ds_read_b64_tr_b16 v[26:27], v5 offset:10240
    v_mul_f32 v59, v59, v187
    v_mfma_f32_16x16x32_bf16 v[236:239], v[36:39], a[140:143], v[236:239]
    v_cvt_pk_bf16_f32 v170, v56, v57
    v_cvt_pk_bf16_f32 v171, v58, v59
    v_mfma_f32_16x16x32_bf16 v[236:239], v[32:35], a[156:159], v[236:239]
    ds_read_b64_tr_b16 v[28:29], v5 offset:12288
    ds_read_b64_tr_b16 v[30:31], v5 offset:14336
    v_mul_f32 v56, v172, v172
    v_mfma_f32_16x16x32_bf16 v[240:243], v[40:43], a[144:147], v[240:243]
    buffer_load_dwordx4 v49, s[16:19], s56 offen offset:2048 lds
    v_mul_f32 v57, v173, v173
    v_mfma_f32_16x16x32_bf16 v[240:243], v[44:47], a[128:131], v[240:243]
    s_mov_b32 s57, 0x3a7480
    v_mul_f32 v58, v174, v174
    v_mul_f32 v59, v175, v175
    v_fma_f32 v56, v56, s71, v51
    v_fma_f32 v57, v57, s71, v51
    v_mfma_f32_16x16x32_bf16 v[244:247], v[44:47], a[132:135], v[244:247]
    v_fma_f32 v58, v58, s71, v51
    v_fma_f32 v59, v59, s71, v51
    v_mul_f32 v56, v56, v172
    v_mfma_f32_16x16x32_bf16 v[244:247], v[40:43], a[148:151], v[244:247]
    v_mul_f32 v57, v57, v173
    v_mul_f32 v58, v58, v174
    v_mul_f32 v59, v59, v175
    v_mfma_f32_16x16x32_bf16 v[248:251], v[40:43], a[152:155], v[248:251]
    buffer_load_dwordx4 v49, s[16:19], s57 offen offset:3072 lds
    v_mfma_f32_16x16x32_bf16 v[248:251], v[44:47], a[136:139], v[248:251]
    s_mov_b32 s54, 0x3c0080
    v_exp_f32 v56, v56
    v_mfma_f32_16x16x32_bf16 v[252:255], v[44:47], a[140:143], v[252:255]
    s_add_u32 m0, s63, 0x13000
    v_exp_f32 v57, v57
    v_mfma_f32_16x16x32_bf16 v[252:255], v[40:43], a[156:159], v[252:255]
    s_waitcnt lgkmcnt(0)
    v_exp_f32 v58, v58
    v_mfma_f32_16x16x32_bf16 v[192:195], v[16:19], a[112:115], v[192:195]
    buffer_load_dwordx4 v49, s[16:19], s54 offen lds
    v_mfma_f32_16x16x32_bf16 v[192:195], v[20:23], a[96:99], v[192:195]
    s_mov_b32 s55, 0x3dfc80
    ds_read_b64_tr_b16 v[32:33], v6 offset:8192
    ds_read_b64_tr_b16 v[34:35], v6 offset:10240
    v_mfma_f32_16x16x32_bf16 v[196:199], v[20:23], a[100:103], v[196:199]
    v_exp_f32 v59, v59
    v_add_f32 v56, 1.0, v56
    v_mfma_f32_16x16x32_bf16 v[196:199], v[16:19], a[116:119], v[196:199]
    ds_read_b64_tr_b16 v[36:37], v6 offset:12288
    ds_read_b64_tr_b16 v[38:39], v6 offset:14336
    v_add_f32 v57, 1.0, v57
    v_mfma_f32_16x16x32_bf16 v[200:203], v[16:19], a[120:123], v[200:203]
    buffer_load_dwordx4 v49, s[16:19], s55 offen offset:1024 lds
    v_add_f32 v58, 1.0, v58
    v_mfma_f32_16x16x32_bf16 v[200:203], v[20:23], a[104:107], v[200:203]
    s_mov_b32 s56, 0x3c7880
    ds_read_b64_tr_b16 v[40:41], v7 offset:8192
    ds_read_b64_tr_b16 v[42:43], v7 offset:10240
    v_add_f32 v59, 1.0, v59
    v_mfma_f32_16x16x32_bf16 v[204:207], v[20:23], a[108:111], v[204:207]
    v_rcp_f32 v56, v56
    v_mfma_f32_16x16x32_bf16 v[204:207], v[16:19], a[124:127], v[204:207]
    ds_read_b64_tr_b16 v[44:45], v7 offset:12288
    ds_read_b64_tr_b16 v[46:47], v7 offset:14336
    v_mfma_f32_16x16x32_bf16 v[208:211], v[24:27], a[112:115], v[208:211]
    buffer_load_dwordx4 v49, s[16:19], s56 offen offset:2048 lds
    v_mfma_f32_16x16x32_bf16 v[208:211], v[28:31], a[96:99], v[208:211]
    s_mov_b32 s57, 0x3e7480
    v_rcp_f32 v57, v57
    v_mfma_f32_16x16x32_bf16 v[212:215], v[28:31], a[100:103], v[212:215]
    v_rcp_f32 v58, v58
    v_mfma_f32_16x16x32_bf16 v[212:215], v[24:27], a[116:119], v[212:215]
    v_rcp_f32 v59, v59
    v_mfma_f32_16x16x32_bf16 v[216:219], v[24:27], a[120:123], v[216:219]
L_PAD2:
    s_cbranch_execz L_PAD6
    buffer_load_dwordx4 v49, s[16:19], s57 offen offset:3072 lds
    v_mfma_f32_16x16x32_bf16 v[216:219], v[28:31], a[104:107], v[216:219]
    s_mov_b32 s54, 0x0
    v_mul_f32 v56, v56, v172
    v_mul_f32 v57, v57, v173
    v_mfma_f32_16x16x32_bf16 v[220:223], v[28:31], a[108:111], v[220:223]
    s_add_u32 m0, s63, 0x2000
    v_mul_f32 v58, v58, v174
    v_mul_f32 v59, v59, v175
    v_mfma_f32_16x16x32_bf16 v[220:223], v[24:27], a[124:127], v[220:223]
    s_waitcnt vmcnt(16) lgkmcnt(0)
    v_cvt_pk_bf16_f32 v172, v56, v57
    v_cvt_pk_bf16_f32 v173, v58, v59
    v_mul_f32 v56, v188, v188
    v_mfma_f32_16x16x32_bf16 v[224:227], v[32:35], a[112:115], v[224:227]
    buffer_load_dwordx4 v50, s[28:31], s54 offen lds
    v_mfma_f32_16x16x32_bf16 v[224:227], v[36:39], a[96:99], v[224:227]
    s_mov_b32 s55, 0x1c00
    ds_read_b64_tr_b16 v[16:17], v8 offset:0
    ds_read_b64_tr_b16 v[18:19], v8 offset:2048
    v_mfma_f32_16x16x32_bf16 v[228:231], v[36:39], a[100:103], v[228:231]
    v_mul_f32 v57, v189, v189
    v_mul_f32 v58, v190, v190
    v_mfma_f32_16x16x32_bf16 v[228:231], v[32:35], a[116:119], v[228:231]
    ds_read_b64_tr_b16 v[20:21], v8 offset:4096
    ds_read_b64_tr_b16 v[22:23], v8 offset:6144
    v_mfma_f32_16x16x32_bf16 v[232:235], v[32:35], a[120:123], v[232:235]
    buffer_load_dwordx4 v50, s[28:31], s55 offen offset:1024 lds
    v_mfma_f32_16x16x32_bf16 v[232:235], v[36:39], a[104:107], v[232:235]
    s_mov_b32 s56, 0x3800
    ds_read_b64_tr_b16 v[24:25], v9 offset:0
    ds_read_b64_tr_b16 v[26:27], v9 offset:2048
    v_mfma_f32_16x16x32_bf16 v[236:239], v[36:39], a[108:111], v[236:239]
    v_mul_f32 v59, v191, v191
    v_fma_f32 v56, v56, s71, v51
    v_mfma_f32_16x16x32_bf16 v[236:239], v[32:35], a[124:127], v[236:239]
    ds_read_b64_tr_b16 v[28:29], v9 offset:4096
    ds_read_b64_tr_b16 v[30:31], v9 offset:6144
    v_mfma_f32_16x16x32_bf16 v[240:243], v[40:43], a[112:115], v[240:243]
    v_fma_f32 v57, v57, s71, v51
    v_fma_f32 v58, v58, s71, v51
    v_mfma_f32_16x16x32_bf16 v[240:243], v[44:47], a[96:99], v[240:243]
    v_fma_f32 v59, v59, s71, v51
    v_mul_f32 v56, v56, v188
    v_mfma_f32_16x16x32_bf16 v[244:247], v[44:47], a[100:103], v[244:247]
    v_mul_f32 v57, v57, v189
    v_mul_f32 v58, v58, v190
    v_mfma_f32_16x16x32_bf16 v[244:247], v[40:43], a[116:119], v[244:247]
    buffer_load_dword v60, v14, s[28:31], s78 offen
    v_mfma_f32_16x16x32_bf16 v[248:251], v[40:43], a[120:123], v[248:251]
    buffer_load_dword v60, v55, s[8:11], s79 offen
    v_mfma_f32_16x16x32_bf16 v[248:251], v[44:47], a[104:107], v[248:251]
    buffer_load_dword v60, v55, s[12:15], s79 offen
    v_mfma_f32_16x16x32_bf16 v[252:255], v[44:47], a[108:111], v[252:255]
    buffer_load_dwordx4 v50, s[28:31], s56 offen offset:2048 lds
    v_mfma_f32_16x16x32_bf16 v[252:255], v[40:43], a[124:127], v[252:255]
    s_waitcnt lgkmcnt(0)
    s_barrier
    v_mul_f32 v59, v59, v191
    v_mfma_f32_16x16x32_bf16 v[192:195], v[16:19], a[80:83], v[192:195]
    s_mov_b32 s57, 0x5400
    ds_read_b64_tr_b16 v[32:33], v10 offset:0
    ds_read_b64_tr_b16 v[34:35], v10 offset:2048
    v_mfma_f32_16x16x32_bf16 v[192:195], v[20:23], a[64:67], v[192:195]
    s_nop 0
    ds_read_b64_tr_b16 v[36:37], v10 offset:4096
    ds_read_b64_tr_b16 v[38:39], v10 offset:6144
    v_mfma_f32_16x16x32_bf16 v[196:199], v[20:23], a[68:71], v[196:199]
    s_nop 0
    ds_read_b64_tr_b16 v[40:41], v11 offset:0
    ds_read_b64_tr_b16 v[42:43], v11 offset:2048
    v_mfma_f32_16x16x32_bf16 v[196:199], v[16:19], a[84:87], v[196:199]
    s_nop 0
    ds_read_b64_tr_b16 v[44:45], v11 offset:4096
    ds_read_b64_tr_b16 v[46:47], v11 offset:6144
    v_mfma_f32_16x16x32_bf16 v[200:203], v[16:19], a[88:91], v[200:203]
    v_exp_f32 v56, v56
    v_mfma_f32_16x16x32_bf16 v[200:203], v[20:23], a[72:75], v[200:203]
    ds_write_b128 v53, v[128:131] offset:0
    v_mfma_f32_16x16x32_bf16 v[204:207], v[20:23], a[76:79], v[204:207]
    v_exp_f32 v57, v57
    v_mfma_f32_16x16x32_bf16 v[204:207], v[16:19], a[92:95], v[204:207]
    v_exp_f32 v58, v58
    v_mfma_f32_16x16x32_bf16 v[208:211], v[24:27], a[80:83], v[208:211]
    ds_write_b128 v53, v[132:135] offset:1024
    v_mfma_f32_16x16x32_bf16 v[208:211], v[28:31], a[64:67], v[208:211]
    v_exp_f32 v59, v59
    v_mfma_f32_16x16x32_bf16 v[212:215], v[28:31], a[68:71], v[212:215]
    buffer_load_dwordx4 v50, s[28:31], s57 offen offset:3072 lds
    v_mfma_f32_16x16x32_bf16 v[212:215], v[24:27], a[84:87], v[212:215]
    s_mov_b32 s54, 0x8000
    ds_write_b128 v53, v[136:139] offset:2048
    v_mfma_f32_16x16x32_bf16 v[216:219], v[24:27], a[88:91], v[216:219]
    s_add_u32 m0, s63, 0x3000
    v_add_f32 v56, 1.0, v56
    v_add_f32 v57, 1.0, v57
    v_mfma_f32_16x16x32_bf16 v[216:219], v[28:31], a[72:75], v[216:219]
    v_add_f32 v58, 1.0, v58
    v_add_f32 v59, 1.0, v59
    v_mfma_f32_16x16x32_bf16 v[220:223], v[28:31], a[76:79], v[220:223]
    ds_write_b128 v53, v[140:143] offset:3072
    v_mfma_f32_16x16x32_bf16 v[220:223], v[24:27], a[92:95], v[220:223]
    s_waitcnt vmcnt(15) lgkmcnt(4)
    v_rcp_f32 v56, v56
    v_mfma_f32_16x16x32_bf16 v[224:227], v[32:35], a[80:83], v[224:227]
    s_nop 0
    ds_read_b64_tr_b16 v[16:17], v4 offset:0
    ds_read_b64_tr_b16 v[18:19], v4 offset:2048
    v_mfma_f32_16x16x32_bf16 v[224:227], v[36:39], a[64:67], v[224:227]
    s_nop 0
    ds_read_b64_tr_b16 v[20:21], v4 offset:4096
    ds_read_b64_tr_b16 v[22:23], v4 offset:6144
    v_mfma_f32_16x16x32_bf16 v[228:231], v[36:39], a[68:71], v[228:231]
    s_nop 0
    ds_read_b64_tr_b16 v[24:25], v5 offset:0
    ds_read_b64_tr_b16 v[26:27], v5 offset:2048
    buffer_load_dwordx4 v50, s[28:31], s54 offen lds
    v_mfma_f32_16x16x32_bf16 v[228:231], v[32:35], a[84:87], v[228:231]
    s_mov_b32 s55, 0x9c00
    ds_read_b64_tr_b16 v[28:29], v5 offset:4096
    ds_read_b64_tr_b16 v[30:31], v5 offset:6144
    v_mfma_f32_16x16x32_bf16 v[232:235], v[32:35], a[88:91], v[232:235]
    v_rcp_f32 v57, v57
    v_mfma_f32_16x16x32_bf16 v[232:235], v[36:39], a[72:75], v[232:235]
    ds_write_b128 v53, v[160:163] offset:4096
    v_mfma_f32_16x16x32_bf16 v[236:239], v[36:39], a[76:79], v[236:239]
    v_rcp_f32 v58, v58
    v_mfma_f32_16x16x32_bf16 v[236:239], v[32:35], a[92:95], v[236:239]
    v_rcp_f32 v59, v59
    v_mfma_f32_16x16x32_bf16 v[240:243], v[40:43], a[80:83], v[240:243]
    ds_write_b128 v53, v[164:167] offset:5120
    v_mfma_f32_16x16x32_bf16 v[240:243], v[44:47], a[64:67], v[240:243]
    v_mul_f32 v56, v56, v188
    v_mul_f32 v57, v57, v189
    v_mfma_f32_16x16x32_bf16 v[244:247], v[44:47], a[68:71], v[244:247]
    v_mul_f32 v58, v58, v190
    v_mul_f32 v59, v59, v191
    v_mfma_f32_16x16x32_bf16 v[244:247], v[40:43], a[84:87], v[244:247]
    ds_write_b128 v53, v[168:171] offset:6144
    v_mfma_f32_16x16x32_bf16 v[248:251], v[40:43], a[88:91], v[248:251]
    v_cvt_pk_bf16_f32 v174, v56, v57
    v_cvt_pk_bf16_f32 v175, v58, v59
    v_mfma_f32_16x16x32_bf16 v[248:251], v[44:47], a[72:75], v[248:251]
    buffer_load_dwordx4 v50, s[28:31], s55 offen offset:1024 lds
    v_mfma_f32_16x16x32_bf16 v[252:255], v[44:47], a[76:79], v[252:255]
    s_mov_b32 s56, 0xb800
    ds_write_b128 v53, v[172:175] offset:7168
    v_mfma_f32_16x16x32_bf16 v[252:255], v[40:43], a[92:95], v[252:255]
    s_waitcnt lgkmcnt(4)
    v_mfma_f32_16x16x32_bf16 v[192:195], v[16:19], a[48:51], v[192:195]
    v_mfma_f32_16x16x32_bf16 v[192:195], v[20:23], a[32:35], v[192:195]
    s_nop 0
    ds_read_b64_tr_b16 v[32:33], v6 offset:0
    ds_read_b64_tr_b16 v[34:35], v6 offset:2048
    v_mfma_f32_16x16x32_bf16 v[196:199], v[20:23], a[36:39], v[196:199]
    buffer_load_dwordx4 v50, s[28:31], s56 offen offset:2048 lds
    v_mfma_f32_16x16x32_bf16 v[196:199], v[16:19], a[52:55], v[196:199]
    s_mov_b32 s57, 0xd400
    ds_read_b64_tr_b16 v[36:37], v6 offset:4096
    ds_read_b64_tr_b16 v[38:39], v6 offset:6144
    v_mfma_f32_16x16x32_bf16 v[200:203], v[16:19], a[56:59], v[200:203]
    buffer_load_dwordx4 v50, s[28:31], s57 offen offset:3072 lds
    v_mfma_f32_16x16x32_bf16 v[200:203], v[20:23], a[40:43], v[200:203]
    s_mov_b32 s54, 0x10000
    s_waitcnt lgkmcnt(4)
    s_barrier
    ds_read_b64_tr_b16 v[40:41], v7 offset:0
    ds_read_b64_tr_b16 v[42:43], v7 offset:2048
    v_mfma_f32_16x16x32_bf16 v[204:207], v[20:23], a[44:47], v[204:207]
    s_add_u32 m0, s63, 0x10000
    ds_read_b128 a[144:147], v54 offset:0
    v_mfma_f32_16x16x32_bf16 v[204:207], v[16:19], a[60:63], v[204:207]
    s_nop 0
    ds_read_b64_tr_b16 v[44:45], v7 offset:4096
    ds_read_b64_tr_b16 v[46:47], v7 offset:6144
    ds_read_b128 a[148:151], v54 offset:1024
    v_mfma_f32_16x16x32_bf16 v[208:211], v[24:27], a[48:51], v[208:211]
    buffer_load_dwordx4 v50, s[28:31], s54 offen lds
    v_mfma_f32_16x16x32_bf16 v[208:211], v[28:31], a[32:35], v[208:211]
    s_mov_b32 s55, 0x11c00
    ds_read_b128 a[152:155], v54 offset:2048
    v_mfma_f32_16x16x32_bf16 v[212:215], v[28:31], a[36:39], v[212:215]
    ds_read_b128 a[156:159], v54 offset:3072
    v_mfma_f32_16x16x32_bf16 v[212:215], v[24:27], a[52:55], v[212:215]
    buffer_load_dwordx4 v50, s[28:31], s55 offen offset:1024 lds
    v_mfma_f32_16x16x32_bf16 v[216:219], v[24:27], a[56:59], v[216:219]
    s_mov_b32 s56, 0x13800
    ds_read_b128 a[160:163], v54 offset:4096
    v_mfma_f32_16x16x32_bf16 v[216:219], v[28:31], a[40:43], v[216:219]
    ds_read_b128 a[164:167], v54 offset:5120
    v_mfma_f32_16x16x32_bf16 v[220:223], v[28:31], a[44:47], v[220:223]
    ds_read_b128 a[168:171], v54 offset:6144
    v_mfma_f32_16x16x32_bf16 v[220:223], v[24:27], a[60:63], v[220:223]
    s_waitcnt vmcnt(13) lgkmcnt(6)
    ds_read_b128 a[172:175], v54 offset:7168
    v_mfma_f32_16x16x32_bf16 v[224:227], v[32:35], a[48:51], v[224:227]
    buffer_load_dwordx4 v50, s[28:31], s56 offen offset:2048 lds
    v_mfma_f32_16x16x32_bf16 v[224:227], v[36:39], a[32:35], v[224:227]
    s_mov_b32 s57, 0x15400
    ds_read_b64_tr_b16 v[16:17], v8 offset:8192
    ds_read_b64_tr_b16 v[18:19], v8 offset:10240
    v_mfma_f32_16x16x32_bf16 v[228:231], v[36:39], a[36:39], v[228:231]
    buffer_load_dwordx4 v50, s[28:31], s57 offen offset:3072 lds
    v_mfma_f32_16x16x32_bf16 v[228:231], v[32:35], a[52:55], v[228:231]
    s_mov_b32 s54, 0x18000
    ds_read_b64_tr_b16 v[20:21], v8 offset:12288
    ds_read_b64_tr_b16 v[22:23], v8 offset:14336
    ds_read_b128 a[176:179], v54 offset:8192
    v_mfma_f32_16x16x32_bf16 v[232:235], v[32:35], a[56:59], v[232:235]
    s_add_u32 m0, s63, 0x11000
    ds_read_b128 a[180:183], v54 offset:9216
    v_sub_u32 v4, v4, v52
    v_sub_u32 v5, v5, v52
    v_mfma_f32_16x16x32_bf16 v[232:235], v[36:39], a[40:43], v[232:235]
    s_nop 0
    ds_read_b64_tr_b16 v[24:25], v9 offset:8192
    ds_read_b64_tr_b16 v[26:27], v9 offset:10240
    v_mfma_f32_16x16x32_bf16 v[236:239], v[36:39], a[44:47], v[236:239]
    buffer_load_dwordx4 v50, s[28:31], s54 offen lds
    v_mfma_f32_16x16x32_bf16 v[236:239], v[32:35], a[60:63], v[236:239]
    s_mov_b32 s55, 0x19c00
    ds_read_b64_tr_b16 v[28:29], v9 offset:12288
    ds_read_b64_tr_b16 v[30:31], v9 offset:14336
    ds_read_b128 a[184:187], v54 offset:10240
    v_mfma_f32_16x16x32_bf16 v[240:243], v[40:43], a[48:51], v[240:243]
    v_sub_u32 v6, v6, v52
    v_sub_u32 v7, v7, v52
    v_mfma_f32_16x16x32_bf16 v[240:243], v[44:47], a[32:35], v[240:243]
    buffer_load_dwordx4 v50, s[28:31], s55 offen offset:1024 lds
    v_mfma_f32_16x16x32_bf16 v[244:247], v[44:47], a[36:39], v[244:247]
    s_mov_b32 s56, 0x1b800
    ds_read_b128 a[188:191], v54 offset:11264
    v_mfma_f32_16x16x32_bf16 v[244:247], v[40:43], a[52:55], v[244:247]
    ds_read_b128 a[192:195], v54 offset:12288
    v_mfma_f32_16x16x32_bf16 v[248:251], v[40:43], a[56:59], v[248:251]
    ds_read_b128 a[196:199], v54 offset:13312
    v_mfma_f32_16x16x32_bf16 v[248:251], v[44:47], a[40:43], v[248:251]
    buffer_load_dwordx4 v50, s[28:31], s56 offen offset:2048 lds
    ds_read_b128 a[200:203], v54 offset:14336
    v_mfma_f32_16x16x32_bf16 v[252:255], v[44:47], a[44:47], v[252:255]
    s_mov_b32 s57, 0x1d400
    ds_read_b128 a[204:207], v54 offset:15360
    v_mfma_f32_16x16x32_bf16 v[252:255], v[40:43], a[60:63], v[252:255]
    s_waitcnt lgkmcnt(6)
    ds_read_b128 a[208:211], v54 offset:16384
    v_mfma_f32_16x16x32_bf16 v[192:195], v[16:19], a[16:19], v[192:195]
    buffer_load_dwordx4 v50, s[28:31], s57 offen offset:3072 lds
    v_mfma_f32_16x16x32_bf16 v[192:195], v[20:23], a[0:3], v[192:195]
    s_mov_b32 s54, 0x20000
    ds_read_b64_tr_b16 v[32:33], v10 offset:8192
    ds_read_b64_tr_b16 v[34:35], v10 offset:10240
    ds_read_b128 a[212:215], v54 offset:17408
    v_mfma_f32_16x16x32_bf16 v[196:199], v[20:23], a[4:7], v[196:199]
    s_add_u32 m0, s63, 0x0
    ds_read_b128 a[216:219], v54 offset:18432
    v_mfma_f32_16x16x32_bf16 v[196:199], v[16:19], a[20:23], v[196:199]
    s_nop 0
    ds_read_b64_tr_b16 v[36:37], v10 offset:12288
    ds_read_b64_tr_b16 v[38:39], v10 offset:14336
    ds_read_b128 a[220:223], v54 offset:19456
    v_mfma_f32_16x16x32_bf16 v[200:203], v[16:19], a[24:27], v[200:203]
    buffer_load_dwordx4 v50, s[28:31], s54 offen lds
    ds_read_b128 a[224:227], v54 offset:20480
    v_mfma_f32_16x16x32_bf16 v[200:203], v[20:23], a[8:11], v[200:203]
    s_mov_b32 s55, 0x21c00
    ds_read_b64_tr_b16 v[40:41], v11 offset:8192
    ds_read_b64_tr_b16 v[42:43], v11 offset:10240
    v_mfma_f32_16x16x32_bf16 v[204:207], v[20:23], a[12:15], v[204:207]
    ds_read_b128 a[228:231], v54 offset:21504
    v_mfma_f32_16x16x32_bf16 v[204:207], v[16:19], a[28:31], v[204:207]
    s_nop 0
    ds_read_b64_tr_b16 v[44:45], v11 offset:12288
    ds_read_b64_tr_b16 v[46:47], v11 offset:14336
    ds_read_b128 a[232:235], v54 offset:22528
    v_mfma_f32_16x16x32_bf16 v[208:211], v[24:27], a[16:19], v[208:211]
    buffer_load_dwordx4 v50, s[28:31], s55 offen offset:1024 lds
    v_mfma_f32_16x16x32_bf16 v[208:211], v[28:31], a[0:3], v[208:211]
    s_mov_b32 s56, 0x23800
    v_cvt_pk_bf16_f32 v72, v192, v193
    v_cvt_pk_bf16_f32 v73, v194, v195
    v_mfma_f32_16x16x32_bf16 v[212:215], v[28:31], a[4:7], v[212:215]
    v_cvt_pk_bf16_f32 v88, v196, v197
    v_cvt_pk_bf16_f32 v89, v198, v199
    v_mfma_f32_16x16x32_bf16 v[212:215], v[24:27], a[20:23], v[212:215]
    buffer_load_dwordx4 v50, s[28:31], s56 offen offset:2048 lds
    v_mfma_f32_16x16x32_bf16 v[216:219], v[24:27], a[24:27], v[216:219]
    s_mov_b32 s57, 0x25400
    v_cvt_pk_bf16_f32 v104, v200, v201
    v_cvt_pk_bf16_f32 v105, v202, v203
    v_mfma_f32_16x16x32_bf16 v[216:219], v[28:31], a[8:11], v[216:219]
    ds_read_b128 a[236:239], v54 offset:23552
    v_cvt_pk_bf16_f32 v120, v204, v205
    v_cvt_pk_bf16_f32 v121, v206, v207
    v_mfma_f32_16x16x32_bf16 v[220:223], v[28:31], a[12:15], v[220:223]
    buffer_load_dwordx4 v50, s[28:31], s57 offen offset:3072 lds
    v_mfma_f32_16x16x32_bf16 v[220:223], v[24:27], a[28:31], v[220:223]
    s_waitcnt vmcnt(12) lgkmcnt(2)
    ds_read_b128 a[240:243], v54 offset:24576
    v_cvt_pk_bf16_f32 v74, v208, v209
    v_cvt_pk_bf16_f32 v75, v210, v211
    v_mfma_f32_16x16x32_bf16 v[224:227], v[32:35], a[16:19], v[224:227]
    s_mov_b32 s54, 0x28000
    v_sub_u32 v8, v8, v52
    v_sub_u32 v9, v9, v52
    v_mfma_f32_16x16x32_bf16 v[224:227], v[36:39], a[0:3], v[224:227]
    s_add_u32 m0, s63, 0x1000
    ds_read_b64_tr_b16 a[32:33], v4 offset:8192
    ds_read_b64_tr_b16 a[34:35], v4 offset:10240
    ds_read_b128 a[244:247], v54 offset:25600
    v_mfma_f32_16x16x32_bf16 v[228:231], v[36:39], a[4:7], v[228:231]
    buffer_load_dwordx4 v50, s[28:31], s54 offen lds
    v_mfma_f32_16x16x32_bf16 v[228:231], v[32:35], a[20:23], v[228:231]
    s_mov_b32 s55, 0x29c00
    ds_read_b64_tr_b16 a[36:37], v4 offset:12288
    ds_read_b64_tr_b16 a[38:39], v4 offset:14336
    v_mfma_f32_16x16x32_bf16 v[232:235], v[32:35], a[24:27], v[232:235]
    v_sub_u32 v10, v10, v52
    v_sub_u32 v11, v11, v52
    v_mfma_f32_16x16x32_bf16 v[232:235], v[36:39], a[8:11], v[232:235]
    ds_read_b64_tr_b16 a[40:41], v5 offset:8192
    ds_read_b64_tr_b16 a[42:43], v5 offset:10240
    v_mfma_f32_16x16x32_bf16 v[236:239], v[36:39], a[12:15], v[236:239]
    buffer_load_dwordx4 v50, s[28:31], s55 offen offset:1024 lds
    ds_read_b128 a[248:251], v54 offset:26624
    v_mfma_f32_16x16x32_bf16 v[236:239], v[32:35], a[28:31], v[236:239]
    s_mov_b32 s56, 0x2b800
    ds_read_b64_tr_b16 a[44:45], v5 offset:12288
    ds_read_b64_tr_b16 a[46:47], v5 offset:14336
    v_mfma_f32_16x16x32_bf16 v[240:243], v[40:43], a[16:19], v[240:243]
    ds_read_b128 a[252:255], v54 offset:27648
    v_cvt_pk_bf16_f32 v90, v212, v213
    v_cvt_pk_bf16_f32 v91, v214, v215
    v_mfma_f32_16x16x32_bf16 v[240:243], v[44:47], a[0:3], v[240:243]
    buffer_load_dwordx4 v50, s[28:31], s56 offen offset:2048 lds
    v_mfma_f32_16x16x32_bf16 v[244:247], v[44:47], a[4:7], v[244:247]
    s_mov_b32 s57, 0x2d400
    v_cvt_pk_bf16_f32 v106, v216, v217
    v_cvt_pk_bf16_f32 v107, v218, v219
    v_mfma_f32_16x16x32_bf16 v[244:247], v[40:43], a[20:23], v[244:247]
    v_cvt_pk_bf16_f32 v122, v220, v221
    v_cvt_pk_bf16_f32 v123, v222, v223
    v_mfma_f32_16x16x32_bf16 v[248:251], v[40:43], a[24:27], v[248:251]
    buffer_load_dwordx4 v50, s[28:31], s57 offen offset:3072 lds
    v_mfma_f32_16x16x32_bf16 v[248:251], v[44:47], a[8:11], v[248:251]
    s_lshl_b32 s77, s3, 13
    v_permlane32_swap_b32 v72, v74
    v_mfma_f32_16x16x32_bf16 v[252:255], v[44:47], a[12:15], v[252:255]
    s_add_u32 m0, s77, 0x20000
    v_permlane32_swap_b32 v73, v75
    v_mfma_f32_16x16x32_bf16 v[252:255], v[40:43], a[28:31], v[252:255]
    s_waitcnt lgkmcnt(0)
    s_barrier
    v_cvt_pk_bf16_f32 v76, v224, v225
    v_mfma_f32_16x16x32_bf16 v[128:131], a[32:35], a[144:147], 0
    buffer_load_dwordx4 v12, s[8:11], s64 offen lds
    v_mfma_f32_16x16x32_bf16 v[128:131], a[36:39], a[160:163], v[128:131]
    s_nop 0
    ds_read_b64_tr_b16 a[48:49], v6 offset:8192
    ds_read_b64_tr_b16 a[50:51], v6 offset:10240
    v_mfma_f32_16x16x32_bf16 v[132:135], a[36:39], a[164:167], 0
    v_permlane32_swap_b32 v88, v90
    v_mfma_f32_16x16x32_bf16 v[132:135], a[32:35], a[148:151], v[132:135]
    ds_read_b64_tr_b16 a[52:53], v6 offset:12288
    ds_read_b64_tr_b16 a[54:55], v6 offset:14336
    v_mfma_f32_16x16x32_bf16 v[136:139], a[32:35], a[152:155], 0
    buffer_load_dwordx4 v13, s[8:11], s64 offen offset:1024 lds
    v_mfma_f32_16x16x32_bf16 v[136:139], a[36:39], a[168:171], v[136:139]
    s_nop 0
    ds_read_b64_tr_b16 a[56:57], v7 offset:8192
    ds_read_b64_tr_b16 a[58:59], v7 offset:10240
    v_mfma_f32_16x16x32_bf16 v[140:143], a[36:39], a[172:175], 0
    v_permlane32_swap_b32 v89, v91
    v_mfma_f32_16x16x32_bf16 v[140:143], a[32:35], a[156:159], v[140:143]
    ds_read_b64_tr_b16 a[60:61], v7 offset:12288
    ds_read_b64_tr_b16 a[62:63], v7 offset:14336
    v_mfma_f32_16x16x32_bf16 v[144:147], a[40:43], a[144:147], 0
    buffer_load_dwordx4 v12, s[8:11], s64 offen offset:2048 lds
    v_mfma_f32_16x16x32_bf16 v[144:147], a[44:47], a[160:163], v[144:147]
    v_permlane32_swap_b32 v104, v106
    v_mfma_f32_16x16x32_bf16 v[148:151], a[44:47], a[164:167], 0
    v_permlane32_swap_b32 v105, v107
    v_mfma_f32_16x16x32_bf16 v[148:151], a[40:43], a[148:151], v[148:151]
    v_permlane32_swap_b32 v120, v122
    v_mfma_f32_16x16x32_bf16 v[152:155], a[40:43], a[152:155], 0
    buffer_load_dwordx4 v13, s[8:11], s64 offen offset:3072 lds
    v_mfma_f32_16x16x32_bf16 v[152:155], a[44:47], a[168:171], v[152:155]
    s_add_u32 m0, s77, 0x21000
    v_permlane32_swap_b32 v121, v123
    v_mfma_f32_16x16x32_bf16 v[156:159], a[44:47], a[172:175], 0
    v_cvt_pk_bf16_f32 v77, v226, v227
    v_cvt_pk_bf16_f32 v92, v228, v229
    v_mfma_f32_16x16x32_bf16 v[156:159], a[40:43], a[156:159], v[156:159]
    s_waitcnt vmcnt(12) lgkmcnt(0)
    v_cvt_pk_bf16_f32 v93, v230, v231
    v_cvt_pk_bf16_f32 v108, v232, v233
    v_mfma_f32_16x16x32_bf16 v[160:163], a[48:51], a[144:147], 0
    buffer_load_dwordx4 v12, s[8:11], s65 offen lds
    v_mfma_f32_16x16x32_bf16 v[160:163], a[52:55], a[160:163], v[160:163]
    s_nop 0
    ds_read_b64_tr_b16 a[32:33], v8 offset:0
    ds_read_b64_tr_b16 a[34:35], v8 offset:2048
    v_mfma_f32_16x16x32_bf16 v[164:167], a[52:55], a[164:167], 0
    v_cvt_pk_bf16_f32 v109, v234, v235
    v_cvt_pk_bf16_f32 v124, v236, v237
    v_mfma_f32_16x16x32_bf16 v[164:167], a[48:51], a[148:151], v[164:167]
    ds_read_b64_tr_b16 a[36:37], v8 offset:4096
    ds_read_b64_tr_b16 a[38:39], v8 offset:6144
    v_mfma_f32_16x16x32_bf16 v[168:171], a[48:51], a[152:155], 0
    buffer_load_dwordx4 v13, s[8:11], s65 offen offset:1024 lds
    v_mfma_f32_16x16x32_bf16 v[168:171], a[52:55], a[168:171], v[168:171]
    s_nop 0
    ds_read_b64_tr_b16 a[40:41], v9 offset:0
    ds_read_b64_tr_b16 a[42:43], v9 offset:2048
    v_mfma_f32_16x16x32_bf16 v[172:175], a[52:55], a[172:175], 0
    v_cvt_pk_bf16_f32 v125, v238, v239
    v_cvt_pk_bf16_f32 v78, v240, v241
    v_mfma_f32_16x16x32_bf16 v[172:175], a[48:51], a[156:159], v[172:175]
    ds_read_b64_tr_b16 a[44:45], v9 offset:4096
    ds_read_b64_tr_b16 a[46:47], v9 offset:6144
    v_mfma_f32_16x16x32_bf16 v[176:179], a[56:59], a[144:147], 0
    buffer_load_dwordx4 v12, s[8:11], s65 offen offset:2048 lds
    v_mfma_f32_16x16x32_bf16 v[176:179], a[60:63], a[160:163], v[176:179]
    v_cvt_pk_bf16_f32 v79, v242, v243
    v_cvt_pk_bf16_f32 v94, v244, v245
    v_mfma_f32_16x16x32_bf16 v[180:183], a[60:63], a[164:167], 0
    v_cvt_pk_bf16_f32 v95, v246, v247
    v_cvt_pk_bf16_f32 v110, v248, v249
    v_mfma_f32_16x16x32_bf16 v[180:183], a[56:59], a[148:151], v[180:183]
    v_cvt_pk_bf16_f32 v111, v250, v251
    v_cvt_pk_bf16_f32 v126, v252, v253
    v_mfma_f32_16x16x32_bf16 v[184:187], a[56:59], a[152:155], 0
    buffer_load_dwordx4 v13, s[8:11], s65 offen offset:3072 lds
    v_mfma_f32_16x16x32_bf16 v[184:187], a[60:63], a[168:171], v[184:187]
    s_nop 0
    v_cvt_pk_bf16_f32 v127, v254, v255
    v_lshrrev_b32 v56, 6, v15
    v_mfma_f32_16x16x32_bf16 v[188:191], a[60:63], a[172:175], 0
    s_add_u32 s64, s64, 0x8000
    s_add_u32 s65, s65, 0x8000
    s_mov_b32 s54, 0x30000
    s_add_u32 m0, s63, 0x12000
    v_mfma_f32_16x16x32_bf16 v[188:191], a[56:59], a[156:159], v[188:191]
    s_waitcnt lgkmcnt(0)
    v_permlane32_swap_b32 v76, v78
    v_mfma_f32_16x16x32_bf16 v[128:131], a[32:35], a[176:179], v[128:131]
    buffer_load_dwordx4 v50, s[28:31], s54 offen lds
    v_mfma_f32_16x16x32_bf16 v[128:131], a[36:39], a[192:195], v[128:131]
    s_mov_b32 s55, 0x31c00
    ds_read_b64_tr_b16 a[48:49], v10 offset:0
    ds_read_b64_tr_b16 a[50:51], v10 offset:2048
    v_mfma_f32_16x16x32_bf16 v[132:135], a[36:39], a[196:199], v[132:135]
    v_permlane32_swap_b32 v77, v79
    v_mfma_f32_16x16x32_bf16 v[132:135], a[32:35], a[180:183], v[132:135]
    ds_read_b64_tr_b16 a[52:53], v10 offset:4096
    ds_read_b64_tr_b16 a[54:55], v10 offset:6144
    v_mfma_f32_16x16x32_bf16 v[136:139], a[32:35], a[184:187], v[136:139]
    buffer_load_dwordx4 v50, s[28:31], s55 offen offset:1024 lds
    v_mfma_f32_16x16x32_bf16 v[136:139], a[36:39], a[200:203], v[136:139]
    s_mov_b32 s56, 0x33800
    ds_read_b64_tr_b16 a[56:57], v11 offset:0
    ds_read_b64_tr_b16 a[58:59], v11 offset:2048
    v_mfma_f32_16x16x32_bf16 v[140:143], a[36:39], a[204:207], v[140:143]
    buffer_load_dwordx4 v50, s[28:31], s56 offen offset:2048 lds
    v_mfma_f32_16x16x32_bf16 v[140:143], a[32:35], a[188:191], v[140:143]
    s_mov_b32 s57, 0x35400
    ds_read_b64_tr_b16 a[60:61], v11 offset:4096
    ds_read_b64_tr_b16 a[62:63], v11 offset:6144
    v_mfma_f32_16x16x32_bf16 v[144:147], a[40:43], a[176:179], v[144:147]
    v_permlane32_swap_b32 v92, v94
    v_mfma_f32_16x16x32_bf16 v[144:147], a[44:47], a[192:195], v[144:147]
    v_permlane32_swap_b32 v93, v95
    v_mfma_f32_16x16x32_bf16 v[148:151], a[44:47], a[196:199], v[148:151]
    buffer_load_dwordx4 v50, s[28:31], s57 offen offset:3072 lds
    v_mfma_f32_16x16x32_bf16 v[148:151], a[40:43], a[180:183], v[148:151]
    s_mov_b32 s54, 0x200
    v_permlane32_swap_b32 v108, v110
    v_mfma_f32_16x16x32_bf16 v[152:155], a[40:43], a[184:187], v[152:155]
    s_add_u32 m0, s63, 0x2000
    v_permlane32_swap_b32 v109, v111
    v_mfma_f32_16x16x32_bf16 v[152:155], a[44:47], a[200:203], v[152:155]
    buffer_load_dwordx4 v50, s[28:31], s54 offen lds
    v_mfma_f32_16x16x32_bf16 v[156:159], a[44:47], a[204:207], v[156:159]
    s_mov_b32 s55, 0x1e00
    v_permlane32_swap_b32 v124, v126
    v_mfma_f32_16x16x32_bf16 v[156:159], a[40:43], a[188:191], v[156:159]
    s_waitcnt vmcnt(13) lgkmcnt(0)
    v_permlane32_swap_b32 v125, v127
    v_mfma_f32_16x16x32_bf16 v[160:163], a[48:51], a[176:179], v[160:163]
    v_lshlrev_b32 v58, 7, v56
    v_bfe_u32 v57, v15, 4, 2
    v_mfma_f32_16x16x32_bf16 v[160:163], a[52:55], a[192:195], v[160:163]
    ds_read_b64_tr_b16 a[32:33], v4 offset:0
    ds_read_b64_tr_b16 a[34:35], v4 offset:2048
    v_mfma_f32_16x16x32_bf16 v[164:167], a[52:55], a[196:199], v[164:167]
    buffer_load_dwordx4 v50, s[28:31], s55 offen offset:1024 lds
    v_mfma_f32_16x16x32_bf16 v[164:167], a[48:51], a[180:183], v[164:167]
    s_mov_b32 s56, 0x3a00
    ds_read_b64_tr_b16 a[36:37], v4 offset:4096
    ds_read_b64_tr_b16 a[38:39], v4 offset:6144
    v_mfma_f32_16x16x32_bf16 v[168:171], a[48:51], a[184:187], v[168:171]
    buffer_load_dwordx4 v50, s[28:31], s56 offen offset:2048 lds
    v_mfma_f32_16x16x32_bf16 v[168:171], a[52:55], a[200:203], v[168:171]
    s_mov_b32 s57, 0x5600
    ds_read_b64_tr_b16 a[40:41], v5 offset:0
    ds_read_b64_tr_b16 a[42:43], v5 offset:2048
    v_mfma_f32_16x16x32_bf16 v[172:175], a[52:55], a[204:207], v[172:175]
    v_lshl_add_u32 v58, v57, 3, v58
    v_bfe_u32 v59, v15, 7, 2
    v_mfma_f32_16x16x32_bf16 v[172:175], a[48:51], a[188:191], v[172:175]
    ds_read_b64_tr_b16 a[44:45], v5 offset:4096
    ds_read_b64_tr_b16 a[46:47], v5 offset:6144
    v_mfma_f32_16x16x32_bf16 v[176:179], a[56:59], a[176:179], v[176:179]
    buffer_load_dwordx4 v50, s[28:31], s57 offen offset:3072 lds
    v_mfma_f32_16x16x32_bf16 v[176:179], a[60:63], a[192:195], v[176:179]
    s_mov_b32 s54, 0x8200
    v_xor_b32 v59, s3, v59
    v_lshl_add_u32 v48, v59, 5, v58
    v_mfma_f32_16x16x32_bf16 v[180:183], a[60:63], a[196:199], v[180:183]
    s_add_u32 m0, s63, 0x3000
    v_bfe_u32 v58, v56, 1, 2
    v_lshlrev_b32 v58, 2, v58
    v_mfma_f32_16x16x32_bf16 v[180:183], a[56:59], a[180:183], v[180:183]
    buffer_load_dwordx4 v50, s[28:31], s54 offen lds
    v_mfma_f32_16x16x32_bf16 v[184:187], a[56:59], a[184:187], v[184:187]
    s_mov_b32 s55, 0x9e00
    v_and_or_b32 v58, v56, 1, v58
    v_xor_b32 v57, v57, v58
    v_mfma_f32_16x16x32_bf16 v[184:187], a[60:63], a[200:203], v[184:187]
    v_lshrrev_b32 v58, 2, v56
    v_and_b32 v58, 2, v58
    v_mfma_f32_16x16x32_bf16 v[188:191], a[60:63], a[204:207], v[188:191]
    v_xor_b32 v57, v57, v58
    v_lshlrev_b32 v49, 7, v56
    v_mfma_f32_16x16x32_bf16 v[188:191], a[56:59], a[188:191], v[188:191]
    s_waitcnt vmcnt(9) lgkmcnt(0)
    s_barrier
    buffer_load_dwordx4 v50, s[28:31], s55 offen offset:1024 lds
    v_mfma_f32_16x16x32_bf16 v[128:131], a[32:35], a[208:211], v[128:131]
    s_mov_b32 s56, 0xba00
    ds_read_b128 a[64:67], v0 offset:0
    v_lshl_add_u32 v49, v57, 3, v49
    v_mfma_f32_16x16x32_bf16 v[128:131], a[36:39], a[224:227], v[128:131]
    s_nop 0
    ds_read_b64_tr_b16 a[48:49], v6 offset:0
    ds_read_b64_tr_b16 a[50:51], v6 offset:2048
    v_mfma_f32_16x16x32_bf16 v[132:135], a[36:39], a[228:231], v[132:135]
    ds_read_b128 a[68:71], v1 offset:0
    buffer_load_dwordx4 v50, s[28:31], s56 offen offset:2048 lds
    v_mfma_f32_16x16x32_bf16 v[132:135], a[32:35], a[212:215], v[132:135]
    s_mov_b32 s57, 0xd600
    ds_read_b64_tr_b16 a[52:53], v6 offset:4096
    ds_read_b64_tr_b16 a[54:55], v6 offset:6144
    v_mfma_f32_16x16x32_bf16 v[136:139], a[32:35], a[216:219], v[136:139]
    ds_read_b128 a[72:75], v2 offset:0
    v_bfe_u32 v56, v15, 4, 4
    v_mfma_f32_16x16x32_bf16 v[136:139], a[36:39], a[232:235], v[136:139]
    s_nop 0
    ds_read_b64_tr_b16 a[56:57], v7 offset:0
    ds_read_b64_tr_b16 a[58:59], v7 offset:2048
    v_mfma_f32_16x16x32_bf16 v[140:143], a[36:39], a[236:239], v[140:143]
    ds_read_b128 a[76:79], v3 offset:0
    buffer_load_dwordx4 v50, s[28:31], s57 offen offset:3072 lds
    v_mfma_f32_16x16x32_bf16 v[140:143], a[32:35], a[220:223], v[140:143]
L_PAD3:
    s_cbranch_execz L_PAD7
    s_mov_b32 s54, 0x10200
    ds_read_b64_tr_b16 a[60:61], v7 offset:4096
    ds_read_b64_tr_b16 a[62:63], v7 offset:6144
    v_mfma_f32_16x16x32_bf16 v[144:147], a[40:43], a[208:211], v[144:147]
    s_add_u32 m0, s63, 0x10000
    v_lshrrev_b32 v57, 8, v15
    v_bfe_u32 v58, v56, 1, 2
    v_mfma_f32_16x16x32_bf16 v[144:147], a[44:47], a[224:227], v[144:147]
    buffer_load_dwordx4 v50, s[28:31], s54 offen lds
    v_mfma_f32_16x16x32_bf16 v[148:151], a[44:47], a[228:231], v[148:151]
    s_mov_b32 s55, 0x11e00
    v_lshlrev_b32 v58, 2, v58
    v_and_or_b32 v58, v56, 1, v58
    v_mfma_f32_16x16x32_bf16 v[148:151], a[40:43], a[212:215], v[148:151]
    v_xor_b32 v57, v57, v58
    v_lshrrev_b32 v58, 2, v56
    v_mfma_f32_16x16x32_bf16 v[152:155], a[40:43], a[216:219], v[152:155]
    v_and_b32 v58, 2, v58
    v_xor_b32 v57, v57, v58
    v_mfma_f32_16x16x32_bf16 v[152:155], a[44:47], a[232:235], v[152:155]
    buffer_load_dwordx4 v50, s[28:31], s55 offen offset:1024 lds
    v_mfma_f32_16x16x32_bf16 v[156:159], a[44:47], a[236:239], v[156:159]
    s_mov_b32 s56, 0x13a00
    v_lshlrev_b32 v51, 7, v56
    v_lshl_add_u32 v51, v57, 3, v51
    v_mfma_f32_16x16x32_bf16 v[156:159], a[40:43], a[220:223], v[156:159]
    s_waitcnt lgkmcnt(2)
    v_add_u32 v51, s63, v51
    v_mfma_f32_16x16x32_bf16 v[16:19], a[64:67], v[64:67], 0
    buffer_load_dwordx4 v50, s[28:31], s56 offen offset:2048 lds
    v_mfma_f32_16x16x32_bf16 v[16:19], a[68:71], v[68:71], v[16:19]
    s_mov_b32 s57, 0x15600
    v_bfe_u32 v58, v15, 4, 2
    v_cmp_eq_u32 vcc, 1, v58
    v_mfma_f32_16x16x32_bf16 v[16:19], a[72:75], v[72:75], v[16:19]
    v_mov_b32 v56, 0x44444444
    v_mov_b32 v57, 0xeeeeeeee
    v_mfma_f32_16x16x32_bf16 v[16:19], a[76:79], v[76:79], v[16:19]
    v_cndmask_b32 v14, v56, v57, vcc
    v_cmp_gt_u32 vcc, 2, v58
    v_mfma_f32_16x16x32_bf16 v[20:23], a[64:67], v[80:83], 0
    buffer_load_dwordx4 v50, s[28:31], s57 offen offset:3072 lds
    v_mfma_f32_16x16x32_bf16 v[20:23], a[68:71], v[84:87], v[20:23]
    s_mov_b32 s54, 0x18200
    v_mov_b32 v56, 0x3f803f80
    v_lshrrev_b32 v57, 6, v15
    v_mfma_f32_16x16x32_bf16 v[20:23], a[72:75], v[88:91], v[20:23]
    s_add_u32 m0, s63, 0x11000
    v_cndmask_b32 v59, 0, v56, vcc
    v_lshlrev_b32 v56, 8, v57
    v_mfma_f32_16x16x32_bf16 v[20:23], a[76:79], v[92:95], v[20:23]
    buffer_load_dwordx4 v50, s[28:31], s54 offen lds
    v_mfma_f32_16x16x32_bf16 v[24:27], a[64:67], v[96:99], 0
    s_mov_b32 s55, 0x19e00
    v_and_b32 v57, 7, v57
    v_lshl_add_u32 v56, v58, 3, v56
    v_mfma_f32_16x16x32_bf16 v[24:27], a[68:71], v[100:103], v[24:27]
    v_add_u32 v56, 0x10000, v56
    v_accvgpr_write_b32 a128, 0
    v_mfma_f32_16x16x32_bf16 v[24:27], a[72:75], v[104:107], v[24:27]
    v_accvgpr_write_b32 a129, 0
    v_accvgpr_write_b32 a132, 0
    v_mfma_f32_16x16x32_bf16 v[24:27], a[76:79], v[108:111], v[24:27]
    buffer_load_dwordx4 v50, s[28:31], s55 offen offset:1024 lds
    v_max3_f32 v16, v16, v17, v18
    v_mfma_f32_16x16x32_bf16 v[28:31], a[64:67], v[112:115], 0
    s_mov_b32 s56, 0x1ba00
    v_max_f32 v16, v16, v19
    v_accvgpr_write_b32 a133, 0
    v_accvgpr_write_b32 a136, 0
    v_mfma_f32_16x16x32_bf16 v[28:31], a[68:71], v[116:119], v[28:31]
    v_accvgpr_write_b32 a137, 0
    v_accvgpr_write_b32 a140, 0
    v_accvgpr_write_b32 a141, 0
    v_mfma_f32_16x16x32_bf16 v[28:31], a[72:75], v[120:123], v[28:31]
    buffer_load_dwordx4 v50, s[28:31], s56 offen offset:2048 lds
    v_mfma_f32_16x16x32_bf16 v[28:31], a[76:79], v[124:127], v[28:31]
    s_waitcnt vmcnt(15) lgkmcnt(0)
    v_max3_f32 v20, v20, v21, v22
    v_max_f32 v20, v20, v23
    v_mfma_f32_16x16x32_bf16 v[160:163], a[48:51], a[208:211], v[160:163]
    s_mov_b32 s57, 0x1d600
    ds_read_b64_tr_b16 a[32:33], v8 offset:8192
    ds_read_b64_tr_b16 a[34:35], v8 offset:10240
    v_mfma_f32_16x16x32_bf16 v[160:163], a[52:55], a[224:227], v[160:163]
    s_nop 0
    ds_read_b64_tr_b16 a[40:41], v9 offset:8192
    ds_read_b64_tr_b16 a[42:43], v9 offset:10240
    v_mfma_f32_16x16x32_bf16 v[164:167], a[52:55], a[228:231], v[164:167]
    buffer_load_dwordx4 v50, s[28:31], s57 offen offset:3072 lds
    v_mfma_f32_16x16x32_bf16 v[164:167], a[48:51], a[212:215], v[164:167]
    s_mov_b32 s54, 0x20200
    v_max3_f32 v24, v24, v25, v26
    v_max_f32 v24, v24, v27
    v_mfma_f32_16x16x32_bf16 v[168:171], a[48:51], a[216:219], v[168:171]
    s_add_u32 m0, s63, 0x0
    v_mfma_f32_16x16x32_bf16 v[168:171], a[52:55], a[232:235], v[168:171]
    buffer_load_dwordx4 v50, s[28:31], s54 offen lds
    v_mfma_f32_16x16x32_bf16 v[172:175], a[52:55], a[236:239], v[172:175]
    s_mov_b32 s55, 0x21e00
    v_mfma_f32_16x16x32_bf16 v[172:175], a[48:51], a[220:223], v[172:175]
    v_max3_f32 v28, v28, v29, v30
    v_max_f32 v28, v28, v31
    v_mov_b32 v17, v16
    v_mfma_f32_16x16x32_bf16 v[176:179], a[56:59], a[208:211], v[176:179]
    v_mov_b32 v21, v20
    v_mov_b32 v25, v24
    v_mov_b32 v29, v28
    v_mfma_f32_16x16x32_bf16 v[176:179], a[60:63], a[224:227], v[176:179]
    buffer_load_dwordx4 v50, s[28:31], s55 offen offset:1024 lds
    v_mfma_f32_16x16x32_bf16 v[180:183], a[60:63], a[228:231], v[180:183]
    s_mov_b32 s56, 0x23a00
    v_permlane32_swap_b32 v16, v17
    v_mfma_f32_16x16x32_bf16 v[180:183], a[56:59], a[212:215], v[180:183]
    v_permlane32_swap_b32 v20, v21
    v_mfma_f32_16x16x32_bf16 v[184:187], a[56:59], a[216:219], v[184:187]
    buffer_load_dwordx4 v50, s[28:31], s56 offen offset:2048 lds
    v_permlane32_swap_b32 v24, v25
    v_mfma_f32_16x16x32_bf16 v[184:187], a[60:63], a[232:235], v[184:187]
    s_mov_b32 s57, 0x25600
    v_permlane32_swap_b32 v28, v29
    v_max_f32 v16, v16, v17
    v_max_f32 v20, v20, v21
    v_mfma_f32_16x16x32_bf16 v[188:191], a[60:63], a[236:239], v[188:191]
    v_max_f32 v24, v24, v25
    v_max_f32 v28, v28, v29
    v_mov_b32 v17, v16
    v_mfma_f32_16x16x32_bf16 v[188:191], a[56:59], a[220:223], v[188:191]
    s_waitcnt lgkmcnt(0)
    v_mov_b32 v21, v20
    v_mov_b32 v25, v24
    v_mov_b32 v29, v28
    v_mfma_f32_16x16x32_bf16 v[128:131], a[32:35], a[240:243], v[128:131]
    s_nop 0
    ds_read_b64_tr_b16 a[48:49], v10 offset:8192
    ds_read_b64_tr_b16 a[50:51], v10 offset:10240
    buffer_load_dwordx4 v50, s[28:31], s57 offen offset:3072 lds
    v_mfma_f32_16x16x32_bf16 v[132:135], a[32:35], a[244:247], v[132:135]
    s_mov_b32 s54, 0x28200
    ds_read_b64_tr_b16 a[56:57], v11 offset:8192
    ds_read_b64_tr_b16 a[58:59], v11 offset:10240
    v_mfma_f32_16x16x32_bf16 v[136:139], a[32:35], a[248:251], v[136:139]
    s_add_u32 m0, s63, 0x1000
    v_permlane16_swap_b32 v16, v17
    v_permlane16_swap_b32 v20, v21
    v_mfma_f32_16x16x32_bf16 v[140:143], a[32:35], a[252:255], v[140:143]
    buffer_load_dwordx4 v50, s[28:31], s54 offen lds
    v_permlane16_swap_b32 v24, v25
    v_mfma_f32_16x16x32_bf16 v[144:147], a[40:43], a[240:243], v[144:147]
    s_mov_b32 s55, 0x29e00
    v_permlane16_swap_b32 v28, v29
    v_max_f32 v16, v16, v17
    v_mfma_f32_16x16x32_bf16 v[148:151], a[40:43], a[244:247], v[148:151]
    v_max_f32 v20, v20, v21
    v_max_f32 v24, v24, v25
    v_max_f32 v28, v28, v29
    v_mfma_f32_16x16x32_bf16 v[152:155], a[40:43], a[248:251], v[152:155]
    v_sub_f32 v16, 0xc1200000, v16
    v_sub_f32 v20, 0xc1200000, v20
    v_sub_f32 v24, 0xc1200000, v24
    v_mfma_f32_16x16x32_bf16 v[156:159], a[40:43], a[252:255], v[156:159]
    s_waitcnt vmcnt(13) lgkmcnt(0)
    v_sub_f32 v28, 0xc1200000, v28
    v_mov_b32 v17, v16
    v_mov_b32 v18, v16
    v_mfma_f32_16x16x32_bf16 v[160:163], a[48:51], a[240:243], v[160:163]
    buffer_load_dwordx4 v50, s[28:31], s55 offen offset:1024 lds
    v_mov_b32 v19, v16
    v_mfma_f32_16x16x32_bf16 v[164:167], a[48:51], a[244:247], v[164:167]
    s_mov_b32 s56, 0x2ba00
    ds_read_b64_tr_b16 a[32:33], v4 offset:8192
    ds_read_b64_tr_b16 a[34:35], v4 offset:10240
    v_mov_b32 v21, v20
    v_mfma_f32_16x16x32_bf16 v[168:171], a[48:51], a[248:251], v[168:171]
    buffer_load_dwordx4 v50, s[28:31], s56 offen offset:2048 lds
    v_mov_b32 v22, v20
    v_mov_b32 v23, v20
    v_mfma_f32_16x16x32_bf16 v[172:175], a[48:51], a[252:255], v[172:175]
    s_mov_b32 s57, 0x2d600
    ds_read_b64_tr_b16 a[36:37], v4 offset:12288
    ds_read_b64_tr_b16 a[38:39], v4 offset:14336
    v_mov_b32 v25, v24
    v_mov_b32 v26, v24
    v_mfma_f32_16x16x32_bf16 v[176:179], a[56:59], a[240:243], v[176:179]
    v_mov_b32 v27, v24
    v_mov_b32 v29, v28
    v_mov_b32 v30, v28
    v_mfma_f32_16x16x32_bf16 v[180:183], a[56:59], a[244:247], v[180:183]
    ds_read_b64_tr_b16 a[40:41], v5 offset:8192
    ds_read_b64_tr_b16 a[42:43], v5 offset:10240
    v_mov_b32 v31, v28
    v_mfma_f32_16x16x32_bf16 v[184:187], a[56:59], a[248:251], v[184:187]
    s_nop 0
    ds_read_b64_tr_b16 a[44:45], v5 offset:12288
    ds_read_b64_tr_b16 a[46:47], v5 offset:14336
    v_cvt_pk_bf16_f32 v143, v142, v143
    v_cvt_pk_bf16_f32 v142, v140, v141
    v_mfma_f32_16x16x32_bf16 v[188:191], a[56:59], a[252:255], v[188:191]
    s_waitcnt lgkmcnt(0)
    buffer_load_dwordx4 v50, s[28:31], s57 offen offset:3072 lds
    v_mfma_f32_16x16x32_bf16 v[32:35], a[64:67], v[64:67], v[16:19]
    s_mov_b32 s54, 0x30200
    s_add_u32 m0, s63, 0x12000
    ds_read_b128 a[80:83], v0 offset:4096
    v_cvt_pk_bf16_f32 v141, v138, v139
    v_mfma_f32_16x16x32_bf16 v[32:35], a[68:71], v[68:71], v[32:35]
    ds_read_b128 a[84:87], v1 offset:4096
    v_cvt_pk_bf16_f32 v140, v136, v137
    v_mfma_f32_16x16x32_bf16 v[32:35], a[72:75], v[72:75], v[32:35]
    ds_read_b128 a[88:91], v2 offset:4096
    v_cvt_pk_bf16_f32 v139, v134, v135
    v_cvt_pk_bf16_f32 v159, v158, v159
    v_mfma_f32_16x16x32_bf16 v[32:35], a[76:79], v[76:79], v[32:35]
    s_nop 0
    ds_read_b128 a[92:95], v3 offset:4096
    ds_read_b64_tr_b16 a[48:49], v6 offset:8192
    v_cvt_pk_bf16_f32 v138, v132, v133
    v_mfma_f32_16x16x32_bf16 v[192:195], a[32:35], a[144:147], 0
    s_nop 0
    ds_read_b64_tr_b16 a[50:51], v6 offset:10240
    ds_read_b64_tr_b16 a[52:53], v6 offset:12288
    v_cvt_pk_bf16_f32 v175, v174, v175
    v_mfma_f32_16x16x32_bf16 v[192:195], a[36:39], a[160:163], v[192:195]
    s_nop 0
    ds_read_b64_tr_b16 a[54:55], v6 offset:14336
    ds_read_b64_tr_b16 a[56:57], v7 offset:8192
    v_cvt_pk_bf16_f32 v158, v156, v157
    v_mfma_f32_16x16x32_bf16 v[196:199], a[36:39], a[164:167], 0
    s_nop 0
    ds_read_b64_tr_b16 a[58:59], v7 offset:10240
    ds_read_b64_tr_b16 a[60:61], v7 offset:12288
    v_mfma_f32_16x16x32_bf16 v[196:199], a[32:35], a[148:151], v[196:199]
    ds_read_b64_tr_b16 a[62:63], v7 offset:14336
    v_cvt_pk_bf16_f32 v137, v130, v131
    v_cvt_pk_bf16_f32 v157, v154, v155
    v_mfma_f32_16x16x32_bf16 v[36:39], a[64:67], v[80:83], v[20:23]
    v_exp_f32 v32, v32
    v_cvt_pk_bf16_f32 v136, v128, v129
    v_mfma_f32_16x16x32_bf16 v[36:39], a[68:71], v[84:87], v[36:39]
    buffer_load_dwordx4 v50, s[28:31], s54 offen lds
    s_mov_b32 s55, 0x31e00
    v_mfma_f32_16x16x32_bf16 v[36:39], a[72:75], v[88:91], v[36:39]
    v_exp_f32 v33, v33
    v_mfma_f32_16x16x32_bf16 v[36:39], a[76:79], v[92:95], v[36:39]
    v_cvt_pk_bf16_f32 v128, v32, v33
    v_cvt_pk_bf16_f32 v156, v152, v153
    v_cvt_pk_bf16_f32 v155, v150, v151
    v_mfma_f32_16x16x32_bf16 v[200:203], a[32:35], a[152:155], 0
    v_exp_f32 v34, v34
    v_cvt_pk_bf16_f32 v191, v190, v191
    v_mfma_f32_16x16x32_bf16 v[200:203], a[36:39], a[168:171], v[200:203]
    buffer_load_dwordx4 v50, s[28:31], s55 offen offset:1024 lds
    s_mov_b32 s56, 0x33a00
    v_mfma_f32_16x16x32_bf16 v[204:207], a[36:39], a[172:175], 0
    v_exp_f32 v35, v35
    v_cvt_pk_bf16_f32 v174, v172, v173
    v_mfma_f32_16x16x32_bf16 v[204:207], a[32:35], a[156:159], v[204:207]
    v_cvt_pk_bf16_f32 v129, v34, v35
    v_cvt_pk_bf16_f32 v154, v148, v149
    v_cvt_pk_bf16_f32 v153, v146, v147
    v_mfma_f32_16x16x32_bf16 v[32:35], a[64:67], v[96:99], v[24:27]
    v_exp_f32 v36, v36
    v_cvt_pk_bf16_f32 v152, v144, v145
    v_mfma_f32_16x16x32_bf16 v[32:35], a[68:71], v[100:103], v[32:35]
    buffer_load_dwordx4 v50, s[28:31], s56 offen offset:2048 lds
    s_mov_b32 s57, 0x35600
    v_mfma_f32_16x16x32_bf16 v[32:35], a[72:75], v[104:107], v[32:35]
    v_exp_f32 v37, v37
    v_mfma_f32_16x16x32_bf16 v[32:35], a[76:79], v[108:111], v[32:35]
    v_cvt_pk_bf16_f32 v144, v36, v37
    v_cvt_pk_bf16_f32 v173, v170, v171
    v_mfma_f32_16x16x32_bf16 v[208:211], a[40:43], a[144:147], 0
    v_exp_f32 v38, v38
    v_cvt_pk_bf16_f32 v172, v168, v169
    v_mfma_f32_16x16x32_bf16 v[208:211], a[44:47], a[160:163], v[208:211]
    buffer_load_dwordx4 v50, s[28:31], s57 offen offset:3072 lds
    v_mfma_f32_16x16x32_bf16 v[212:215], a[44:47], a[164:167], 0
    v_exp_f32 v39, v39
    v_cvt_pk_bf16_f32 v190, v188, v189
    v_mfma_f32_16x16x32_bf16 v[212:215], a[40:43], a[148:151], v[212:215]
    v_cvt_pk_bf16_f32 v145, v38, v39
    v_cvt_pk_bf16_f32 v171, v166, v167
    v_cvt_pk_bf16_f32 v170, v164, v165
    v_mfma_f32_16x16x32_bf16 v[36:39], a[64:67], v[112:115], v[28:31]
    v_exp_f32 v32, v32
    v_mfma_f32_16x16x32_bf16 v[36:39], a[68:71], v[116:119], v[36:39]
    v_cvt_pk_bf16_f32 v169, v162, v163
    v_cvt_pk_bf16_f32 v168, v160, v161
    v_mfma_f32_16x16x32_bf16 v[36:39], a[72:75], v[120:123], v[36:39]
    v_exp_f32 v33, v33
    v_cvt_pk_bf16_f32 v189, v186, v187
    v_mfma_f32_16x16x32_bf16 v[36:39], a[76:79], v[124:127], v[36:39]
    v_cvt_pk_bf16_f32 v160, v32, v33
    v_cvt_pk_bf16_f32 v188, v184, v185
    v_mfma_f32_16x16x32_bf16 v[216:219], a[40:43], a[152:155], 0
    v_exp_f32 v34, v34
    v_mfma_f32_16x16x32_bf16 v[216:219], a[44:47], a[168:171], v[216:219]
    s_add_u32 m0, s63, 0x2000
    v_cvt_pk_bf16_f32 v187, v182, v183
    v_cvt_pk_bf16_f32 v186, v180, v181
    v_mfma_f32_16x16x32_bf16 v[220:223], a[44:47], a[172:175], 0
    v_exp_f32 v35, v35
    v_cvt_pk_bf16_f32 v185, v178, v179
    v_mfma_f32_16x16x32_bf16 v[220:223], a[40:43], a[156:159], v[220:223]
    s_waitcnt vmcnt(12) lgkmcnt(0)
    v_cvt_pk_bf16_f32 v161, v34, v35
    v_cvt_pk_bf16_f32 v184, v176, v177
    v_mfma_f32_16x16x32_bf16 v[32:35], a[80:83], v[64:67], v[16:19]
    v_exp_f32 v36, v36
    v_mfma_f32_16x16x32_bf16 v[32:35], a[84:87], v[68:71], v[32:35]
    ds_read_b128 a[64:67], v0 offset:8192
    buffer_load_dwordx4 v12, s[8:11], s64 offen lds
    v_mfma_f32_16x16x32_bf16 v[32:35], a[88:91], v[72:75], v[32:35]
    v_exp_f32 v37, v37
    v_mfma_f32_16x16x32_bf16 v[32:35], a[92:95], v[76:79], v[32:35]
    ds_read_b128 a[68:71], v1 offset:8192
    v_cvt_pk_bf16_f32 v176, v36, v37
    v_mfma_f32_16x16x32_bf16 v[224:227], a[48:51], a[144:147], 0
    v_exp_f32 v38, v38
    v_mfma_f32_16x16x32_bf16 v[224:227], a[52:55], a[160:163], v[224:227]
    ds_read_b128 a[72:75], v2 offset:8192
    buffer_load_dwordx4 v13, s[8:11], s64 offen offset:1024 lds
    v_mfma_f32_16x16x32_bf16 v[228:231], a[52:55], a[164:167], 0
    v_exp_f32 v39, v39
    v_mfma_f32_16x16x32_bf16 v[228:231], a[48:51], a[148:151], v[228:231]
    ds_read_b128 a[76:79], v3 offset:8192
    v_cvt_pk_bf16_f32 v177, v38, v39
    v_mfma_f32_16x16x32_bf16 v[36:39], a[80:83], v[80:83], v[20:23]
    buffer_load_dwordx4 v12, s[8:11], s64 offen offset:2048 lds
    v_exp_f32 v32, v32
    v_mfma_f32_16x16x32_bf16 v[36:39], a[84:87], v[84:87], v[36:39]
    s_nop 0
    ds_read_b64_tr_b16 a[32:33], v8 offset:0
    ds_read_b64_tr_b16 a[34:35], v8 offset:2048
    v_mfma_f32_16x16x32_bf16 v[36:39], a[88:91], v[88:91], v[36:39]
    v_exp_f32 v33, v33
    v_mfma_f32_16x16x32_bf16 v[36:39], a[92:95], v[92:95], v[36:39]
    ds_read_b64_tr_b16 a[36:37], v8 offset:4096
    v_cvt_pk_bf16_f32 v130, v32, v33
    v_mfma_f32_16x16x32_bf16 v[232:235], a[48:51], a[152:155], 0
    v_exp_f32 v34, v34
    v_mfma_f32_16x16x32_bf16 v[232:235], a[52:55], a[168:171], v[232:235]
    ds_read_b64_tr_b16 a[38:39], v8 offset:6144
    ds_read_b64_tr_b16 a[40:41], v9 offset:0
    v_mfma_f32_16x16x32_bf16 v[236:239], a[52:55], a[172:175], 0
    v_exp_f32 v35, v35
    v_mfma_f32_16x16x32_bf16 v[236:239], a[48:51], a[156:159], v[236:239]
    ds_read_b64_tr_b16 a[42:43], v9 offset:2048
    v_cvt_pk_bf16_f32 v131, v34, v35
    v_mfma_f32_16x16x32_bf16 v[32:35], a[80:83], v[96:99], v[24:27]
    v_exp_f32 v36, v36
    v_mfma_f32_16x16x32_bf16 v[32:35], a[84:87], v[100:103], v[32:35]
    ds_read_b64_tr_b16 a[44:45], v9 offset:4096
    ds_read_b64_tr_b16 a[46:47], v9 offset:6144
    v_mfma_f32_16x16x32_bf16 v[32:35], a[88:91], v[104:107], v[32:35]
    v_exp_f32 v37, v37
    v_mfma_f32_16x16x32_bf16 v[32:35], a[92:95], v[108:111], v[32:35]
    buffer_load_dwordx4 v13, s[8:11], s64 offen offset:3072 lds
    s_add_u32 m0, s63, 0x3000
    v_cvt_pk_bf16_f32 v146, v36, v37
    v_mfma_f32_16x16x32_bf16 v[240:243], a[56:59], a[144:147], 0
    v_exp_f32 v38, v38
    v_mfma_f32_16x16x32_bf16 v[240:243], a[60:63], a[160:163], v[240:243]
    buffer_load_dwordx4 v12, s[8:11], s65 offen lds
    v_mfma_f32_16x16x32_bf16 v[244:247], a[60:63], a[164:167], 0
    v_exp_f32 v39, v39
    v_mfma_f32_16x16x32_bf16 v[244:247], a[56:59], a[148:151], v[244:247]
    v_cvt_pk_bf16_f32 v147, v38, v39
    v_mfma_f32_16x16x32_bf16 v[36:39], a[80:83], v[112:115], v[28:31]
    s_add_u32 s73, s72, 0x0
    v_exp_f32 v32, v32
    v_mfma_f32_16x16x32_bf16 v[36:39], a[84:87], v[116:119], v[36:39]
    buffer_load_dwordx4 v13, s[8:11], s65 offen offset:1024 lds
    buffer_store_dwordx4 v[136:139], v15, s[80:83], s73 offen sc1
    v_mfma_f32_16x16x32_bf16 v[36:39], a[88:91], v[120:123], v[36:39]
    v_exp_f32 v33, v33
    v_mfma_f32_16x16x32_bf16 v[36:39], a[92:95], v[124:127], v[36:39]
    v_cvt_pk_bf16_f32 v162, v32, v33
    v_mfma_f32_16x16x32_bf16 v[248:251], a[56:59], a[152:155], 0
    s_add_u32 s74, s72, 0x200000
    v_exp_f32 v34, v34
    v_mfma_f32_16x16x32_bf16 v[248:251], a[60:63], a[168:171], v[248:251]
    buffer_load_dwordx4 v12, s[8:11], s65 offen offset:2048 lds
    buffer_store_dwordx4 v[152:155], v15, s[80:83], s74 offen sc1
    v_mfma_f32_16x16x32_bf16 v[252:255], a[60:63], a[172:175], 0
    v_exp_f32 v35, v35
    v_mfma_f32_16x16x32_bf16 v[252:255], a[56:59], a[156:159], v[252:255]
    s_waitcnt lgkmcnt(0)
    buffer_load_dwordx4 v13, s[8:11], s65 offen offset:3072 lds
    v_cvt_pk_bf16_f32 v163, v34, v35
    v_mfma_f32_16x16x32_bf16 v[32:35], a[64:67], v[64:67], v[16:19]
    s_nop 0
    v_exp_f32 v36, v36
    v_mfma_f32_16x16x32_bf16 v[32:35], a[68:71], v[68:71], v[32:35]
    s_add_u32 s64, s64, 0x8000
    ds_read_b128 a[80:83], v0 offset:12288
    v_mfma_f32_16x16x32_bf16 v[32:35], a[72:75], v[72:75], v[32:35]
    s_add_u32 s65, s65, 0x8000
    v_exp_f32 v37, v37
    v_mfma_f32_16x16x32_bf16 v[32:35], a[76:79], v[76:79], v[32:35]
    ds_read_b128 a[84:87], v1 offset:12288
    v_cvt_pk_bf16_f32 v178, v36, v37
    v_mfma_f32_16x16x32_bf16 v[192:195], a[32:35], a[176:179], v[192:195]
    v_exp_f32 v38, v38
    v_mfma_f32_16x16x32_bf16 v[192:195], a[36:39], a[192:195], v[192:195]
    ds_read_b128 a[88:91], v2 offset:12288
    v_mfma_f32_16x16x32_bf16 v[196:199], a[36:39], a[196:199], v[196:199]
    v_exp_f32 v39, v39
    v_mfma_f32_16x16x32_bf16 v[196:199], a[32:35], a[180:183], v[196:199]
    ds_read_b128 a[92:95], v3 offset:12288
    v_cvt_pk_bf16_f32 v179, v38, v39
    v_mfma_f32_16x16x32_bf16 v[36:39], a[64:67], v[80:83], v[20:23]
    v_exp_f32 v32, v32
    v_mfma_f32_16x16x32_bf16 v[36:39], a[68:71], v[84:87], v[36:39]
    ds_read_b64_tr_b16 a[48:49], v10 offset:0
    ds_read_b64_tr_b16 a[50:51], v10 offset:2048
    v_mfma_f32_16x16x32_bf16 v[36:39], a[72:75], v[88:91], v[36:39]
    v_exp_f32 v33, v33
    v_mfma_f32_16x16x32_bf16 v[36:39], a[76:79], v[92:95], v[36:39]
    ds_read_b64_tr_b16 a[52:53], v10 offset:4096
    v_cvt_pk_bf16_f32 v132, v32, v33
    v_mfma_f32_16x16x32_bf16 v[200:203], a[32:35], a[184:187], v[200:203]
    v_exp_f32 v34, v34
    v_mfma_f32_16x16x32_bf16 v[200:203], a[36:39], a[200:203], v[200:203]
    ds_read_b64_tr_b16 a[54:55], v10 offset:6144
    ds_read_b64_tr_b16 a[56:57], v11 offset:0
    v_mfma_f32_16x16x32_bf16 v[204:207], a[36:39], a[204:207], v[204:207]
    v_exp_f32 v35, v35
    v_mfma_f32_16x16x32_bf16 v[204:207], a[32:35], a[188:191], v[204:207]
    ds_read_b64_tr_b16 a[58:59], v11 offset:2048
    v_cvt_pk_bf16_f32 v133, v34, v35
    v_mfma_f32_16x16x32_bf16 v[32:35], a[64:67], v[96:99], v[24:27]
    v_exp_f32 v36, v36
    v_mfma_f32_16x16x32_bf16 v[32:35], a[68:71], v[100:103], v[32:35]
    ds_read_b64_tr_b16 a[60:61], v11 offset:4096
    ds_read_b64_tr_b16 a[62:63], v11 offset:6144
    v_mfma_f32_16x16x32_bf16 v[32:35], a[72:75], v[104:107], v[32:35]
    v_exp_f32 v37, v37
    v_mfma_f32_16x16x32_bf16 v[32:35], a[76:79], v[108:111], v[32:35]
    v_cvt_pk_bf16_f32 v148, v36, v37
    v_mfma_f32_16x16x32_bf16 v[208:211], a[40:43], a[176:179], v[208:211]
    v_exp_f32 v38, v38
    v_mfma_f32_16x16x32_bf16 v[208:211], a[44:47], a[192:195], v[208:211]
    v_mfma_f32_16x16x32_bf16 v[212:215], a[44:47], a[196:199], v[212:215]
    v_exp_f32 v39, v39
    v_mfma_f32_16x16x32_bf16 v[212:215], a[40:43], a[180:183], v[212:215]
    v_cvt_pk_bf16_f32 v149, v38, v39
    v_mfma_f32_16x16x32_bf16 v[36:39], a[64:67], v[112:115], v[28:31]
    s_add_u32 s73, s72, 0x400000
    v_exp_f32 v32, v32
    v_mfma_f32_16x16x32_bf16 v[36:39], a[68:71], v[116:119], v[36:39]
    buffer_store_dwordx4 v[168:171], v15, s[80:83], s73 offen sc1
    v_mfma_f32_16x16x32_bf16 v[36:39], a[72:75], v[120:123], v[36:39]
    v_exp_f32 v33, v33
    v_mfma_f32_16x16x32_bf16 v[36:39], a[76:79], v[124:127], v[36:39]
    v_cvt_pk_bf16_f32 v164, v32, v33
    v_mfma_f32_16x16x32_bf16 v[216:219], a[40:43], a[184:187], v[216:219]
    s_add_u32 s74, s72, 0x600000
    v_exp_f32 v34, v34
    v_mfma_f32_16x16x32_bf16 v[216:219], a[44:47], a[200:203], v[216:219]
    s_add_u32 m0, s63, 0x10000
    buffer_store_dwordx4 v[184:187], v15, s[80:83], s74 offen sc1
    v_mfma_f32_16x16x32_bf16 v[220:223], a[44:47], a[204:207], v[220:223]
    v_exp_f32 v35, v35
    v_mfma_f32_16x16x32_bf16 v[220:223], a[40:43], a[188:191], v[220:223]
    s_waitcnt vmcnt(16) lgkmcnt(0)
    v_cvt_pk_bf16_f32 v165, v34, v35
    v_mfma_f32_16x16x32_bf16 v[32:35], a[80:83], v[64:67], v[16:19]
    v_exp_f32 v36, v36
    v_mfma_f32_16x16x32_bf16 v[32:35], a[84:87], v[68:71], v[32:35]
    ds_read_b128 a[64:67], v0 offset:16384
    buffer_load_dwordx4 v12, s[12:15], s66 offen lds
    v_mfma_f32_16x16x32_bf16 v[32:35], a[88:91], v[72:75], v[32:35]
    v_exp_f32 v37, v37
    v_mfma_f32_16x16x32_bf16 v[32:35], a[92:95], v[76:79], v[32:35]
    ds_read_b128 a[68:71], v1 offset:16384
    v_cvt_pk_bf16_f32 v180, v36, v37
    v_mfma_f32_16x16x32_bf16 v[224:227], a[48:51], a[176:179], v[224:227]
    v_exp_f32 v38, v38
    v_mfma_f32_16x16x32_bf16 v[224:227], a[52:55], a[192:195], v[224:227]
    ds_read_b128 a[72:75], v2 offset:16384
    buffer_load_dwordx4 v13, s[12:15], s66 offen offset:1024 lds
    v_mfma_f32_16x16x32_bf16 v[228:231], a[52:55], a[196:199], v[228:231]
    v_exp_f32 v39, v39
    v_mfma_f32_16x16x32_bf16 v[228:231], a[48:51], a[180:183], v[228:231]
    ds_read_b128 a[76:79], v3 offset:16384
    v_cvt_pk_bf16_f32 v181, v38, v39
    v_mfma_f32_16x16x32_bf16 v[36:39], a[80:83], v[80:83], v[20:23]
    buffer_load_dwordx4 v12, s[12:15], s66 offen offset:2048 lds
    v_exp_f32 v32, v32
    v_mfma_f32_16x16x32_bf16 v[36:39], a[84:87], v[84:87], v[36:39]
    s_nop 0
    ds_read_b64_tr_b16 a[32:33], v4 offset:0
    ds_read_b64_tr_b16 a[34:35], v4 offset:2048
    v_mfma_f32_16x16x32_bf16 v[36:39], a[88:91], v[88:91], v[36:39]
    v_exp_f32 v33, v33
    v_mfma_f32_16x16x32_bf16 v[36:39], a[92:95], v[92:95], v[36:39]
    ds_read_b64_tr_b16 a[36:37], v4 offset:4096
    v_cvt_pk_bf16_f32 v134, v32, v33
    v_mfma_f32_16x16x32_bf16 v[232:235], a[48:51], a[184:187], v[232:235]
    v_exp_f32 v34, v34
    v_mfma_f32_16x16x32_bf16 v[232:235], a[52:55], a[200:203], v[232:235]
    ds_read_b64_tr_b16 a[38:39], v4 offset:6144
    ds_read_b64_tr_b16 a[40:41], v5 offset:0
    v_mfma_f32_16x16x32_bf16 v[236:239], a[52:55], a[204:207], v[236:239]
    v_exp_f32 v35, v35
    v_mfma_f32_16x16x32_bf16 v[236:239], a[48:51], a[188:191], v[236:239]
    ds_read_b64_tr_b16 a[42:43], v5 offset:2048
    v_cvt_pk_bf16_f32 v135, v34, v35
    v_mfma_f32_16x16x32_bf16 v[32:35], a[80:83], v[96:99], v[24:27]
    v_exp_f32 v36, v36
    v_mfma_f32_16x16x32_bf16 v[32:35], a[84:87], v[100:103], v[32:35]
    ds_read_b64_tr_b16 a[44:45], v5 offset:4096
    ds_read_b64_tr_b16 a[46:47], v5 offset:6144
    v_mfma_f32_16x16x32_bf16 v[32:35], a[88:91], v[104:107], v[32:35]
    v_exp_f32 v37, v37
    v_mfma_f32_16x16x32_bf16 v[32:35], a[92:95], v[108:111], v[32:35]
    buffer_load_dwordx4 v13, s[12:15], s66 offen offset:3072 lds
    s_add_u32 m0, s63, 0x11000
    v_cvt_pk_bf16_f32 v150, v36, v37
    v_mfma_f32_16x16x32_bf16 v[240:243], a[56:59], a[176:179], v[240:243]
    v_exp_f32 v38, v38
    v_mfma_f32_16x16x32_bf16 v[240:243], a[60:63], a[192:195], v[240:243]
    buffer_load_dwordx4 v12, s[12:15], s67 offen lds
    v_mfma_f32_16x16x32_bf16 v[244:247], a[60:63], a[196:199], v[244:247]
    v_exp_f32 v39, v39
    v_mfma_f32_16x16x32_bf16 v[244:247], a[56:59], a[180:183], v[244:247]
    v_cvt_pk_bf16_f32 v151, v38, v39
    v_mfma_f32_16x16x32_bf16 v[36:39], a[80:83], v[112:115], v[28:31]
    s_add_u32 s73, s72, 0x100000
    v_exp_f32 v32, v32
    v_mfma_f32_16x16x32_bf16 v[36:39], a[84:87], v[116:119], v[36:39]
    buffer_load_dwordx4 v13, s[12:15], s67 offen offset:1024 lds
    buffer_store_dwordx4 v[140:143], v15, s[80:83], s73 offen sc1
    v_mfma_f32_16x16x32_bf16 v[36:39], a[88:91], v[120:123], v[36:39]
    v_exp_f32 v33, v33
    v_mfma_f32_16x16x32_bf16 v[36:39], a[92:95], v[124:127], v[36:39]
    v_cvt_pk_bf16_f32 v166, v32, v33
    v_mfma_f32_16x16x32_bf16 v[248:251], a[56:59], a[184:187], v[248:251]
    s_add_u32 s74, s72, 0x300000
    v_exp_f32 v34, v34
    v_mfma_f32_16x16x32_bf16 v[248:251], a[60:63], a[200:203], v[248:251]
    buffer_load_dwordx4 v12, s[12:15], s67 offen offset:2048 lds
    buffer_store_dwordx4 v[156:159], v15, s[80:83], s74 offen sc1
    v_mfma_f32_16x16x32_bf16 v[252:255], a[60:63], a[204:207], v[252:255]
    v_exp_f32 v35, v35
    v_mfma_f32_16x16x32_bf16 v[252:255], a[56:59], a[188:191], v[252:255]
    s_waitcnt lgkmcnt(0)
    buffer_load_dwordx4 v13, s[12:15], s67 offen offset:3072 lds
    v_cvt_pk_bf16_f32 v167, v34, v35
    v_mfma_f32_16x16x32_bf16 v[32:35], a[64:67], v[64:67], v[16:19]
    s_nop 0
    v_exp_f32 v36, v36
    v_mfma_f32_16x16x32_bf16 v[32:35], a[68:71], v[68:71], v[32:35]
    s_add_u32 s66, s66, 0x8000
    ds_read_b128 a[80:83], v0 offset:20480
    v_mfma_f32_16x16x32_bf16 v[32:35], a[72:75], v[72:75], v[32:35]
    s_add_u32 s67, s67, 0x8000
    v_exp_f32 v37, v37
    v_mfma_f32_16x16x32_bf16 v[32:35], a[76:79], v[76:79], v[32:35]
    s_add_u32 m0, s63, 0x0
    ds_read_b128 a[84:87], v1 offset:20480
    v_cvt_pk_bf16_f32 v182, v36, v37
    v_mfma_f32_16x16x32_bf16 v[192:195], a[32:35], a[208:211], v[192:195]
    v_exp_f32 v38, v38
    v_mfma_f32_16x16x32_bf16 v[192:195], a[36:39], a[224:227], v[192:195]
    ds_read_b128 a[88:91], v2 offset:20480
    v_mfma_f32_16x16x32_bf16 v[196:199], a[36:39], a[228:231], v[196:199]
    v_exp_f32 v39, v39
    v_mfma_f32_16x16x32_bf16 v[196:199], a[32:35], a[212:215], v[196:199]
    ds_read_b128 a[92:95], v3 offset:20480
    v_cvt_pk_bf16_f32 v183, v38, v39
    v_mfma_f32_16x16x32_bf16 v[36:39], a[64:67], v[80:83], v[20:23]
    v_exp_f32 v32, v32
    v_mfma_f32_16x16x32_bf16 v[36:39], a[68:71], v[84:87], v[36:39]
    ds_read_b64_tr_b16 a[48:49], v6 offset:0
    ds_read_b64_tr_b16 a[50:51], v6 offset:2048
    v_mfma_f32_16x16x32_bf16 v[36:39], a[72:75], v[88:91], v[36:39]
    v_exp_f32 v33, v33
    v_mfma_f32_16x16x32_bf16 v[36:39], a[76:79], v[92:95], v[36:39]
    ds_read_b64_tr_b16 a[52:53], v6 offset:4096
    v_cvt_pk_bf16_f32 v136, v32, v33
    v_mfma_f32_16x16x32_bf16 v[200:203], a[32:35], a[216:219], v[200:203]
L_PAD4:
    s_cbranch_execz L_PAD8
    v_exp_f32 v34, v34
    v_mfma_f32_16x16x32_bf16 v[200:203], a[36:39], a[232:235], v[200:203]
    ds_read_b64_tr_b16 a[54:55], v6 offset:6144
    ds_read_b64_tr_b16 a[56:57], v7 offset:0
    v_mfma_f32_16x16x32_bf16 v[204:207], a[36:39], a[236:239], v[204:207]
    v_exp_f32 v35, v35
    v_mfma_f32_16x16x32_bf16 v[204:207], a[32:35], a[220:223], v[204:207]
    ds_read_b64_tr_b16 a[58:59], v7 offset:2048
    v_cvt_pk_bf16_f32 v137, v34, v35
    v_mfma_f32_16x16x32_bf16 v[32:35], a[64:67], v[96:99], v[24:27]
    v_exp_f32 v36, v36
    v_mfma_f32_16x16x32_bf16 v[32:35], a[68:71], v[100:103], v[32:35]
    ds_read_b64_tr_b16 a[60:61], v7 offset:4096
    ds_read_b64_tr_b16 a[62:63], v7 offset:6144
    v_mfma_f32_16x16x32_bf16 v[32:35], a[72:75], v[104:107], v[32:35]
    v_exp_f32 v37, v37
    v_mfma_f32_16x16x32_bf16 v[32:35], a[76:79], v[108:111], v[32:35]
    v_cvt_pk_bf16_f32 v152, v36, v37
    v_mfma_f32_16x16x32_bf16 v[208:211], a[40:43], a[208:211], v[208:211]
    v_exp_f32 v38, v38
    v_mfma_f32_16x16x32_bf16 v[208:211], a[44:47], a[224:227], v[208:211]
    v_mfma_f32_16x16x32_bf16 v[212:215], a[44:47], a[228:231], v[212:215]
    v_exp_f32 v39, v39
    v_mfma_f32_16x16x32_bf16 v[212:215], a[40:43], a[212:215], v[212:215]
    v_cvt_pk_bf16_f32 v153, v38, v39
    v_mfma_f32_16x16x32_bf16 v[36:39], a[64:67], v[112:115], v[28:31]
    s_add_u32 s73, s72, 0x500000
    v_exp_f32 v32, v32
    v_mfma_f32_16x16x32_bf16 v[36:39], a[68:71], v[116:119], v[36:39]
    buffer_store_dwordx4 v[172:175], v15, s[80:83], s73 offen sc1
    v_mfma_f32_16x16x32_bf16 v[36:39], a[72:75], v[120:123], v[36:39]
    v_exp_f32 v33, v33
    v_mfma_f32_16x16x32_bf16 v[36:39], a[76:79], v[124:127], v[36:39]
    v_cvt_pk_bf16_f32 v168, v32, v33
    v_mfma_f32_16x16x32_bf16 v[216:219], a[40:43], a[216:219], v[216:219]
    s_add_u32 s74, s72, 0x700000
    v_exp_f32 v34, v34
    v_mfma_f32_16x16x32_bf16 v[216:219], a[44:47], a[232:235], v[216:219]
    buffer_store_dwordx4 v[188:191], v15, s[80:83], s74 offen sc1
    v_mfma_f32_16x16x32_bf16 v[220:223], a[44:47], a[236:239], v[220:223]
    v_exp_f32 v35, v35
    v_mfma_f32_16x16x32_bf16 v[220:223], a[40:43], a[220:223], v[220:223]
    s_waitcnt vmcnt(24) lgkmcnt(0)
    v_cvt_pk_bf16_f32 v169, v34, v35
    v_mfma_f32_16x16x32_bf16 v[32:35], a[80:83], v[64:67], v[16:19]
    v_exp_f32 v36, v36
    v_mfma_f32_16x16x32_bf16 v[32:35], a[84:87], v[68:71], v[32:35]
    ds_read_b128 a[64:67], v0 offset:24576
    v_xor_b32 v4, 0, v57
    v_mfma_f32_16x16x32_bf16 v[32:35], a[88:91], v[72:75], v[32:35]
    v_exp_f32 v37, v37
    v_mfma_f32_16x16x32_bf16 v[32:35], a[92:95], v[76:79], v[32:35]
    ds_read_b128 a[68:71], v1 offset:24576
    v_cvt_pk_bf16_f32 v184, v36, v37
    v_mfma_f32_16x16x32_bf16 v[224:227], a[48:51], a[208:211], v[224:227]
    v_exp_f32 v38, v38
    v_mfma_f32_16x16x32_bf16 v[224:227], a[52:55], a[224:227], v[224:227]
    ds_read_b128 a[72:75], v2 offset:24576
    v_lshl_add_u32 v4, v4, 5, v56
    v_mfma_f32_16x16x32_bf16 v[228:231], a[52:55], a[228:231], v[228:231]
    v_exp_f32 v39, v39
    v_mfma_f32_16x16x32_bf16 v[228:231], a[48:51], a[212:215], v[228:231]
    ds_read_b128 a[76:79], v3 offset:24576
    v_cvt_pk_bf16_f32 v185, v38, v39
    v_mfma_f32_16x16x32_bf16 v[36:39], a[80:83], v[80:83], v[20:23]
    v_exp_f32 v32, v32
    v_mfma_f32_16x16x32_bf16 v[36:39], a[84:87], v[84:87], v[36:39]
    ds_read_b64_tr_b16 a[32:33], v8 offset:8192
    ds_read_b64_tr_b16 a[34:35], v8 offset:10240
    v_mfma_f32_16x16x32_bf16 v[36:39], a[88:91], v[88:91], v[36:39]
    v_exp_f32 v33, v33
    v_mfma_f32_16x16x32_bf16 v[36:39], a[92:95], v[92:95], v[36:39]
    ds_read_b64_tr_b16 a[40:41], v9 offset:8192
    v_cvt_pk_bf16_f32 v138, v32, v33
    v_mfma_f32_16x16x32_bf16 v[232:235], a[48:51], a[216:219], v[232:235]
    v_exp_f32 v34, v34
    v_mfma_f32_16x16x32_bf16 v[232:235], a[52:55], a[232:235], v[232:235]
    ds_read_b64_tr_b16 a[42:43], v9 offset:10240
    v_xor_b32 v5, 1, v57
    v_mfma_f32_16x16x32_bf16 v[236:239], a[52:55], a[236:239], v[236:239]
    v_exp_f32 v35, v35
    v_mfma_f32_16x16x32_bf16 v[236:239], a[48:51], a[220:223], v[236:239]
    v_cvt_pk_bf16_f32 v139, v34, v35
    v_lshl_add_u32 v5, v5, 5, v56
    v_mfma_f32_16x16x32_bf16 v[32:35], a[80:83], v[96:99], v[24:27]
    v_exp_f32 v36, v36
    v_mfma_f32_16x16x32_bf16 v[32:35], a[84:87], v[100:103], v[32:35]
    v_xor_b32 v6, 2, v57
    v_lshl_add_u32 v6, v6, 5, v56
    v_mfma_f32_16x16x32_bf16 v[32:35], a[88:91], v[104:107], v[32:35]
    v_exp_f32 v37, v37
    v_mfma_f32_16x16x32_bf16 v[32:35], a[92:95], v[108:111], v[32:35]
    v_cvt_pk_bf16_f32 v154, v36, v37
    v_xor_b32 v7, 3, v57
    v_mfma_f32_16x16x32_bf16 v[240:243], a[56:59], a[208:211], v[240:243]
    v_exp_f32 v38, v38
    v_mfma_f32_16x16x32_bf16 v[240:243], a[60:63], a[224:227], v[240:243]
    v_lshl_add_u32 v7, v7, 5, v56
    v_mfma_f32_16x16x32_bf16 v[244:247], a[60:63], a[228:231], v[244:247]
    v_exp_f32 v39, v39
    v_mfma_f32_16x16x32_bf16 v[244:247], a[56:59], a[212:215], v[244:247]
    v_cvt_pk_bf16_f32 v155, v38, v39
    v_mfma_f32_16x16x32_bf16 v[36:39], a[80:83], v[112:115], v[28:31]
    v_exp_f32 v32, v32
    v_mfma_f32_16x16x32_bf16 v[36:39], a[84:87], v[116:119], v[36:39]
    v_mfma_f32_16x16x32_bf16 v[36:39], a[88:91], v[120:123], v[36:39]
    v_exp_f32 v33, v33
    v_mfma_f32_16x16x32_bf16 v[36:39], a[92:95], v[124:127], v[36:39]
    v_cvt_pk_bf16_f32 v170, v32, v33
    v_mfma_f32_16x16x32_bf16 v[248:251], a[56:59], a[216:219], v[248:251]
    v_exp_f32 v34, v34
    v_mfma_f32_16x16x32_bf16 v[248:251], a[60:63], a[232:235], v[248:251]
    v_mfma_f32_16x16x32_bf16 v[252:255], a[60:63], a[236:239], v[252:255]
    v_exp_f32 v35, v35
    v_mfma_f32_16x16x32_bf16 v[252:255], a[56:59], a[220:223], v[252:255]
    s_waitcnt lgkmcnt(0)
    v_cvt_pk_bf16_f32 v171, v34, v35
    v_mfma_f32_16x16x32_bf16 v[32:35], a[64:67], v[64:67], v[16:19]
    ds_read_b128 a[80:83], v0 offset:28672
    v_accvgpr_write_b32 a208, v59
    v_mfma_f32_16x16x32_bf16 v[32:35], a[68:71], v[68:71], v[32:35]
    v_exp_f32 v36, v36
    v_mfma_f32_16x16x32_bf16 v[32:35], a[72:75], v[72:75], v[32:35]
    ds_read_b128 a[84:87], v1 offset:28672
    v_exp_f32 v37, v37
    v_mfma_f32_16x16x32_bf16 v[32:35], a[76:79], v[76:79], v[32:35]
    v_exp_f32 v38, v38
    v_mfma_f32_16x16x32_bf16 v[192:195], a[32:35], a[240:243], v[192:195]
    v_exp_f32 v39, v39
    v_mfma_f32_16x16x32_bf16 v[196:199], a[32:35], a[244:247], v[196:199]
    v_cvt_pk_bf16_f32 v186, v36, v37
    v_cvt_pk_bf16_f32 v187, v38, v39
    v_mfma_f32_16x16x32_bf16 v[36:39], a[64:67], v[80:83], v[20:23]
    ds_read_b128 a[88:91], v2 offset:28672
    v_accvgpr_write_b32 a209, v59
    v_accvgpr_write_b32 a210, v59
    v_mfma_f32_16x16x32_bf16 v[36:39], a[68:71], v[84:87], v[36:39]
    v_exp_f32 v32, v32
    v_mfma_f32_16x16x32_bf16 v[36:39], a[72:75], v[88:91], v[36:39]
    v_exp_f32 v33, v33
    v_mfma_f32_16x16x32_bf16 v[36:39], a[76:79], v[92:95], v[36:39]
    ds_read_b128 a[92:95], v3 offset:28672
    v_exp_f32 v34, v34
    v_mfma_f32_16x16x32_bf16 v[200:203], a[32:35], a[248:251], v[200:203]
    v_exp_f32 v35, v35
    v_mfma_f32_16x16x32_bf16 v[204:207], a[32:35], a[252:255], v[204:207]
    v_cvt_pk_bf16_f32 v140, v32, v33
    v_cvt_pk_bf16_f32 v141, v34, v35
    v_subrev_u32 v0, 0x20000, v0
    v_mfma_f32_16x16x32_bf16 v[32:35], a[64:67], v[96:99], v[24:27]
    ds_read_b64_tr_b16 a[48:49], v10 offset:8192
    ds_read_b64_tr_b16 a[50:51], v10 offset:10240
    v_mfma_f32_16x16x32_bf16 v[32:35], a[68:71], v[100:103], v[32:35]
    ds_read_b64_tr_b16 a[56:57], v11 offset:8192
    v_exp_f32 v36, v36
    v_mfma_f32_16x16x32_bf16 v[32:35], a[72:75], v[104:107], v[32:35]
    v_exp_f32 v37, v37
    v_mfma_f32_16x16x32_bf16 v[32:35], a[76:79], v[108:111], v[32:35]
    v_exp_f32 v38, v38
    v_subrev_u32 v1, 0x20000, v1
    v_mfma_f32_16x16x32_bf16 v[208:211], a[40:43], a[240:243], v[208:211]
    ds_read_b64_tr_b16 a[58:59], v11 offset:10240
    v_exp_f32 v39, v39
    v_mfma_f32_16x16x32_bf16 v[212:215], a[40:43], a[244:247], v[212:215]
    v_cvt_pk_bf16_f32 v156, v36, v37
    v_cvt_pk_bf16_f32 v157, v38, v39
    v_mfma_f32_16x16x32_bf16 v[36:39], a[64:67], v[112:115], v[28:31]
    v_accvgpr_write_b32 a211, v59
    v_accvgpr_write_b32 a212, -1
    v_subrev_u32 v2, 0x20000, v2
    v_mfma_f32_16x16x32_bf16 v[36:39], a[68:71], v[116:119], v[36:39]
    v_exp_f32 v32, v32
    v_mfma_f32_16x16x32_bf16 v[36:39], a[72:75], v[120:123], v[36:39]
    v_exp_f32 v33, v33
    v_mfma_f32_16x16x32_bf16 v[36:39], a[76:79], v[124:127], v[36:39]
    v_exp_f32 v34, v34
    v_subrev_u32 v3, 0x20000, v3
    v_mfma_f32_16x16x32_bf16 v[216:219], a[40:43], a[248:251], v[216:219]
    v_exp_f32 v35, v35
    v_mfma_f32_16x16x32_bf16 v[220:223], a[40:43], a[252:255], v[220:223]
    s_waitcnt vmcnt(2) lgkmcnt(0)
    s_barrier
    v_cvt_pk_bf16_f32 v172, v32, v33
    v_cvt_pk_bf16_f32 v173, v34, v35
    v_mfma_f32_16x16x32_bf16 v[32:35], a[80:83], v[64:67], v[16:19]
    ds_read_b128 a[144:147], v0 offset:8192
    v_accvgpr_write_b32 a213, -1
    v_mfma_f32_16x16x32_bf16 v[32:35], a[84:87], v[68:71], v[32:35]
    v_exp_f32 v36, v36
    v_mfma_f32_16x16x32_bf16 v[32:35], a[88:91], v[72:75], v[32:35]
    ds_read_b128 a[148:151], v1 offset:8192
    v_exp_f32 v37, v37
    v_mfma_f32_16x16x32_bf16 v[32:35], a[92:95], v[76:79], v[32:35]
    v_exp_f32 v38, v38
    v_mfma_f32_16x16x32_bf16 v[224:227], a[48:51], a[240:243], v[224:227]
    ds_read_b128 a[152:155], v2 offset:8192
    v_exp_f32 v39, v39
    v_mfma_f32_16x16x32_bf16 v[228:231], a[48:51], a[244:247], v[228:231]
    v_cvt_pk_bf16_f32 v188, v36, v37
    v_cvt_pk_bf16_f32 v189, v38, v39
    v_mfma_f32_16x16x32_bf16 v[36:39], a[80:83], v[80:83], v[20:23]
    ds_read_b128 a[156:159], v3 offset:8192
    ds_read_b64_tr_b16 a[176:177], v4 offset:0
    ds_read_b64_tr_b16 a[178:179], v4 offset:4096
    v_mfma_f32_16x16x32_bf16 v[36:39], a[84:87], v[84:87], v[36:39]
    v_exp_f32 v32, v32
    v_mfma_f32_16x16x32_bf16 v[36:39], a[88:91], v[88:91], v[36:39]
    v_exp_f32 v33, v33
    v_mfma_f32_16x16x32_bf16 v[36:39], a[92:95], v[92:95], v[36:39]
    ds_read_b64_tr_b16 a[180:181], v4 offset:16384
    v_exp_f32 v34, v34
    v_mfma_f32_16x16x32_bf16 v[232:235], a[48:51], a[248:251], v[232:235]
    v_exp_f32 v35, v35
    v_mfma_f32_16x16x32_bf16 v[236:239], a[48:51], a[252:255], v[236:239]
    v_cvt_pk_bf16_f32 v142, v32, v33
    v_cvt_pk_bf16_f32 v143, v34, v35
    v_mfma_f32_16x16x32_bf16 v[32:35], a[80:83], v[96:99], v[24:27]
    ds_read_b64_tr_b16 a[182:183], v4 offset:20480
    ds_read_b64_tr_b16 a[184:185], v4 offset:32768
    ds_read_b64_tr_b16 a[186:187], v4 offset:36864
    v_mfma_f32_16x16x32_bf16 v[32:35], a[84:87], v[100:103], v[32:35]
    ds_read_b64_tr_b16 a[188:189], v4 offset:49152
    v_exp_f32 v36, v36
    v_mfma_f32_16x16x32_bf16 v[32:35], a[88:91], v[104:107], v[32:35]
    v_exp_f32 v37, v37
    v_mfma_f32_16x16x32_bf16 v[32:35], a[92:95], v[108:111], v[32:35]
    v_exp_f32 v38, v38
    v_mfma_f32_16x16x32_bf16 v[240:243], a[56:59], a[240:243], v[240:243]
    ds_read_b64_tr_b16 a[190:191], v4 offset:53248
    v_exp_f32 v39, v39
    v_mfma_f32_16x16x32_bf16 v[244:247], a[56:59], a[244:247], v[244:247]
    v_cvt_pk_bf16_f32 v158, v36, v37
    v_cvt_pk_bf16_f32 v159, v38, v39
    v_mfma_f32_16x16x32_bf16 v[36:39], a[80:83], v[112:115], v[28:31]
    v_accvgpr_write_b32 a214, -1
    v_accvgpr_write_b32 a215, -1
    v_mfma_f32_16x16x32_bf16 v[36:39], a[84:87], v[116:119], v[36:39]
    v_exp_f32 v32, v32
    v_mfma_f32_16x16x32_bf16 v[36:39], a[88:91], v[120:123], v[36:39]
    v_exp_f32 v33, v33
    v_mfma_f32_16x16x32_bf16 v[36:39], a[92:95], v[124:127], v[36:39]
    v_exp_f32 v34, v34
    v_mfma_f32_16x16x32_bf16 v[248:251], a[56:59], a[248:251], v[248:251]
    v_exp_f32 v35, v35
    v_mfma_f32_16x16x32_bf16 v[252:255], a[56:59], a[252:255], v[252:255]
    s_waitcnt lgkmcnt(0)
    v_cvt_pk_bf16_f32 v174, v32, v33
    v_cvt_pk_bf16_f32 v175, v34, v35
    v_accvgpr_write_b32 a240, v48
    v_accvgpr_write_b32 a241, v49
    v_accvgpr_write_b32 a242, v51
L_IT1:
    v_mfma_f32_16x16x32_bf16 v[32:35], a[144:147], v[64:67], v[16:19]
    v_exp_f32 v36, v36
    v_cvt_pk_bf16_f32 v207, v206, v207
    v_mfma_f32_16x16x32_bf16 v[32:35], a[148:151], v[68:71], v[32:35]
    buffer_load_dwordx4 v12, s[8:11], s64 offen lds
    v_cvt_pk_bf16_f32 v206, v204, v205
    v_mfma_f32_16x16x32_bf16 v[32:35], a[152:155], v[72:75], v[32:35]
    v_exp_f32 v37, v37
    v_cvt_pk_bf16_f32 v205, v202, v203
    v_mfma_f32_16x16x32_bf16 v[32:35], a[156:159], v[76:79], v[32:35]
    ds_read_b128 a[160:163], v0 offset:12288
    v_cvt_pk_bf16_f32 v190, v36, v37
    v_cvt_pk_bf16_f32 v223, v222, v223
    v_mfma_f32_16x16x32_bf16 a[0:3], v[128:131], a[176:179], 0
    v_exp_f32 v38, v38
    v_cvt_pk_bf16_f32 v204, v200, v201
    v_mfma_f32_16x16x32_bf16 a[0:3], v[132:135], a[180:183], a[0:3]
    ds_read_b128 a[164:167], v1 offset:12288
    ds_read_b128 a[168:171], v2 offset:12288
    v_cvt_pk_bf16_f32 v222, v220, v221
    v_mfma_f32_16x16x32_bf16 a[0:3], v[136:139], a[184:187], a[0:3]
    v_exp_f32 v39, v39
    v_cvt_pk_bf16_f32 v203, v198, v199
    v_mfma_f32_16x16x32_bf16 a[0:3], v[140:143], a[188:191], a[0:3]
    ds_read_b128 a[172:175], v3 offset:12288
    v_cvt_pk_bf16_f32 v191, v38, v39
    v_cvt_pk_bf16_f32 v202, v196, v197
    v_mfma_f32_16x16x32_bf16 v[36:39], a[144:147], v[80:83], v[20:23]
    s_lshl_b32 s87, s53, 3
    v_exp_f32 v32, v32
    v_cvt_pk_bf16_f32 v201, v194, v195
    v_mfma_f32_16x16x32_bf16 v[36:39], a[148:151], v[84:87], v[36:39]
    buffer_load_dwordx4 v13, s[8:11], s64 offen offset:1024 lds
    v_cvt_pk_bf16_f32 v221, v218, v219
    v_mfma_f32_16x16x32_bf16 v[36:39], a[152:155], v[88:91], v[36:39]
    s_mov_b32 s90, s84
    v_exp_f32 v33, v33
    v_cvt_pk_bf16_f32 v200, v192, v193
    v_mfma_f32_16x16x32_bf16 v[36:39], a[156:159], v[92:95], v[36:39]
    s_and_b32 s85, s52, 4
    ds_read_b64_tr_b16 a[192:193], v5 offset:0
    v_cvt_pk_bf16_f32 v192, v32, v33
    v_cvt_pk_bf16_f32 v239, v238, v239
    v_mfma_f32_16x16x32_bf16 a[4:7], v[144:147], a[176:179], 0
    s_add_u32 s85, s85, s3
    v_exp_f32 v34, v34
    v_cvt_pk_bf16_f32 v220, v216, v217
    v_mfma_f32_16x16x32_bf16 a[4:7], v[148:151], a[180:183], a[4:7]
    s_lshl_b32 s85, s85, 21
    ds_read_b64_tr_b16 a[194:195], v5 offset:4096
    ds_read_b64_tr_b16 a[196:197], v5 offset:16384
    v_cvt_pk_bf16_f32 v238, v236, v237
    v_mfma_f32_16x16x32_bf16 a[4:7], v[152:155], a[184:187], a[4:7]
    s_and_b32 s88, s52, 3
    v_exp_f32 v35, v35
    v_cvt_pk_bf16_f32 v219, v214, v215
    v_mfma_f32_16x16x32_bf16 a[4:7], v[156:159], a[188:191], a[4:7]
    s_lshl_b32 s88, s88, 13
    ds_read_b64_tr_b16 a[198:199], v5 offset:20480
    v_cvt_pk_bf16_f32 v193, v34, v35
    v_cvt_pk_bf16_f32 v218, v212, v213
    v_mfma_f32_16x16x32_bf16 v[32:35], a[144:147], v[96:99], v[24:27]
    s_add_u32 s88, s88, s62
    v_exp_f32 v36, v36
    v_cvt_pk_bf16_f32 v217, v210, v211
    v_mfma_f32_16x16x32_bf16 v[32:35], a[148:151], v[100:103], v[32:35]
    buffer_load_dwordx4 v12, s[8:11], s64 offen offset:2048 lds
    v_cvt_pk_bf16_f32 v237, v234, v235
    v_mfma_f32_16x16x32_bf16 v[32:35], a[152:155], v[104:107], v[32:35]
    s_add_u32 s85, s85, s88
    v_exp_f32 v37, v37
    v_cvt_pk_bf16_f32 v216, v208, v209
    v_mfma_f32_16x16x32_bf16 v[32:35], a[156:159], v[108:111], v[32:35]
    s_add_u32 s88, s52, 7
    ds_read_b64_tr_b16 a[200:201], v5 offset:32768
    v_cvt_pk_bf16_f32 v208, v36, v37
    v_mfma_f32_16x16x32_bf16 a[8:11], v[160:163], a[176:179], 0
    s_lshl_b32 s88, s88, 10
    v_exp_f32 v38, v38
    v_cvt_pk_bf16_f32 v236, v232, v233
    v_mfma_f32_16x16x32_bf16 a[8:11], v[164:167], a[180:183], a[8:11]
    s_mov_b32 s89, 0x10000000
    ds_read_b64_tr_b16 a[202:203], v5 offset:36864
    ds_read_b64_tr_b16 a[204:205], v5 offset:49152
    v_mfma_f32_16x16x32_bf16 a[8:11], v[168:171], a[184:187], a[8:11]
    s_lshl_b32 s76, s52, 7
    v_exp_f32 v39, v39
    v_cvt_pk_bf16_f32 v235, v230, v231
    v_mfma_f32_16x16x32_bf16 a[8:11], v[172:175], a[188:191], a[8:11]
    s_lshl_b32 s77, s3, 5
    ds_read_b64_tr_b16 a[206:207], v5 offset:53248
    v_cvt_pk_bf16_f32 v209, v38, v39
    v_cvt_pk_bf16_f32 v234, v228, v229
    v_mfma_f32_16x16x32_bf16 v[36:39], a[144:147], v[112:115], v[28:31]
    s_add_u32 s76, s76, s77
    v_exp_f32 v32, v32
    v_cvt_pk_bf16_f32 v233, v226, v227
    v_mfma_f32_16x16x32_bf16 v[36:39], a[148:151], v[116:119], v[36:39]
    buffer_load_dwordx4 v13, s[8:11], s64 offen offset:3072 lds
    v_lshrrev_b32 v52, 8, v15
    v_mfma_f32_16x16x32_bf16 v[36:39], a[152:155], v[120:123], v[36:39]
    v_exp_f32 v33, v33
    v_cvt_pk_bf16_f32 v232, v224, v225
    v_mfma_f32_16x16x32_bf16 v[36:39], a[156:159], v[124:127], v[36:39]
    v_cvt_pk_bf16_f32 v224, v32, v33
    v_cvt_pk_bf16_f32 v255, v254, v255
    v_lshlrev_b32 v52, 3, v52
    v_mfma_f32_16x16x32_bf16 a[12:15], v[176:179], a[176:179], 0
    s_add_u32 m0, s63, 0x1000
    v_exp_f32 v34, v34
    v_cvt_pk_bf16_f32 v254, v252, v253
    v_mfma_f32_16x16x32_bf16 a[12:15], v[180:183], a[180:183], a[12:15]
    v_cvt_pk_bf16_f32 v253, v250, v251
    v_cvt_pk_bf16_f32 v252, v248, v249
    v_mfma_f32_16x16x32_bf16 a[12:15], v[184:187], a[184:187], a[12:15]
    buffer_load_dwordx2 v[40:41], v52, s[44:47], s76 offen
    v_exp_f32 v35, v35
    v_mfma_f32_16x16x32_bf16 a[12:15], v[188:191], a[188:191], a[12:15]
    v_cvt_pk_bf16_f32 v225, v34, v35
    v_cvt_pk_bf16_f32 v251, v246, v247
    v_smfmac_f32_16x16x64_bf16 a[128:131], a[208:211], v[128:135], v14
    s_waitcnt lgkmcnt(0)
    v_cvt_pk_bf16_f32 v250, v244, v245
    v_cvt_pk_bf16_f32 v249, v242, v243
    v_mfma_f32_16x16x32_bf16 v[32:35], a[160:163], v[64:67], v[16:19]
    v_exp_f32 v36, v36
    v_cvt_pk_bf16_f32 v248, v240, v241
    v_mfma_f32_16x16x32_bf16 v[32:35], a[164:167], v[68:71], v[32:35]
    buffer_load_dwordx4 v12, s[8:11], s65 offen lds
    v_mfma_f32_16x16x32_bf16 v[32:35], a[168:171], v[72:75], v[32:35]
    v_exp_f32 v37, v37
    v_mfma_f32_16x16x32_bf16 v[32:35], a[172:175], v[76:79], v[32:35]
    ds_read_b128 a[144:147], v0 offset:24576
    v_cvt_pk_bf16_f32 v240, v36, v37
    v_mfma_f32_16x16x32_bf16 a[16:19], v[128:131], a[192:195], 0
    v_exp_f32 v38, v38
    v_mfma_f32_16x16x32_bf16 a[16:19], v[132:135], a[196:199], a[16:19]
    ds_read_b128 a[148:151], v1 offset:24576
    ds_read_b128 a[152:155], v2 offset:24576
    v_mfma_f32_16x16x32_bf16 a[16:19], v[136:139], a[200:203], a[16:19]
    v_exp_f32 v39, v39
    v_mfma_f32_16x16x32_bf16 a[16:19], v[140:143], a[204:207], a[16:19]
    ds_read_b128 a[156:159], v3 offset:24576
    v_cvt_pk_bf16_f32 v241, v38, v39
    v_mfma_f32_16x16x32_bf16 v[36:39], a[160:163], v[80:83], v[20:23]
    v_exp_f32 v32, v32
    v_mfma_f32_16x16x32_bf16 v[36:39], a[164:167], v[84:87], v[36:39]
    buffer_load_dwordx4 v13, s[8:11], s65 offen offset:1024 lds
    v_mfma_f32_16x16x32_bf16 v[36:39], a[168:171], v[88:91], v[36:39]
    v_exp_f32 v33, v33
    v_mfma_f32_16x16x32_bf16 v[36:39], a[172:175], v[92:95], v[36:39]
    ds_read_b64_tr_b16 a[176:177], v6 offset:0
    v_cvt_pk_bf16_f32 v194, v32, v33
    v_mfma_f32_16x16x32_bf16 a[20:23], v[144:147], a[192:195], 0
    v_exp_f32 v34, v34
    v_mfma_f32_16x16x32_bf16 a[20:23], v[148:151], a[196:199], a[20:23]
    ds_read_b64_tr_b16 a[178:179], v6 offset:4096
    ds_read_b64_tr_b16 a[180:181], v6 offset:16384
    v_mfma_f32_16x16x32_bf16 a[20:23], v[152:155], a[200:203], a[20:23]
    v_exp_f32 v35, v35
    v_mfma_f32_16x16x32_bf16 a[20:23], v[156:159], a[204:207], a[20:23]
    ds_read_b64_tr_b16 a[182:183], v6 offset:20480
    v_cvt_pk_bf16_f32 v195, v34, v35
    v_mfma_f32_16x16x32_bf16 v[32:35], a[160:163], v[96:99], v[24:27]
    v_exp_f32 v36, v36
    v_mfma_f32_16x16x32_bf16 v[32:35], a[164:167], v[100:103], v[32:35]
    buffer_load_dwordx4 v12, s[8:11], s65 offen offset:2048 lds
    v_mfma_f32_16x16x32_bf16 v[32:35], a[168:171], v[104:107], v[32:35]
    v_exp_f32 v37, v37
    v_mfma_f32_16x16x32_bf16 v[32:35], a[172:175], v[108:111], v[32:35]
    ds_read_b64_tr_b16 a[184:185], v6 offset:32768
    v_cvt_pk_bf16_f32 v210, v36, v37
    v_mfma_f32_16x16x32_bf16 a[24:27], v[160:163], a[192:195], 0
    v_exp_f32 v38, v38
    v_mfma_f32_16x16x32_bf16 a[24:27], v[164:167], a[196:199], a[24:27]
    ds_read_b64_tr_b16 a[186:187], v6 offset:36864
    ds_read_b64_tr_b16 a[188:189], v6 offset:49152
    v_mfma_f32_16x16x32_bf16 a[24:27], v[168:171], a[200:203], a[24:27]
    v_exp_f32 v39, v39
    v_mfma_f32_16x16x32_bf16 a[24:27], v[172:175], a[204:207], a[24:27]
    ds_read_b64_tr_b16 a[190:191], v6 offset:53248
    v_cvt_pk_bf16_f32 v211, v38, v39
    v_mfma_f32_16x16x32_bf16 v[36:39], a[160:163], v[112:115], v[28:31]
    v_exp_f32 v32, v32
    v_mfma_f32_16x16x32_bf16 v[36:39], a[164:167], v[116:119], v[36:39]
    buffer_load_dwordx4 v13, s[8:11], s65 offen offset:3072 lds
    v_mfma_f32_16x16x32_bf16 v[36:39], a[168:171], v[120:123], v[36:39]
    v_exp_f32 v33, v33
    v_mfma_f32_16x16x32_bf16 v[36:39], a[172:175], v[124:127], v[36:39]
    v_cvt_pk_bf16_f32 v226, v32, v33
    v_xor_b32 v8, 4, v57
    v_mfma_f32_16x16x32_bf16 a[28:31], v[176:179], a[192:195], 0
    s_add_u32 m0, s63, 0x12000
    v_exp_f32 v34, v34
    v_mfma_f32_16x16x32_bf16 a[28:31], v[180:183], a[196:199], a[28:31]
    v_lshl_add_u32 v8, v8, 5, v56
    v_xor_b32 v9, 5, v57
    v_mfma_f32_16x16x32_bf16 a[28:31], v[184:187], a[200:203], a[28:31]
    v_exp_f32 v35, v35
    v_mfma_f32_16x16x32_bf16 a[28:31], v[188:191], a[204:207], a[28:31]
    v_cvt_pk_bf16_f32 v227, v34, v35
    v_lshl_add_u32 v9, v9, 5, v56
    v_smfmac_f32_16x16x64_bf16 a[128:131], a[208:211], v[136:143], v14
    s_waitcnt lgkmcnt(0)
    v_xor_b32 v10, 6, v57
    v_lshl_add_u32 v10, v10, 5, v56
    v_mfma_f32_16x16x32_bf16 v[32:35], a[144:147], v[64:67], v[16:19]
    v_exp_f32 v36, v36
    v_mfma_f32_16x16x32_bf16 v[32:35], a[148:151], v[68:71], v[32:35]
    buffer_load_dwordx4 v12, s[12:15], s66 offen lds
    v_mfma_f32_16x16x32_bf16 v[32:35], a[152:155], v[72:75], v[32:35]
    v_exp_f32 v37, v37
    v_mfma_f32_16x16x32_bf16 v[32:35], a[156:159], v[76:79], v[32:35]
    ds_read_b128 a[160:163], v0 offset:28672
    v_cvt_pk_bf16_f32 v242, v36, v37
    v_mfma_f32_16x16x32_bf16 a[32:35], v[128:131], a[176:179], 0
    v_exp_f32 v38, v38
    v_mfma_f32_16x16x32_bf16 a[32:35], v[132:135], a[180:183], a[32:35]
    ds_read_b128 a[164:167], v1 offset:28672
    ds_read_b128 a[168:171], v2 offset:28672
    v_mfma_f32_16x16x32_bf16 a[32:35], v[136:139], a[184:187], a[32:35]
    v_exp_f32 v39, v39
    v_mfma_f32_16x16x32_bf16 a[32:35], v[140:143], a[188:191], a[32:35]
    ds_read_b128 a[172:175], v3 offset:28672
    v_cvt_pk_bf16_f32 v243, v38, v39
    v_mfma_f32_16x16x32_bf16 v[36:39], a[144:147], v[80:83], v[20:23]
    v_exp_f32 v32, v32
    v_mfma_f32_16x16x32_bf16 v[36:39], a[148:151], v[84:87], v[36:39]
    buffer_load_dwordx4 v13, s[12:15], s66 offen offset:1024 lds
    v_mfma_f32_16x16x32_bf16 v[36:39], a[152:155], v[88:91], v[36:39]
    v_exp_f32 v33, v33
    v_mfma_f32_16x16x32_bf16 v[36:39], a[156:159], v[92:95], v[36:39]
    ds_read_b64_tr_b16 a[192:193], v7 offset:0
    v_cvt_pk_bf16_f32 v196, v32, v33
    v_mfma_f32_16x16x32_bf16 a[36:39], v[144:147], a[176:179], 0
    v_exp_f32 v34, v34
    v_mfma_f32_16x16x32_bf16 a[36:39], v[148:151], a[180:183], a[36:39]
    ds_read_b64_tr_b16 a[194:195], v7 offset:4096
    ds_read_b64_tr_b16 a[196:197], v7 offset:16384
    v_mfma_f32_16x16x32_bf16 a[36:39], v[152:155], a[184:187], a[36:39]
    v_exp_f32 v35, v35
    v_mfma_f32_16x16x32_bf16 a[36:39], v[156:159], a[188:191], a[36:39]
    ds_read_b64_tr_b16 a[198:199], v7 offset:20480
    v_cvt_pk_bf16_f32 v197, v34, v35
    v_mfma_f32_16x16x32_bf16 v[32:35], a[144:147], v[96:99], v[24:27]
    v_exp_f32 v36, v36
    v_mfma_f32_16x16x32_bf16 v[32:35], a[148:151], v[100:103], v[32:35]
    buffer_load_dwordx4 v12, s[12:15], s66 offen offset:2048 lds
    v_mfma_f32_16x16x32_bf16 v[32:35], a[152:155], v[104:107], v[32:35]
    v_exp_f32 v37, v37
    v_mfma_f32_16x16x32_bf16 v[32:35], a[156:159], v[108:111], v[32:35]
    ds_read_b64_tr_b16 a[200:201], v7 offset:32768
    v_cvt_pk_bf16_f32 v212, v36, v37
    v_mfma_f32_16x16x32_bf16 a[40:43], v[160:163], a[176:179], 0
    v_exp_f32 v38, v38
    v_mfma_f32_16x16x32_bf16 a[40:43], v[164:167], a[180:183], a[40:43]
    ds_read_b64_tr_b16 a[202:203], v7 offset:36864
    ds_read_b64_tr_b16 a[204:205], v7 offset:49152
    v_mfma_f32_16x16x32_bf16 a[40:43], v[168:171], a[184:187], a[40:43]
    v_exp_f32 v39, v39
    v_mfma_f32_16x16x32_bf16 a[40:43], v[172:175], a[188:191], a[40:43]
    ds_read_b64_tr_b16 a[206:207], v7 offset:53248
    v_cvt_pk_bf16_f32 v213, v38, v39
    v_mfma_f32_16x16x32_bf16 v[36:39], a[144:147], v[112:115], v[28:31]
    v_exp_f32 v32, v32
    v_mfma_f32_16x16x32_bf16 v[36:39], a[148:151], v[116:119], v[36:39]
    buffer_load_dwordx4 v13, s[12:15], s66 offen offset:3072 lds
    v_mfma_f32_16x16x32_bf16 v[36:39], a[152:155], v[120:123], v[36:39]
    v_exp_f32 v33, v33
    v_mfma_f32_16x16x32_bf16 v[36:39], a[156:159], v[124:127], v[36:39]
    v_cvt_pk_bf16_f32 v228, v32, v33
    v_xor_b32 v11, 7, v57
    v_mfma_f32_16x16x32_bf16 a[44:47], v[176:179], a[176:179], 0
    s_add_u32 m0, s63, 0x13000
    v_exp_f32 v34, v34
    v_mfma_f32_16x16x32_bf16 a[44:47], v[180:183], a[180:183], a[44:47]
    v_lshl_add_u32 v11, v11, 5, v56
    v_mfma_f32_16x16x32_bf16 a[44:47], v[184:187], a[184:187], a[44:47]
    v_exp_f32 v35, v35
    v_mfma_f32_16x16x32_bf16 a[44:47], v[188:191], a[188:191], a[44:47]
    v_cvt_pk_bf16_f32 v229, v34, v35
    v_smfmac_f32_16x16x64_bf16 a[132:135], a[208:211], v[144:151], v14
    s_waitcnt lgkmcnt(0)
    v_mfma_f32_16x16x32_bf16 v[32:35], a[160:163], v[64:67], v[16:19]
    s_waitcnt vmcnt(8)
    v_exp_f32 v36, v36
    v_mfma_f32_16x16x32_bf16 v[32:35], a[164:167], v[68:71], v[32:35]
    buffer_load_dwordx4 v12, s[12:15], s67 offen lds
    v_mfma_f32_16x16x32_bf16 v[32:35], a[168:171], v[72:75], v[32:35]
    v_exp_f32 v37, v37
    v_lshlrev_b32 v56, 16, v40
    v_mfma_f32_16x16x32_bf16 v[32:35], a[172:175], v[76:79], v[32:35]
    ds_read_b128 a[144:147], v0 offset:40960
    v_cvt_pk_bf16_f32 v244, v36, v37
    v_mfma_f32_16x16x32_bf16 a[48:51], v[128:131], a[192:195], 0
    v_exp_f32 v38, v38
    v_mfma_f32_16x16x32_bf16 a[48:51], v[132:135], a[196:199], a[48:51]
    ds_read_b128 a[148:151], v1 offset:40960
    ds_read_b128 a[152:155], v2 offset:40960
    v_mfma_f32_16x16x32_bf16 a[48:51], v[136:139], a[200:203], a[48:51]
    v_exp_f32 v39, v39
    v_and_b32 v57, 0xffff0000, v40
    v_mfma_f32_16x16x32_bf16 a[48:51], v[140:143], a[204:207], a[48:51]
    ds_read_b128 a[156:159], v3 offset:40960
    v_cvt_pk_bf16_f32 v245, v38, v39
    v_mfma_f32_16x16x32_bf16 v[36:39], a[160:163], v[80:83], v[20:23]
    v_exp_f32 v32, v32
    v_mfma_f32_16x16x32_bf16 v[36:39], a[164:167], v[84:87], v[36:39]
    buffer_load_dwordx4 v13, s[12:15], s67 offen offset:1024 lds
    v_mfma_f32_16x16x32_bf16 v[36:39], a[168:171], v[88:91], v[36:39]
    v_exp_f32 v33, v33
    v_mfma_f32_16x16x32_bf16 v[36:39], a[172:175], v[92:95], v[36:39]
    ds_read_b64_tr_b16 a[176:177], v8 offset:0
    v_cvt_pk_bf16_f32 v198, v32, v33
    v_mfma_f32_16x16x32_bf16 a[52:55], v[144:147], a[192:195], 0
    v_exp_f32 v34, v34
    v_mfma_f32_16x16x32_bf16 a[52:55], v[148:151], a[196:199], a[52:55]
    ds_read_b64_tr_b16 a[178:179], v8 offset:4096
    ds_read_b64_tr_b16 a[180:181], v8 offset:16384
    v_mfma_f32_16x16x32_bf16 a[52:55], v[152:155], a[200:203], a[52:55]
    v_exp_f32 v35, v35
    v_mfma_f32_16x16x32_bf16 a[52:55], v[156:159], a[204:207], a[52:55]
    ds_read_b64_tr_b16 a[182:183], v8 offset:20480
    v_cvt_pk_bf16_f32 v199, v34, v35
    v_lshlrev_b32 v58, 16, v41
    v_mfma_f32_16x16x32_bf16 v[32:35], a[160:163], v[96:99], v[24:27]
    v_exp_f32 v36, v36
    v_mfma_f32_16x16x32_bf16 v[32:35], a[164:167], v[100:103], v[32:35]
    buffer_load_dwordx4 v12, s[12:15], s67 offen offset:2048 lds
    v_mfma_f32_16x16x32_bf16 v[32:35], a[168:171], v[104:107], v[32:35]
    v_exp_f32 v37, v37
    v_mfma_f32_16x16x32_bf16 v[32:35], a[172:175], v[108:111], v[32:35]
    ds_read_b64_tr_b16 a[184:185], v8 offset:32768
    v_cvt_pk_bf16_f32 v214, v36, v37
    v_mfma_f32_16x16x32_bf16 a[56:59], v[160:163], a[192:195], 0
L_PAD5:
    s_cbranch_execz L_PAD9
    v_exp_f32 v38, v38
    v_mfma_f32_16x16x32_bf16 a[56:59], v[164:167], a[196:199], a[56:59]
    ds_read_b64_tr_b16 a[186:187], v8 offset:36864
    ds_read_b64_tr_b16 a[188:189], v8 offset:49152
    v_mfma_f32_16x16x32_bf16 a[56:59], v[168:171], a[200:203], a[56:59]
    v_exp_f32 v39, v39
    v_and_b32 v59, 0xffff0000, v41
    v_mfma_f32_16x16x32_bf16 a[56:59], v[172:175], a[204:207], a[56:59]
    ds_read_b64_tr_b16 a[190:191], v8 offset:53248
    v_cvt_pk_bf16_f32 v215, v38, v39
    v_mfma_f32_16x16x32_bf16 v[36:39], a[160:163], v[112:115], v[28:31]
    v_exp_f32 v32, v32
    v_mul_f32 v44, s70, v56
    v_mfma_f32_16x16x32_bf16 v[36:39], a[164:167], v[116:119], v[36:39]
    buffer_load_dwordx4 v13, s[12:15], s67 offen offset:3072 lds
    v_mfma_f32_16x16x32_bf16 v[36:39], a[168:171], v[120:123], v[36:39]
    v_exp_f32 v33, v33
    v_mfma_f32_16x16x32_bf16 v[36:39], a[172:175], v[124:127], v[36:39]
    v_cvt_pk_bf16_f32 v230, v32, v33
    v_mul_f32 v45, s70, v57
    v_mfma_f32_16x16x32_bf16 a[60:63], v[176:179], a[192:195], 0
    s_add_u32 s73, s72, 0x800000
    v_exp_f32 v34, v34
    v_mfma_f32_16x16x32_bf16 a[60:63], v[180:183], a[196:199], a[60:63]
    buffer_store_dwordx4 v[200:203], v15, s[80:83], s73 offen sc1
    v_mfma_f32_16x16x32_bf16 a[60:63], v[184:187], a[200:203], a[60:63]
    v_exp_f32 v35, v35
    v_mfma_f32_16x16x32_bf16 a[60:63], v[188:191], a[204:207], a[60:63]
    s_add_u32 s74, s72, 0xa00000
    v_cvt_pk_bf16_f32 v231, v34, v35
    v_mul_f32 v46, s70, v58
    v_smfmac_f32_16x16x64_bf16 a[132:135], a[208:211], v[152:159], v14
    s_waitcnt lgkmcnt(0)
    buffer_store_dwordx4 v[216:219], v15, s[80:83], s74 offen sc1
    v_mfma_f32_16x16x32_bf16 v[32:35], a[144:147], v[64:67], v[16:19]
    v_exp_f32 v36, v36
    v_mfma_f32_16x16x32_bf16 v[32:35], a[148:151], v[68:71], v[32:35]
    v_mul_f32 v47, s70, v59
    v_mul_f32 v48, s70, v56
    v_mfma_f32_16x16x32_bf16 v[32:35], a[152:155], v[72:75], v[32:35]
    v_exp_f32 v37, v37
    v_mfma_f32_16x16x32_bf16 v[32:35], a[156:159], v[76:79], v[32:35]
    ds_read_b128 a[160:163], v0 offset:45056
    v_cvt_pk_bf16_f32 v246, v36, v37
    v_mul_f32 v49, s70, v57
    v_mfma_f32_16x16x32_bf16 a[64:67], v[128:131], a[176:179], 0
    v_exp_f32 v38, v38
    v_mfma_f32_16x16x32_bf16 a[64:67], v[132:135], a[180:183], a[64:67]
    ds_read_b128 a[164:167], v1 offset:45056
    ds_read_b128 a[168:171], v2 offset:45056
    v_mfma_f32_16x16x32_bf16 a[64:67], v[136:139], a[184:187], a[64:67]
    v_exp_f32 v39, v39
    v_mul_f32 v50, s70, v58
    v_mfma_f32_16x16x32_bf16 a[64:67], v[140:143], a[188:191], a[64:67]
    ds_read_b128 a[172:175], v3 offset:45056
    v_cvt_pk_bf16_f32 v247, v38, v39
    v_mfma_f32_16x16x32_bf16 v[36:39], a[144:147], v[80:83], v[20:23]
    s_add_u32 s73, s72, 0xc00000
    v_exp_f32 v32, v32
    v_mfma_f32_16x16x32_bf16 v[36:39], a[148:151], v[84:87], v[36:39]
    buffer_store_dwordx4 v[232:235], v15, s[80:83], s73 offen sc1
    v_mfma_f32_16x16x32_bf16 v[36:39], a[152:155], v[88:91], v[36:39]
    v_exp_f32 v33, v33
    v_mfma_f32_16x16x32_bf16 v[36:39], a[156:159], v[92:95], v[36:39]
    ds_read_b64_tr_b16 a[192:193], v9 offset:0
    v_cvt_pk_bf16_f32 v200, v32, v33
    v_mul_f32 v51, s70, v59
    v_mfma_f32_16x16x32_bf16 a[68:71], v[144:147], a[176:179], 0
    v_exp_f32 v34, v34
    v_mfma_f32_16x16x32_bf16 a[68:71], v[148:151], a[180:183], a[68:71]
    ds_read_b64_tr_b16 a[194:195], v9 offset:4096
    ds_read_b64_tr_b16 a[196:197], v9 offset:16384
    v_mfma_f32_16x16x32_bf16 a[68:71], v[152:155], a[184:187], a[68:71]
    v_exp_f32 v35, v35
    v_mfma_f32_16x16x32_bf16 a[68:71], v[156:159], a[188:191], a[68:71]
    ds_read_b64_tr_b16 a[198:199], v9 offset:20480
    v_cvt_pk_bf16_f32 v201, v34, v35
    v_mfma_f32_16x16x32_bf16 v[32:35], a[144:147], v[96:99], v[24:27]
    s_add_u32 s74, s72, 0xe00000
    v_exp_f32 v36, v36
    v_mfma_f32_16x16x32_bf16 v[32:35], a[148:151], v[100:103], v[32:35]
    buffer_store_dwordx4 v[248:251], v15, s[80:83], s74 offen sc1
    v_mfma_f32_16x16x32_bf16 v[32:35], a[152:155], v[104:107], v[32:35]
    v_exp_f32 v37, v37
    v_mfma_f32_16x16x32_bf16 v[32:35], a[156:159], v[108:111], v[32:35]
    ds_read_b64_tr_b16 a[200:201], v9 offset:32768
    v_cvt_pk_bf16_f32 v216, v36, v37
    v_mfma_f32_16x16x32_bf16 a[72:75], v[160:163], a[176:179], 0
    v_exp_f32 v38, v38
    v_mfma_f32_16x16x32_bf16 a[72:75], v[164:167], a[180:183], a[72:75]
    ds_read_b64_tr_b16 a[202:203], v9 offset:36864
    ds_read_b64_tr_b16 a[204:205], v9 offset:49152
    v_mfma_f32_16x16x32_bf16 a[72:75], v[168:171], a[184:187], a[72:75]
    v_exp_f32 v39, v39
    v_mfma_f32_16x16x32_bf16 a[72:75], v[172:175], a[188:191], a[72:75]
    ds_read_b64_tr_b16 a[206:207], v9 offset:53248
    v_cvt_pk_bf16_f32 v217, v38, v39
    v_mul_f32 v56, s70, v56
    v_mfma_f32_16x16x32_bf16 v[36:39], a[144:147], v[112:115], v[28:31]
    s_add_u32 s73, s72, 0x900000
    v_exp_f32 v32, v32
    v_mul_f32 v57, s70, v57
    v_mfma_f32_16x16x32_bf16 v[36:39], a[148:151], v[116:119], v[36:39]
    buffer_store_dwordx4 v[204:207], v15, s[80:83], s73 offen sc1
    v_mfma_f32_16x16x32_bf16 v[36:39], a[152:155], v[120:123], v[36:39]
    v_exp_f32 v33, v33
    v_mfma_f32_16x16x32_bf16 v[36:39], a[156:159], v[124:127], v[36:39]
    v_cvt_pk_bf16_f32 v232, v32, v33
    v_mul_f32 v58, s70, v58
    v_mfma_f32_16x16x32_bf16 a[76:79], v[176:179], a[176:179], 0
    s_add_u32 s74, s72, 0xb00000
    v_exp_f32 v34, v34
    v_mfma_f32_16x16x32_bf16 a[76:79], v[180:183], a[180:183], a[76:79]
    buffer_store_dwordx4 v[220:223], v15, s[80:83], s74 offen sc1
    v_mfma_f32_16x16x32_bf16 a[76:79], v[184:187], a[184:187], a[76:79]
    v_exp_f32 v35, v35
    v_mfma_f32_16x16x32_bf16 a[76:79], v[188:191], a[188:191], a[76:79]
    v_cvt_pk_bf16_f32 v233, v34, v35
    v_mul_f32 v59, s70, v59
    v_smfmac_f32_16x16x64_bf16 a[136:139], a[208:211], v[160:167], v14
    s_waitcnt lgkmcnt(0)
    buffer_load_dwordx4 v[40:43], v15, s[32:35], s89 offen sc1
    v_mfma_f32_16x16x32_bf16 v[32:35], a[160:163], v[64:67], v[16:19]
    s_lshl_b32 s91, s53, 16
    v_exp_f32 v36, v36
    v_mfma_f32_16x16x32_bf16 v[32:35], a[164:167], v[68:71], v[32:35]
    s_add_u32 s91, s91, s76
    v_mfma_f32_16x16x32_bf16 v[32:35], a[168:171], v[72:75], v[32:35]
    s_add_u32 s92, s91, 32768
    v_exp_f32 v37, v37
    v_mfma_f32_16x16x32_bf16 v[32:35], a[172:175], v[76:79], v[32:35]
    ds_read_b128 a[144:147], v0 offset:57344
    v_cvt_pk_bf16_f32 v248, v36, v37
    v_mfma_f32_16x16x32_bf16 a[80:83], v[128:131], a[192:195], 0
    v_exp_f32 v38, v38
    v_mfma_f32_16x16x32_bf16 a[80:83], v[132:135], a[196:199], a[80:83]
    ds_read_b128 a[148:151], v1 offset:57344
    ds_read_b128 a[152:155], v2 offset:57344
    v_mfma_f32_16x16x32_bf16 a[80:83], v[136:139], a[200:203], a[80:83]
    v_exp_f32 v39, v39
    v_mfma_f32_16x16x32_bf16 a[80:83], v[140:143], a[204:207], a[80:83]
    ds_read_b128 a[156:159], v3 offset:57344
    v_cvt_pk_bf16_f32 v249, v38, v39
    v_mfma_f32_16x16x32_bf16 v[36:39], a[160:163], v[80:83], v[20:23]
    v_exp_f32 v32, v32
    v_mfma_f32_16x16x32_bf16 v[36:39], a[164:167], v[84:87], v[36:39]
    v_bfe_u32 v53, v15, 4, 5
    v_lshlrev_b32 v53, 10, v53
    v_mfma_f32_16x16x32_bf16 v[36:39], a[168:171], v[88:91], v[36:39]
    v_exp_f32 v33, v33
    v_mfma_f32_16x16x32_bf16 v[36:39], a[172:175], v[92:95], v[36:39]
    ds_read_b64_tr_b16 a[176:177], v10 offset:0
    v_cvt_pk_bf16_f32 v202, v32, v33
    v_mfma_f32_16x16x32_bf16 a[84:87], v[144:147], a[192:195], 0
    v_exp_f32 v34, v34
    v_mfma_f32_16x16x32_bf16 a[84:87], v[148:151], a[196:199], a[84:87]
    ds_read_b64_tr_b16 a[178:179], v10 offset:4096
    ds_read_b64_tr_b16 a[180:181], v10 offset:16384
    v_mfma_f32_16x16x32_bf16 a[84:87], v[152:155], a[200:203], a[84:87]
    v_exp_f32 v35, v35
    v_mfma_f32_16x16x32_bf16 a[84:87], v[156:159], a[204:207], a[84:87]
    ds_read_b64_tr_b16 a[182:183], v10 offset:20480
    v_cvt_pk_bf16_f32 v203, v34, v35
    v_mfma_f32_16x16x32_bf16 v[32:35], a[160:163], v[96:99], v[24:27]
    v_exp_f32 v36, v36
    v_mfma_f32_16x16x32_bf16 v[32:35], a[164:167], v[100:103], v[32:35]
    v_lshrrev_b32 v54, 9, v15
    v_lshl_add_u32 v53, v54, 4, v53
    v_mfma_f32_16x16x32_bf16 v[32:35], a[168:171], v[104:107], v[32:35]
    v_exp_f32 v37, v37
    v_mfma_f32_16x16x32_bf16 v[32:35], a[172:175], v[108:111], v[32:35]
    ds_read_b64_tr_b16 a[184:185], v10 offset:32768
    v_cvt_pk_bf16_f32 v218, v36, v37
    v_mfma_f32_16x16x32_bf16 a[88:91], v[160:163], a[192:195], 0
    v_exp_f32 v38, v38
    v_mfma_f32_16x16x32_bf16 a[88:91], v[164:167], a[196:199], a[88:91]
    ds_read_b64_tr_b16 a[186:187], v10 offset:36864
    ds_read_b64_tr_b16 a[188:189], v10 offset:49152
    v_mfma_f32_16x16x32_bf16 a[88:91], v[168:171], a[200:203], a[88:91]
    v_exp_f32 v39, v39
    v_mfma_f32_16x16x32_bf16 a[88:91], v[172:175], a[204:207], a[88:91]
    ds_read_b64_tr_b16 a[190:191], v10 offset:53248
    v_cvt_pk_bf16_f32 v219, v38, v39
    v_mfma_f32_16x16x32_bf16 v[36:39], a[160:163], v[112:115], v[28:31]
    s_add_u32 s73, s72, 0xd00000
    v_exp_f32 v32, v32
    v_mfma_f32_16x16x32_bf16 v[36:39], a[164:167], v[116:119], v[36:39]
    buffer_store_dwordx4 v[236:239], v15, s[80:83], s73 offen sc1
    v_mfma_f32_16x16x32_bf16 v[36:39], a[168:171], v[120:123], v[36:39]
    v_exp_f32 v33, v33
    v_mfma_f32_16x16x32_bf16 v[36:39], a[172:175], v[124:127], v[36:39]
    v_cvt_pk_bf16_f32 v234, v32, v33
    v_mfma_f32_16x16x32_bf16 a[92:95], v[176:179], a[192:195], 0
    s_add_u32 s74, s72, 0xf00000
    v_exp_f32 v34, v34
    v_mfma_f32_16x16x32_bf16 a[92:95], v[180:183], a[196:199], a[92:95]
    buffer_store_dwordx4 v[252:255], v15, s[80:83], s74 offen sc1
    v_mfma_f32_16x16x32_bf16 a[92:95], v[184:187], a[200:203], a[92:95]
    s_lshl_b32 s77, s3, 13
    v_exp_f32 v35, v35
    v_mfma_f32_16x16x32_bf16 a[92:95], v[188:191], a[204:207], a[92:95]
    s_add_u32 s40, s48, s87
    s_addc_u32 s41, s49, 0
    v_cvt_pk_bf16_f32 v235, v34, v35
    v_smfmac_f32_16x16x64_bf16 a[136:139], a[208:211], v[168:175], v14
    s_waitcnt lgkmcnt(0)
    v_mfma_f32_16x16x32_bf16 v[32:35], a[144:147], v[64:67], v[16:19]
    s_min_u32 s82, s82, s61
    v_exp_f32 v36, v36
    v_mfma_f32_16x16x32_bf16 v[32:35], a[148:151], v[68:71], v[32:35]
    buffer_load_dwordx4 a[216:219], v53, s[4:7], s91 offen
    v_mfma_f32_16x16x32_bf16 v[32:35], a[152:155], v[72:75], v[32:35]
    s_mov_b32 s58, 0
    v_exp_f32 v37, v37
    v_mfma_f32_16x16x32_bf16 v[32:35], a[156:159], v[76:79], v[32:35]
    s_mov_b32 s59, 0x1000
    ds_read_b128 a[160:163], v0 offset:61440
    v_cvt_pk_bf16_f32 v250, v36, v37
    v_mfma_f32_16x16x32_bf16 a[96:99], v[128:131], a[176:179], 0
    s_or_b32 s18, s3, s69
    s_cselect_b32 s42, 0, 4
    v_exp_f32 v38, v38
    v_mfma_f32_16x16x32_bf16 a[96:99], v[132:135], a[180:183], a[96:99]
    s_mov_b32 s43, 0x20000
    ds_read_b128 a[164:167], v1 offset:61440
    ds_read_b128 a[168:171], v2 offset:61440
    v_mfma_f32_16x16x32_bf16 a[96:99], v[136:139], a[184:187], a[96:99]
    s_add_u32 s24, s52, 6
    v_exp_f32 v39, v39
    v_mfma_f32_16x16x32_bf16 a[96:99], v[140:143], a[188:191], a[96:99]
    s_and_b32 s24, s24, 7
    ds_read_b128 a[172:175], v3 offset:61440
    v_cvt_pk_bf16_f32 v251, v38, v39
    v_mfma_f32_16x16x32_bf16 v[36:39], a[144:147], v[80:83], v[20:23]
    s_lshl_b32 s24, s24, 10
    v_exp_f32 v32, v32
    v_mfma_f32_16x16x32_bf16 v[36:39], a[148:151], v[84:87], v[36:39]
    buffer_load_dwordx4 a[220:223], v53, s[4:7], s92 offen
    v_mfma_f32_16x16x32_bf16 v[36:39], a[152:155], v[88:91], v[36:39]
    s_add_u32 s24, s24, s85
    v_exp_f32 v33, v33
    v_mfma_f32_16x16x32_bf16 v[36:39], a[156:159], v[92:95], v[36:39]
    s_add_u32 s24, s24, 0x100000
    ds_read_b64_tr_b16 a[192:193], v11 offset:0
    v_cvt_pk_bf16_f32 v204, v32, v33
    v_mfma_f32_16x16x32_bf16 a[100:103], v[144:147], a[176:179], 0
    s_add_u32 s25, s52, 7
    v_exp_f32 v34, v34
    v_mfma_f32_16x16x32_bf16 a[100:103], v[148:151], a[180:183], a[100:103]
    s_and_b32 s25, s25, 7
    ds_read_b64_tr_b16 a[194:195], v11 offset:4096
    ds_read_b64_tr_b16 a[196:197], v11 offset:16384
    v_mfma_f32_16x16x32_bf16 a[100:103], v[152:155], a[184:187], a[100:103]
    s_lshl_b32 s25, s25, 10
    v_exp_f32 v35, v35
    v_mfma_f32_16x16x32_bf16 a[100:103], v[156:159], a[188:191], a[100:103]
    s_add_u32 s25, s25, s85
    ds_read_b64_tr_b16 a[198:199], v11 offset:20480
    v_cvt_pk_bf16_f32 v205, v34, v35
    v_mfma_f32_16x16x32_bf16 v[32:35], a[144:147], v[96:99], v[24:27]
    s_add_u32 s26, s52, 7
    v_exp_f32 v36, v36
    v_mfma_f32_16x16x32_bf16 v[32:35], a[148:151], v[100:103], v[32:35]
    s_and_b32 s26, s26, 7
    v_mov_b32 v52, v44
    v_mov_b32 v53, v45
    v_mfma_f32_16x16x32_bf16 v[32:35], a[152:155], v[104:107], v[32:35]
    s_lshl_b32 s26, s26, 10
    v_exp_f32 v37, v37
    v_mfma_f32_16x16x32_bf16 v[32:35], a[156:159], v[108:111], v[32:35]
    s_add_u32 s26, s26, s85
    ds_read_b64_tr_b16 a[200:201], v11 offset:32768
    v_cvt_pk_bf16_f32 v220, v36, v37
    v_mfma_f32_16x16x32_bf16 a[104:107], v[160:163], a[176:179], 0
    s_add_u32 s26, s26, 0x100000
    v_exp_f32 v38, v38
    v_mfma_f32_16x16x32_bf16 a[104:107], v[164:167], a[180:183], a[104:107]
    s_lshr_b32 s18, s2, 3
    ds_read_b64_tr_b16 a[202:203], v11 offset:36864
    ds_read_b64_tr_b16 a[204:205], v11 offset:49152
    v_mfma_f32_16x16x32_bf16 a[104:107], v[168:171], a[184:187], a[104:107]
    s_lshl_b32 s18, s18, 2
    v_exp_f32 v39, v39
    v_mfma_f32_16x16x32_bf16 a[104:107], v[172:175], a[188:191], a[104:107]
    s_add_u32 s18, s18, s3
    ds_read_b64_tr_b16 a[206:207], v11 offset:53248
    v_cvt_pk_bf16_f32 v221, v38, v39
    v_mfma_f32_16x16x32_bf16 v[36:39], a[144:147], v[112:115], v[28:31]
    s_and_b32 s18, s18, 31
    v_exp_f32 v32, v32
    v_mfma_f32_16x16x32_bf16 v[36:39], a[148:151], v[116:119], v[36:39]
    buffer_store_dwordx4 a[212:215], v15, s[80:83], s90 offen sc1
    v_mov_b32 v54, v46
    v_mov_b32 v55, v47
    v_mfma_f32_16x16x32_bf16 v[36:39], a[152:155], v[120:123], v[36:39]
    s_mul_i32 s18, s18, 608
    v_exp_f32 v33, v33
    v_mfma_f32_16x16x32_bf16 v[36:39], a[156:159], v[124:127], v[36:39]
    s_add_u32 s18, s18, L_FIN-L_PC3
    v_cvt_pk_bf16_f32 v236, v32, v33
    v_mfma_f32_16x16x32_bf16 a[108:111], v[176:179], a[176:179], 0
    s_getpc_b64 s[16:17]
L_PC3:
    v_exp_f32 v34, v34
    v_mfma_f32_16x16x32_bf16 a[108:111], v[180:183], a[180:183], a[108:111]
    s_add_u32 s16, s16, s18
    s_addc_u32 s17, s17, 0
    v_mfma_f32_16x16x32_bf16 a[108:111], v[184:187], a[184:187], a[108:111]
    s_add_u32 s90, s90, 0x100000
    v_exp_f32 v35, v35
    v_mfma_f32_16x16x32_bf16 a[108:111], v[188:191], a[188:191], a[108:111]
    v_cvt_pk_bf16_f32 v237, v34, v35
    v_smfmac_f32_16x16x64_bf16 a[140:143], a[208:211], v[176:183], v14
    s_waitcnt vmcnt(12) lgkmcnt(0)
    s_barrier
    v_mfma_f32_16x16x32_bf16 v[32:35], a[160:163], v[64:67], v[16:19]
    v_exp_f32 v36, v36
    v_mfma_f32_16x16x32_bf16 v[32:35], a[164:167], v[68:71], v[32:35]
    v_mfma_f32_16x16x32_bf16 v[32:35], a[168:171], v[72:75], v[32:35]
    v_exp_f32 v37, v37
    v_mfma_f32_16x16x32_bf16 v[32:35], a[172:175], v[76:79], v[32:35]
    ds_read_b128 a[144:147], v0 offset:0
    v_cvt_pk_bf16_f32 v252, v36, v37
    v_mfma_f32_16x16x32_bf16 a[112:115], v[128:131], a[192:195], 0
    s_add_u32 s64, s64, 0x8000
    v_exp_f32 v38, v38
    v_mfma_f32_16x16x32_bf16 a[112:115], v[132:135], a[196:199], a[112:115]
    s_nop 0
    ds_read_b128 a[148:151], v1 offset:0
    ds_read_b128 a[152:155], v2 offset:0
    v_mfma_f32_16x16x32_bf16 a[112:115], v[136:139], a[200:203], a[112:115]
    s_add_u32 s65, s65, 0x8000
    v_exp_f32 v39, v39
    v_mfma_f32_16x16x32_bf16 a[112:115], v[140:143], a[204:207], a[112:115]
    ds_read_b128 a[156:159], v3 offset:0
    v_cvt_pk_bf16_f32 v253, v38, v39
    v_mfma_f32_16x16x32_bf16 v[36:39], a[160:163], v[80:83], v[20:23]
    v_exp_f32 v32, v32
    v_mfma_f32_16x16x32_bf16 v[36:39], a[164:167], v[84:87], v[36:39]
    v_mfma_f32_16x16x32_bf16 v[36:39], a[168:171], v[88:91], v[36:39]
    v_exp_f32 v33, v33
    v_mfma_f32_16x16x32_bf16 v[36:39], a[172:175], v[92:95], v[36:39]
    ds_read_b64_tr_b16 a[176:177], v4 offset:8192
    v_cvt_pk_bf16_f32 v206, v32, v33
    v_mfma_f32_16x16x32_bf16 a[116:119], v[144:147], a[192:195], 0
    s_add_u32 s66, s66, 0x8000
    v_exp_f32 v34, v34
    v_mfma_f32_16x16x32_bf16 a[116:119], v[148:151], a[196:199], a[116:119]
    s_nop 0
    ds_read_b64_tr_b16 a[178:179], v4 offset:12288
    ds_read_b64_tr_b16 a[180:181], v4 offset:24576
    v_mfma_f32_16x16x32_bf16 a[116:119], v[152:155], a[200:203], a[116:119]
    s_add_u32 s67, s67, 0x8000
    v_exp_f32 v35, v35
    v_mfma_f32_16x16x32_bf16 a[116:119], v[156:159], a[204:207], a[116:119]
    ds_read_b64_tr_b16 a[182:183], v4 offset:28672
    v_cvt_pk_bf16_f32 v207, v34, v35
    v_mfma_f32_16x16x32_bf16 v[32:35], a[160:163], v[96:99], v[24:27]
    v_exp_f32 v36, v36
    v_mfma_f32_16x16x32_bf16 v[32:35], a[164:167], v[100:103], v[32:35]
    v_mfma_f32_16x16x32_bf16 v[32:35], a[168:171], v[104:107], v[32:35]
    v_exp_f32 v37, v37
    v_mfma_f32_16x16x32_bf16 v[32:35], a[172:175], v[108:111], v[32:35]
    ds_read_b64_tr_b16 a[184:185], v4 offset:40960
    v_cvt_pk_bf16_f32 v222, v36, v37
    v_mfma_f32_16x16x32_bf16 a[120:123], v[160:163], a[192:195], 0
    v_exp_f32 v38, v38
    v_mfma_f32_16x16x32_bf16 a[120:123], v[164:167], a[196:199], a[120:123]
    ds_read_b64_tr_b16 a[186:187], v4 offset:45056
    ds_read_b64_tr_b16 a[188:189], v4 offset:57344
    v_mfma_f32_16x16x32_bf16 a[120:123], v[168:171], a[200:203], a[120:123]
    v_exp_f32 v39, v39
    v_mfma_f32_16x16x32_bf16 a[120:123], v[172:175], a[204:207], a[120:123]
    ds_read_b64_tr_b16 a[190:191], v4 offset:61440
    v_cvt_pk_bf16_f32 v223, v38, v39
    v_mfma_f32_16x16x32_bf16 v[36:39], a[160:163], v[112:115], v[28:31]
    v_exp_f32 v32, v32
    v_mfma_f32_16x16x32_bf16 v[36:39], a[164:167], v[116:119], v[36:39]
    buffer_store_dwordx4 a[212:215], v15, s[80:83], s90 offen sc1
    v_mfma_f32_16x16x32_bf16 v[36:39], a[168:171], v[120:123], v[36:39]
    v_exp_f32 v33, v33
    v_mfma_f32_16x16x32_bf16 v[36:39], a[172:175], v[124:127], v[36:39]
    s_add_u32 m0, s63, 0x2000
    v_cvt_pk_bf16_f32 v238, v32, v33
    v_mfma_f32_16x16x32_bf16 a[124:127], v[176:179], a[192:195], 0
    v_exp_f32 v34, v34
    v_mfma_f32_16x16x32_bf16 a[124:127], v[180:183], a[196:199], a[124:127]
    v_mfma_f32_16x16x32_bf16 a[124:127], v[184:187], a[200:203], a[124:127]
    s_add_u32 s90, s90, 0x100000
    v_exp_f32 v35, v35
    v_mfma_f32_16x16x32_bf16 a[124:127], v[188:191], a[204:207], a[124:127]
    v_cvt_pk_bf16_f32 v239, v34, v35
    v_smfmac_f32_16x16x64_bf16 a[140:143], a[208:211], v[184:191], v14
    s_waitcnt lgkmcnt(0)
    s_mov_b32 s68, 7
.p2align 6
L_LOOP:
    v_mfma_f32_16x16x32_bf16 v[32:35], a[144:147], v[64:67], v[16:19]
    v_exp_f32 v36, v36
    v_mfma_f32_16x16x32_bf16 v[32:35], a[148:151], v[68:71], v[32:35]
    buffer_load_dwordx4 v12, s[8:11], s64 offen lds
    v_mfma_f32_16x16x32_bf16 v[32:35], a[152:155], v[72:75], v[32:35]
    v_exp_f32 v37, v37
    v_mfma_f32_16x16x32_bf16 v[32:35], a[156:159], v[76:79], v[32:35]
    ds_read_b128 a[160:163], v0 offset:4096
    v_cvt_pk_bf16_f32 v254, v36, v37
    v_mfma_f32_16x16x32_bf16 a[0:3], v[192:195], a[176:179], a[0:3]
    v_exp_f32 v38, v38
    v_mfma_f32_16x16x32_bf16 a[0:3], v[196:199], a[180:183], a[0:3]
    ds_read_b128 a[164:167], v1 offset:4096
    ds_read_b128 a[168:171], v2 offset:4096
    v_mfma_f32_16x16x32_bf16 a[0:3], v[200:203], a[184:187], a[0:3]
    v_exp_f32 v39, v39
    v_mfma_f32_16x16x32_bf16 a[0:3], v[204:207], a[188:191], a[0:3]
    ds_read_b128 a[172:175], v3 offset:4096
    v_cvt_pk_bf16_f32 v255, v38, v39
    v_mfma_f32_16x16x32_bf16 v[36:39], a[144:147], v[80:83], v[20:23]
    v_exp_f32 v32, v32
    v_mfma_f32_16x16x32_bf16 v[36:39], a[148:151], v[84:87], v[36:39]
    buffer_load_dwordx4 v13, s[8:11], s64 offen offset:1024 lds
    v_mfma_f32_16x16x32_bf16 v[36:39], a[152:155], v[88:91], v[36:39]
    v_exp_f32 v33, v33
    v_mfma_f32_16x16x32_bf16 v[36:39], a[156:159], v[92:95], v[36:39]
    ds_read_b64_tr_b16 a[192:193], v5 offset:8192
    v_cvt_pk_bf16_f32 v128, v32, v33
    v_mfma_f32_16x16x32_bf16 a[4:7], v[208:211], a[176:179], a[4:7]
    v_exp_f32 v34, v34
    v_mfma_f32_16x16x32_bf16 a[4:7], v[212:215], a[180:183], a[4:7]
    ds_read_b64_tr_b16 a[194:195], v5 offset:12288
    ds_read_b64_tr_b16 a[196:197], v5 offset:24576
    v_mfma_f32_16x16x32_bf16 a[4:7], v[216:219], a[184:187], a[4:7]
    v_exp_f32 v35, v35
    v_mfma_f32_16x16x32_bf16 a[4:7], v[220:223], a[188:191], a[4:7]
    ds_read_b64_tr_b16 a[198:199], v5 offset:28672
    v_cvt_pk_bf16_f32 v129, v34, v35
    v_mfma_f32_16x16x32_bf16 v[32:35], a[144:147], v[96:99], v[24:27]
    v_exp_f32 v36, v36
    v_mfma_f32_16x16x32_bf16 v[32:35], a[148:151], v[100:103], v[32:35]
    buffer_load_dwordx4 v12, s[8:11], s64 offen offset:2048 lds
    v_mfma_f32_16x16x32_bf16 v[32:35], a[152:155], v[104:107], v[32:35]
    v_exp_f32 v37, v37
    v_mfma_f32_16x16x32_bf16 v[32:35], a[156:159], v[108:111], v[32:35]
    ds_read_b64_tr_b16 a[200:201], v5 offset:40960
    v_cvt_pk_bf16_f32 v144, v36, v37
    v_mfma_f32_16x16x32_bf16 a[8:11], v[224:227], a[176:179], a[8:11]
    v_exp_f32 v38, v38
    v_mfma_f32_16x16x32_bf16 a[8:11], v[228:231], a[180:183], a[8:11]
    ds_read_b64_tr_b16 a[202:203], v5 offset:45056
    ds_read_b64_tr_b16 a[204:205], v5 offset:57344
    v_mfma_f32_16x16x32_bf16 a[8:11], v[232:235], a[184:187], a[8:11]
    v_exp_f32 v39, v39
    v_mfma_f32_16x16x32_bf16 a[8:11], v[236:239], a[188:191], a[8:11]
    ds_read_b64_tr_b16 a[206:207], v5 offset:61440
    v_cvt_pk_bf16_f32 v145, v38, v39
    v_mfma_f32_16x16x32_bf16 v[36:39], a[144:147], v[112:115], v[28:31]
    v_exp_f32 v32, v32
    v_mfma_f32_16x16x32_bf16 v[36:39], a[148:151], v[116:119], v[36:39]
    buffer_load_dwordx4 v13, s[8:11], s64 offen offset:3072 lds
    v_mfma_f32_16x16x32_bf16 v[36:39], a[152:155], v[120:123], v[36:39]
    v_exp_f32 v33, v33
    v_mfma_f32_16x16x32_bf16 v[36:39], a[156:159], v[124:127], v[36:39]
    v_cvt_pk_bf16_f32 v160, v32, v33
    v_mfma_f32_16x16x32_bf16 a[12:15], v[240:243], a[176:179], a[12:15]
    s_add_u32 m0, s63, 0x3000
    v_exp_f32 v34, v34
    v_mfma_f32_16x16x32_bf16 a[12:15], v[244:247], a[180:183], a[12:15]
    v_mfma_f32_16x16x32_bf16 a[12:15], v[248:251], a[184:187], a[12:15]
    v_exp_f32 v35, v35
    v_mfma_f32_16x16x32_bf16 a[12:15], v[252:255], a[188:191], a[12:15]
    v_cvt_pk_bf16_f32 v161, v34, v35
    v_smfmac_f32_16x16x64_bf16 a[128:131], a[208:211], v[192:199], v14
    s_waitcnt lgkmcnt(0)
    v_mfma_f32_16x16x32_bf16 v[32:35], a[160:163], v[64:67], v[16:19]
    v_exp_f32 v36, v36
    v_mfma_f32_16x16x32_bf16 v[32:35], a[164:167], v[68:71], v[32:35]
    buffer_load_dwordx4 v12, s[8:11], s65 offen lds
    v_mfma_f32_16x16x32_bf16 v[32:35], a[168:171], v[72:75], v[32:35]
    v_exp_f32 v37, v37
    v_mfma_f32_16x16x32_bf16 v[32:35], a[172:175], v[76:79], v[32:35]
    ds_read_b128 a[144:147], v0 offset:16384
    v_cvt_pk_bf16_f32 v176, v36, v37
    v_mfma_f32_16x16x32_bf16 a[16:19], v[192:195], a[192:195], a[16:19]
    v_exp_f32 v38, v38
    v_mfma_f32_16x16x32_bf16 a[16:19], v[196:199], a[196:199], a[16:19]
    ds_read_b128 a[148:151], v1 offset:16384
    ds_read_b128 a[152:155], v2 offset:16384
    v_mfma_f32_16x16x32_bf16 a[16:19], v[200:203], a[200:203], a[16:19]
    v_exp_f32 v39, v39
    v_mfma_f32_16x16x32_bf16 a[16:19], v[204:207], a[204:207], a[16:19]
    ds_read_b128 a[156:159], v3 offset:16384
    v_cvt_pk_bf16_f32 v177, v38, v39
    v_mfma_f32_16x16x32_bf16 v[36:39], a[160:163], v[80:83], v[20:23]
    v_exp_f32 v32, v32
    v_mfma_f32_16x16x32_bf16 v[36:39], a[164:167], v[84:87], v[36:39]
    buffer_load_dwordx4 v13, s[8:11], s65 offen offset:1024 lds
    v_mfma_f32_16x16x32_bf16 v[36:39], a[168:171], v[88:91], v[36:39]
    v_exp_f32 v33, v33
    v_mfma_f32_16x16x32_bf16 v[36:39], a[172:175], v[92:95], v[36:39]
    ds_read_b64_tr_b16 a[176:177], v6 offset:8192
    v_cvt_pk_bf16_f32 v130, v32, v33
    v_mfma_f32_16x16x32_bf16 a[20:23], v[208:211], a[192:195], a[20:23]
    v_exp_f32 v34, v34
    v_mfma_f32_16x16x32_bf16 a[20:23], v[212:215], a[196:199], a[20:23]
    ds_read_b64_tr_b16 a[178:179], v6 offset:12288
    ds_read_b64_tr_b16 a[180:181], v6 offset:24576
    v_mfma_f32_16x16x32_bf16 a[20:23], v[216:219], a[200:203], a[20:23]
    v_exp_f32 v35, v35
    v_mfma_f32_16x16x32_bf16 a[20:23], v[220:223], a[204:207], a[20:23]
    ds_read_b64_tr_b16 a[182:183], v6 offset:28672
    v_cvt_pk_bf16_f32 v131, v34, v35
    v_mfma_f32_16x16x32_bf16 v[32:35], a[160:163], v[96:99], v[24:27]
    v_exp_f32 v36, v36
    v_mfma_f32_16x16x32_bf16 v[32:35], a[164:167], v[100:103], v[32:35]
    buffer_load_dwordx4 v12, s[8:11], s65 offen offset:2048 lds
    v_mfma_f32_16x16x32_bf16 v[32:35], a[168:171], v[104:107], v[32:35]
    v_exp_f32 v37, v37
    v_mfma_f32_16x16x32_bf16 v[32:35], a[172:175], v[108:111], v[32:35]
    ds_read_b64_tr_b16 a[184:185], v6 offset:40960
    v_cvt_pk_bf16_f32 v146, v36, v37
    v_mfma_f32_16x16x32_bf16 a[24:27], v[224:227], a[192:195], a[24:27]
    v_exp_f32 v38, v38
    v_mfma_f32_16x16x32_bf16 a[24:27], v[228:231], a[196:199], a[24:27]
    ds_read_b64_tr_b16 a[186:187], v6 offset:45056
    ds_read_b64_tr_b16 a[188:189], v6 offset:57344
    v_mfma_f32_16x16x32_bf16 a[24:27], v[232:235], a[200:203], a[24:27]
    v_exp_f32 v39, v39
    v_mfma_f32_16x16x32_bf16 a[24:27], v[236:239], a[204:207], a[24:27]
    ds_read_b64_tr_b16 a[190:191], v6 offset:61440
    v_cvt_pk_bf16_f32 v147, v38, v39
    v_mfma_f32_16x16x32_bf16 v[36:39], a[160:163], v[112:115], v[28:31]
    v_exp_f32 v32, v32
    v_mfma_f32_16x16x32_bf16 v[36:39], a[164:167], v[116:119], v[36:39]
    buffer_load_dwordx4 v13, s[8:11], s65 offen offset:3072 lds
    v_mfma_f32_16x16x32_bf16 v[36:39], a[168:171], v[120:123], v[36:39]
    v_exp_f32 v33, v33
    v_mfma_f32_16x16x32_bf16 v[36:39], a[172:175], v[124:127], v[36:39]
    v_cvt_pk_bf16_f32 v162, v32, v33
    v_mfma_f32_16x16x32_bf16 a[28:31], v[240:243], a[192:195], a[28:31]
    s_add_u32 m0, s63, 0x10000
    v_exp_f32 v34, v34
    v_mfma_f32_16x16x32_bf16 a[28:31], v[244:247], a[196:199], a[28:31]
    v_mfma_f32_16x16x32_bf16 a[28:31], v[248:251], a[200:203], a[28:31]
    v_exp_f32 v35, v35
    v_mfma_f32_16x16x32_bf16 a[28:31], v[252:255], a[204:207], a[28:31]
    v_cvt_pk_bf16_f32 v163, v34, v35
    v_smfmac_f32_16x16x64_bf16 a[128:131], a[208:211], v[200:207], v14
    s_waitcnt lgkmcnt(0)
    v_mfma_f32_16x16x32_bf16 v[32:35], a[144:147], v[64:67], v[16:19]
    v_exp_f32 v36, v36
    v_mfma_f32_16x16x32_bf16 v[32:35], a[148:151], v[68:71], v[32:35]
    buffer_load_dwordx4 v12, s[12:15], s66 offen lds
    v_mfma_f32_16x16x32_bf16 v[32:35], a[152:155], v[72:75], v[32:35]
    v_exp_f32 v37, v37
    v_mfma_f32_16x16x32_bf16 v[32:35], a[156:159], v[76:79], v[32:35]
    ds_read_b128 a[160:163], v0 offset:20480
    v_cvt_pk_bf16_f32 v178, v36, v37
    v_mfma_f32_16x16x32_bf16 a[32:35], v[192:195], a[176:179], a[32:35]
    v_exp_f32 v38, v38
    v_mfma_f32_16x16x32_bf16 a[32:35], v[196:199], a[180:183], a[32:35]
    ds_read_b128 a[164:167], v1 offset:20480
    ds_read_b128 a[168:171], v2 offset:20480
    v_mfma_f32_16x16x32_bf16 a[32:35], v[200:203], a[184:187], a[32:35]
    v_exp_f32 v39, v39
    v_mfma_f32_16x16x32_bf16 a[32:35], v[204:207], a[188:191], a[32:35]
    ds_read_b128 a[172:175], v3 offset:20480
    v_cvt_pk_bf16_f32 v179, v38, v39
    v_mfma_f32_16x16x32_bf16 v[36:39], a[144:147], v[80:83], v[20:23]
    v_exp_f32 v32, v32
    v_mfma_f32_16x16x32_bf16 v[36:39], a[148:151], v[84:87], v[36:39]
    buffer_load_dwordx4 v13, s[12:15], s66 offen offset:1024 lds
    v_mfma_f32_16x16x32_bf16 v[36:39], a[152:155], v[88:91], v[36:39]
    v_exp_f32 v33, v33
    v_mfma_f32_16x16x32_bf16 v[36:39], a[156:159], v[92:95], v[36:39]
    ds_read_b64_tr_b16 a[192:193], v7 offset:8192
    v_cvt_pk_bf16_f32 v132, v32, v33
    v_mfma_f32_16x16x32_bf16 a[36:39], v[208:211], a[176:179], a[36:39]
    v_exp_f32 v34, v34
    v_mfma_f32_16x16x32_bf16 a[36:39], v[212:215], a[180:183], a[36:39]
    ds_read_b64_tr_b16 a[194:195], v7 offset:12288
    ds_read_b64_tr_b16 a[196:197], v7 offset:24576
    v_mfma_f32_16x16x32_bf16 a[36:39], v[216:219], a[184:187], a[36:39]
    v_exp_f32 v35, v35
    v_mfma_f32_16x16x32_bf16 a[36:39], v[220:223], a[188:191], a[36:39]
    ds_read_b64_tr_b16 a[198:199], v7 offset:28672
    v_cvt_pk_bf16_f32 v133, v34, v35
    v_mfma_f32_16x16x32_bf16 v[32:35], a[144:147], v[96:99], v[24:27]
    v_exp_f32 v36, v36
    v_mfma_f32_16x16x32_bf16 v[32:35], a[148:151], v[100:103], v[32:35]
    buffer_load_dwordx4 v12, s[12:15], s66 offen offset:2048 lds
    v_mfma_f32_16x16x32_bf16 v[32:35], a[152:155], v[104:107], v[32:35]
    v_exp_f32 v37, v37
    v_mfma_f32_16x16x32_bf16 v[32:35], a[156:159], v[108:111], v[32:35]
    ds_read_b64_tr_b16 a[200:201], v7 offset:40960
    v_cvt_pk_bf16_f32 v148, v36, v37
    v_mfma_f32_16x16x32_bf16 a[40:43], v[224:227], a[176:179], a[40:43]
L_PAD6:
    s_cbranch_execz L_PAD10
    v_exp_f32 v38, v38
    v_mfma_f32_16x16x32_bf16 a[40:43], v[228:231], a[180:183], a[40:43]
    ds_read_b64_tr_b16 a[202:203], v7 offset:45056
    ds_read_b64_tr_b16 a[204:205], v7 offset:57344
    v_mfma_f32_16x16x32_bf16 a[40:43], v[232:235], a[184:187], a[40:43]
    v_exp_f32 v39, v39
    v_mfma_f32_16x16x32_bf16 a[40:43], v[236:239], a[188:191], a[40:43]
    ds_read_b64_tr_b16 a[206:207], v7 offset:61440
    v_cvt_pk_bf16_f32 v149, v38, v39
    v_mfma_f32_16x16x32_bf16 v[36:39], a[144:147], v[112:115], v[28:31]
    v_exp_f32 v32, v32
    v_mfma_f32_16x16x32_bf16 v[36:39], a[148:151], v[116:119], v[36:39]
    buffer_load_dwordx4 v13, s[12:15], s66 offen offset:3072 lds
    v_mfma_f32_16x16x32_bf16 v[36:39], a[152:155], v[120:123], v[36:39]
    v_exp_f32 v33, v33
    v_mfma_f32_16x16x32_bf16 v[36:39], a[156:159], v[124:127], v[36:39]
    v_cvt_pk_bf16_f32 v164, v32, v33
    v_mfma_f32_16x16x32_bf16 a[44:47], v[240:243], a[176:179], a[44:47]
    s_add_u32 m0, s63, 0x11000
    v_exp_f32 v34, v34
    v_mfma_f32_16x16x32_bf16 a[44:47], v[244:247], a[180:183], a[44:47]
    v_mfma_f32_16x16x32_bf16 a[44:47], v[248:251], a[184:187], a[44:47]
    v_exp_f32 v35, v35
    v_mfma_f32_16x16x32_bf16 a[44:47], v[252:255], a[188:191], a[44:47]
    v_cvt_pk_bf16_f32 v165, v34, v35
    v_smfmac_f32_16x16x64_bf16 a[132:135], a[208:211], v[208:215], v14
    s_waitcnt lgkmcnt(0)
    v_mfma_f32_16x16x32_bf16 v[32:35], a[160:163], v[64:67], v[16:19]
    v_exp_f32 v36, v36
    v_mfma_f32_16x16x32_bf16 v[32:35], a[164:167], v[68:71], v[32:35]
    buffer_load_dwordx4 v12, s[12:15], s67 offen lds
    v_mfma_f32_16x16x32_bf16 v[32:35], a[168:171], v[72:75], v[32:35]
    v_exp_f32 v37, v37
    v_mfma_f32_16x16x32_bf16 v[32:35], a[172:175], v[76:79], v[32:35]
    ds_read_b128 a[144:147], v0 offset:32768
    v_cvt_pk_bf16_f32 v180, v36, v37
    v_mfma_f32_16x16x32_bf16 a[48:51], v[192:195], a[192:195], a[48:51]
    v_exp_f32 v38, v38
    v_mfma_f32_16x16x32_bf16 a[48:51], v[196:199], a[196:199], a[48:51]
    ds_read_b128 a[148:151], v1 offset:32768
    ds_read_b128 a[152:155], v2 offset:32768
    v_mfma_f32_16x16x32_bf16 a[48:51], v[200:203], a[200:203], a[48:51]
    v_exp_f32 v39, v39
    v_mfma_f32_16x16x32_bf16 a[48:51], v[204:207], a[204:207], a[48:51]
    ds_read_b128 a[156:159], v3 offset:32768
    v_cvt_pk_bf16_f32 v181, v38, v39
    v_mfma_f32_16x16x32_bf16 v[36:39], a[160:163], v[80:83], v[20:23]
    v_exp_f32 v32, v32
    v_mfma_f32_16x16x32_bf16 v[36:39], a[164:167], v[84:87], v[36:39]
    buffer_load_dwordx4 v13, s[12:15], s67 offen offset:1024 lds
    v_mfma_f32_16x16x32_bf16 v[36:39], a[168:171], v[88:91], v[36:39]
    v_exp_f32 v33, v33
    v_mfma_f32_16x16x32_bf16 v[36:39], a[172:175], v[92:95], v[36:39]
    ds_read_b64_tr_b16 a[176:177], v8 offset:8192
    v_cvt_pk_bf16_f32 v134, v32, v33
    v_mfma_f32_16x16x32_bf16 a[52:55], v[208:211], a[192:195], a[52:55]
    v_exp_f32 v34, v34
    v_mfma_f32_16x16x32_bf16 a[52:55], v[212:215], a[196:199], a[52:55]
    ds_read_b64_tr_b16 a[178:179], v8 offset:12288
    ds_read_b64_tr_b16 a[180:181], v8 offset:24576
    v_mfma_f32_16x16x32_bf16 a[52:55], v[216:219], a[200:203], a[52:55]
    v_exp_f32 v35, v35
    v_mfma_f32_16x16x32_bf16 a[52:55], v[220:223], a[204:207], a[52:55]
    ds_read_b64_tr_b16 a[182:183], v8 offset:28672
    v_cvt_pk_bf16_f32 v135, v34, v35
    v_mfma_f32_16x16x32_bf16 v[32:35], a[160:163], v[96:99], v[24:27]
    v_exp_f32 v36, v36
    v_mfma_f32_16x16x32_bf16 v[32:35], a[164:167], v[100:103], v[32:35]
    buffer_load_dwordx4 v12, s[12:15], s67 offen offset:2048 lds
    v_mfma_f32_16x16x32_bf16 v[32:35], a[168:171], v[104:107], v[32:35]
    v_exp_f32 v37, v37
    v_mfma_f32_16x16x32_bf16 v[32:35], a[172:175], v[108:111], v[32:35]
    ds_read_b64_tr_b16 a[184:185], v8 offset:40960
    v_cvt_pk_bf16_f32 v150, v36, v37
    v_mfma_f32_16x16x32_bf16 a[56:59], v[224:227], a[192:195], a[56:59]
    v_exp_f32 v38, v38
    v_mfma_f32_16x16x32_bf16 a[56:59], v[228:231], a[196:199], a[56:59]
    ds_read_b64_tr_b16 a[186:187], v8 offset:45056
    ds_read_b64_tr_b16 a[188:189], v8 offset:57344
    v_mfma_f32_16x16x32_bf16 a[56:59], v[232:235], a[200:203], a[56:59]
    v_exp_f32 v39, v39
    v_mfma_f32_16x16x32_bf16 a[56:59], v[236:239], a[204:207], a[56:59]
    ds_read_b64_tr_b16 a[190:191], v8 offset:61440
    v_cvt_pk_bf16_f32 v151, v38, v39
    v_mfma_f32_16x16x32_bf16 v[36:39], a[160:163], v[112:115], v[28:31]
    v_exp_f32 v32, v32
    v_mfma_f32_16x16x32_bf16 v[36:39], a[164:167], v[116:119], v[36:39]
    buffer_load_dwordx4 v13, s[12:15], s67 offen offset:3072 lds
    v_mfma_f32_16x16x32_bf16 v[36:39], a[168:171], v[120:123], v[36:39]
    v_exp_f32 v33, v33
    v_mfma_f32_16x16x32_bf16 v[36:39], a[172:175], v[124:127], v[36:39]
    v_cvt_pk_bf16_f32 v166, v32, v33
    v_mfma_f32_16x16x32_bf16 a[60:63], v[240:243], a[192:195], a[60:63]
    v_exp_f32 v34, v34
    v_mfma_f32_16x16x32_bf16 a[60:63], v[244:247], a[196:199], a[60:63]
    v_mfma_f32_16x16x32_bf16 a[60:63], v[248:251], a[200:203], a[60:63]
    v_exp_f32 v35, v35
    v_mfma_f32_16x16x32_bf16 a[60:63], v[252:255], a[204:207], a[60:63]
    v_cvt_pk_bf16_f32 v167, v34, v35
    v_smfmac_f32_16x16x64_bf16 a[132:135], a[208:211], v[216:223], v14
    s_waitcnt lgkmcnt(0)
    v_mfma_f32_16x16x32_bf16 v[32:35], a[144:147], v[64:67], v[16:19]
    s_waitcnt vmcnt(22)
    v_exp_f32 v36, v36
    v_mfma_f32_16x16x32_bf16 v[32:35], a[148:151], v[68:71], v[32:35]
    v_lshlrev_b32 v60, 16, v40
    v_and_b32 v40, 0xffff0000, v40
    v_mfma_f32_16x16x32_bf16 v[32:35], a[152:155], v[72:75], v[32:35]
    v_exp_f32 v37, v37
    v_mfma_f32_16x16x32_bf16 v[32:35], a[156:159], v[76:79], v[32:35]
    ds_read_b128 a[160:163], v0 offset:36864
    v_cvt_pk_bf16_f32 v182, v36, v37
    v_mfma_f32_16x16x32_bf16 a[64:67], v[192:195], a[176:179], a[64:67]
    v_exp_f32 v38, v38
    v_mfma_f32_16x16x32_bf16 a[64:67], v[196:199], a[180:183], a[64:67]
    ds_read_b128 a[164:167], v1 offset:36864
    ds_read_b128 a[168:171], v2 offset:36864
    v_mfma_f32_16x16x32_bf16 a[64:67], v[200:203], a[184:187], a[64:67]
    v_exp_f32 v39, v39
    v_mfma_f32_16x16x32_bf16 a[64:67], v[204:207], a[188:191], a[64:67]
    ds_read_b128 a[172:175], v3 offset:36864
    v_cvt_pk_bf16_f32 v183, v38, v39
    v_mfma_f32_16x16x32_bf16 v[36:39], a[144:147], v[80:83], v[20:23]
    v_exp_f32 v32, v32
    v_mfma_f32_16x16x32_bf16 v[36:39], a[148:151], v[84:87], v[36:39]
    v_add_f32 v44, v44, v60
    v_add_f32 v45, v45, v40
    v_mfma_f32_16x16x32_bf16 v[36:39], a[152:155], v[88:91], v[36:39]
    v_exp_f32 v33, v33
    v_mfma_f32_16x16x32_bf16 v[36:39], a[156:159], v[92:95], v[36:39]
    ds_read_b64_tr_b16 a[192:193], v9 offset:8192
    v_cvt_pk_bf16_f32 v136, v32, v33
    v_mfma_f32_16x16x32_bf16 a[68:71], v[208:211], a[176:179], a[68:71]
    v_exp_f32 v34, v34
    v_mfma_f32_16x16x32_bf16 a[68:71], v[212:215], a[180:183], a[68:71]
    ds_read_b64_tr_b16 a[194:195], v9 offset:12288
    ds_read_b64_tr_b16 a[196:197], v9 offset:24576
    v_mfma_f32_16x16x32_bf16 a[68:71], v[216:219], a[184:187], a[68:71]
    v_exp_f32 v35, v35
    v_mfma_f32_16x16x32_bf16 a[68:71], v[220:223], a[188:191], a[68:71]
    ds_read_b64_tr_b16 a[198:199], v9 offset:28672
    v_cvt_pk_bf16_f32 v137, v34, v35
    v_mfma_f32_16x16x32_bf16 v[32:35], a[144:147], v[96:99], v[24:27]
    v_exp_f32 v36, v36
    v_mfma_f32_16x16x32_bf16 v[32:35], a[148:151], v[100:103], v[32:35]
    v_lshlrev_b32 v60, 16, v41
    v_and_b32 v41, 0xffff0000, v41
    v_mfma_f32_16x16x32_bf16 v[32:35], a[152:155], v[104:107], v[32:35]
    v_exp_f32 v37, v37
    v_mfma_f32_16x16x32_bf16 v[32:35], a[156:159], v[108:111], v[32:35]
    ds_read_b64_tr_b16 a[200:201], v9 offset:40960
    v_cvt_pk_bf16_f32 v152, v36, v37
    v_mfma_f32_16x16x32_bf16 a[72:75], v[224:227], a[176:179], a[72:75]
    v_exp_f32 v38, v38
    v_mfma_f32_16x16x32_bf16 a[72:75], v[228:231], a[180:183], a[72:75]
    ds_read_b64_tr_b16 a[202:203], v9 offset:45056
    ds_read_b64_tr_b16 a[204:205], v9 offset:57344
    v_mfma_f32_16x16x32_bf16 a[72:75], v[232:235], a[184:187], a[72:75]
    v_exp_f32 v39, v39
    v_mfma_f32_16x16x32_bf16 a[72:75], v[236:239], a[188:191], a[72:75]
    ds_read_b64_tr_b16 a[206:207], v9 offset:61440
    v_cvt_pk_bf16_f32 v153, v38, v39
    v_mfma_f32_16x16x32_bf16 v[36:39], a[144:147], v[112:115], v[28:31]
    v_exp_f32 v32, v32
    v_mfma_f32_16x16x32_bf16 v[36:39], a[148:151], v[116:119], v[36:39]
    v_add_f32 v46, v46, v60
    v_add_f32 v47, v47, v41
    v_mfma_f32_16x16x32_bf16 v[36:39], a[152:155], v[120:123], v[36:39]
    v_exp_f32 v33, v33
    v_mfma_f32_16x16x32_bf16 v[36:39], a[156:159], v[124:127], v[36:39]
    v_cvt_pk_bf16_f32 v168, v32, v33
    v_lshlrev_b32 v60, 16, v42
    v_mfma_f32_16x16x32_bf16 a[76:79], v[240:243], a[176:179], a[76:79]
    v_exp_f32 v34, v34
    v_mfma_f32_16x16x32_bf16 a[76:79], v[244:247], a[180:183], a[76:79]
    v_and_b32 v42, 0xffff0000, v42
    v_add_f32 v48, v48, v60
    v_mfma_f32_16x16x32_bf16 a[76:79], v[248:251], a[184:187], a[76:79]
    v_exp_f32 v35, v35
    v_mfma_f32_16x16x32_bf16 a[76:79], v[252:255], a[188:191], a[76:79]
    v_cvt_pk_bf16_f32 v169, v34, v35
    v_add_f32 v49, v49, v42
    v_smfmac_f32_16x16x64_bf16 a[136:139], a[208:211], v[224:231], v14
    s_waitcnt lgkmcnt(0)
    v_lshlrev_b32 v60, 16, v43
    v_and_b32 v43, 0xffff0000, v43
    v_mfma_f32_16x16x32_bf16 v[32:35], a[160:163], v[64:67], v[16:19]
    v_exp_f32 v36, v36
    v_mfma_f32_16x16x32_bf16 v[32:35], a[164:167], v[68:71], v[32:35]
    v_add_f32 v50, v50, v60
    v_add_f32 v51, v51, v43
    v_mfma_f32_16x16x32_bf16 v[32:35], a[168:171], v[72:75], v[32:35]
    v_exp_f32 v37, v37
    v_mfma_f32_16x16x32_bf16 v[32:35], a[172:175], v[76:79], v[32:35]
    ds_read_b128 a[144:147], v0 offset:49152
    v_cvt_pk_bf16_f32 v184, v36, v37
    v_mfma_f32_16x16x32_bf16 a[80:83], v[192:195], a[192:195], a[80:83]
    v_exp_f32 v38, v38
    v_mfma_f32_16x16x32_bf16 a[80:83], v[196:199], a[196:199], a[80:83]
    ds_read_b128 a[148:151], v1 offset:49152
    ds_read_b128 a[152:155], v2 offset:49152
    v_mfma_f32_16x16x32_bf16 a[80:83], v[200:203], a[200:203], a[80:83]
    v_exp_f32 v39, v39
    v_mfma_f32_16x16x32_bf16 a[80:83], v[204:207], a[204:207], a[80:83]
    ds_read_b128 a[156:159], v3 offset:49152
    v_cvt_pk_bf16_f32 v185, v38, v39
    v_mfma_f32_16x16x32_bf16 v[36:39], a[160:163], v[80:83], v[20:23]
    v_exp_f32 v32, v32
    v_mfma_f32_16x16x32_bf16 v[36:39], a[164:167], v[84:87], v[36:39]
    v_mfma_f32_16x16x32_bf16 v[36:39], a[168:171], v[88:91], v[36:39]
    v_exp_f32 v33, v33
    v_mfma_f32_16x16x32_bf16 v[36:39], a[172:175], v[92:95], v[36:39]
    ds_read_b64_tr_b16 a[176:177], v10 offset:8192
    v_cvt_pk_bf16_f32 v138, v32, v33
    v_mfma_f32_16x16x32_bf16 a[84:87], v[208:211], a[192:195], a[84:87]
    v_exp_f32 v34, v34
    v_mfma_f32_16x16x32_bf16 a[84:87], v[212:215], a[196:199], a[84:87]
    ds_read_b64_tr_b16 a[178:179], v10 offset:12288
    ds_read_b64_tr_b16 a[180:181], v10 offset:24576
    v_mfma_f32_16x16x32_bf16 a[84:87], v[216:219], a[200:203], a[84:87]
    v_exp_f32 v35, v35
    v_mfma_f32_16x16x32_bf16 a[84:87], v[220:223], a[204:207], a[84:87]
    ds_read_b64_tr_b16 a[182:183], v10 offset:28672
    v_cvt_pk_bf16_f32 v139, v34, v35
    v_mfma_f32_16x16x32_bf16 v[32:35], a[160:163], v[96:99], v[24:27]
    v_exp_f32 v36, v36
    v_mfma_f32_16x16x32_bf16 v[32:35], a[164:167], v[100:103], v[32:35]
    buffer_load_dwordx4 v[40:43], v15, s[32:35], s89 offen sc1
    v_mfma_f32_16x16x32_bf16 v[32:35], a[168:171], v[104:107], v[32:35]
    s_cmp_eq_u32 s68, 1
    v_exp_f32 v37, v37
    v_mfma_f32_16x16x32_bf16 v[32:35], a[172:175], v[108:111], v[32:35]
    s_cselect_b32 s27, s24, 0x10000000
    ds_read_b64_tr_b16 a[184:185], v10 offset:40960
    v_cvt_pk_bf16_f32 v154, v36, v37
    v_mfma_f32_16x16x32_bf16 a[88:91], v[224:227], a[192:195], a[88:91]
    s_cselect_b32 s28, s25, 0x10000000
    v_exp_f32 v38, v38
    v_mfma_f32_16x16x32_bf16 a[88:91], v[228:231], a[196:199], a[88:91]
    s_cselect_b32 s29, s26, 0x10000000
    ds_read_b64_tr_b16 a[186:187], v10 offset:45056
    ds_read_b64_tr_b16 a[188:189], v10 offset:57344
    v_mfma_f32_16x16x32_bf16 a[88:91], v[232:235], a[200:203], a[88:91]
    v_exp_f32 v39, v39
    v_mfma_f32_16x16x32_bf16 a[88:91], v[236:239], a[204:207], a[88:91]
    ds_read_b64_tr_b16 a[190:191], v10 offset:61440
    v_cvt_pk_bf16_f32 v155, v38, v39
    v_mfma_f32_16x16x32_bf16 v[36:39], a[160:163], v[112:115], v[28:31]
    v_exp_f32 v32, v32
    v_mfma_f32_16x16x32_bf16 v[36:39], a[164:167], v[116:119], v[36:39]
    buffer_store_dwordx4 a[212:215], v15, s[80:83], s90 offen sc1
    v_mfma_f32_16x16x32_bf16 v[36:39], a[168:171], v[120:123], v[36:39]
    v_exp_f32 v33, v33
    v_mfma_f32_16x16x32_bf16 v[36:39], a[172:175], v[124:127], v[36:39]
    v_cvt_pk_bf16_f32 v170, v32, v33
    v_mfma_f32_16x16x32_bf16 a[92:95], v[240:243], a[192:195], a[92:95]
    v_exp_f32 v34, v34
    v_mfma_f32_16x16x32_bf16 a[92:95], v[244:247], a[196:199], a[92:95]
    v_mfma_f32_16x16x32_bf16 a[92:95], v[248:251], a[200:203], a[92:95]
    s_add_u32 s90, s90, 0x100000
    v_exp_f32 v35, v35
    v_mfma_f32_16x16x32_bf16 a[92:95], v[252:255], a[204:207], a[92:95]
    v_cvt_pk_bf16_f32 v171, v34, v35
    v_smfmac_f32_16x16x64_bf16 a[136:139], a[208:211], v[232:239], v14
    s_waitcnt lgkmcnt(0)
    v_mfma_f32_16x16x32_bf16 v[32:35], a[144:147], v[64:67], v[16:19]
    v_exp_f32 v36, v36
    v_mfma_f32_16x16x32_bf16 v[32:35], a[148:151], v[68:71], v[32:35]
    buffer_load_dwordx4 a[228:231], v15, s[32:35], s27 offen sc1
    v_mfma_f32_16x16x32_bf16 v[32:35], a[152:155], v[72:75], v[32:35]
    v_exp_f32 v37, v37
    v_mfma_f32_16x16x32_bf16 v[32:35], a[156:159], v[76:79], v[32:35]
    ds_read_b128 a[160:163], v0 offset:53248
    v_cvt_pk_bf16_f32 v186, v36, v37
    v_mfma_f32_16x16x32_bf16 a[96:99], v[192:195], a[176:179], a[96:99]
    v_exp_f32 v38, v38
    v_mfma_f32_16x16x32_bf16 a[96:99], v[196:199], a[180:183], a[96:99]
    ds_read_b128 a[164:167], v1 offset:53248
    ds_read_b128 a[168:171], v2 offset:53248
    v_mfma_f32_16x16x32_bf16 a[96:99], v[200:203], a[184:187], a[96:99]
    v_exp_f32 v39, v39
    v_mfma_f32_16x16x32_bf16 a[96:99], v[204:207], a[188:191], a[96:99]
    ds_read_b128 a[172:175], v3 offset:53248
    v_cvt_pk_bf16_f32 v187, v38, v39
    v_mfma_f32_16x16x32_bf16 v[36:39], a[144:147], v[80:83], v[20:23]
    v_exp_f32 v32, v32
    v_mfma_f32_16x16x32_bf16 v[36:39], a[148:151], v[84:87], v[36:39]
    buffer_load_dwordx4 a[232:235], v15, s[32:35], s28 offen sc1
    v_mfma_f32_16x16x32_bf16 v[36:39], a[152:155], v[88:91], v[36:39]
    v_exp_f32 v33, v33
    v_mfma_f32_16x16x32_bf16 v[36:39], a[156:159], v[92:95], v[36:39]
    ds_read_b64_tr_b16 a[192:193], v11 offset:8192
    v_cvt_pk_bf16_f32 v140, v32, v33
    v_mfma_f32_16x16x32_bf16 a[100:103], v[208:211], a[176:179], a[100:103]
    v_exp_f32 v34, v34
    v_mfma_f32_16x16x32_bf16 a[100:103], v[212:215], a[180:183], a[100:103]
    ds_read_b64_tr_b16 a[194:195], v11 offset:12288
    ds_read_b64_tr_b16 a[196:197], v11 offset:24576
    v_mfma_f32_16x16x32_bf16 a[100:103], v[216:219], a[184:187], a[100:103]
    v_exp_f32 v35, v35
    v_mfma_f32_16x16x32_bf16 a[100:103], v[220:223], a[188:191], a[100:103]
    ds_read_b64_tr_b16 a[198:199], v11 offset:28672
    v_cvt_pk_bf16_f32 v141, v34, v35
    v_mfma_f32_16x16x32_bf16 v[32:35], a[144:147], v[96:99], v[24:27]
    v_exp_f32 v36, v36
    v_mfma_f32_16x16x32_bf16 v[32:35], a[148:151], v[100:103], v[32:35]
    buffer_load_dwordx4 a[236:239], v15, s[32:35], s29 offen sc1
    v_mfma_f32_16x16x32_bf16 v[32:35], a[152:155], v[104:107], v[32:35]
    v_exp_f32 v37, v37
    v_mfma_f32_16x16x32_bf16 v[32:35], a[156:159], v[108:111], v[32:35]
    ds_read_b64_tr_b16 a[200:201], v11 offset:40960
    v_cvt_pk_bf16_f32 v156, v36, v37
    v_mfma_f32_16x16x32_bf16 a[104:107], v[224:227], a[176:179], a[104:107]
    v_exp_f32 v38, v38
    v_mfma_f32_16x16x32_bf16 a[104:107], v[228:231], a[180:183], a[104:107]
    ds_read_b64_tr_b16 a[202:203], v11 offset:45056
    ds_read_b64_tr_b16 a[204:205], v11 offset:57344
    v_mfma_f32_16x16x32_bf16 a[104:107], v[232:235], a[184:187], a[104:107]
    v_exp_f32 v39, v39
    v_mfma_f32_16x16x32_bf16 a[104:107], v[236:239], a[188:191], a[104:107]
    ds_read_b64_tr_b16 a[206:207], v11 offset:61440
    v_cvt_pk_bf16_f32 v157, v38, v39
    v_mfma_f32_16x16x32_bf16 v[36:39], a[144:147], v[112:115], v[28:31]
    v_exp_f32 v32, v32
    v_mfma_f32_16x16x32_bf16 v[36:39], a[148:151], v[116:119], v[36:39]
    buffer_store_dwordx4 a[212:215], v15, s[80:83], s90 offen sc1
    v_mfma_f32_16x16x32_bf16 v[36:39], a[152:155], v[120:123], v[36:39]
    v_exp_f32 v33, v33
    v_mfma_f32_16x16x32_bf16 v[36:39], a[156:159], v[124:127], v[36:39]
    v_cvt_pk_bf16_f32 v172, v32, v33
    v_mfma_f32_16x16x32_bf16 a[108:111], v[240:243], a[176:179], a[108:111]
    v_exp_f32 v34, v34
    v_mfma_f32_16x16x32_bf16 a[108:111], v[244:247], a[180:183], a[108:111]
    v_mfma_f32_16x16x32_bf16 a[108:111], v[248:251], a[184:187], a[108:111]
    s_add_u32 s90, s90, 0x100000
    v_exp_f32 v35, v35
    v_mfma_f32_16x16x32_bf16 a[108:111], v[252:255], a[188:191], a[108:111]
    v_cvt_pk_bf16_f32 v173, v34, v35
    v_smfmac_f32_16x16x64_bf16 a[140:143], a[208:211], v[240:247], v14
    s_waitcnt vmcnt(6) lgkmcnt(0)
    s_barrier
    v_mfma_f32_16x16x32_bf16 v[32:35], a[160:163], v[64:67], v[16:19]
    v_exp_f32 v36, v36
    v_mfma_f32_16x16x32_bf16 v[32:35], a[164:167], v[68:71], v[32:35]
    v_mfma_f32_16x16x32_bf16 v[32:35], a[168:171], v[72:75], v[32:35]
    v_exp_f32 v37, v37
    v_mfma_f32_16x16x32_bf16 v[32:35], a[172:175], v[76:79], v[32:35]
    ds_read_b128 a[144:147], v0 offset:8192
    v_cvt_pk_bf16_f32 v188, v36, v37
    v_mfma_f32_16x16x32_bf16 a[112:115], v[192:195], a[192:195], a[112:115]
    s_add_u32 s64, s64, 0x8000
    v_exp_f32 v38, v38
    v_mfma_f32_16x16x32_bf16 a[112:115], v[196:199], a[196:199], a[112:115]
    s_nop 0
    ds_read_b128 a[148:151], v1 offset:8192
    ds_read_b128 a[152:155], v2 offset:8192
    v_mfma_f32_16x16x32_bf16 a[112:115], v[200:203], a[200:203], a[112:115]
    s_add_u32 s65, s65, 0x8000
    v_exp_f32 v39, v39
    v_mfma_f32_16x16x32_bf16 a[112:115], v[204:207], a[204:207], a[112:115]
    ds_read_b128 a[156:159], v3 offset:8192
    v_cvt_pk_bf16_f32 v189, v38, v39
    v_mfma_f32_16x16x32_bf16 v[36:39], a[160:163], v[80:83], v[20:23]
    v_exp_f32 v32, v32
    v_mfma_f32_16x16x32_bf16 v[36:39], a[164:167], v[84:87], v[36:39]
    global_load_dword a224, v15, s[16:17]
    v_mfma_f32_16x16x32_bf16 v[36:39], a[168:171], v[88:91], v[36:39]
    v_exp_f32 v33, v33
    v_mfma_f32_16x16x32_bf16 v[36:39], a[172:175], v[92:95], v[36:39]
    ds_read_b64_tr_b16 a[176:177], v4 offset:0
    v_cvt_pk_bf16_f32 v142, v32, v33
    v_mfma_f32_16x16x32_bf16 a[116:119], v[208:211], a[192:195], a[116:119]
    s_add_u32 s66, s66, 0x8000
    v_exp_f32 v34, v34
    v_mfma_f32_16x16x32_bf16 a[116:119], v[212:215], a[196:199], a[116:119]
    s_nop 0
    ds_read_b64_tr_b16 a[178:179], v4 offset:4096
    ds_read_b64_tr_b16 a[180:181], v4 offset:16384
    v_mfma_f32_16x16x32_bf16 a[116:119], v[216:219], a[200:203], a[116:119]
    s_add_u32 s67, s67, 0x8000
    v_exp_f32 v35, v35
    v_mfma_f32_16x16x32_bf16 a[116:119], v[220:223], a[204:207], a[116:119]
    s_cmp_eq_u32 s68, 7
    ds_read_b64_tr_b16 a[182:183], v4 offset:20480
    v_cvt_pk_bf16_f32 v143, v34, v35
    v_mfma_f32_16x16x32_bf16 v[32:35], a[160:163], v[96:99], v[24:27]
    s_cselect_b32 s18, 0, 0x1000
    v_exp_f32 v36, v36
    v_mfma_f32_16x16x32_bf16 v[32:35], a[164:167], v[100:103], v[32:35]
    buffer_atomic_sub a212, v15, s[40:43], s18 offen sc1
    v_mfma_f32_16x16x32_bf16 v[32:35], a[168:171], v[104:107], v[32:35]
    v_exp_f32 v37, v37
    v_mfma_f32_16x16x32_bf16 v[32:35], a[172:175], v[108:111], v[32:35]
    ds_read_b64_tr_b16 a[184:185], v4 offset:32768
    v_cvt_pk_bf16_f32 v158, v36, v37
    v_mfma_f32_16x16x32_bf16 a[120:123], v[224:227], a[192:195], a[120:123]
    v_exp_f32 v38, v38
    v_mfma_f32_16x16x32_bf16 a[120:123], v[228:231], a[196:199], a[120:123]
    ds_read_b64_tr_b16 a[186:187], v4 offset:36864
    ds_read_b64_tr_b16 a[188:189], v4 offset:49152
    v_mfma_f32_16x16x32_bf16 a[120:123], v[232:235], a[200:203], a[120:123]
    v_exp_f32 v39, v39
    v_mfma_f32_16x16x32_bf16 a[120:123], v[236:239], a[204:207], a[120:123]
    ds_read_b64_tr_b16 a[190:191], v4 offset:53248
    v_cvt_pk_bf16_f32 v159, v38, v39
    v_mfma_f32_16x16x32_bf16 v[36:39], a[160:163], v[112:115], v[28:31]
    v_exp_f32 v32, v32
    v_mfma_f32_16x16x32_bf16 v[36:39], a[164:167], v[116:119], v[36:39]
    buffer_load_dword v60, off, s[48:51], s59 sc1
    v_mfma_f32_16x16x32_bf16 v[36:39], a[168:171], v[120:123], v[36:39]
    v_exp_f32 v33, v33
    v_mfma_f32_16x16x32_bf16 v[36:39], a[172:175], v[124:127], v[36:39]
    s_add_u32 m0, s63, 0x0
    v_cvt_pk_bf16_f32 v174, v32, v33
    v_mfma_f32_16x16x32_bf16 a[124:127], v[240:243], a[192:195], a[124:127]
    v_exp_f32 v34, v34
    v_mfma_f32_16x16x32_bf16 a[124:127], v[244:247], a[196:199], a[124:127]
    v_mfma_f32_16x16x32_bf16 a[124:127], v[248:251], a[200:203], a[124:127]
    v_exp_f32 v35, v35
    v_mfma_f32_16x16x32_bf16 a[124:127], v[252:255], a[204:207], a[124:127]
    v_cvt_pk_bf16_f32 v175, v34, v35
    v_smfmac_f32_16x16x64_bf16 a[140:143], a[208:211], v[248:255], v14
    s_waitcnt lgkmcnt(0)
    v_mfma_f32_16x16x32_bf16 v[32:35], a[144:147], v[64:67], v[16:19]
    v_exp_f32 v36, v36
    v_mfma_f32_16x16x32_bf16 v[32:35], a[148:151], v[68:71], v[32:35]
    buffer_load_dwordx4 v12, s[8:11], s64 offen lds
    v_mfma_f32_16x16x32_bf16 v[32:35], a[152:155], v[72:75], v[32:35]
    v_exp_f32 v37, v37
    v_mfma_f32_16x16x32_bf16 v[32:35], a[156:159], v[76:79], v[32:35]
    ds_read_b128 a[160:163], v0 offset:12288
    v_cvt_pk_bf16_f32 v190, v36, v37
    v_mfma_f32_16x16x32_bf16 a[0:3], v[128:131], a[176:179], a[0:3]
    v_exp_f32 v38, v38
    v_mfma_f32_16x16x32_bf16 a[0:3], v[132:135], a[180:183], a[0:3]
    ds_read_b128 a[164:167], v1 offset:12288
    ds_read_b128 a[168:171], v2 offset:12288
    v_mfma_f32_16x16x32_bf16 a[0:3], v[136:139], a[184:187], a[0:3]
    v_exp_f32 v39, v39
    v_mfma_f32_16x16x32_bf16 a[0:3], v[140:143], a[188:191], a[0:3]
    ds_read_b128 a[172:175], v3 offset:12288
    v_cvt_pk_bf16_f32 v191, v38, v39
    v_mfma_f32_16x16x32_bf16 v[36:39], a[144:147], v[80:83], v[20:23]
    v_exp_f32 v32, v32
    v_mfma_f32_16x16x32_bf16 v[36:39], a[148:151], v[84:87], v[36:39]
    buffer_load_dwordx4 v13, s[8:11], s64 offen offset:1024 lds
    v_mfma_f32_16x16x32_bf16 v[36:39], a[152:155], v[88:91], v[36:39]
    v_exp_f32 v33, v33
    v_mfma_f32_16x16x32_bf16 v[36:39], a[156:159], v[92:95], v[36:39]
    ds_read_b64_tr_b16 a[192:193], v5 offset:0
    v_cvt_pk_bf16_f32 v192, v32, v33
    v_mfma_f32_16x16x32_bf16 a[4:7], v[144:147], a[176:179], a[4:7]
    v_exp_f32 v34, v34
    v_mfma_f32_16x16x32_bf16 a[4:7], v[148:151], a[180:183], a[4:7]
    ds_read_b64_tr_b16 a[194:195], v5 offset:4096
    ds_read_b64_tr_b16 a[196:197], v5 offset:16384
    v_mfma_f32_16x16x32_bf16 a[4:7], v[152:155], a[184:187], a[4:7]
    v_exp_f32 v35, v35
    v_mfma_f32_16x16x32_bf16 a[4:7], v[156:159], a[188:191], a[4:7]
    ds_read_b64_tr_b16 a[198:199], v5 offset:20480
    v_cvt_pk_bf16_f32 v193, v34, v35
    v_mfma_f32_16x16x32_bf16 v[32:35], a[144:147], v[96:99], v[24:27]
    v_exp_f32 v36, v36
    v_mfma_f32_16x16x32_bf16 v[32:35], a[148:151], v[100:103], v[32:35]
    buffer_load_dwordx4 v12, s[8:11], s64 offen offset:2048 lds
    v_mfma_f32_16x16x32_bf16 v[32:35], a[152:155], v[104:107], v[32:35]
    v_exp_f32 v37, v37
    v_mfma_f32_16x16x32_bf16 v[32:35], a[156:159], v[108:111], v[32:35]
    ds_read_b64_tr_b16 a[200:201], v5 offset:32768
    v_cvt_pk_bf16_f32 v208, v36, v37
    v_mfma_f32_16x16x32_bf16 a[8:11], v[160:163], a[176:179], a[8:11]
    v_exp_f32 v38, v38
    v_mfma_f32_16x16x32_bf16 a[8:11], v[164:167], a[180:183], a[8:11]
    ds_read_b64_tr_b16 a[202:203], v5 offset:36864
    ds_read_b64_tr_b16 a[204:205], v5 offset:49152
    v_mfma_f32_16x16x32_bf16 a[8:11], v[168:171], a[184:187], a[8:11]
    v_exp_f32 v39, v39
    v_mfma_f32_16x16x32_bf16 a[8:11], v[172:175], a[188:191], a[8:11]
    ds_read_b64_tr_b16 a[206:207], v5 offset:53248
    v_cvt_pk_bf16_f32 v209, v38, v39
    v_mfma_f32_16x16x32_bf16 v[36:39], a[144:147], v[112:115], v[28:31]
    v_exp_f32 v32, v32
    v_mfma_f32_16x16x32_bf16 v[36:39], a[148:151], v[116:119], v[36:39]
    buffer_load_dwordx4 v13, s[8:11], s64 offen offset:3072 lds
    v_mfma_f32_16x16x32_bf16 v[36:39], a[152:155], v[120:123], v[36:39]
    v_exp_f32 v33, v33
    v_mfma_f32_16x16x32_bf16 v[36:39], a[156:159], v[124:127], v[36:39]
    v_cvt_pk_bf16_f32 v224, v32, v33
    v_mfma_f32_16x16x32_bf16 a[12:15], v[176:179], a[176:179], a[12:15]
    s_add_u32 m0, s63, 0x1000
    v_exp_f32 v34, v34
    v_mfma_f32_16x16x32_bf16 a[12:15], v[180:183], a[180:183], a[12:15]
    v_mfma_f32_16x16x32_bf16 a[12:15], v[184:187], a[184:187], a[12:15]
    v_exp_f32 v35, v35
    v_mfma_f32_16x16x32_bf16 a[12:15], v[188:191], a[188:191], a[12:15]
    v_cvt_pk_bf16_f32 v225, v34, v35
    v_smfmac_f32_16x16x64_bf16 a[128:131], a[208:211], v[128:135], v14
    s_waitcnt lgkmcnt(0)
    v_mfma_f32_16x16x32_bf16 v[32:35], a[160:163], v[64:67], v[16:19]
    v_exp_f32 v36, v36
    v_mfma_f32_16x16x32_bf16 v[32:35], a[164:167], v[68:71], v[32:35]
    buffer_load_dwordx4 v12, s[8:11], s65 offen lds
    v_mfma_f32_16x16x32_bf16 v[32:35], a[168:171], v[72:75], v[32:35]
    v_exp_f32 v37, v37
    v_mfma_f32_16x16x32_bf16 v[32:35], a[172:175], v[76:79], v[32:35]
    ds_read_b128 a[144:147], v0 offset:24576
    v_cvt_pk_bf16_f32 v240, v36, v37
    v_mfma_f32_16x16x32_bf16 a[16:19], v[128:131], a[192:195], a[16:19]
    v_exp_f32 v38, v38
    v_mfma_f32_16x16x32_bf16 a[16:19], v[132:135], a[196:199], a[16:19]
    ds_read_b128 a[148:151], v1 offset:24576
    ds_read_b128 a[152:155], v2 offset:24576
    v_mfma_f32_16x16x32_bf16 a[16:19], v[136:139], a[200:203], a[16:19]
    v_exp_f32 v39, v39
    v_mfma_f32_16x16x32_bf16 a[16:19], v[140:143], a[204:207], a[16:19]
    ds_read_b128 a[156:159], v3 offset:24576
    v_cvt_pk_bf16_f32 v241, v38, v39
    v_mfma_f32_16x16x32_bf16 v[36:39], a[160:163], v[80:83], v[20:23]
    v_exp_f32 v32, v32
    v_mfma_f32_16x16x32_bf16 v[36:39], a[164:167], v[84:87], v[36:39]
    buffer_load_dwordx4 v13, s[8:11], s65 offen offset:1024 lds
    v_mfma_f32_16x16x32_bf16 v[36:39], a[168:171], v[88:91], v[36:39]
    v_exp_f32 v33, v33
    v_mfma_f32_16x16x32_bf16 v[36:39], a[172:175], v[92:95], v[36:39]
    ds_read_b64_tr_b16 a[176:177], v6 offset:0
    v_cvt_pk_bf16_f32 v194, v32, v33
    v_mfma_f32_16x16x32_bf16 a[20:23], v[144:147], a[192:195], a[20:23]
    v_exp_f32 v34, v34
    v_mfma_f32_16x16x32_bf16 a[20:23], v[148:151], a[196:199], a[20:23]
    ds_read_b64_tr_b16 a[178:179], v6 offset:4096
    ds_read_b64_tr_b16 a[180:181], v6 offset:16384
    v_mfma_f32_16x16x32_bf16 a[20:23], v[152:155], a[200:203], a[20:23]
    v_exp_f32 v35, v35
    v_mfma_f32_16x16x32_bf16 a[20:23], v[156:159], a[204:207], a[20:23]
    ds_read_b64_tr_b16 a[182:183], v6 offset:20480
    v_cvt_pk_bf16_f32 v195, v34, v35
    v_mfma_f32_16x16x32_bf16 v[32:35], a[160:163], v[96:99], v[24:27]
    v_exp_f32 v36, v36
    v_mfma_f32_16x16x32_bf16 v[32:35], a[164:167], v[100:103], v[32:35]
    buffer_load_dwordx4 v12, s[8:11], s65 offen offset:2048 lds
    v_mfma_f32_16x16x32_bf16 v[32:35], a[168:171], v[104:107], v[32:35]
    v_exp_f32 v37, v37
    v_mfma_f32_16x16x32_bf16 v[32:35], a[172:175], v[108:111], v[32:35]
    ds_read_b64_tr_b16 a[184:185], v6 offset:32768
    v_cvt_pk_bf16_f32 v210, v36, v37
    v_mfma_f32_16x16x32_bf16 a[24:27], v[160:163], a[192:195], a[24:27]
    v_exp_f32 v38, v38
    v_mfma_f32_16x16x32_bf16 a[24:27], v[164:167], a[196:199], a[24:27]
    ds_read_b64_tr_b16 a[186:187], v6 offset:36864
    ds_read_b64_tr_b16 a[188:189], v6 offset:49152
    v_mfma_f32_16x16x32_bf16 a[24:27], v[168:171], a[200:203], a[24:27]
    v_exp_f32 v39, v39
    v_mfma_f32_16x16x32_bf16 a[24:27], v[172:175], a[204:207], a[24:27]
    ds_read_b64_tr_b16 a[190:191], v6 offset:53248
    v_cvt_pk_bf16_f32 v211, v38, v39
    v_mfma_f32_16x16x32_bf16 v[36:39], a[160:163], v[112:115], v[28:31]
    v_exp_f32 v32, v32
    v_mfma_f32_16x16x32_bf16 v[36:39], a[164:167], v[116:119], v[36:39]
    buffer_load_dwordx4 v13, s[8:11], s65 offen offset:3072 lds
    v_mfma_f32_16x16x32_bf16 v[36:39], a[168:171], v[120:123], v[36:39]
    v_exp_f32 v33, v33
    v_mfma_f32_16x16x32_bf16 v[36:39], a[172:175], v[124:127], v[36:39]
    v_cvt_pk_bf16_f32 v226, v32, v33
    v_mfma_f32_16x16x32_bf16 a[28:31], v[176:179], a[192:195], a[28:31]
    s_add_u32 m0, s63, 0x12000
    v_exp_f32 v34, v34
    v_mfma_f32_16x16x32_bf16 a[28:31], v[180:183], a[196:199], a[28:31]
    v_mfma_f32_16x16x32_bf16 a[28:31], v[184:187], a[200:203], a[28:31]
    v_exp_f32 v35, v35
    v_mfma_f32_16x16x32_bf16 a[28:31], v[188:191], a[204:207], a[28:31]
    v_cvt_pk_bf16_f32 v227, v34, v35
    v_smfmac_f32_16x16x64_bf16 a[128:131], a[208:211], v[136:143], v14
    s_waitcnt lgkmcnt(0)
    v_mfma_f32_16x16x32_bf16 v[32:35], a[144:147], v[64:67], v[16:19]
    v_exp_f32 v36, v36
    v_mfma_f32_16x16x32_bf16 v[32:35], a[148:151], v[68:71], v[32:35]
    buffer_load_dwordx4 v12, s[12:15], s66 offen lds
    v_mfma_f32_16x16x32_bf16 v[32:35], a[152:155], v[72:75], v[32:35]
    v_exp_f32 v37, v37
    v_mfma_f32_16x16x32_bf16 v[32:35], a[156:159], v[76:79], v[32:35]
    ds_read_b128 a[160:163], v0 offset:28672
    v_cvt_pk_bf16_f32 v242, v36, v37
    v_mfma_f32_16x16x32_bf16 a[32:35], v[128:131], a[176:179], a[32:35]
    v_exp_f32 v38, v38
    v_mfma_f32_16x16x32_bf16 a[32:35], v[132:135], a[180:183], a[32:35]
    ds_read_b128 a[164:167], v1 offset:28672
    ds_read_b128 a[168:171], v2 offset:28672
    v_mfma_f32_16x16x32_bf16 a[32:35], v[136:139], a[184:187], a[32:35]
L_PAD7:
    s_cbranch_execz L_PAD11
    v_exp_f32 v39, v39
    v_mfma_f32_16x16x32_bf16 a[32:35], v[140:143], a[188:191], a[32:35]
    ds_read_b128 a[172:175], v3 offset:28672
    v_cvt_pk_bf16_f32 v243, v38, v39
    v_mfma_f32_16x16x32_bf16 v[36:39], a[144:147], v[80:83], v[20:23]
    v_exp_f32 v32, v32
    v_mfma_f32_16x16x32_bf16 v[36:39], a[148:151], v[84:87], v[36:39]
    buffer_load_dwordx4 v13, s[12:15], s66 offen offset:1024 lds
    v_mfma_f32_16x16x32_bf16 v[36:39], a[152:155], v[88:91], v[36:39]
    v_exp_f32 v33, v33
    v_mfma_f32_16x16x32_bf16 v[36:39], a[156:159], v[92:95], v[36:39]
    ds_read_b64_tr_b16 a[192:193], v7 offset:0
    v_cvt_pk_bf16_f32 v196, v32, v33
    v_mfma_f32_16x16x32_bf16 a[36:39], v[144:147], a[176:179], a[36:39]
    v_exp_f32 v34, v34
    v_mfma_f32_16x16x32_bf16 a[36:39], v[148:151], a[180:183], a[36:39]
    ds_read_b64_tr_b16 a[194:195], v7 offset:4096
    ds_read_b64_tr_b16 a[196:197], v7 offset:16384
    v_mfma_f32_16x16x32_bf16 a[36:39], v[152:155], a[184:187], a[36:39]
    v_exp_f32 v35, v35
    v_mfma_f32_16x16x32_bf16 a[36:39], v[156:159], a[188:191], a[36:39]
    ds_read_b64_tr_b16 a[198:199], v7 offset:20480
    v_cvt_pk_bf16_f32 v197, v34, v35
    v_mfma_f32_16x16x32_bf16 v[32:35], a[144:147], v[96:99], v[24:27]
    v_exp_f32 v36, v36
    v_mfma_f32_16x16x32_bf16 v[32:35], a[148:151], v[100:103], v[32:35]
    buffer_load_dwordx4 v12, s[12:15], s66 offen offset:2048 lds
    v_mfma_f32_16x16x32_bf16 v[32:35], a[152:155], v[104:107], v[32:35]
    v_exp_f32 v37, v37
    v_mfma_f32_16x16x32_bf16 v[32:35], a[156:159], v[108:111], v[32:35]
    ds_read_b64_tr_b16 a[200:201], v7 offset:32768
    v_cvt_pk_bf16_f32 v212, v36, v37
    v_mfma_f32_16x16x32_bf16 a[40:43], v[160:163], a[176:179], a[40:43]
    v_exp_f32 v38, v38
    v_mfma_f32_16x16x32_bf16 a[40:43], v[164:167], a[180:183], a[40:43]
    ds_read_b64_tr_b16 a[202:203], v7 offset:36864
    ds_read_b64_tr_b16 a[204:205], v7 offset:49152
    v_mfma_f32_16x16x32_bf16 a[40:43], v[168:171], a[184:187], a[40:43]
    v_exp_f32 v39, v39
    v_mfma_f32_16x16x32_bf16 a[40:43], v[172:175], a[188:191], a[40:43]
    ds_read_b64_tr_b16 a[206:207], v7 offset:53248
    v_cvt_pk_bf16_f32 v213, v38, v39
    v_mfma_f32_16x16x32_bf16 v[36:39], a[144:147], v[112:115], v[28:31]
    v_exp_f32 v32, v32
    v_mfma_f32_16x16x32_bf16 v[36:39], a[148:151], v[116:119], v[36:39]
    buffer_load_dwordx4 v13, s[12:15], s66 offen offset:3072 lds
    v_mfma_f32_16x16x32_bf16 v[36:39], a[152:155], v[120:123], v[36:39]
    v_exp_f32 v33, v33
    v_mfma_f32_16x16x32_bf16 v[36:39], a[156:159], v[124:127], v[36:39]
    v_cvt_pk_bf16_f32 v228, v32, v33
    v_mfma_f32_16x16x32_bf16 a[44:47], v[176:179], a[176:179], a[44:47]
    s_add_u32 m0, s63, 0x13000
    v_exp_f32 v34, v34
    v_mfma_f32_16x16x32_bf16 a[44:47], v[180:183], a[180:183], a[44:47]
    v_mfma_f32_16x16x32_bf16 a[44:47], v[184:187], a[184:187], a[44:47]
    v_exp_f32 v35, v35
    v_mfma_f32_16x16x32_bf16 a[44:47], v[188:191], a[188:191], a[44:47]
    v_cvt_pk_bf16_f32 v229, v34, v35
    v_smfmac_f32_16x16x64_bf16 a[132:135], a[208:211], v[144:151], v14
    s_waitcnt lgkmcnt(0)
    v_mfma_f32_16x16x32_bf16 v[32:35], a[160:163], v[64:67], v[16:19]
    v_exp_f32 v36, v36
    v_mfma_f32_16x16x32_bf16 v[32:35], a[164:167], v[68:71], v[32:35]
    buffer_load_dwordx4 v12, s[12:15], s67 offen lds
    v_mfma_f32_16x16x32_bf16 v[32:35], a[168:171], v[72:75], v[32:35]
    v_exp_f32 v37, v37
    v_mfma_f32_16x16x32_bf16 v[32:35], a[172:175], v[76:79], v[32:35]
    ds_read_b128 a[144:147], v0 offset:40960
    v_cvt_pk_bf16_f32 v244, v36, v37
    v_mfma_f32_16x16x32_bf16 a[48:51], v[128:131], a[192:195], a[48:51]
    v_exp_f32 v38, v38
    v_mfma_f32_16x16x32_bf16 a[48:51], v[132:135], a[196:199], a[48:51]
    ds_read_b128 a[148:151], v1 offset:40960
    ds_read_b128 a[152:155], v2 offset:40960
    v_mfma_f32_16x16x32_bf16 a[48:51], v[136:139], a[200:203], a[48:51]
    v_exp_f32 v39, v39
    v_mfma_f32_16x16x32_bf16 a[48:51], v[140:143], a[204:207], a[48:51]
    ds_read_b128 a[156:159], v3 offset:40960
    v_cvt_pk_bf16_f32 v245, v38, v39
    v_mfma_f32_16x16x32_bf16 v[36:39], a[160:163], v[80:83], v[20:23]
    v_exp_f32 v32, v32
    v_mfma_f32_16x16x32_bf16 v[36:39], a[164:167], v[84:87], v[36:39]
    buffer_load_dwordx4 v13, s[12:15], s67 offen offset:1024 lds
    v_mfma_f32_16x16x32_bf16 v[36:39], a[168:171], v[88:91], v[36:39]
    v_exp_f32 v33, v33
    v_mfma_f32_16x16x32_bf16 v[36:39], a[172:175], v[92:95], v[36:39]
    ds_read_b64_tr_b16 a[176:177], v8 offset:0
    v_cvt_pk_bf16_f32 v198, v32, v33
    v_mfma_f32_16x16x32_bf16 a[52:55], v[144:147], a[192:195], a[52:55]
    v_exp_f32 v34, v34
    v_mfma_f32_16x16x32_bf16 a[52:55], v[148:151], a[196:199], a[52:55]
    ds_read_b64_tr_b16 a[178:179], v8 offset:4096
    ds_read_b64_tr_b16 a[180:181], v8 offset:16384
    v_mfma_f32_16x16x32_bf16 a[52:55], v[152:155], a[200:203], a[52:55]
    v_exp_f32 v35, v35
    v_mfma_f32_16x16x32_bf16 a[52:55], v[156:159], a[204:207], a[52:55]
    ds_read_b64_tr_b16 a[182:183], v8 offset:20480
    v_cvt_pk_bf16_f32 v199, v34, v35
    v_mfma_f32_16x16x32_bf16 v[32:35], a[160:163], v[96:99], v[24:27]
    v_exp_f32 v36, v36
    v_mfma_f32_16x16x32_bf16 v[32:35], a[164:167], v[100:103], v[32:35]
    buffer_load_dwordx4 v12, s[12:15], s67 offen offset:2048 lds
    v_mfma_f32_16x16x32_bf16 v[32:35], a[168:171], v[104:107], v[32:35]
    v_exp_f32 v37, v37
    v_mfma_f32_16x16x32_bf16 v[32:35], a[172:175], v[108:111], v[32:35]
    ds_read_b64_tr_b16 a[184:185], v8 offset:32768
    v_cvt_pk_bf16_f32 v214, v36, v37
    v_mfma_f32_16x16x32_bf16 a[56:59], v[160:163], a[192:195], a[56:59]
    v_exp_f32 v38, v38
    v_mfma_f32_16x16x32_bf16 a[56:59], v[164:167], a[196:199], a[56:59]
    ds_read_b64_tr_b16 a[186:187], v8 offset:36864
    ds_read_b64_tr_b16 a[188:189], v8 offset:49152
    v_mfma_f32_16x16x32_bf16 a[56:59], v[168:171], a[200:203], a[56:59]
    v_exp_f32 v39, v39
    v_mfma_f32_16x16x32_bf16 a[56:59], v[172:175], a[204:207], a[56:59]
    ds_read_b64_tr_b16 a[190:191], v8 offset:53248
    v_cvt_pk_bf16_f32 v215, v38, v39
    v_mfma_f32_16x16x32_bf16 v[36:39], a[160:163], v[112:115], v[28:31]
    v_exp_f32 v32, v32
    v_mfma_f32_16x16x32_bf16 v[36:39], a[164:167], v[116:119], v[36:39]
    buffer_load_dwordx4 v13, s[12:15], s67 offen offset:3072 lds
    v_mfma_f32_16x16x32_bf16 v[36:39], a[168:171], v[120:123], v[36:39]
    v_exp_f32 v33, v33
    v_mfma_f32_16x16x32_bf16 v[36:39], a[172:175], v[124:127], v[36:39]
    s_waitcnt vmcnt(16)
    v_cvt_pk_bf16_f32 v230, v32, v33
    v_mfma_f32_16x16x32_bf16 a[60:63], v[176:179], a[192:195], a[60:63]
    v_exp_f32 v34, v34
    v_mfma_f32_16x16x32_bf16 a[60:63], v[180:183], a[196:199], a[60:63]
    v_readfirstlane_b32 s78, v60
    v_mfma_f32_16x16x32_bf16 a[60:63], v[184:187], a[200:203], a[60:63]
    s_cmp_lt_u32 s78, s58
    v_exp_f32 v35, v35
    v_mfma_f32_16x16x32_bf16 a[60:63], v[188:191], a[204:207], a[60:63]
    s_cbranch_scc1 L_WA
L_BA:
    v_cvt_pk_bf16_f32 v231, v34, v35
    v_smfmac_f32_16x16x64_bf16 a[132:135], a[208:211], v[152:159], v14
    s_waitcnt lgkmcnt(0)
    v_mfma_f32_16x16x32_bf16 v[32:35], a[144:147], v[64:67], v[16:19]
    s_waitcnt vmcnt(24)
    v_exp_f32 v36, v36
    v_mfma_f32_16x16x32_bf16 v[32:35], a[148:151], v[68:71], v[32:35]
    s_add_u32 s88, s88, 0x400
    v_lshlrev_b32 v60, 16, v40
    v_and_b32 v40, 0xffff0000, v40
    v_mfma_f32_16x16x32_bf16 v[32:35], a[152:155], v[72:75], v[32:35]
    s_and_b32 s88, s88, 0x1fff
    v_exp_f32 v37, v37
    v_mfma_f32_16x16x32_bf16 v[32:35], a[156:159], v[76:79], v[32:35]
    s_add_u32 s89, s88, s85
    ds_read_b128 a[160:163], v0 offset:45056
    v_cvt_pk_bf16_f32 v246, v36, v37
    v_mfma_f32_16x16x32_bf16 a[64:67], v[128:131], a[176:179], a[64:67]
    v_exp_f32 v38, v38
    v_mfma_f32_16x16x32_bf16 a[64:67], v[132:135], a[180:183], a[64:67]
    ds_read_b128 a[164:167], v1 offset:45056
    ds_read_b128 a[168:171], v2 offset:45056
    v_mfma_f32_16x16x32_bf16 a[64:67], v[136:139], a[184:187], a[64:67]
    v_exp_f32 v39, v39
    v_mfma_f32_16x16x32_bf16 a[64:67], v[140:143], a[188:191], a[64:67]
    ds_read_b128 a[172:175], v3 offset:45056
    v_cvt_pk_bf16_f32 v247, v38, v39
    v_mfma_f32_16x16x32_bf16 v[36:39], a[144:147], v[80:83], v[20:23]
    v_exp_f32 v32, v32
    v_mfma_f32_16x16x32_bf16 v[36:39], a[148:151], v[84:87], v[36:39]
    v_add_f32 v52, v52, v60
    v_add_f32 v53, v53, v40
    v_mfma_f32_16x16x32_bf16 v[36:39], a[152:155], v[88:91], v[36:39]
    v_exp_f32 v33, v33
    v_mfma_f32_16x16x32_bf16 v[36:39], a[156:159], v[92:95], v[36:39]
    ds_read_b64_tr_b16 a[192:193], v9 offset:0
    v_cvt_pk_bf16_f32 v200, v32, v33
    v_mfma_f32_16x16x32_bf16 a[68:71], v[144:147], a[176:179], a[68:71]
    v_exp_f32 v34, v34
    v_mfma_f32_16x16x32_bf16 a[68:71], v[148:151], a[180:183], a[68:71]
    ds_read_b64_tr_b16 a[194:195], v9 offset:4096
    ds_read_b64_tr_b16 a[196:197], v9 offset:16384
    v_mfma_f32_16x16x32_bf16 a[68:71], v[152:155], a[184:187], a[68:71]
    v_exp_f32 v35, v35
    v_mfma_f32_16x16x32_bf16 a[68:71], v[156:159], a[188:191], a[68:71]
    ds_read_b64_tr_b16 a[198:199], v9 offset:20480
    v_cvt_pk_bf16_f32 v201, v34, v35
    v_mfma_f32_16x16x32_bf16 v[32:35], a[144:147], v[96:99], v[24:27]
    v_exp_f32 v36, v36
    v_mfma_f32_16x16x32_bf16 v[32:35], a[148:151], v[100:103], v[32:35]
    v_lshlrev_b32 v60, 16, v41
    v_and_b32 v41, 0xffff0000, v41
    v_mfma_f32_16x16x32_bf16 v[32:35], a[152:155], v[104:107], v[32:35]
    s_sub_u32 s31, s52, s68
    v_exp_f32 v37, v37
    v_mfma_f32_16x16x32_bf16 v[32:35], a[156:159], v[108:111], v[32:35]
    ds_read_b64_tr_b16 a[200:201], v9 offset:32768
    v_cvt_pk_bf16_f32 v216, v36, v37
    v_mfma_f32_16x16x32_bf16 a[72:75], v[160:163], a[176:179], a[72:75]
    s_add_u32 s31, s31, 3
    v_exp_f32 v38, v38
    v_mfma_f32_16x16x32_bf16 a[72:75], v[164:167], a[180:183], a[72:75]
    s_nop 0
    ds_read_b64_tr_b16 a[202:203], v9 offset:36864
    ds_read_b64_tr_b16 a[204:205], v9 offset:49152
    v_mfma_f32_16x16x32_bf16 a[72:75], v[168:171], a[184:187], a[72:75]
    s_and_b32 s31, s31, 7
    v_exp_f32 v39, v39
    v_mfma_f32_16x16x32_bf16 a[72:75], v[172:175], a[188:191], a[72:75]
    ds_read_b64_tr_b16 a[206:207], v9 offset:53248
    v_cvt_pk_bf16_f32 v217, v38, v39
    v_mfma_f32_16x16x32_bf16 v[36:39], a[144:147], v[112:115], v[28:31]
    v_exp_f32 v32, v32
    v_mfma_f32_16x16x32_bf16 v[36:39], a[148:151], v[116:119], v[36:39]
    v_add_f32 v54, v54, v60
    v_add_f32 v55, v55, v41
    v_mfma_f32_16x16x32_bf16 v[36:39], a[152:155], v[120:123], v[36:39]
    s_lshl_b32 s31, s31, 7
    v_exp_f32 v33, v33
    v_mfma_f32_16x16x32_bf16 v[36:39], a[156:159], v[124:127], v[36:39]
    v_cvt_pk_bf16_f32 v232, v32, v33
    v_lshlrev_b32 v60, 16, v42
    v_mfma_f32_16x16x32_bf16 a[76:79], v[176:179], a[176:179], a[76:79]
    s_add_u32 s30, s77, 0x20000
    v_exp_f32 v34, v34
    v_mfma_f32_16x16x32_bf16 a[76:79], v[180:183], a[180:183], a[76:79]
    v_and_b32 v42, 0xffff0000, v42
    v_add_f32 v56, v56, v60
    v_mfma_f32_16x16x32_bf16 a[76:79], v[184:187], a[184:187], a[76:79]
    v_exp_f32 v35, v35
    v_mfma_f32_16x16x32_bf16 a[76:79], v[188:191], a[188:191], a[76:79]
    v_cvt_pk_bf16_f32 v233, v34, v35
    v_add_f32 v57, v57, v42
    v_smfmac_f32_16x16x64_bf16 a[136:139], a[208:211], v[160:167], v14
    s_waitcnt lgkmcnt(0)
    v_lshlrev_b32 v60, 16, v43
    v_and_b32 v43, 0xffff0000, v43
    v_mfma_f32_16x16x32_bf16 v[32:35], a[160:163], v[64:67], v[16:19]
    v_exp_f32 v36, v36
    v_mfma_f32_16x16x32_bf16 v[32:35], a[164:167], v[68:71], v[32:35]
    v_add_f32 v58, v58, v60
    v_add_f32 v59, v59, v43
    v_mfma_f32_16x16x32_bf16 v[32:35], a[168:171], v[72:75], v[32:35]
    s_cmp_le_u32 s68, 2
    v_exp_f32 v37, v37
    v_mfma_f32_16x16x32_bf16 v[32:35], a[172:175], v[76:79], v[32:35]
    s_cselect_b32 s31, s31, 0x10000000
    ds_read_b128 a[144:147], v0 offset:57344
    v_cvt_pk_bf16_f32 v248, v36, v37
    v_mfma_f32_16x16x32_bf16 a[80:83], v[128:131], a[192:195], a[80:83]
    s_cmp_eq_u32 s68, 1
    v_exp_f32 v38, v38
    v_mfma_f32_16x16x32_bf16 a[80:83], v[132:135], a[196:199], a[80:83]
    s_cselect_b32 s30, s63, s30
    ds_read_b128 a[148:151], v1 offset:57344
    ds_read_b128 a[152:155], v2 offset:57344
    v_mfma_f32_16x16x32_bf16 a[80:83], v[136:139], a[200:203], a[80:83]
    v_exp_f32 v39, v39
    v_mfma_f32_16x16x32_bf16 a[80:83], v[140:143], a[204:207], a[80:83]
    ds_read_b128 a[156:159], v3 offset:57344
    v_cvt_pk_bf16_f32 v249, v38, v39
    v_mfma_f32_16x16x32_bf16 v[36:39], a[160:163], v[80:83], v[20:23]
    v_exp_f32 v32, v32
    v_mfma_f32_16x16x32_bf16 v[36:39], a[164:167], v[84:87], v[36:39]
    v_mfma_f32_16x16x32_bf16 v[36:39], a[168:171], v[88:91], v[36:39]
    v_exp_f32 v33, v33
    v_mfma_f32_16x16x32_bf16 v[36:39], a[172:175], v[92:95], v[36:39]
    ds_read_b64_tr_b16 a[176:177], v10 offset:0
    v_cvt_pk_bf16_f32 v202, v32, v33
    v_mfma_f32_16x16x32_bf16 a[84:87], v[144:147], a[192:195], a[84:87]
    v_exp_f32 v34, v34
    v_mfma_f32_16x16x32_bf16 a[84:87], v[148:151], a[196:199], a[84:87]
    ds_read_b64_tr_b16 a[178:179], v10 offset:4096
    ds_read_b64_tr_b16 a[180:181], v10 offset:16384
    v_mfma_f32_16x16x32_bf16 a[84:87], v[152:155], a[200:203], a[84:87]
    v_exp_f32 v35, v35
    v_mfma_f32_16x16x32_bf16 a[84:87], v[156:159], a[204:207], a[84:87]
    ds_read_b64_tr_b16 a[182:183], v10 offset:20480
    v_cvt_pk_bf16_f32 v203, v34, v35
    v_mfma_f32_16x16x32_bf16 v[32:35], a[160:163], v[96:99], v[24:27]
    v_exp_f32 v36, v36
    v_mfma_f32_16x16x32_bf16 v[32:35], a[164:167], v[100:103], v[32:35]
    buffer_load_dwordx4 v[40:43], v15, s[32:35], s89 offen sc1
    v_mfma_f32_16x16x32_bf16 v[32:35], a[168:171], v[104:107], v[32:35]
    v_exp_f32 v37, v37
    v_mfma_f32_16x16x32_bf16 v[32:35], a[172:175], v[108:111], v[32:35]
    ds_read_b64_tr_b16 a[184:185], v10 offset:32768
    v_cvt_pk_bf16_f32 v218, v36, v37
    v_mfma_f32_16x16x32_bf16 a[88:91], v[160:163], a[192:195], a[88:91]
    v_exp_f32 v38, v38
    v_mfma_f32_16x16x32_bf16 a[88:91], v[164:167], a[196:199], a[88:91]
    ds_read_b64_tr_b16 a[186:187], v10 offset:36864
    ds_read_b64_tr_b16 a[188:189], v10 offset:49152
    v_mfma_f32_16x16x32_bf16 a[88:91], v[168:171], a[200:203], a[88:91]
    v_exp_f32 v39, v39
    v_mfma_f32_16x16x32_bf16 a[88:91], v[172:175], a[204:207], a[88:91]
    ds_read_b64_tr_b16 a[190:191], v10 offset:53248
    v_cvt_pk_bf16_f32 v219, v38, v39
    v_mfma_f32_16x16x32_bf16 v[36:39], a[160:163], v[112:115], v[28:31]
    v_exp_f32 v32, v32
    v_mfma_f32_16x16x32_bf16 v[36:39], a[164:167], v[116:119], v[36:39]
    buffer_load_dword a224, v61, s[20:23], s99 offen
    v_mfma_f32_16x16x32_bf16 v[36:39], a[168:171], v[120:123], v[36:39]
    v_exp_f32 v33, v33
    v_mfma_f32_16x16x32_bf16 v[36:39], a[172:175], v[124:127], v[36:39]
    s_add_u32 m0, s30, 0x0
    v_cvt_pk_bf16_f32 v234, v32, v33
    v_mfma_f32_16x16x32_bf16 a[92:95], v[176:179], a[192:195], a[92:95]
    s_add_u32 s54, s31, 0x0
    v_exp_f32 v34, v34
    v_mfma_f32_16x16x32_bf16 a[92:95], v[180:183], a[196:199], a[92:95]
    buffer_load_dwordx4 v62, s[20:23], s54 offen lds
    v_mfma_f32_16x16x32_bf16 a[92:95], v[184:187], a[200:203], a[92:95]
    v_exp_f32 v35, v35
    v_mfma_f32_16x16x32_bf16 a[92:95], v[188:191], a[204:207], a[92:95]
    v_cvt_pk_bf16_f32 v235, v34, v35
    v_smfmac_f32_16x16x64_bf16 a[136:139], a[208:211], v[168:175], v14
    s_waitcnt lgkmcnt(0)
    v_mfma_f32_16x16x32_bf16 v[32:35], a[144:147], v[64:67], v[16:19]
    s_add_u32 s55, s31, 0x1c00
    v_exp_f32 v36, v36
    v_mfma_f32_16x16x32_bf16 v[32:35], a[148:151], v[68:71], v[32:35]
    buffer_load_dwordx4 v62, s[20:23], s55 offen offset:1024 lds
    v_mfma_f32_16x16x32_bf16 v[32:35], a[152:155], v[72:75], v[32:35]
    s_add_u32 s89, s89, 0x100000
    v_exp_f32 v37, v37
    v_mfma_f32_16x16x32_bf16 v[32:35], a[156:159], v[76:79], v[32:35]
    ds_read_b128 a[160:163], v0 offset:61440
    v_cvt_pk_bf16_f32 v250, v36, v37
    v_mfma_f32_16x16x32_bf16 a[96:99], v[128:131], a[176:179], a[96:99]
    v_exp_f32 v38, v38
    v_mfma_f32_16x16x32_bf16 a[96:99], v[132:135], a[180:183], a[96:99]
    ds_read_b128 a[164:167], v1 offset:61440
    ds_read_b128 a[168:171], v2 offset:61440
    v_mfma_f32_16x16x32_bf16 a[96:99], v[136:139], a[184:187], a[96:99]
    v_exp_f32 v39, v39
    v_mfma_f32_16x16x32_bf16 a[96:99], v[140:143], a[188:191], a[96:99]
    ds_read_b128 a[172:175], v3 offset:61440
    v_cvt_pk_bf16_f32 v251, v38, v39
    v_mfma_f32_16x16x32_bf16 v[36:39], a[144:147], v[80:83], v[20:23]
    s_add_u32 s56, s31, 0x3800
    v_exp_f32 v32, v32
    v_mfma_f32_16x16x32_bf16 v[36:39], a[148:151], v[84:87], v[36:39]
    buffer_load_dwordx4 v62, s[20:23], s56 offen offset:2048 lds
    v_mfma_f32_16x16x32_bf16 v[36:39], a[152:155], v[88:91], v[36:39]
    s_mov_b32 s58, 8
    v_exp_f32 v33, v33
    v_mfma_f32_16x16x32_bf16 v[36:39], a[156:159], v[92:95], v[36:39]
    ds_read_b64_tr_b16 a[192:193], v11 offset:0
    v_cvt_pk_bf16_f32 v204, v32, v33
    v_mfma_f32_16x16x32_bf16 a[100:103], v[144:147], a[176:179], a[100:103]
    s_mov_b32 s59, s87
    v_exp_f32 v34, v34
    v_mfma_f32_16x16x32_bf16 a[100:103], v[148:151], a[180:183], a[100:103]
    s_nop 0
    ds_read_b64_tr_b16 a[194:195], v11 offset:4096
    ds_read_b64_tr_b16 a[196:197], v11 offset:16384
    v_mfma_f32_16x16x32_bf16 a[100:103], v[152:155], a[184:187], a[100:103]
    v_exp_f32 v35, v35
    v_mfma_f32_16x16x32_bf16 a[100:103], v[156:159], a[188:191], a[100:103]
    ds_read_b64_tr_b16 a[198:199], v11 offset:20480
    v_cvt_pk_bf16_f32 v205, v34, v35
    v_mfma_f32_16x16x32_bf16 v[32:35], a[144:147], v[96:99], v[24:27]
    s_add_u32 s57, s31, 0x5400
    v_exp_f32 v36, v36
    v_mfma_f32_16x16x32_bf16 v[32:35], a[148:151], v[100:103], v[32:35]
    buffer_load_dwordx4 v62, s[20:23], s57 offen offset:3072 lds
    v_mfma_f32_16x16x32_bf16 v[32:35], a[152:155], v[104:107], v[32:35]
    s_add_u32 s99, s99, 2048
    v_exp_f32 v37, v37
    v_mfma_f32_16x16x32_bf16 v[32:35], a[156:159], v[108:111], v[32:35]
    ds_read_b64_tr_b16 a[200:201], v11 offset:32768
    v_cvt_pk_bf16_f32 v220, v36, v37
    v_mfma_f32_16x16x32_bf16 a[104:107], v[160:163], a[176:179], a[104:107]
    v_exp_f32 v38, v38
    v_mfma_f32_16x16x32_bf16 a[104:107], v[164:167], a[180:183], a[104:107]
    ds_read_b64_tr_b16 a[202:203], v11 offset:36864
    ds_read_b64_tr_b16 a[204:205], v11 offset:49152
    v_mfma_f32_16x16x32_bf16 a[104:107], v[168:171], a[184:187], a[104:107]
    v_exp_f32 v39, v39
    v_mfma_f32_16x16x32_bf16 a[104:107], v[172:175], a[188:191], a[104:107]
    s_add_u32 m0, s30, 0x1000
    ds_read_b64_tr_b16 a[206:207], v11 offset:53248
    v_cvt_pk_bf16_f32 v221, v38, v39
    v_mfma_f32_16x16x32_bf16 v[36:39], a[144:147], v[112:115], v[28:31]
    s_add_u32 s54, s31, 0x8000
    v_exp_f32 v32, v32
    v_mfma_f32_16x16x32_bf16 v[36:39], a[148:151], v[116:119], v[36:39]
    buffer_load_dwordx4 v62, s[20:23], s54 offen lds
    v_mfma_f32_16x16x32_bf16 v[36:39], a[152:155], v[120:123], v[36:39]
    v_exp_f32 v33, v33
    v_mfma_f32_16x16x32_bf16 v[36:39], a[156:159], v[124:127], v[36:39]
    v_cvt_pk_bf16_f32 v236, v32, v33
    v_mfma_f32_16x16x32_bf16 a[108:111], v[176:179], a[176:179], a[108:111]
    s_add_u32 s55, s31, 0x9c00
    v_exp_f32 v34, v34
    v_mfma_f32_16x16x32_bf16 a[108:111], v[180:183], a[180:183], a[108:111]
    buffer_load_dwordx4 v62, s[20:23], s55 offen offset:1024 lds
    v_mfma_f32_16x16x32_bf16 a[108:111], v[184:187], a[184:187], a[108:111]
    v_exp_f32 v35, v35
    v_mfma_f32_16x16x32_bf16 a[108:111], v[188:191], a[188:191], a[108:111]
    v_cvt_pk_bf16_f32 v237, v34, v35
    v_smfmac_f32_16x16x64_bf16 a[140:143], a[208:211], v[176:183], v14
    s_waitcnt vmcnt(8) lgkmcnt(0)
    s_barrier
    v_mfma_f32_16x16x32_bf16 v[32:35], a[160:163], v[64:67], v[16:19]
    s_add_u32 s56, s31, 0xb800
    v_exp_f32 v36, v36
    v_mfma_f32_16x16x32_bf16 v[32:35], a[164:167], v[68:71], v[32:35]
    buffer_load_dwordx4 v62, s[20:23], s56 offen offset:2048 lds
    v_mfma_f32_16x16x32_bf16 v[32:35], a[168:171], v[72:75], v[32:35]
    v_exp_f32 v37, v37
    v_mfma_f32_16x16x32_bf16 v[32:35], a[172:175], v[76:79], v[32:35]
    ds_read_b128 a[144:147], v0 offset:0
    v_cvt_pk_bf16_f32 v252, v36, v37
    v_mfma_f32_16x16x32_bf16 a[112:115], v[128:131], a[192:195], a[112:115]
    s_add_u32 s64, s64, 0x8000
    v_exp_f32 v38, v38
    v_mfma_f32_16x16x32_bf16 a[112:115], v[132:135], a[196:199], a[112:115]
    s_nop 0
    ds_read_b128 a[148:151], v1 offset:0
    ds_read_b128 a[152:155], v2 offset:0
    v_mfma_f32_16x16x32_bf16 a[112:115], v[136:139], a[200:203], a[112:115]
    s_add_u32 s65, s65, 0x8000
    v_exp_f32 v39, v39
    v_mfma_f32_16x16x32_bf16 a[112:115], v[140:143], a[204:207], a[112:115]
    ds_read_b128 a[156:159], v3 offset:0
    v_cvt_pk_bf16_f32 v253, v38, v39
    v_mfma_f32_16x16x32_bf16 v[36:39], a[160:163], v[80:83], v[20:23]
    s_add_u32 s57, s31, 0xd400
    v_exp_f32 v32, v32
    v_mfma_f32_16x16x32_bf16 v[36:39], a[164:167], v[84:87], v[36:39]
    buffer_load_dwordx4 v62, s[20:23], s57 offen offset:3072 lds
    v_mfma_f32_16x16x32_bf16 v[36:39], a[168:171], v[88:91], v[36:39]
    v_exp_f32 v33, v33
    v_mfma_f32_16x16x32_bf16 v[36:39], a[172:175], v[92:95], v[36:39]
    ds_read_b64_tr_b16 a[176:177], v4 offset:8192
    v_cvt_pk_bf16_f32 v206, v32, v33
    v_mfma_f32_16x16x32_bf16 a[116:119], v[144:147], a[192:195], a[116:119]
    s_add_u32 s66, s66, 0x8000
    v_exp_f32 v34, v34
    v_mfma_f32_16x16x32_bf16 a[116:119], v[148:151], a[196:199], a[116:119]
    s_nop 0
    ds_read_b64_tr_b16 a[178:179], v4 offset:12288
    ds_read_b64_tr_b16 a[180:181], v4 offset:24576
    v_mfma_f32_16x16x32_bf16 a[116:119], v[152:155], a[200:203], a[116:119]
    s_add_u32 s67, s67, 0x8000
    v_exp_f32 v35, v35
    v_mfma_f32_16x16x32_bf16 a[116:119], v[156:159], a[204:207], a[116:119]
    s_cmp_eq_u32 s68, 2
    ds_read_b64_tr_b16 a[182:183], v4 offset:28672
    v_cvt_pk_bf16_f32 v207, v34, v35
    v_mfma_f32_16x16x32_bf16 v[32:35], a[160:163], v[96:99], v[24:27]
    s_cselect_b32 s18, 0, 0x1000
    v_exp_f32 v36, v36
    v_mfma_f32_16x16x32_bf16 v[32:35], a[164:167], v[100:103], v[32:35]
    buffer_atomic_sub a212, v15, s[40:43], s18 offen sc1
    v_mfma_f32_16x16x32_bf16 v[32:35], a[168:171], v[104:107], v[32:35]
    v_exp_f32 v37, v37
    v_mfma_f32_16x16x32_bf16 v[32:35], a[172:175], v[108:111], v[32:35]
    ds_read_b64_tr_b16 a[184:185], v4 offset:40960
    v_cvt_pk_bf16_f32 v222, v36, v37
    v_mfma_f32_16x16x32_bf16 a[120:123], v[160:163], a[192:195], a[120:123]
    v_exp_f32 v38, v38
    v_mfma_f32_16x16x32_bf16 a[120:123], v[164:167], a[196:199], a[120:123]
    ds_read_b64_tr_b16 a[186:187], v4 offset:45056
    ds_read_b64_tr_b16 a[188:189], v4 offset:57344
    v_mfma_f32_16x16x32_bf16 a[120:123], v[168:171], a[200:203], a[120:123]
    v_exp_f32 v39, v39
    v_mfma_f32_16x16x32_bf16 a[120:123], v[172:175], a[204:207], a[120:123]
    ds_read_b64_tr_b16 a[190:191], v4 offset:61440
    v_cvt_pk_bf16_f32 v223, v38, v39
    v_mfma_f32_16x16x32_bf16 v[36:39], a[160:163], v[112:115], v[28:31]
    v_exp_f32 v32, v32
    v_mfma_f32_16x16x32_bf16 v[36:39], a[164:167], v[116:119], v[36:39]
    v_mfma_f32_16x16x32_bf16 v[36:39], a[168:171], v[120:123], v[36:39]
    v_exp_f32 v33, v33
    v_mfma_f32_16x16x32_bf16 v[36:39], a[172:175], v[124:127], v[36:39]
    s_add_u32 m0, s63, 0x2000
    v_cvt_pk_bf16_f32 v238, v32, v33
    v_mfma_f32_16x16x32_bf16 a[124:127], v[176:179], a[192:195], a[124:127]
    s_sub_u32 s68, s68, 1
    v_exp_f32 v34, v34
    v_mfma_f32_16x16x32_bf16 a[124:127], v[180:183], a[196:199], a[124:127]
    s_cmp_lg_u32 s68, 0
    v_mfma_f32_16x16x32_bf16 a[124:127], v[184:187], a[200:203], a[124:127]
    v_exp_f32 v35, v35
    v_mfma_f32_16x16x32_bf16 a[124:127], v[188:191], a[204:207], a[124:127]
    s_waitcnt lgkmcnt(0)
    v_cvt_pk_bf16_f32 v239, v34, v35
    v_smfmac_f32_16x16x64_bf16 a[140:143], a[208:211], v[184:191], v14
    s_cbranch_scc1 L_LOOP
L_FIN:
    v_mfma_f32_16x16x32_bf16 a[0:3], v[192:195], a[176:179], a[0:3]
    s_add_u32 s76, s52, 1
    v_exp_f32 v36, v36
    v_mfma_f32_16x16x32_bf16 a[0:3], v[196:199], a[180:183], a[0:3]
    s_and_b32 s76, s76, 7
    ds_read_b64_tr_b16 a[192:193], v5 offset:8192
    v_exp_f32 v37, v37
    v_mfma_f32_16x16x32_bf16 a[0:3], v[200:203], a[184:187], a[0:3]
    s_lshl_b32 s76, s76, 7
    ds_read_b64_tr_b16 a[194:195], v5 offset:12288
    v_exp_f32 v38, v38
    v_mfma_f32_16x16x32_bf16 a[0:3], v[204:207], a[188:191], a[0:3]
    s_add_u32 s54, s76, 0x10000
    ds_read_b64_tr_b16 a[196:197], v5 offset:24576
    v_exp_f32 v39, v39
    v_smfmac_f32_16x16x64_bf16 a[128:131], a[208:211], v[192:199], v14
    s_add_u32 m0, s63, 0x10000
    ds_read_b64_tr_b16 a[198:199], v5 offset:28672
    buffer_load_dwordx4 v62, s[20:23], s54 offen lds
    v_cvt_pk_bf16_f32 v254, v36, v37
    v_cvt_pk_bf16_f32 v255, v38, v39
    v_smfmac_f32_16x16x64_bf16 a[128:131], a[208:211], v[200:207], v14
    s_add_u32 s55, s76, 0x11c00
    ds_read_b64_tr_b16 a[200:201], v5 offset:40960
    v_accvgpr_read_b32 v60, a240
    v_add_u32 v35, 0x20000, v60
    v_mfma_f32_16x16x32_bf16 a[4:7], v[220:223], a[188:191], a[4:7]
    s_nop 0
    ds_read_b64_tr_b16 a[202:203], v5 offset:45056
    ds_read_b64_tr_b16 v[160:161], v35 offset:0
    v_mfma_f32_16x16x32_bf16 a[4:7], v[216:219], a[184:187], a[4:7]
    s_nop 0
    ds_read_b64_tr_b16 a[204:205], v5 offset:57344
    ds_read_b64_tr_b16 v[162:163], v35 offset:2048
    buffer_load_dwordx4 v62, s[20:23], s55 offen offset:1024 lds
    v_mfma_f32_16x16x32_bf16 a[4:7], v[212:215], a[180:183], a[4:7]
    s_add_u32 s56, s76, 0x13800
    ds_read_b64_tr_b16 a[206:207], v5 offset:61440
    ds_read_b64_tr_b16 v[164:165], v35 offset:4096
    v_mfma_f32_16x16x32_bf16 a[4:7], v[208:211], a[176:179], a[4:7]
    s_nop 0
    ds_read_b64_tr_b16 v[166:167], v35 offset:6144
    ds_read_b64_tr_b16 v[168:169], v35 offset:8192
    v_smfmac_f32_16x16x64_bf16 a[132:135], a[208:211], v[208:215], v14
    s_nop 0
    ds_read_b64_tr_b16 v[170:171], v35 offset:10240
    ds_read_b64_tr_b16 v[172:173], v35 offset:12288
    buffer_load_dwordx4 v62, s[20:23], s56 offen offset:2048 lds
    v_smfmac_f32_16x16x64_bf16 a[132:135], a[208:211], v[216:223], v14
    s_add_u32 s57, s76, 0x15400
    ds_read_b64_tr_b16 v[174:175], v35 offset:14336
    ds_read_b64_tr_b16 v[176:177], v35 offset:16384
    v_mfma_f32_16x16x32_bf16 a[8:11], v[224:227], a[176:179], a[8:11]
    s_nop 0
    ds_read_b64_tr_b16 v[178:179], v35 offset:18432
    ds_read_b64_tr_b16 v[180:181], v35 offset:20480
    v_mfma_f32_16x16x32_bf16 a[8:11], v[228:231], a[180:183], a[8:11]
    s_nop 0
    ds_read_b64_tr_b16 v[182:183], v35 offset:22528
    ds_read_b64_tr_b16 v[184:185], v35 offset:24576
    buffer_load_dwordx4 v62, s[20:23], s57 offen offset:3072 lds
    v_mfma_f32_16x16x32_bf16 a[8:11], v[232:235], a[184:187], a[8:11]
    s_add_u32 s54, s76, 0x18000
    ds_read_b64_tr_b16 v[186:187], v35 offset:26624
    ds_read_b64_tr_b16 v[188:189], v35 offset:28672
    v_mfma_f32_16x16x32_bf16 a[8:11], v[236:239], a[188:191], a[8:11]
    s_add_u32 m0, s63, 0x11000
    ds_read_b64_tr_b16 v[190:191], v35 offset:30720
    v_cmp_gt_u32 vcc, 0x100, v15
    v_smfmac_f32_16x16x64_bf16 a[136:139], a[208:211], v[224:231], v14
    buffer_load_dwordx4 v62, s[20:23], s54 offen lds
    v_smfmac_f32_16x16x64_bf16 a[136:139], a[208:211], v[232:239], v14
    s_add_u32 s55, s76, 0x19c00
    v_accvgpr_read_b32 v33, a241
    v_accvgpr_read_b32 v32, a242
    v_mfma_f32_16x16x32_bf16 a[12:15], v[252:255], a[188:191], a[12:15]
    v_cndmask_b32 v34, 0, 1.0, vcc
    v_add_u32 v61, 0x10000, v60
    v_mfma_f32_16x16x32_bf16 a[12:15], v[248:251], a[184:187], a[12:15]
    buffer_load_dwordx4 v62, s[20:23], s55 offen offset:1024 lds
    v_mfma_f32_16x16x32_bf16 a[12:15], v[244:247], a[180:183], a[12:15]
    s_add_u32 s56, s76, 0x1b800
    v_mfma_f32_16x16x32_bf16 a[12:15], v[240:243], a[176:179], a[12:15]
    s_lshl_b32 s94, s3, 10
    v_smfmac_f32_16x16x64_bf16 a[140:143], a[208:211], v[240:247], v14
    buffer_load_dwordx4 v62, s[20:23], s56 offen offset:2048 lds
    v_smfmac_f32_16x16x64_bf16 a[140:143], a[208:211], v[248:255], v14
    s_add_u32 s57, s76, 0x1d400
    s_waitcnt lgkmcnt(0)
    s_barrier
    v_mfma_f32_16x16x32_bf16 a[16:19], v[192:195], a[192:195], a[16:19]
    s_add_u32 s94, s94, s60
    ds_read_b64_tr_b16 a[176:177], v6 offset:8192
    ds_read_b64_tr_b16 a[178:179], v6 offset:12288
    v_mfma_f32_16x16x32_bf16 a[16:19], v[196:199], a[196:199], a[16:19]
    s_nop 0
    ds_read_b64_tr_b16 a[180:181], v6 offset:24576
    ds_read_b64_tr_b16 a[182:183], v6 offset:28672
    buffer_load_dwordx4 v62, s[20:23], s57 offen offset:3072 lds
    v_mfma_f32_16x16x32_bf16 a[16:19], v[200:203], a[200:203], a[16:19]
L_PAD8:
    s_cbranch_execz L_PADX
    s_add_u32 s76, s52, 2
    ds_read_b64_tr_b16 a[184:185], v6 offset:40960
    ds_read_b64_tr_b16 a[186:187], v6 offset:45056
    v_mfma_f32_16x16x32_bf16 a[16:19], v[204:207], a[204:207], a[16:19]
    s_and_b32 s76, s76, 7
    ds_read_b64_tr_b16 a[188:189], v6 offset:57344
    ds_read_b64_tr_b16 a[190:191], v6 offset:61440
    v_mfma_f32_16x16x32_bf16 a[20:23], v[220:223], a[204:207], a[20:23]
    s_lshl_b32 s76, s76, 7
    v_accvgpr_read_b32 v36, a128
    v_accvgpr_read_b32 v16, a129
    v_add_f32 v36, v36, v16
    v_mfma_f32_16x16x32_bf16 a[20:23], v[216:219], a[200:203], a[20:23]
    s_add_u32 s54, s76, 0x10000
    v_accvgpr_read_b32 v37, a132
    v_accvgpr_read_b32 v16, a133
    v_add_f32 v37, v37, v16
    v_accvgpr_read_b32 v38, a136
    v_mfma_f32_16x16x32_bf16 a[20:23], v[212:215], a[196:199], a[20:23]
    s_add_u32 m0, s77, 0x20000
    s_nop 0
    buffer_load_dwordx4 v62, s[20:23], s54 offen lds
    v_mfma_f32_16x16x32_bf16 a[20:23], v[208:211], a[192:195], a[20:23]
    s_add_u32 s55, s76, 0x11c00
    v_accvgpr_read_b32 v16, a137
    v_add_f32 v38, v38, v16
    v_accvgpr_read_b32 v39, a140
    v_mfma_f32_16x16x32_bf16 a[24:27], v[224:227], a[192:195], a[24:27]
    v_accvgpr_read_b32 v16, a141
    v_add_f32 v39, v39, v16
    v_add_f32 v16, v36, v37
    v_mfma_f32_16x16x32_bf16 a[24:27], v[228:231], a[196:199], a[24:27]
    buffer_load_dwordx4 v62, s[20:23], s55 offen offset:1024 lds
    v_add_f32 v17, v38, v39
    v_mfma_f32_16x16x32_bf16 a[24:27], v[232:235], a[200:203], a[24:27]
    s_add_u32 s56, s76, 0x13800
    v_add_f32 v16, v16, v17
    v_cmp_ngt_f32 vcc, 0x4e800000, v16
    v_mfma_f32_16x16x32_bf16 a[24:27], v[236:239], a[204:207], a[24:27]
    v_rcp_f32 v36, v36
    v_rcp_f32 v37, v37
    v_mfma_f32_16x16x32_bf16 a[28:31], v[252:255], a[204:207], a[28:31]
    buffer_load_dwordx4 v62, s[20:23], s56 offen offset:2048 lds
    v_mfma_f32_16x16x32_bf16 a[28:31], v[248:251], a[200:203], a[28:31]
    s_add_u32 s57, s76, 0x15400
    v_rcp_f32 v38, v38
    v_mfma_f32_16x16x32_bf16 a[28:31], v[244:247], a[196:199], a[28:31]
    v_rcp_f32 v39, v39
    v_mfma_f32_16x16x32_bf16 a[28:31], v[240:243], a[192:195], a[28:31]
    s_waitcnt lgkmcnt(0)
    buffer_load_dwordx4 v62, s[20:23], s57 offen offset:3072 lds
    v_mfma_f32_16x16x32_bf16 a[32:35], v[192:195], a[176:179], a[32:35]
    s_add_u32 s54, s76, 0x18000
    ds_read_b64_tr_b16 a[192:193], v7 offset:8192
    ds_read_b64_tr_b16 a[194:195], v7 offset:12288
    v_mfma_f32_16x16x32_bf16 a[32:35], v[196:199], a[180:183], a[32:35]
    s_add_u32 m0, s77, 0x21000
    ds_read_b64_tr_b16 a[196:197], v7 offset:24576
    ds_read_b64_tr_b16 a[198:199], v7 offset:28672
    v_mfma_f32_16x16x32_bf16 a[32:35], v[200:203], a[184:187], a[32:35]
    s_nop 0
    ds_read_b64_tr_b16 a[200:201], v7 offset:40960
    ds_read_b64_tr_b16 a[202:203], v7 offset:45056
    buffer_load_dwordx4 v62, s[20:23], s54 offen lds
    v_mfma_f32_16x16x32_bf16 a[32:35], v[204:207], a[188:191], a[32:35]
    s_add_u32 s55, s76, 0x19c00
    s_cbranch_vccnz L_MARK
L_MARKED:
    ds_read_b64_tr_b16 a[204:205], v7 offset:57344
    ds_read_b64_tr_b16 a[206:207], v7 offset:61440
    v_mfma_f32_16x16x4_f32 v[16:19], v36, v34, 0
    v_mfma_f32_16x16x4_f32 v[20:23], v37, v34, 0
    buffer_load_dwordx4 v62, s[20:23], s55 offen offset:1024 lds
    v_mfma_f32_16x16x4_f32 v[24:27], v38, v34, 0
    s_add_u32 s56, s76, 0x1b800
    v_mfma_f32_16x16x4_f32 v[28:31], v39, v34, 0
    v_bfe_u32 v34, v15, 4, 2
    v_lshlrev_b32 v34, 14, v34
    v_accvgpr_read_b32 v36, a0
    v_accvgpr_read_b32 v37, a1
    v_accvgpr_read_b32 v38, a2
    v_accvgpr_read_b32 v39, a3
    v_mfma_f32_16x16x32_bf16 a[36:39], v[220:223], a[188:191], a[36:39]
    buffer_load_dwordx4 v62, s[20:23], s56 offen offset:2048 lds
    v_mfma_f32_16x16x32_bf16 a[36:39], v[216:219], a[184:187], a[36:39]
    s_add_u32 s57, s76, 0x1d400
    v_mul_f32 v36, v36, v16
    v_mul_f32 v37, v37, v17
    v_mfma_f32_16x16x32_bf16 a[36:39], v[212:215], a[180:183], a[36:39]
    v_mul_f32 v38, v38, v18
    v_mul_f32 v39, v39, v19
    v_mfma_f32_16x16x32_bf16 a[36:39], v[208:211], a[176:179], a[36:39]
    buffer_load_dwordx4 v62, s[20:23], s57 offen offset:3072 lds
    v_cvt_pk_bf16_f32 v128, v36, v37
    v_mfma_f32_16x16x32_bf16 a[40:43], v[224:227], a[176:179], a[40:43]
    v_cvt_pk_bf16_f32 v129, v38, v39
    v_accvgpr_read_b32 v36, a16
    v_mfma_f32_16x16x32_bf16 a[40:43], v[228:231], a[180:183], a[40:43]
    v_accvgpr_read_b32 v37, a17
    v_accvgpr_read_b32 v38, a18
    v_mfma_f32_16x16x32_bf16 a[40:43], v[232:235], a[184:187], a[40:43]
    v_accvgpr_read_b32 v39, a19
    v_mul_f32 v36, v36, v16
    v_mfma_f32_16x16x32_bf16 a[40:43], v[236:239], a[188:191], a[40:43]
    v_mul_f32 v37, v37, v17
    v_mul_f32 v38, v38, v18
    v_mul_f32 v39, v39, v19
    v_mfma_f32_16x16x32_bf16 a[44:47], v[252:255], a[188:191], a[44:47]
    v_cvt_pk_bf16_f32 v130, v36, v37
    v_cvt_pk_bf16_f32 v131, v38, v39
    v_mfma_f32_16x16x32_bf16 a[44:47], v[248:251], a[184:187], a[44:47]
    v_accvgpr_read_b32 v36, a4
    v_accvgpr_read_b32 v37, a5
    v_accvgpr_read_b32 v38, a6
    v_mfma_f32_16x16x32_bf16 a[44:47], v[244:247], a[180:183], a[44:47]
    v_accvgpr_read_b32 v39, a7
    v_mul_f32 v36, v36, v20
    v_mul_f32 v37, v37, v21
    v_mul_f32 v38, v38, v22
    v_mfma_f32_16x16x32_bf16 a[44:47], v[240:243], a[176:179], a[44:47]
    s_waitcnt vmcnt(8) lgkmcnt(0)
    s_barrier
    ds_read_b32 v34, v34 offset:8192
    v_mul_f32 v39, v39, v23
    v_cvt_pk_bf16_f32 v132, v36, v37
    v_mfma_f32_16x16x32_bf16 a[48:51], v[192:195], a[192:195], a[48:51]
    s_nop 0
    ds_read_b64_tr_b16 a[176:177], v8 offset:8192
    ds_read_b64_tr_b16 a[178:179], v8 offset:12288
    v_cvt_pk_bf16_f32 v133, v38, v39
    v_mfma_f32_16x16x32_bf16 a[48:51], v[196:199], a[196:199], a[48:51]
    s_nop 0
    ds_read_b64_tr_b16 a[180:181], v8 offset:24576
    ds_read_b64_tr_b16 a[182:183], v8 offset:28672
    v_accvgpr_read_b32 v36, a20
    v_accvgpr_read_b32 v37, a21
    v_mfma_f32_16x16x32_bf16 a[48:51], v[200:203], a[200:203], a[48:51]
    s_nop 0
    ds_read_b64_tr_b16 a[184:185], v8 offset:40960
    ds_read_b64_tr_b16 a[186:187], v8 offset:45056
    v_accvgpr_read_b32 v38, a22
    v_accvgpr_read_b32 v39, a23
    v_mfma_f32_16x16x32_bf16 a[48:51], v[204:207], a[204:207], a[48:51]
    s_waitcnt lgkmcnt(6)
    ds_read_b64_tr_b16 a[188:189], v8 offset:57344
    ds_read_b64_tr_b16 a[190:191], v8 offset:61440
    v_cmp_eq_u32 vcc, -1, v34
    v_mfma_f32_16x16x32_bf16 a[52:55], v[220:223], a[204:207], a[52:55]
    v_mul_f32 v36, v36, v20
    v_mul_f32 v37, v37, v21
    v_mul_f32 v38, v38, v22
    v_mul_f32 v39, v39, v23
    v_mfma_f32_16x16x32_bf16 a[52:55], v[216:219], a[200:203], a[52:55]
    s_cbranch_vccnz L_FALLBACK0
L_NOFB:
    ds_read_b64_tr_b16 v[64:65], v60 offset:0
    ds_read_b64_tr_b16 v[66:67], v60 offset:2048
    v_cvt_pk_bf16_f32 v134, v36, v37
    v_cvt_pk_bf16_f32 v135, v38, v39
    v_mfma_f32_16x16x32_bf16 a[52:55], v[212:215], a[196:199], a[52:55]
    s_nop 0
    ds_read_b64_tr_b16 v[68:69], v60 offset:4096
    ds_read_b64_tr_b16 v[70:71], v60 offset:6144
    v_accvgpr_read_b32 v36, a8
    v_accvgpr_read_b32 v37, a9
    v_mfma_f32_16x16x32_bf16 a[52:55], v[208:211], a[192:195], a[52:55]
    s_nop 0
    ds_read_b64_tr_b16 v[72:73], v60 offset:16384
    ds_read_b64_tr_b16 v[74:75], v60 offset:18432
    v_accvgpr_read_b32 v38, a10
    v_accvgpr_read_b32 v39, a11
    v_mfma_f32_16x16x32_bf16 a[56:59], v[224:227], a[192:195], a[56:59]
    s_nop 0
    ds_read_b64_tr_b16 v[76:77], v60 offset:20480
    ds_read_b64_tr_b16 v[78:79], v60 offset:22528
    v_mul_f32 v36, v36, v24
    v_mul_f32 v37, v37, v25
    v_mul_f32 v38, v38, v26
    v_mfma_f32_16x16x32_bf16 a[56:59], v[228:231], a[196:199], a[56:59]
    s_nop 0
    ds_read_b64_tr_b16 v[80:81], v60 offset:32768
    ds_read_b64_tr_b16 v[82:83], v60 offset:34816
    v_mul_f32 v39, v39, v27
    v_cvt_pk_bf16_f32 v136, v36, v37
    v_mfma_f32_16x16x32_bf16 a[56:59], v[232:235], a[200:203], a[56:59]
    s_nop 0
    ds_read_b64_tr_b16 v[84:85], v60 offset:36864
    ds_read_b64_tr_b16 v[86:87], v60 offset:38912
    v_cvt_pk_bf16_f32 v137, v38, v39
    v_accvgpr_read_b32 v36, a24
    v_mfma_f32_16x16x32_bf16 a[56:59], v[236:239], a[204:207], a[56:59]
    s_nop 0
    ds_read_b64_tr_b16 v[88:89], v60 offset:49152
    ds_read_b64_tr_b16 v[90:91], v60 offset:51200
    v_accvgpr_read_b32 v37, a25
    v_accvgpr_read_b32 v38, a26
    v_mfma_f32_16x16x32_bf16 a[60:63], v[252:255], a[204:207], a[60:63]
    s_nop 0
    ds_read_b64_tr_b16 v[92:93], v60 offset:53248
    ds_read_b64_tr_b16 v[94:95], v60 offset:55296
    v_accvgpr_read_b32 v39, a27
    v_mul_f32 v36, v36, v24
    v_mul_f32 v37, v37, v25
    v_mfma_f32_16x16x32_bf16 a[60:63], v[248:251], a[200:203], a[60:63]
    s_nop 0
    ds_read_b64_tr_b16 v[96:97], v61 offset:0
    ds_read_b64_tr_b16 v[98:99], v61 offset:2048
    v_mul_f32 v38, v38, v26
    v_mul_f32 v39, v39, v27
    v_mfma_f32_16x16x32_bf16 a[60:63], v[244:247], a[196:199], a[60:63]
    s_nop 0
    ds_read_b64_tr_b16 v[100:101], v61 offset:4096
    ds_read_b64_tr_b16 v[102:103], v61 offset:6144
    v_cvt_pk_bf16_f32 v138, v36, v37
    v_cvt_pk_bf16_f32 v139, v38, v39
    v_mfma_f32_16x16x32_bf16 a[60:63], v[240:243], a[192:195], a[60:63]
    s_waitcnt lgkmcnt(15)
    ds_read_b64_tr_b16 v[104:105], v61 offset:16384
    ds_read_b64_tr_b16 v[106:107], v61 offset:18432
    v_accvgpr_read_b32 v36, a12
    v_accvgpr_read_b32 v37, a13
    v_mfma_f32_16x16x32_bf16 a[64:67], v[192:195], a[176:179], a[64:67]
    s_nop 0
    ds_read_b64_tr_b16 a[192:193], v9 offset:8192
    ds_read_b64_tr_b16 a[194:195], v9 offset:12288
    v_accvgpr_read_b32 v38, a14
    v_accvgpr_read_b32 v39, a15
    v_mfma_f32_16x16x32_bf16 a[64:67], v[196:199], a[180:183], a[64:67]
    s_nop 0
    ds_read_b64_tr_b16 a[196:197], v9 offset:24576
    ds_read_b64_tr_b16 a[198:199], v9 offset:28672
    v_mul_f32 v36, v36, v28
    v_mul_f32 v37, v37, v29
    v_mul_f32 v38, v38, v30
    v_mfma_f32_16x16x32_bf16 a[64:67], v[200:203], a[184:187], a[64:67]
    s_nop 0
    ds_read_b64_tr_b16 a[200:201], v9 offset:40960
    ds_read_b64_tr_b16 a[202:203], v9 offset:45056
    v_mul_f32 v39, v39, v31
    v_cvt_pk_bf16_f32 v140, v36, v37
    v_mfma_f32_16x16x32_bf16 a[64:67], v[204:207], a[188:191], a[64:67]
    s_nop 0
    ds_read_b64_tr_b16 a[204:205], v9 offset:57344
    ds_read_b64_tr_b16 a[206:207], v9 offset:61440
    v_cvt_pk_bf16_f32 v141, v38, v39
    v_accvgpr_read_b32 v36, a28
    v_mfma_f32_16x16x32_bf16 a[68:71], v[220:223], a[188:191], a[68:71]
    s_nop 0
    ds_read_b64_tr_b16 v[108:109], v61 offset:20480
    ds_read_b64_tr_b16 v[110:111], v61 offset:22528
    v_accvgpr_read_b32 v37, a29
    v_accvgpr_read_b32 v38, a30
    v_mfma_f32_16x16x32_bf16 a[68:71], v[216:219], a[184:187], a[68:71]
    s_nop 0
    ds_read_b64_tr_b16 v[112:113], v61 offset:32768
    ds_read_b64_tr_b16 v[114:115], v61 offset:34816
    v_accvgpr_read_b32 v39, a31
    v_mul_f32 v36, v36, v28
    v_mul_f32 v37, v37, v29
    v_mfma_f32_16x16x32_bf16 a[68:71], v[212:215], a[180:183], a[68:71]
    s_nop 0
    ds_read_b64_tr_b16 v[116:117], v61 offset:36864
    ds_read_b64_tr_b16 v[118:119], v61 offset:38912
    v_mul_f32 v38, v38, v30
    v_mul_f32 v39, v39, v31
    v_mfma_f32_16x16x32_bf16 a[68:71], v[208:211], a[176:179], a[68:71]
    s_nop 0
    ds_read_b64_tr_b16 v[120:121], v61 offset:49152
    ds_read_b64_tr_b16 v[122:123], v61 offset:51200
    v_cvt_pk_bf16_f32 v142, v36, v37
    v_cvt_pk_bf16_f32 v143, v38, v39
    v_mfma_f32_16x16x32_bf16 a[72:75], v[224:227], a[176:179], a[72:75]
    s_nop 0
    ds_read_b64_tr_b16 v[124:125], v61 offset:53248
    ds_read_b64_tr_b16 v[126:127], v61 offset:55296
    v_accvgpr_read_b32 v36, a32
    v_mfma_f32_16x16x32_bf16 a[72:75], v[228:231], a[180:183], a[72:75]
    v_accvgpr_read_b32 v37, a33
    v_accvgpr_read_b32 v38, a34
    v_accvgpr_read_b32 v39, a35
    v_mfma_f32_16x16x32_bf16 a[72:75], v[232:235], a[184:187], a[72:75]
    v_mul_f32 v36, v36, v16
    v_mul_f32 v37, v37, v17
    v_mul_f32 v38, v38, v18
    v_mfma_f32_16x16x32_bf16 a[72:75], v[236:239], a[188:191], a[72:75]
    v_mul_f32 v39, v39, v19
    v_cvt_pk_bf16_f32 v144, v36, v37
    v_cvt_pk_bf16_f32 v145, v38, v39
    v_mfma_f32_16x16x32_bf16 a[76:79], v[252:255], a[188:191], a[76:79]
    v_accvgpr_read_b32 v36, a48
    v_accvgpr_read_b32 v37, a49
    v_mfma_f32_16x16x32_bf16 a[76:79], v[248:251], a[184:187], a[76:79]
    s_add_u32 s76, s52, 3
    v_accvgpr_read_b32 v38, a50
    v_accvgpr_read_b32 v39, a51
    v_mul_f32 v36, v36, v16
    v_mfma_f32_16x16x32_bf16 a[76:79], v[244:247], a[180:183], a[76:79]
    s_and_b32 s76, s76, 7
    v_mul_f32 v37, v37, v17
    v_mul_f32 v38, v38, v18
    v_mul_f32 v39, v39, v19
    v_mfma_f32_16x16x32_bf16 a[76:79], v[240:243], a[176:179], a[76:79]
    s_waitcnt lgkmcnt(0)
    s_barrier
    v_cvt_pk_bf16_f32 v146, v36, v37
    v_cvt_pk_bf16_f32 v147, v38, v39
    v_mfma_f32_16x16x32_bf16 a[80:83], v[192:195], a[192:195], a[80:83]
    s_lshl_b32 s76, s76, 7
    ds_write2st64_b64 v32, v[128:129], v[130:131] offset0:16 offset1:20
    v_mfma_f32_16x16x32_bf16 a[80:83], v[196:199], a[196:199], a[80:83]
    s_add_u32 s54, s76, 0x0
    v_xor_b32 v32, 0x20, v32
    v_accvgpr_read_b32 v36, a36
    v_accvgpr_read_b32 v37, a37
    v_accvgpr_read_b32 v38, a38
    v_accvgpr_read_b32 v39, a39
    v_mfma_f32_16x16x32_bf16 a[80:83], v[200:203], a[200:203], a[80:83]
    s_add_u32 m0, s63, 0x0
    ds_read_b64_tr_b16 a[176:177], v10 offset:8192
    ds_read_b64_tr_b16 a[178:179], v10 offset:12288
    buffer_load_dwordx4 v62, s[20:23], s54 offen lds
    v_mul_f32 v36, v36, v20
    v_mfma_f32_16x16x32_bf16 a[80:83], v[204:207], a[204:207], a[80:83]
    s_add_u32 s55, s76, 0x1c00
    ds_read_b64_tr_b16 a[180:181], v10 offset:24576
    ds_read_b64_tr_b16 a[182:183], v10 offset:28672
    v_mul_f32 v37, v37, v21
    v_mul_f32 v38, v38, v22
    v_mul_f32 v39, v39, v23
    v_mfma_f32_16x16x32_bf16 a[84:87], v[220:223], a[204:207], a[84:87]
    ds_write2st64_b64 v32, v[132:133], v[134:135] offset0:16 offset1:20
    v_mfma_f32_16x16x32_bf16 a[84:87], v[216:219], a[200:203], a[84:87]
    v_xor_b32 v32, 0x60, v32
    v_cvt_pk_bf16_f32 v148, v36, v37
    v_cvt_pk_bf16_f32 v149, v38, v39
    v_accvgpr_read_b32 v36, a52
    v_accvgpr_read_b32 v37, a53
    v_mfma_f32_16x16x32_bf16 a[84:87], v[212:215], a[196:199], a[84:87]
    ds_read_b64_tr_b16 a[184:185], v10 offset:40960
    ds_read_b64_tr_b16 a[186:187], v10 offset:45056
    buffer_load_dwordx4 v62, s[20:23], s55 offen offset:1024 lds
    v_accvgpr_read_b32 v38, a54
    v_mfma_f32_16x16x32_bf16 a[84:87], v[208:211], a[192:195], a[84:87]
    s_add_u32 s56, s76, 0x3800
    ds_read_b64_tr_b16 a[188:189], v10 offset:57344
    ds_read_b64_tr_b16 a[190:191], v10 offset:61440
    v_accvgpr_read_b32 v39, a55
    v_mul_f32 v36, v36, v20
    v_mul_f32 v37, v37, v21
    v_mfma_f32_16x16x32_bf16 a[88:91], v[224:227], a[192:195], a[88:91]
    ds_write2st64_b64 v32, v[136:137], v[138:139] offset0:16 offset1:20
    v_mfma_f32_16x16x32_bf16 a[88:91], v[228:231], a[196:199], a[88:91]
    v_xor_b32 v32, 0x20, v32
    v_mul_f32 v38, v38, v22
    v_mul_f32 v39, v39, v23
    v_cvt_pk_bf16_f32 v150, v36, v37
    v_cvt_pk_bf16_f32 v151, v38, v39
    v_mfma_f32_16x16x32_bf16 a[88:91], v[232:235], a[200:203], a[88:91]
    buffer_load_dwordx4 v62, s[20:23], s56 offen offset:2048 lds
    v_accvgpr_read_b32 v36, a40
    v_accvgpr_read_b32 v37, a41
    v_accvgpr_read_b32 v38, a42
    v_mfma_f32_16x16x32_bf16 a[88:91], v[236:239], a[204:207], a[88:91]
    s_add_u32 s57, s76, 0x5400
    v_accvgpr_read_b32 v39, a43
    v_mul_f32 v36, v36, v24
    v_mul_f32 v37, v37, v25
    v_mul_f32 v38, v38, v26
    v_mfma_f32_16x16x32_bf16 a[92:95], v[252:255], a[204:207], a[92:95]
    ds_write2st64_b64 v32, v[140:141], v[142:143] offset0:16 offset1:20
    v_mfma_f32_16x16x32_bf16 a[92:95], v[248:251], a[200:203], a[92:95]
    v_xor_b32 v32, 0x60, v32
    v_mul_f32 v39, v39, v27
    v_cvt_pk_bf16_f32 v152, v36, v37
    v_cvt_pk_bf16_f32 v153, v38, v39
    v_mfma_f32_16x16x32_bf16 a[92:95], v[244:247], a[196:199], a[92:95]
    buffer_load_dwordx4 v62, s[20:23], s57 offen offset:3072 lds
    v_accvgpr_read_b32 v36, a56
    v_accvgpr_read_b32 v37, a57
    v_accvgpr_read_b32 v38, a58
    v_mfma_f32_16x16x32_bf16 a[92:95], v[240:243], a[192:195], a[92:95]
    s_waitcnt lgkmcnt(2)
    v_accvgpr_read_b32 v39, a59
    v_mul_f32 v36, v36, v24
    v_mul_f32 v37, v37, v25
    v_mul_f32 v38, v38, v26
    v_mfma_f32_16x16x32_bf16 a[96:99], v[192:195], a[176:179], a[96:99]
    s_add_u32 s54, s76, 0x8000
    ds_write2st64_b64 v32, v[144:145], v[146:147] offset0:24 offset1:28
    v_mfma_f32_16x16x32_bf16 a[96:99], v[196:199], a[180:183], a[96:99]
    s_add_u32 m0, s63, 0x1000
    v_xor_b32 v32, 0x20, v32
    v_mul_f32 v39, v39, v27
    v_cvt_pk_bf16_f32 v154, v36, v37
    v_cvt_pk_bf16_f32 v155, v38, v39
    v_mfma_f32_16x16x32_bf16 a[96:99], v[200:203], a[184:187], a[96:99]
    s_nop 0
    ds_read_b64_tr_b16 a[192:193], v11 offset:8192
    ds_read_b64_tr_b16 a[194:195], v11 offset:12288
    buffer_load_dwordx4 v62, s[20:23], s54 offen lds
    v_accvgpr_read_b32 v36, a44
    v_mfma_f32_16x16x32_bf16 a[96:99], v[204:207], a[188:191], a[96:99]
    s_add_u32 s55, s76, 0x9c00
    ds_read_b64_tr_b16 a[196:197], v11 offset:24576
    ds_read_b64_tr_b16 a[198:199], v11 offset:28672
    v_accvgpr_read_b32 v37, a45
    v_accvgpr_read_b32 v38, a46
    v_accvgpr_read_b32 v39, a47
    v_mfma_f32_16x16x32_bf16 a[100:103], v[220:223], a[188:191], a[100:103]
    ds_write2st64_b64 v32, v[148:149], v[150:151] offset0:24 offset1:28
    v_mfma_f32_16x16x32_bf16 a[100:103], v[216:219], a[184:187], a[100:103]
    v_xor_b32 v32, 0x60, v32
    v_mul_f32 v36, v36, v28
    v_mul_f32 v37, v37, v29
    v_mul_f32 v38, v38, v30
    v_mfma_f32_16x16x32_bf16 a[100:103], v[212:215], a[180:183], a[100:103]
    ds_read_b64_tr_b16 a[200:201], v11 offset:40960
    ds_read_b64_tr_b16 a[202:203], v11 offset:45056
    buffer_load_dwordx4 v62, s[20:23], s55 offen offset:1024 lds
    v_mul_f32 v39, v39, v31
    v_mfma_f32_16x16x32_bf16 a[100:103], v[208:211], a[176:179], a[100:103]
    s_add_u32 s56, s76, 0xb800
    ds_read_b64_tr_b16 a[204:205], v11 offset:57344
    ds_read_b64_tr_b16 a[206:207], v11 offset:61440
    v_cvt_pk_bf16_f32 v156, v36, v37
    v_cvt_pk_bf16_f32 v157, v38, v39
    v_mfma_f32_16x16x32_bf16 a[104:107], v[224:227], a[176:179], a[104:107]
    ds_write2st64_b64 v32, v[152:153], v[154:155] offset0:24 offset1:28
    v_mfma_f32_16x16x32_bf16 a[104:107], v[228:231], a[180:183], a[104:107]
    v_xor_b32 v32, 0x20, v32
    v_accvgpr_read_b32 v36, a60
    v_accvgpr_read_b32 v37, a61
    v_accvgpr_read_b32 v38, a62
    v_mfma_f32_16x16x32_bf16 a[104:107], v[232:235], a[184:187], a[104:107]
    buffer_load_dwordx4 v62, s[20:23], s56 offen offset:2048 lds
    v_accvgpr_read_b32 v39, a63
    v_mul_f32 v36, v36, v28
    v_mul_f32 v37, v37, v29
    v_mfma_f32_16x16x32_bf16 a[104:107], v[236:239], a[188:191], a[104:107]
    s_add_u32 s57, s76, 0xd400
    v_mul_f32 v38, v38, v30
    v_mul_f32 v39, v39, v31
    v_cvt_pk_bf16_f32 v158, v36, v37
    v_cvt_pk_bf16_f32 v159, v38, v39
    v_mfma_f32_16x16x32_bf16 a[108:111], v[252:255], a[188:191], a[108:111]
    ds_write2st64_b64 v32, v[156:157], v[158:159] offset0:24 offset1:28
    v_mfma_f32_16x16x32_bf16 a[108:111], v[248:251], a[184:187], a[108:111]
    v_xor_b32 v32, 0x10060, v32
    v_accvgpr_read_b32 v36, a64
    v_accvgpr_read_b32 v37, a65
    v_accvgpr_read_b32 v38, a66
    v_mfma_f32_16x16x32_bf16 a[108:111], v[244:247], a[180:183], a[108:111]
    buffer_load_dwordx4 v62, s[20:23], s57 offen offset:3072 lds
    v_accvgpr_read_b32 v39, a67
    v_mul_f32 v36, v36, v16
    v_mul_f32 v37, v37, v17
    v_mfma_f32_16x16x32_bf16 a[108:111], v[240:243], a[176:179], a[108:111]
    s_waitcnt vmcnt(8) lgkmcnt(0)
    s_barrier
    v_mul_f32 v38, v38, v18
    v_mul_f32 v39, v39, v19
    v_cvt_pk_bf16_f32 v128, v36, v37
    v_mfma_f32_16x16x32_bf16 a[112:115], v[192:195], a[192:195], a[112:115]
    s_add_u32 s76, s52, 3
    ds_read_b64_tr_b16 a[0:1], v33 offset:8192
    ds_read_b64_tr_b16 a[2:3], v33 offset:10240
    v_cvt_pk_bf16_f32 v129, v38, v39
    v_accvgpr_read_b32 v36, a80
    v_accvgpr_read_b32 v37, a81
    v_mfma_f32_16x16x32_bf16 a[112:115], v[196:199], a[196:199], a[112:115]
    s_and_b32 s76, s76, 7
    ds_read_b64_tr_b16 a[4:5], v33 offset:12288
    ds_read_b64_tr_b16 a[6:7], v33 offset:14336
    v_accvgpr_read_b32 v38, a82
    v_accvgpr_read_b32 v39, a83
    v_mfma_f32_16x16x32_bf16 a[112:115], v[200:203], a[200:203], a[112:115]
    s_lshl_b32 s76, s76, 7
    ds_read_b64_tr_b16 a[8:9], v33 offset:24576
    ds_read_b64_tr_b16 a[10:11], v33 offset:26624
    v_mul_f32 v36, v36, v16
    v_mul_f32 v37, v37, v17
    v_mul_f32 v38, v38, v18
    v_mfma_f32_16x16x32_bf16 a[112:115], v[204:207], a[204:207], a[112:115]
    s_add_u32 s54, s76, 0x10000
    ds_read_b64_tr_b16 a[12:13], v33 offset:28672
    ds_read_b64_tr_b16 a[14:15], v33 offset:30720
    v_mul_f32 v39, v39, v19
    v_cvt_pk_bf16_f32 v130, v36, v37
    v_cvt_pk_bf16_f32 v131, v38, v39
    v_mfma_f32_16x16x32_bf16 a[116:119], v[220:223], a[204:207], a[116:119]
    s_add_u32 m0, s63, 0x10000
    ds_read_b64_tr_b16 a[16:17], v33 offset:40960
    ds_read_b64_tr_b16 a[18:19], v33 offset:43008
    buffer_load_dwordx4 v62, s[20:23], s54 offen lds
    v_accvgpr_read_b32 v36, a68
    v_mfma_f32_16x16x32_bf16 a[116:119], v[216:219], a[200:203], a[116:119]
    s_add_u32 s55, s76, 0x11c00
    ds_read_b64_tr_b16 a[20:21], v33 offset:45056
    ds_read_b64_tr_b16 a[22:23], v33 offset:47104
    v_accvgpr_read_b32 v37, a69
    v_accvgpr_read_b32 v38, a70
    v_accvgpr_read_b32 v39, a71
    v_mfma_f32_16x16x32_bf16 a[116:119], v[212:215], a[196:199], a[116:119]
    s_nop 0
    ds_read_b64_tr_b16 a[24:25], v33 offset:57344
    ds_read_b64_tr_b16 a[26:27], v33 offset:59392
    v_mul_f32 v36, v36, v20
    v_mul_f32 v37, v37, v21
    v_mul_f32 v38, v38, v22
    v_mfma_f32_16x16x32_bf16 a[116:119], v[208:211], a[192:195], a[116:119]
    s_nop 0
    ds_read_b64_tr_b16 a[28:29], v33 offset:61440
    ds_read_b64_tr_b16 a[30:31], v33 offset:63488
    v_xor_b32 v33, 0x20, v33
    v_mul_f32 v39, v39, v23
    v_cvt_pk_bf16_f32 v132, v36, v37
    v_mfma_f32_16x16x32_bf16 a[120:123], v[224:227], a[192:195], a[120:123]
    s_nop 0
    ds_read_b64_tr_b16 a[60:61], v33 offset:61440
    ds_read_b64_tr_b16 a[62:63], v33 offset:63488
    buffer_load_dwordx4 v62, s[20:23], s55 offen offset:1024 lds
    v_cvt_pk_bf16_f32 v133, v38, v39
    v_mfma_f32_16x16x32_bf16 a[120:123], v[228:231], a[196:199], a[120:123]
    s_add_u32 s56, s76, 0x13800
    ds_read_b64_tr_b16 a[56:57], v33 offset:57344
    ds_read_b64_tr_b16 a[58:59], v33 offset:59392
    v_accvgpr_read_b32 v36, a84
    v_accvgpr_read_b32 v37, a85
    v_accvgpr_read_b32 v38, a86
    v_mfma_f32_16x16x32_bf16 a[120:123], v[232:235], a[200:203], a[120:123]
    s_nop 0
    ds_read_b64_tr_b16 a[52:53], v33 offset:45056
    ds_read_b64_tr_b16 a[54:55], v33 offset:47104
    v_accvgpr_read_b32 v39, a87
    v_mul_f32 v36, v36, v20
    v_mul_f32 v37, v37, v21
    v_mfma_f32_16x16x32_bf16 a[120:123], v[236:239], a[204:207], a[120:123]
    s_nop 0
    ds_read_b64_tr_b16 a[48:49], v33 offset:40960
    ds_read_b64_tr_b16 a[50:51], v33 offset:43008
    v_mul_f32 v38, v38, v22
    v_mul_f32 v39, v39, v23
    v_cvt_pk_bf16_f32 v134, v36, v37
    v_mfma_f32_16x16x32_bf16 a[124:127], v[252:255], a[204:207], a[124:127]
    s_nop 0
    ds_read_b64_tr_b16 a[44:45], v33 offset:28672
    ds_read_b64_tr_b16 a[46:47], v33 offset:30720
    buffer_load_dwordx4 v62, s[20:23], s56 offen offset:2048 lds
    v_cvt_pk_bf16_f32 v135, v38, v39
    v_mfma_f32_16x16x32_bf16 a[124:127], v[248:251], a[200:203], a[124:127]
    s_add_u32 s57, s76, 0x15400
    ds_read_b64_tr_b16 a[40:41], v33 offset:24576
    ds_read_b64_tr_b16 a[42:43], v33 offset:26624
    v_accvgpr_read_b32 v36, a72
    v_accvgpr_read_b32 v37, a73
    v_accvgpr_read_b32 v38, a74
    v_accvgpr_read_b32 v39, a75
    v_mfma_f32_16x16x32_bf16 a[124:127], v[244:247], a[196:199], a[124:127]
    s_nop 0
    ds_read_b64_tr_b16 a[36:37], v33 offset:12288
    ds_read_b64_tr_b16 a[38:39], v33 offset:14336
    v_mul_f32 v36, v36, v24
    v_mul_f32 v37, v37, v25
    v_mul_f32 v38, v38, v26
    v_mul_f32 v39, v39, v27
    v_mfma_f32_16x16x32_bf16 a[124:127], v[240:243], a[192:195], a[124:127]
    s_waitcnt lgkmcnt(14)
    ds_read_b64_tr_b16 a[32:33], v33 offset:8192
    ds_read_b64_tr_b16 a[34:35], v33 offset:10240
    v_xor_b32 v33, 0x60, v33
    v_cvt_pk_bf16_f32 v136, v36, v37
    v_cvt_pk_bf16_f32 v137, v38, v39
    v_mfma_f32_16x16x32_bf16 v[192:195], v[160:163], a[0:3], 0
    s_nop 0
    ds_read_b64_tr_b16 a[128:129], v33 offset:8192
    ds_read_b64_tr_b16 a[130:131], v33 offset:10240
    ds_read_b64_tr_b16 v[224:225], v35 offset:0
    buffer_load_dwordx4 v62, s[20:23], s57 offen offset:3072 lds
    v_accvgpr_read_b32 v36, a88
    v_mfma_f32_16x16x32_bf16 v[192:195], v[164:167], a[4:7], v[192:195]
    s_add_u32 s54, s76, 0x18000
    ds_read_b64_tr_b16 a[132:133], v33 offset:12288
    ds_read_b64_tr_b16 a[134:135], v33 offset:14336
    ds_read_b64_tr_b16 v[226:227], v35 offset:2048
    v_accvgpr_read_b32 v37, a89
    v_accvgpr_read_b32 v38, a90
    v_accvgpr_read_b32 v39, a91
    v_mfma_f32_16x16x32_bf16 v[192:195], v[168:171], a[8:11], v[192:195]
    s_add_u32 m0, s63, 0x11000
    ds_read_b64_tr_b16 a[136:137], v33 offset:24576
    ds_read_b64_tr_b16 a[138:139], v33 offset:26624
    ds_read_b64_tr_b16 v[228:229], v35 offset:4096
    v_mul_f32 v36, v36, v24
    v_mul_f32 v37, v37, v25
    v_mul_f32 v38, v38, v26
    v_mfma_f32_16x16x32_bf16 v[192:195], v[172:175], a[12:15], v[192:195]
L_PAD9:
    s_cbranch_execz L_PADX
    s_nop 0
    ds_read_b64_tr_b16 a[140:141], v33 offset:28672
    ds_read_b64_tr_b16 a[142:143], v33 offset:30720
    ds_read_b64_tr_b16 v[230:231], v35 offset:6144
    v_mul_f32 v39, v39, v27
    v_cvt_pk_bf16_f32 v138, v36, v37
    v_mfma_f32_16x16x32_bf16 v[192:195], v[176:179], a[16:19], v[192:195]
    s_nop 0
    ds_read_b64_tr_b16 a[144:145], v33 offset:40960
    ds_read_b64_tr_b16 a[146:147], v33 offset:43008
    ds_read_b64_tr_b16 v[232:233], v35 offset:8192
    buffer_load_dwordx4 v62, s[20:23], s54 offen lds
    v_cvt_pk_bf16_f32 v139, v38, v39
    v_mfma_f32_16x16x32_bf16 v[192:195], v[180:183], a[20:23], v[192:195]
    s_add_u32 s55, s76, 0x19c00
    ds_read_b64_tr_b16 a[148:149], v33 offset:45056
    ds_read_b64_tr_b16 a[150:151], v33 offset:47104
    ds_read_b64_tr_b16 v[234:235], v35 offset:10240
    v_accvgpr_read_b32 v36, a76
    v_accvgpr_read_b32 v37, a77
    v_accvgpr_read_b32 v38, a78
    v_mfma_f32_16x16x32_bf16 v[192:195], v[184:187], a[24:27], v[192:195]
    s_nop 0
    ds_read_b64_tr_b16 a[152:153], v33 offset:57344
    ds_read_b64_tr_b16 a[154:155], v33 offset:59392
    ds_read_b64_tr_b16 v[236:237], v35 offset:12288
    v_accvgpr_read_b32 v39, a79
    v_mul_f32 v36, v36, v28
    v_mul_f32 v37, v37, v29
    v_mfma_f32_16x16x32_bf16 v[192:195], v[188:191], a[28:31], v[192:195]
    s_waitcnt lgkmcnt(15)
    ds_read_b64_tr_b16 a[156:157], v33 offset:61440
    ds_read_b64_tr_b16 a[158:159], v33 offset:63488
    ds_read_b64_tr_b16 v[238:239], v35 offset:14336
    v_xor_b32 v33, 0x20, v33
    v_mul_f32 v38, v38, v30
    v_mul_f32 v39, v39, v31
    v_mfma_f32_16x16x32_bf16 v[196:199], v[188:191], a[60:63], 0
    s_nop 0
    ds_read_b64_tr_b16 a[252:253], v33 offset:61440
    ds_read_b64_tr_b16 a[254:255], v33 offset:63488
    ds_read_b64_tr_b16 v[240:241], v35 offset:16384
    buffer_load_dwordx4 v62, s[20:23], s55 offen offset:1024 lds
    v_cvt_pk_bf16_f32 v140, v36, v37
    v_mfma_f32_16x16x32_bf16 v[196:199], v[184:187], a[56:59], v[196:199]
    s_add_u32 s56, s76, 0x1b800
    ds_read_b64_tr_b16 a[248:249], v33 offset:57344
    ds_read_b64_tr_b16 a[250:251], v33 offset:59392
    ds_read_b64_tr_b16 v[242:243], v35 offset:18432
    v_cvt_pk_bf16_f32 v141, v38, v39
    v_accvgpr_read_b32 v36, a92
    v_accvgpr_read_b32 v37, a93
    v_accvgpr_read_b32 v38, a94
    v_mfma_f32_16x16x32_bf16 v[196:199], v[180:183], a[52:55], v[196:199]
    s_nop 0
    ds_read_b64_tr_b16 a[244:245], v33 offset:45056
    ds_read_b64_tr_b16 a[246:247], v33 offset:47104
    ds_read_b64_tr_b16 v[244:245], v35 offset:20480
    v_accvgpr_read_b32 v39, a95
    v_mul_f32 v36, v36, v28
    v_mul_f32 v37, v37, v29
    v_mfma_f32_16x16x32_bf16 v[196:199], v[176:179], a[48:51], v[196:199]
    s_nop 0
    ds_read_b64_tr_b16 a[240:241], v33 offset:40960
    ds_read_b64_tr_b16 a[242:243], v33 offset:43008
    ds_read_b64_tr_b16 v[246:247], v35 offset:22528
    v_mul_f32 v38, v38, v30
    v_mul_f32 v39, v39, v31
    v_cvt_pk_bf16_f32 v142, v36, v37
    v_mfma_f32_16x16x32_bf16 v[196:199], v[172:175], a[44:47], v[196:199]
    s_nop 0
    ds_read_b64_tr_b16 a[172:173], v33 offset:28672
    ds_read_b64_tr_b16 a[174:175], v33 offset:30720
    ds_read_b64_tr_b16 v[248:249], v35 offset:24576
    buffer_load_dwordx4 v62, s[20:23], s56 offen offset:2048 lds
    v_cvt_pk_bf16_f32 v143, v38, v39
    v_mfma_f32_16x16x32_bf16 v[196:199], v[168:171], a[40:43], v[196:199]
    s_add_u32 s57, s76, 0x1d400
    ds_read_b64_tr_b16 a[168:169], v33 offset:24576
    ds_read_b64_tr_b16 a[170:171], v33 offset:26624
    ds_read_b64_tr_b16 v[250:251], v35 offset:26624
    v_accvgpr_read_b32 v36, a96
    v_accvgpr_read_b32 v37, a97
    v_mfma_f32_16x16x32_bf16 v[196:199], v[164:167], a[36:39], v[196:199]
    s_nop 0
    ds_read_b64_tr_b16 a[164:165], v33 offset:12288
    ds_read_b64_tr_b16 a[166:167], v33 offset:14336
    ds_read_b64_tr_b16 v[252:253], v35 offset:28672
    v_accvgpr_read_b32 v38, a98
    v_accvgpr_read_b32 v39, a99
    v_mfma_f32_16x16x32_bf16 v[196:199], v[160:163], a[32:35], v[196:199]
    s_waitcnt lgkmcnt(15)
    ds_read_b64_tr_b16 a[160:161], v33 offset:8192
    ds_read_b64_tr_b16 a[162:163], v33 offset:10240
    ds_read_b64_tr_b16 v[254:255], v35 offset:30720
    v_xor_b32 v33, 0x10060, v33
    v_mfma_f32_16x16x32_bf16 v[200:203], v[160:163], a[128:131], 0
    buffer_load_dwordx4 v62, s[20:23], s57 offen offset:3072 lds
    v_mul_f32 v36, v36, v16
    v_mul_f32 v37, v37, v17
    v_mul_f32 v38, v38, v18
    v_mfma_f32_16x16x32_bf16 v[200:203], v[164:167], a[132:135], v[200:203]
    ds_write2st64_b64 v32, v[128:129], v[130:131] offset0:16 offset1:20
    v_mfma_f32_16x16x32_bf16 v[200:203], v[168:171], a[136:139], v[200:203]
    v_xor_b32 v32, 0x20, v32
    v_mul_f32 v39, v39, v19
    v_cvt_pk_bf16_f32 v144, v36, v37
    v_cvt_pk_bf16_f32 v145, v38, v39
    v_accvgpr_read_b32 v36, a112
    v_mfma_f32_16x16x32_bf16 v[200:203], v[172:175], a[140:143], v[200:203]
    v_accvgpr_read_b32 v37, a113
    v_accvgpr_read_b32 v38, a114
    v_accvgpr_read_b32 v39, a115
    v_mul_f32 v36, v36, v16
    v_mfma_f32_16x16x32_bf16 v[200:203], v[176:179], a[144:147], v[200:203]
    v_mul_f32 v37, v37, v17
    v_mul_f32 v38, v38, v18
    v_mul_f32 v39, v39, v19
    v_cvt_pk_bf16_f32 v146, v36, v37
    v_cvt_pk_bf16_f32 v147, v38, v39
    v_mfma_f32_16x16x32_bf16 v[200:203], v[180:183], a[148:151], v[200:203]
    ds_write2st64_b64 v32, v[132:133], v[134:135] offset0:16 offset1:20
    v_mfma_f32_16x16x32_bf16 v[200:203], v[184:187], a[152:155], v[200:203]
    v_xor_b32 v32, 0x60, v32
    v_accvgpr_read_b32 v36, a100
    v_accvgpr_read_b32 v37, a101
    v_accvgpr_read_b32 v38, a102
    v_mfma_f32_16x16x32_bf16 v[200:203], v[188:191], a[156:159], v[200:203]
    s_waitcnt lgkmcnt(3)
    v_accvgpr_read_b32 v39, a103
    v_mul_f32 v36, v36, v20
    v_mul_f32 v37, v37, v21
    v_mul_f32 v38, v38, v22
    v_mfma_f32_16x16x32_bf16 v[204:207], v[188:191], a[252:255], 0
    v_mul_f32 v39, v39, v23
    v_cvt_pk_bf16_f32 v148, v36, v37
    v_cvt_pk_bf16_f32 v149, v38, v39
    v_accvgpr_read_b32 v36, a116
    v_mfma_f32_16x16x32_bf16 v[204:207], v[184:187], a[248:251], v[204:207]
    s_add_u32 s76, s52, 4
    ds_write2st64_b64 v32, v[136:137], v[138:139] offset0:16 offset1:20
    v_mfma_f32_16x16x32_bf16 v[204:207], v[180:183], a[244:247], v[204:207]
    s_and_b32 s76, s76, 7
    v_xor_b32 v32, 0x20, v32
    v_accvgpr_read_b32 v37, a117
    v_accvgpr_read_b32 v38, a118
    v_mfma_f32_16x16x32_bf16 v[204:207], v[176:179], a[240:243], v[204:207]
    s_waitcnt lgkmcnt(3)
    s_barrier
    v_accvgpr_read_b32 v39, a119
    v_mul_f32 v36, v36, v20
    v_mul_f32 v37, v37, v21
    v_mfma_f32_16x16x32_bf16 v[204:207], v[172:175], a[172:175], v[204:207]
    s_lshl_b32 s76, s76, 7
    v_mul_f32 v38, v38, v22
    v_mul_f32 v39, v39, v23
    v_cvt_pk_bf16_f32 v150, v36, v37
    v_cvt_pk_bf16_f32 v151, v38, v39
    v_mfma_f32_16x16x32_bf16 v[204:207], v[168:171], a[168:171], v[204:207]
    s_add_u32 s54, s76, 0x0
    ds_write2st64_b64 v32, v[140:141], v[142:143] offset0:16 offset1:20
    v_mfma_f32_16x16x32_bf16 v[204:207], v[164:167], a[164:167], v[204:207]
    s_add_u32 m0, s77, 0x20000
    v_xor_b32 v32, 0x60, v32
    v_accvgpr_read_b32 v36, a104
    v_accvgpr_read_b32 v37, a105
    v_accvgpr_read_b32 v38, a106
    v_mfma_f32_16x16x32_bf16 v[204:207], v[160:163], a[160:163], v[204:207]
    buffer_load_dwordx4 v62, s[20:23], s54 offen lds
    v_accvgpr_read_b32 v39, a107
    v_mul_f32 v36, v36, v24
    v_mfma_f32_16x16x32_bf16 v[208:211], v[64:67], a[0:3], 0
    s_add_u32 s55, s76, 0x1c00
    v_mul_f32 v37, v37, v25
    v_mul_f32 v38, v38, v26
    v_mul_f32 v39, v39, v27
    v_cvt_pk_bf16_f32 v152, v36, v37
    v_cvt_pk_bf16_f32 v153, v38, v39
    v_mfma_f32_16x16x32_bf16 v[208:211], v[68:71], a[4:7], v[208:211]
    ds_write2st64_b64 v32, v[144:145], v[146:147] offset0:24 offset1:28
    v_mfma_f32_16x16x32_bf16 v[208:211], v[72:75], a[8:11], v[208:211]
    v_xor_b32 v32, 0x20, v32
    v_accvgpr_read_b32 v36, a120
    v_accvgpr_read_b32 v37, a121
    v_accvgpr_read_b32 v38, a122
    v_mfma_f32_16x16x32_bf16 v[208:211], v[76:79], a[12:15], v[208:211]
    buffer_load_dwordx4 v62, s[20:23], s55 offen offset:1024 lds
    v_accvgpr_read_b32 v39, a123
    v_mul_f32 v36, v36, v24
    v_mfma_f32_16x16x32_bf16 v[208:211], v[80:83], a[16:19], v[208:211]
    s_add_u32 s56, s76, 0x3800
    v_mul_f32 v37, v37, v25
    v_mul_f32 v38, v38, v26
    v_mul_f32 v39, v39, v27
    v_cvt_pk_bf16_f32 v154, v36, v37
    v_cvt_pk_bf16_f32 v155, v38, v39
    v_mfma_f32_16x16x32_bf16 v[208:211], v[84:87], a[20:23], v[208:211]
    ds_write2st64_b64 v32, v[148:149], v[150:151] offset0:24 offset1:28
    v_mfma_f32_16x16x32_bf16 v[208:211], v[88:91], a[24:27], v[208:211]
    v_xor_b32 v32, 0x60, v32
    v_accvgpr_read_b32 v36, a108
    v_accvgpr_read_b32 v37, a109
    v_accvgpr_read_b32 v38, a110
    v_mfma_f32_16x16x32_bf16 v[208:211], v[92:95], a[28:31], v[208:211]
    buffer_load_dwordx4 v62, s[20:23], s56 offen offset:2048 lds
    v_accvgpr_read_b32 v39, a111
    v_mul_f32 v36, v36, v28
    v_mfma_f32_16x16x32_bf16 v[212:215], v[92:95], a[60:63], 0
    s_add_u32 s57, s76, 0x5400
    v_mul_f32 v37, v37, v29
    v_mul_f32 v38, v38, v30
    v_mul_f32 v39, v39, v31
    v_cvt_pk_bf16_f32 v156, v36, v37
    v_cvt_pk_bf16_f32 v157, v38, v39
    v_mfma_f32_16x16x32_bf16 v[212:215], v[88:91], a[56:59], v[212:215]
    ds_write2st64_b64 v32, v[152:153], v[154:155] offset0:24 offset1:28
    v_mfma_f32_16x16x32_bf16 v[212:215], v[84:87], a[52:55], v[212:215]
    v_xor_b32 v32, 0x20, v32
    v_accvgpr_read_b32 v36, a124
    v_accvgpr_read_b32 v37, a125
    v_accvgpr_read_b32 v38, a126
    v_mfma_f32_16x16x32_bf16 v[212:215], v[80:83], a[48:51], v[212:215]
    buffer_load_dwordx4 v62, s[20:23], s57 offen offset:3072 lds
    v_accvgpr_read_b32 v39, a127
    v_mul_f32 v36, v36, v28
    v_mfma_f32_16x16x32_bf16 v[212:215], v[76:79], a[44:47], v[212:215]
    s_add_u32 s54, s76, 0x8000
    v_mul_f32 v37, v37, v29
    v_mul_f32 v38, v38, v30
    v_mul_f32 v39, v39, v31
    v_cvt_pk_bf16_f32 v158, v36, v37
    v_cvt_pk_bf16_f32 v159, v38, v39
    v_mfma_f32_16x16x32_bf16 v[212:215], v[72:75], a[40:43], v[212:215]
    s_add_u32 m0, s77, 0x21000
    ds_write2st64_b64 v32, v[156:157], v[158:159] offset0:24 offset1:28
    v_mfma_f32_16x16x32_bf16 v[212:215], v[68:71], a[36:39], v[212:215]
    v_accvgpr_read_b32 v4, a216
    v_accvgpr_read_b32 v5, a217
    v_mfma_f32_16x16x32_bf16 v[212:215], v[64:67], a[32:35], v[212:215]
    buffer_load_dwordx4 v62, s[20:23], s54 offen lds
    v_accvgpr_read_b32 v6, a218
    v_mfma_f32_16x16x32_bf16 v[216:219], v[64:67], a[128:131], 0
    s_add_u32 s55, s76, 0x9c00
    v_accvgpr_read_b32 v7, a219
    v_accvgpr_read_b32 v8, a220
    v_accvgpr_read_b32 v9, a221
    v_mfma_f32_16x16x32_bf16 v[216:219], v[68:71], a[132:135], v[216:219]
    s_waitcnt lgkmcnt(0)
    s_barrier
    v_accvgpr_read_b32 v10, a222
    v_accvgpr_read_b32 v11, a223
    v_mfma_f32_16x16x32_bf16 v[216:219], v[72:75], a[136:139], v[216:219]
    s_nop 0
    ds_read_b64_tr_b16 a[64:65], v33 offset:8192
    ds_read_b64_tr_b16 a[66:67], v33 offset:10240
    v_mfma_f32_16x16x32_bf16 v[216:219], v[76:79], a[140:143], v[216:219]
    s_nop 0
    ds_read_b64_tr_b16 a[68:69], v33 offset:12288
    ds_read_b64_tr_b16 a[70:71], v33 offset:14336
    buffer_load_dwordx4 v62, s[20:23], s55 offen offset:1024 lds
    v_mfma_f32_16x16x32_bf16 v[216:219], v[80:83], a[144:147], v[216:219]
    s_add_u32 s56, s76, 0xb800
    ds_read_b64_tr_b16 a[72:73], v33 offset:24576
    ds_read_b64_tr_b16 a[74:75], v33 offset:26624
    v_mfma_f32_16x16x32_bf16 v[216:219], v[84:87], a[148:151], v[216:219]
    s_nop 0
    ds_read_b64_tr_b16 a[76:77], v33 offset:28672
    ds_read_b64_tr_b16 a[78:79], v33 offset:30720
    v_accvgpr_read_b32 v16, a228
    v_mfma_f32_16x16x32_bf16 v[216:219], v[88:91], a[152:155], v[216:219]
    s_nop 0
    ds_read_b64_tr_b16 a[80:81], v33 offset:40960
    ds_read_b64_tr_b16 a[82:83], v33 offset:43008
    v_accvgpr_read_b32 v17, a229
    v_mfma_f32_16x16x32_bf16 v[216:219], v[92:95], a[156:159], v[216:219]
    s_nop 0
    ds_read_b64_tr_b16 a[84:85], v33 offset:45056
    ds_read_b64_tr_b16 a[86:87], v33 offset:47104
    buffer_load_dwordx4 v62, s[20:23], s56 offen offset:2048 lds
    v_mfma_f32_16x16x32_bf16 v[220:223], v[92:95], a[252:255], 0
    s_add_u32 s57, s76, 0xd400
    ds_read_b64_tr_b16 a[88:89], v33 offset:57344
    ds_read_b64_tr_b16 a[90:91], v33 offset:59392
    v_mfma_f32_16x16x32_bf16 v[220:223], v[88:91], a[248:251], v[220:223]
    s_nop 0
    ds_read_b64_tr_b16 a[92:93], v33 offset:61440
    ds_read_b64_tr_b16 a[94:95], v33 offset:63488
    v_xor_b32 v33, 0x20, v33
    v_mfma_f32_16x16x32_bf16 v[220:223], v[84:87], a[244:247], v[220:223]
    s_nop 0
    ds_read_b64_tr_b16 a[124:125], v33 offset:61440
    ds_read_b64_tr_b16 a[126:127], v33 offset:63488
    v_accvgpr_read_b32 v18, a230
    v_mfma_f32_16x16x32_bf16 v[220:223], v[80:83], a[240:243], v[220:223]
    s_nop 0
    ds_read_b64_tr_b16 a[120:121], v33 offset:57344
    ds_read_b64_tr_b16 a[122:123], v33 offset:59392
    buffer_load_dwordx4 v62, s[20:23], s57 offen offset:3072 lds
    v_mfma_f32_16x16x32_bf16 v[220:223], v[76:79], a[172:175], v[220:223]
    s_add_u32 s76, s52, 4
    ds_read_b64_tr_b16 a[116:117], v33 offset:45056
    ds_read_b64_tr_b16 a[118:119], v33 offset:47104
    v_accvgpr_read_b32 v19, a231
    v_mfma_f32_16x16x32_bf16 v[220:223], v[72:75], a[168:171], v[220:223]
    s_and_b32 s76, s76, 7
    ds_read_b64_tr_b16 a[112:113], v33 offset:40960
    ds_read_b64_tr_b16 a[114:115], v33 offset:43008
    v_accvgpr_read_b32 v20, a232
    v_mfma_f32_16x16x32_bf16 v[220:223], v[68:71], a[164:167], v[220:223]
    s_lshl_b32 s76, s76, 7
    ds_read_b64_tr_b16 a[108:109], v33 offset:28672
    ds_read_b64_tr_b16 a[110:111], v33 offset:30720
    v_mfma_f32_16x16x32_bf16 v[220:223], v[64:67], a[160:163], v[220:223]
    s_waitcnt lgkmcnt(10)
    ds_read_b64_tr_b16 a[104:105], v33 offset:24576
    ds_read_b64_tr_b16 a[106:107], v33 offset:26624
    v_accvgpr_read_b32 v21, a233
    v_mfma_f32_16x16x32_bf16 v[192:195], v[96:99], a[64:67], v[192:195]
    s_add_u32 s54, s76, 0x10000
    ds_read_b64_tr_b16 a[100:101], v33 offset:12288
    ds_read_b64_tr_b16 a[102:103], v33 offset:14336
    v_accvgpr_read_b32 v22, a234
    v_mfma_f32_16x16x32_bf16 v[192:195], v[100:103], a[68:71], v[192:195]
    s_add_u32 m0, s63, 0x2000
    ds_read_b64_tr_b16 a[96:97], v33 offset:8192
    ds_read_b64_tr_b16 a[98:99], v33 offset:10240
    buffer_load_dwordx4 v62, s[20:23], s54 offen lds
    v_xor_b32 v33, 0x60, v33
    v_mfma_f32_16x16x32_bf16 v[192:195], v[104:107], a[72:75], v[192:195]
    s_add_u32 s55, s76, 0x11c00
    ds_read_b64_tr_b16 a[176:177], v33 offset:8192
    ds_read_b64_tr_b16 a[178:179], v33 offset:10240
    v_accvgpr_read_b32 v23, a235
    v_mfma_f32_16x16x32_bf16 v[192:195], v[108:111], a[76:79], v[192:195]
    s_nop 0
    ds_read_b64_tr_b16 a[180:181], v33 offset:12288
    ds_read_b64_tr_b16 a[182:183], v33 offset:14336
    v_accvgpr_read_b32 v24, a236
    v_mfma_f32_16x16x32_bf16 v[192:195], v[112:115], a[80:83], v[192:195]
    s_nop 0
    ds_read_b64_tr_b16 a[184:185], v33 offset:24576
    ds_read_b64_tr_b16 a[186:187], v33 offset:26624
    v_accvgpr_read_b32 v25, a237
    v_mfma_f32_16x16x32_bf16 v[192:195], v[116:119], a[84:87], v[192:195]
    s_nop 0
    ds_read_b64_tr_b16 a[188:189], v33 offset:28672
    ds_read_b64_tr_b16 a[190:191], v33 offset:30720
    buffer_load_dwordx4 v62, s[20:23], s55 offen offset:1024 lds
    v_mfma_f32_16x16x32_bf16 v[192:195], v[120:123], a[88:91], v[192:195]
    s_add_u32 s56, s76, 0x13800
    ds_read_b64_tr_b16 a[192:193], v33 offset:40960
    ds_read_b64_tr_b16 a[194:195], v33 offset:43008
    v_accvgpr_read_b32 v26, a238
    v_mfma_f32_16x16x32_bf16 v[192:195], v[124:127], a[92:95], v[192:195]
    s_waitcnt lgkmcnt(10)
    ds_read_b64_tr_b16 a[196:197], v33 offset:45056
    ds_read_b64_tr_b16 a[198:199], v33 offset:47104
    v_accvgpr_read_b32 v27, a239
    v_mfma_f32_16x16x32_bf16 v[196:199], v[124:127], a[124:127], v[196:199]
    s_nop 0
    ds_read_b64_tr_b16 a[200:201], v33 offset:57344
    ds_read_b64_tr_b16 a[202:203], v33 offset:59392
    v_mfma_f32_16x16x32_bf16 v[196:199], v[120:123], a[120:123], v[196:199]
    s_nop 0
    ds_read_b64_tr_b16 a[204:205], v33 offset:61440
    ds_read_b64_tr_b16 a[206:207], v33 offset:63488
    buffer_load_dwordx4 v62, s[20:23], s56 offen offset:2048 lds
    v_xor_b32 v33, 0x20, v33
    v_mfma_f32_16x16x32_bf16 v[196:199], v[116:119], a[116:119], v[196:199]
    s_add_u32 s57, s76, 0x15400
    ds_read_b64_tr_b16 a[236:237], v33 offset:61440
    ds_read_b64_tr_b16 a[238:239], v33 offset:63488
    v_mfma_f32_16x16x32_bf16 v[196:199], v[112:115], a[112:115], v[196:199]
    s_nop 0
    ds_read_b64_tr_b16 a[232:233], v33 offset:57344
    ds_read_b64_tr_b16 a[234:235], v33 offset:59392
    v_mfma_f32_16x16x32_bf16 v[196:199], v[108:111], a[108:111], v[196:199]
    s_nop 0
    ds_read_b64_tr_b16 a[228:229], v33 offset:45056
    ds_read_b64_tr_b16 a[230:231], v33 offset:47104
    v_mfma_f32_16x16x32_bf16 v[196:199], v[104:107], a[104:107], v[196:199]
    s_nop 0
    ds_read_b64_tr_b16 a[224:225], v33 offset:40960
    ds_read_b64_tr_b16 a[226:227], v33 offset:43008
    buffer_load_dwordx4 v62, s[20:23], s57 offen offset:3072 lds
    v_mfma_f32_16x16x32_bf16 v[196:199], v[100:103], a[100:103], v[196:199]
    s_add_u32 s54, s76, 0x18000
    ds_read_b64_tr_b16 a[220:221], v33 offset:28672
    ds_read_b64_tr_b16 a[222:223], v33 offset:30720
    v_mfma_f32_16x16x32_bf16 v[196:199], v[96:99], a[96:99], v[196:199]
    s_waitcnt lgkmcnt(10)
    ds_read_b64_tr_b16 a[216:217], v33 offset:24576
    ds_read_b64_tr_b16 a[218:219], v33 offset:26624
    v_mfma_f32_16x16x32_bf16 v[200:203], v[96:99], a[176:179], v[200:203]
    s_add_u32 m0, s63, 0x3000
    ds_read_b64_tr_b16 a[212:213], v33 offset:12288
    ds_read_b64_tr_b16 a[214:215], v33 offset:14336
    v_mfma_f32_16x16x32_bf16 v[200:203], v[100:103], a[180:183], v[200:203]
    s_nop 0
    ds_read_b64_tr_b16 a[208:209], v33 offset:8192
    ds_read_b64_tr_b16 a[210:211], v33 offset:10240
    buffer_load_dwordx4 v62, s[20:23], s54 offen lds
    v_mfma_f32_16x16x32_bf16 v[200:203], v[104:107], a[184:187], v[200:203]
    s_add_u32 s55, s76, 0x19c00
    v_mfma_f32_16x16x32_bf16 v[200:203], v[108:111], a[188:191], v[200:203]
    v_mfma_f32_16x16x32_bf16 v[200:203], v[112:115], a[192:195], v[200:203]
    s_add_u32 s93, s52, 1
    s_and_b32 s93, s93, 7
    s_lshl_b32 s93, s93, 17
    v_mfma_f32_16x16x32_bf16 v[200:203], v[116:119], a[196:199], v[200:203]
    buffer_load_dwordx4 v62, s[20:23], s55 offen offset:1024 lds
    v_mfma_f32_16x16x32_bf16 v[200:203], v[120:123], a[200:203], v[200:203]
    s_add_u32 s56, s76, 0x1b800
    s_add_u32 s24, s93, s94
    v_mfma_f32_16x16x32_bf16 v[200:203], v[124:127], a[204:207], v[200:203]
    s_waitcnt lgkmcnt(0)
    v_mfma_f32_16x16x32_bf16 v[204:207], v[124:127], a[236:239], v[204:207]
    s_add_u32 s25, s24, 0x100000
    s_add_u32 s94, s94, 0x200000
    v_cvt_pk_bf16_f32 v128, v192, v193
    v_mfma_f32_16x16x32_bf16 v[204:207], v[120:123], a[232:235], v[204:207]
    buffer_load_dwordx4 v62, s[20:23], s56 offen offset:2048 lds
    v_mfma_f32_16x16x32_bf16 v[204:207], v[116:119], a[228:231], v[204:207]
    s_add_u32 s57, s76, 0x1d400
    v_cvt_pk_bf16_f32 v129, v194, v195
    v_min_u32 v128, -2, v128
    v_mfma_f32_16x16x32_bf16 v[204:207], v[112:115], a[224:227], v[204:207]
    s_cmp_lt_u32 s78, 16
    s_cbranch_scc1 L_WB
L_BB:
    v_min_u32 v129, -2, v129
    v_mfma_f32_16x16x32_bf16 v[204:207], v[108:111], a[220:223], v[204:207]
    v_cvt_pk_bf16_f32 v130, v196, v197
    v_cvt_pk_bf16_f32 v131, v198, v199
    v_mfma_f32_16x16x32_bf16 v[204:207], v[104:107], a[216:219], v[204:207]
    buffer_load_dwordx4 v62, s[20:23], s57 offen offset:3072 lds
    v_mfma_f32_16x16x32_bf16 v[204:207], v[100:103], a[212:215], v[204:207]
    s_add_u32 s76, s52, 5
    v_min_u32 v130, -2, v130
    v_min_u32 v131, -2, v131
    v_mfma_f32_16x16x32_bf16 v[204:207], v[96:99], a[208:211], v[204:207]
    s_waitcnt vmcnt(24) lgkmcnt(0)
    s_barrier
    v_mfma_f32_16x16x32_bf16 v[208:211], v[224:227], a[64:67], v[208:211]
    s_and_b32 s76, s76, 7
    buffer_store_dwordx4 v[128:131], v15, s[32:35], s24 offen sc1
    v_mfma_f32_16x16x32_bf16 v[208:211], v[228:231], a[68:71], v[208:211]
    s_lshl_b32 s76, s76, 7
    ds_read_b64_tr_b16 v[160:161], v60 offset:0
    ds_read_b64_tr_b16 v[162:163], v60 offset:2048
    v_mfma_f32_16x16x32_bf16 v[208:211], v[232:235], a[72:75], v[208:211]
    s_add_u32 s54, s76, 0x0
    v_mfma_f32_16x16x32_bf16 v[208:211], v[236:239], a[76:79], v[208:211]
    s_add_u32 m0, s63, 0x12000
    s_nop 0
    buffer_load_dwordx4 v62, s[20:23], s54 offen lds
    v_mfma_f32_16x16x32_bf16 v[208:211], v[240:243], a[80:83], v[208:211]
    s_add_u32 s55, s76, 0x1c00
    ds_read_b64_tr_b16 v[164:165], v60 offset:4096
    ds_read_b64_tr_b16 v[166:167], v60 offset:6144
    v_mfma_f32_16x16x32_bf16 v[208:211], v[244:247], a[84:87], v[208:211]
    v_cvt_pk_bf16_f32 v132, v200, v201
    v_cvt_pk_bf16_f32 v133, v202, v203
    v_mfma_f32_16x16x32_bf16 v[208:211], v[248:251], a[88:91], v[208:211]
    v_min_u32 v132, -2, v132
    v_min_u32 v133, -2, v133
    v_mfma_f32_16x16x32_bf16 v[208:211], v[252:255], a[92:95], v[208:211]
    ds_read_b64_tr_b16 v[168:169], v60 offset:16384
    ds_read_b64_tr_b16 v[170:171], v60 offset:18432
    v_mfma_f32_16x16x32_bf16 v[212:215], v[252:255], a[124:127], v[212:215]
    buffer_load_dwordx4 v62, s[20:23], s55 offen offset:1024 lds
    v_mfma_f32_16x16x32_bf16 v[212:215], v[248:251], a[120:123], v[212:215]
    s_add_u32 s56, s76, 0x3800
    v_cvt_pk_bf16_f32 v134, v204, v205
    v_cvt_pk_bf16_f32 v135, v206, v207
    v_mfma_f32_16x16x32_bf16 v[212:215], v[244:247], a[116:119], v[212:215]
    s_nop 0
    ds_read_b64_tr_b16 v[172:173], v60 offset:20480
    ds_read_b64_tr_b16 v[174:175], v60 offset:22528
    v_mfma_f32_16x16x32_bf16 v[212:215], v[240:243], a[112:115], v[212:215]
    v_min_u32 v134, -2, v134
    v_min_u32 v135, -2, v135
    v_mfma_f32_16x16x32_bf16 v[212:215], v[236:239], a[108:111], v[212:215]
    buffer_store_dwordx4 v[132:135], v15, s[32:35], s25 offen sc1
    v_mfma_f32_16x16x32_bf16 v[212:215], v[232:235], a[104:107], v[212:215]
    s_nop 0
    ds_read_b64_tr_b16 v[176:177], v60 offset:32768
    ds_read_b64_tr_b16 v[178:179], v60 offset:34816
    buffer_load_dwordx4 v62, s[20:23], s56 offen offset:2048 lds
    v_mfma_f32_16x16x32_bf16 v[212:215], v[228:231], a[100:103], v[212:215]
    s_add_u32 s57, s76, 0x5400
    v_mfma_f32_16x16x32_bf16 v[212:215], v[224:227], a[96:99], v[212:215]
    v_mfma_f32_16x16x32_bf16 v[216:219], v[224:227], a[176:179], v[216:219]
    s_nop 0
    ds_read_b64_tr_b16 v[180:181], v60 offset:36864
    ds_read_b64_tr_b16 v[182:183], v60 offset:38912
    v_mfma_f32_16x16x32_bf16 v[216:219], v[228:231], a[180:183], v[216:219]
    v_mfma_f32_16x16x32_bf16 v[216:219], v[232:235], a[184:187], v[216:219]
    buffer_load_dwordx4 v62, s[20:23], s57 offen offset:3072 lds
    v_mfma_f32_16x16x32_bf16 v[216:219], v[236:239], a[188:191], v[216:219]
    s_add_u32 s54, s76, 0x8000
    ds_read_b64_tr_b16 v[184:185], v60 offset:49152
    ds_read_b64_tr_b16 v[186:187], v60 offset:51200
    v_mfma_f32_16x16x32_bf16 v[216:219], v[240:243], a[192:195], v[216:219]
    s_add_u32 m0, s63, 0x13000
    v_mfma_f32_16x16x32_bf16 v[216:219], v[244:247], a[196:199], v[216:219]
    s_add_u32 s93, s52, 2
    v_mfma_f32_16x16x32_bf16 v[216:219], v[248:251], a[200:203], v[216:219]
    s_and_b32 s93, s93, 7
    ds_read_b64_tr_b16 v[188:189], v60 offset:53248
    ds_read_b64_tr_b16 v[190:191], v60 offset:55296
    v_mfma_f32_16x16x32_bf16 v[216:219], v[252:255], a[204:207], v[216:219]
    buffer_load_dwordx4 v62, s[20:23], s54 offen lds
    v_mfma_f32_16x16x32_bf16 v[220:223], v[252:255], a[236:239], v[220:223]
    s_add_u32 s55, s76, 0x9c00
    v_mfma_f32_16x16x32_bf16 v[220:223], v[248:251], a[232:235], v[220:223]
    s_lshl_b32 s93, s93, 17
    v_mfma_f32_16x16x32_bf16 v[220:223], v[244:247], a[228:231], v[220:223]
    s_add_u32 s26, s93, s94
    v_mfma_f32_16x16x32_bf16 v[220:223], v[240:243], a[224:227], v[220:223]
    s_add_u32 s27, s26, 0x100000
    v_mfma_f32_16x16x32_bf16 v[220:223], v[236:239], a[220:223], v[220:223]
    buffer_load_dwordx4 v62, s[20:23], s55 offen offset:1024 lds
    v_mfma_f32_16x16x32_bf16 v[220:223], v[232:235], a[216:219], v[220:223]
    s_add_u32 s56, s76, 0xb800
    v_mfma_f32_16x16x32_bf16 v[220:223], v[228:231], a[212:215], v[220:223]
    s_add_u32 s94, s94, 0x200000
    v_cvt_pk_bf16_f32 v136, v208, v209
    v_cvt_pk_bf16_f32 v137, v210, v211
    v_mfma_f32_16x16x32_bf16 v[220:223], v[224:227], a[208:211], v[220:223]
    s_waitcnt vmcnt(24) lgkmcnt(0)
    s_barrier
    v_min_u32 v136, -2, v136
    v_mfma_f32_16x16x32_bf16 v[192:195], v[160:163], a[0:3], 0
    v_min_u32 v137, -2, v137
    v_cvt_pk_bf16_f32 v138, v212, v213
    v_mfma_f32_16x16x32_bf16 v[192:195], v[164:167], a[4:7], v[192:195]
    ds_read_b64_tr_b16 v[64:65], v61 offset:0
    ds_read_b64_tr_b16 v[66:67], v61 offset:2048
    buffer_load_dwordx4 v62, s[20:23], s56 offen offset:2048 lds
    v_mfma_f32_16x16x32_bf16 v[192:195], v[168:171], a[8:11], v[192:195]
    s_add_u32 s57, s76, 0xd400
    v_cvt_pk_bf16_f32 v139, v214, v215
    v_min_u32 v138, -2, v138
    v_mfma_f32_16x16x32_bf16 v[192:195], v[172:175], a[12:15], v[192:195]
    v_min_u32 v139, -2, v139
    v_lshlrev_b32 v28, 16, v40
    v_mfma_f32_16x16x32_bf16 v[192:195], v[176:179], a[16:19], v[192:195]
    ds_read_b64_tr_b16 v[68:69], v61 offset:4096
    ds_read_b64_tr_b16 v[70:71], v61 offset:6144
    v_mfma_f32_16x16x32_bf16 v[192:195], v[180:183], a[20:23], v[192:195]
    buffer_store_dwordx4 v[136:139], v15, s[32:35], s26 offen sc1
    v_mfma_f32_16x16x32_bf16 v[192:195], v[184:187], a[24:27], v[192:195]
    buffer_load_dwordx4 v62, s[20:23], s57 offen offset:3072 lds
    v_mfma_f32_16x16x32_bf16 v[192:195], v[188:191], a[28:31], v[192:195]
    s_add_u32 s76, s52, 5
    ds_read_b64_tr_b16 v[72:73], v61 offset:16384
    ds_read_b64_tr_b16 v[74:75], v61 offset:18432
    v_mfma_f32_16x16x32_bf16 v[196:199], v[188:191], a[60:63], 0
    s_and_b32 s76, s76, 7
    v_cvt_pk_bf16_f32 v140, v216, v217
    v_cvt_pk_bf16_f32 v141, v218, v219
    v_mfma_f32_16x16x32_bf16 v[196:199], v[184:187], a[56:59], v[196:199]
    s_lshl_b32 s76, s76, 7
    v_min_u32 v140, -2, v140
    v_min_u32 v141, -2, v141
    v_mfma_f32_16x16x32_bf16 v[196:199], v[180:183], a[52:55], v[196:199]
    s_add_u32 s54, s76, 0x10000
    ds_read_b64_tr_b16 v[76:77], v61 offset:20480
    ds_read_b64_tr_b16 v[78:79], v61 offset:22528
    v_mfma_f32_16x16x32_bf16 v[196:199], v[176:179], a[48:51], v[196:199]
    s_add_u32 m0, s63, 0x0
    s_nop 0
    buffer_load_dwordx4 v62, s[20:23], s54 offen lds
    v_mfma_f32_16x16x32_bf16 v[196:199], v[172:175], a[44:47], v[196:199]
    s_add_u32 s55, s76, 0x11c00
    v_cvt_pk_bf16_f32 v142, v220, v221
    v_cvt_pk_bf16_f32 v143, v222, v223
    v_mfma_f32_16x16x32_bf16 v[196:199], v[168:171], a[40:43], v[196:199]
L_PAD10:
    s_cbranch_execz L_PADX
    s_nop 0
    ds_read_b64_tr_b16 v[80:81], v61 offset:32768
    ds_read_b64_tr_b16 v[82:83], v61 offset:34816
    v_mfma_f32_16x16x32_bf16 v[196:199], v[164:167], a[36:39], v[196:199]
    v_min_u32 v142, -2, v142
    v_min_u32 v143, -2, v143
    v_mfma_f32_16x16x32_bf16 v[196:199], v[160:163], a[32:35], v[196:199]
    buffer_store_dwordx4 v[140:143], v15, s[32:35], s27 offen sc1
    v_mfma_f32_16x16x32_bf16 v[200:203], v[160:163], a[128:131], 0
    s_nop 0
    ds_read_b64_tr_b16 v[84:85], v61 offset:36864
    ds_read_b64_tr_b16 v[86:87], v61 offset:38912
    buffer_load_dwordx4 v62, s[20:23], s55 offen offset:1024 lds
    v_mfma_f32_16x16x32_bf16 v[200:203], v[164:167], a[132:135], v[200:203]
    s_add_u32 s56, s76, 0x13800
    v_and_b32 v40, 0xffff0000, v40
    v_add_f32 v44, v44, v28
    v_mfma_f32_16x16x32_bf16 v[200:203], v[168:171], a[136:139], v[200:203]
    v_add_f32 v45, v45, v40
    v_lshlrev_b32 v28, 16, v41
    v_mfma_f32_16x16x32_bf16 v[200:203], v[172:175], a[140:143], v[200:203]
    ds_read_b64_tr_b16 v[88:89], v61 offset:49152
    ds_read_b64_tr_b16 v[90:91], v61 offset:51200
    v_mfma_f32_16x16x32_bf16 v[200:203], v[176:179], a[144:147], v[200:203]
    v_and_b32 v41, 0xffff0000, v41
    v_add_f32 v46, v46, v28
    v_mfma_f32_16x16x32_bf16 v[200:203], v[180:183], a[148:151], v[200:203]
    buffer_load_dwordx4 v62, s[20:23], s56 offen offset:2048 lds
    v_mfma_f32_16x16x32_bf16 v[200:203], v[184:187], a[152:155], v[200:203]
    s_add_u32 s57, s76, 0x15400
    ds_read_b64_tr_b16 v[92:93], v61 offset:53248
    ds_read_b64_tr_b16 v[94:95], v61 offset:55296
    v_mfma_f32_16x16x32_bf16 v[200:203], v[188:191], a[156:159], v[200:203]
    v_add_f32 v47, v47, v41
    v_lshlrev_b32 v28, 16, v42
    v_mfma_f32_16x16x32_bf16 v[204:207], v[188:191], a[252:255], 0
    v_and_b32 v42, 0xffff0000, v42
    v_add_f32 v48, v48, v28
    v_mfma_f32_16x16x32_bf16 v[204:207], v[184:187], a[248:251], v[204:207]
    v_add_f32 v49, v49, v42
    v_lshlrev_b32 v28, 16, v43
    v_mfma_f32_16x16x32_bf16 v[204:207], v[180:183], a[244:247], v[204:207]
    buffer_load_dwordx4 v62, s[20:23], s57 offen offset:3072 lds
    v_mfma_f32_16x16x32_bf16 v[204:207], v[176:179], a[240:243], v[204:207]
    s_add_u32 s54, s76, 0x18000
    v_and_b32 v43, 0xffff0000, v43
    v_add_f32 v50, v50, v28
    v_mfma_f32_16x16x32_bf16 v[204:207], v[172:175], a[172:175], v[204:207]
    s_add_u32 m0, s63, 0x1000
    v_add_f32 v51, v51, v43
    v_lshlrev_b32 v28, 16, v16
    v_mfma_f32_16x16x32_bf16 v[204:207], v[168:171], a[168:171], v[204:207]
    v_and_b32 v16, 0xffff0000, v16
    v_add_f32 v52, v52, v28
    v_mfma_f32_16x16x32_bf16 v[204:207], v[164:167], a[164:167], v[204:207]
    v_add_f32 v53, v53, v16
    v_lshlrev_b32 v28, 16, v17
    v_mfma_f32_16x16x32_bf16 v[204:207], v[160:163], a[160:163], v[204:207]
    s_waitcnt vmcnt(24) lgkmcnt(0)
    s_barrier
    buffer_load_dwordx4 v62, s[20:23], s54 offen lds
    v_mfma_f32_16x16x32_bf16 v[192:195], v[64:67], a[64:67], v[192:195]
    s_add_u32 s55, s76, 0x19c00
    v_and_b32 v17, 0xffff0000, v17
    v_add_f32 v54, v54, v28
    v_mfma_f32_16x16x32_bf16 v[192:195], v[68:71], a[68:71], v[192:195]
    s_nop 0
    ds_read_b64_tr_b16 v[160:161], v35 offset:0
    ds_read_b64_tr_b16 v[162:163], v35 offset:2048
    v_mfma_f32_16x16x32_bf16 v[192:195], v[72:75], a[72:75], v[192:195]
    v_add_f32 v55, v55, v17
    v_lshlrev_b32 v28, 16, v18
    v_mfma_f32_16x16x32_bf16 v[192:195], v[76:79], a[76:79], v[192:195]
    v_and_b32 v18, 0xffff0000, v18
    v_add_f32 v56, v56, v28
    v_mfma_f32_16x16x32_bf16 v[192:195], v[80:83], a[80:83], v[192:195]
    ds_read_b64_tr_b16 v[164:165], v35 offset:4096
    ds_read_b64_tr_b16 v[166:167], v35 offset:6144
    buffer_load_dwordx4 v62, s[20:23], s55 offen offset:1024 lds
    v_mfma_f32_16x16x32_bf16 v[192:195], v[84:87], a[84:87], v[192:195]
    s_add_u32 s56, s76, 0x1b800
    v_add_f32 v57, v57, v18
    v_lshlrev_b32 v28, 16, v19
    v_mfma_f32_16x16x32_bf16 v[192:195], v[88:91], a[88:91], v[192:195]
    v_and_b32 v19, 0xffff0000, v19
    v_add_f32 v58, v58, v28
    v_mfma_f32_16x16x32_bf16 v[192:195], v[92:95], a[92:95], v[192:195]
    ds_read_b64_tr_b16 v[168:169], v35 offset:8192
    ds_read_b64_tr_b16 v[170:171], v35 offset:10240
    v_mfma_f32_16x16x32_bf16 v[196:199], v[92:95], a[124:127], v[196:199]
    v_add_f32 v59, v59, v19
    v_lshlrev_b32 v28, 16, v20
    v_mfma_f32_16x16x32_bf16 v[196:199], v[88:91], a[120:123], v[196:199]
    buffer_load_dwordx4 v62, s[20:23], s56 offen offset:2048 lds
    v_mfma_f32_16x16x32_bf16 v[196:199], v[84:87], a[116:119], v[196:199]
    s_add_u32 s57, s76, 0x1d400
    ds_read_b64_tr_b16 v[172:173], v35 offset:12288
    ds_read_b64_tr_b16 v[174:175], v35 offset:14336
    v_mfma_f32_16x16x32_bf16 v[196:199], v[80:83], a[112:115], v[196:199]
    v_and_b32 v20, 0xffff0000, v20
    v_add_f32 v44, v44, v28
    v_mfma_f32_16x16x32_bf16 v[196:199], v[76:79], a[108:111], v[196:199]
    v_add_f32 v45, v45, v20
    v_lshlrev_b32 v28, 16, v21
    v_mfma_f32_16x16x32_bf16 v[196:199], v[72:75], a[104:107], v[196:199]
    ds_read_b64_tr_b16 v[176:177], v35 offset:16384
    ds_read_b64_tr_b16 v[178:179], v35 offset:18432
    v_mfma_f32_16x16x32_bf16 v[196:199], v[68:71], a[100:103], v[196:199]
    buffer_load_dwordx4 v62, s[20:23], s57 offen offset:3072 lds
    v_mfma_f32_16x16x32_bf16 v[196:199], v[64:67], a[96:99], v[196:199]
    s_add_u32 s76, s52, 6
    v_and_b32 v21, 0xffff0000, v21
    v_add_f32 v46, v46, v28
    v_mfma_f32_16x16x32_bf16 v[200:203], v[64:67], a[176:179], v[200:203]
    s_and_b32 s76, s76, 7
    ds_read_b64_tr_b16 v[180:181], v35 offset:20480
    ds_read_b64_tr_b16 v[182:183], v35 offset:22528
    v_mfma_f32_16x16x32_bf16 v[200:203], v[68:71], a[180:183], v[200:203]
    s_lshl_b32 s76, s76, 7
    v_add_f32 v47, v47, v21
    v_lshlrev_b32 v28, 16, v22
    v_mfma_f32_16x16x32_bf16 v[200:203], v[72:75], a[184:187], v[200:203]
    s_add_u32 s54, s76, 0x0
    v_and_b32 v22, 0xffff0000, v22
    v_add_f32 v48, v48, v28
    v_mfma_f32_16x16x32_bf16 v[200:203], v[76:79], a[188:191], v[200:203]
    s_add_u32 m0, s63, 0x10000
    ds_read_b64_tr_b16 v[184:185], v35 offset:24576
    ds_read_b64_tr_b16 v[186:187], v35 offset:26624
    buffer_load_dwordx4 v62, s[20:23], s54 offen lds
    v_mfma_f32_16x16x32_bf16 v[200:203], v[80:83], a[192:195], v[200:203]
    s_add_u32 s55, s76, 0x1c00
    v_add_f32 v49, v49, v22
    v_lshlrev_b32 v28, 16, v23
    v_mfma_f32_16x16x32_bf16 v[200:203], v[84:87], a[196:199], v[200:203]
    s_add_u32 s93, s52, 3
    v_and_b32 v23, 0xffff0000, v23
    v_add_f32 v50, v50, v28
    v_mfma_f32_16x16x32_bf16 v[200:203], v[88:91], a[200:203], v[200:203]
    s_and_b32 s93, s93, 7
    ds_read_b64_tr_b16 v[188:189], v35 offset:28672
    ds_read_b64_tr_b16 v[190:191], v35 offset:30720
    v_mfma_f32_16x16x32_bf16 v[200:203], v[92:95], a[204:207], v[200:203]
    s_lshl_b32 s93, s93, 17
    v_add_f32 v51, v51, v23
    v_lshlrev_b32 v28, 16, v24
    v_mfma_f32_16x16x32_bf16 v[204:207], v[92:95], a[236:239], v[204:207]
    buffer_load_dwordx4 v62, s[20:23], s55 offen offset:1024 lds
    v_mfma_f32_16x16x32_bf16 v[204:207], v[88:91], a[232:235], v[204:207]
    s_add_u32 s56, s76, 0x3800
    v_and_b32 v24, 0xffff0000, v24
    v_add_f32 v52, v52, v28
    v_mfma_f32_16x16x32_bf16 v[204:207], v[84:87], a[228:231], v[204:207]
    s_add_u32 s24, s93, s94
    v_add_f32 v53, v53, v24
    v_lshlrev_b32 v28, 16, v25
    v_mfma_f32_16x16x32_bf16 v[204:207], v[80:83], a[224:227], v[204:207]
    s_add_u32 s25, s24, 0x100000
    v_and_b32 v25, 0xffff0000, v25
    v_add_f32 v54, v54, v28
    v_mfma_f32_16x16x32_bf16 v[204:207], v[76:79], a[220:223], v[204:207]
    s_add_u32 s94, s94, 0x200000
    v_cvt_pk_bf16_f32 v128, v192, v193
    v_cvt_pk_bf16_f32 v129, v194, v195
    v_mfma_f32_16x16x32_bf16 v[204:207], v[72:75], a[216:219], v[204:207]
    buffer_load_dwordx4 v62, s[20:23], s56 offen offset:2048 lds
    v_mfma_f32_16x16x32_bf16 v[204:207], v[68:71], a[212:215], v[204:207]
    s_add_u32 s57, s76, 0x5400
    v_min_u32 v128, -2, v128
    v_min_u32 v129, -2, v129
    v_mfma_f32_16x16x32_bf16 v[204:207], v[64:67], a[208:211], v[204:207]
    s_waitcnt vmcnt(23) lgkmcnt(0)
    s_barrier
    v_cvt_pk_bf16_f32 v130, v196, v197
    v_mfma_f32_16x16x32_bf16 v[208:211], v[160:163], a[0:3], 0
    v_cvt_pk_bf16_f32 v131, v198, v199
    v_min_u32 v130, -2, v130
    v_mfma_f32_16x16x32_bf16 v[208:211], v[164:167], a[4:7], v[208:211]
    ds_read_b64_tr_b16 v[64:65], v60 offset:8192
    ds_read_b64_tr_b16 v[66:67], v60 offset:10240
    v_mfma_f32_16x16x32_bf16 v[208:211], v[168:171], a[8:11], v[208:211]
    buffer_load_dwordx4 v62, s[20:23], s57 offen offset:3072 lds
    v_mfma_f32_16x16x32_bf16 v[208:211], v[172:175], a[12:15], v[208:211]
    s_add_u32 s54, s76, 0x8000
    v_min_u32 v131, -2, v131
    v_add_f32 v55, v55, v25
    v_mfma_f32_16x16x32_bf16 v[208:211], v[176:179], a[16:19], v[208:211]
    s_add_u32 m0, s63, 0x11000
    ds_read_b64_tr_b16 v[68:69], v60 offset:12288
    ds_read_b64_tr_b16 v[70:71], v60 offset:14336
    v_mfma_f32_16x16x32_bf16 v[208:211], v[180:183], a[20:23], v[208:211]
    v_cvt_pk_bf16_f32 v132, v200, v201
    v_cvt_pk_bf16_f32 v133, v202, v203
    v_mfma_f32_16x16x32_bf16 v[208:211], v[184:187], a[24:27], v[208:211]
    v_min_u32 v132, -2, v132
    v_min_u32 v133, -2, v133
    v_mfma_f32_16x16x32_bf16 v[208:211], v[188:191], a[28:31], v[208:211]
    ds_read_b64_tr_b16 v[72:73], v60 offset:24576
    ds_read_b64_tr_b16 v[74:75], v60 offset:26624
    buffer_load_dwordx4 v62, s[20:23], s54 offen lds
    v_mfma_f32_16x16x32_bf16 v[212:215], v[188:191], a[60:63], 0
    s_add_u32 s55, s76, 0x9c00
    v_cvt_pk_bf16_f32 v134, v204, v205
    v_cvt_pk_bf16_f32 v135, v206, v207
    v_mfma_f32_16x16x32_bf16 v[212:215], v[184:187], a[56:59], v[212:215]
    v_min_u32 v134, -2, v134
    v_min_u32 v135, -2, v135
    v_mfma_f32_16x16x32_bf16 v[212:215], v[180:183], a[52:55], v[212:215]
    ds_read_b64_tr_b16 v[76:77], v60 offset:28672
    ds_read_b64_tr_b16 v[78:79], v60 offset:30720
    v_mfma_f32_16x16x32_bf16 v[212:215], v[176:179], a[48:51], v[212:215]
    v_lshlrev_b32 v28, 16, v26
    v_and_b32 v26, 0xffff0000, v26
    v_mfma_f32_16x16x32_bf16 v[212:215], v[172:175], a[44:47], v[212:215]
    buffer_load_dwordx4 v62, s[20:23], s55 offen offset:1024 lds
    v_mfma_f32_16x16x32_bf16 v[212:215], v[168:171], a[40:43], v[212:215]
    s_add_u32 s56, s76, 0xb800
    ds_read_b64_tr_b16 v[80:81], v60 offset:40960
    ds_read_b64_tr_b16 v[82:83], v60 offset:43008
    s_add_u32 s88, s84, 0x0
    v_mfma_f32_16x16x32_bf16 v[212:215], v[164:167], a[36:39], v[212:215]
    buffer_load_dwordx4 v[96:99], v15, s[32:35], s88 offen sc1
    s_add_u32 s89, s84, 0x100000
    v_mfma_f32_16x16x32_bf16 v[212:215], v[160:163], a[32:35], v[212:215]
    buffer_load_dwordx4 v[100:103], v15, s[32:35], s89 offen sc1
    v_mfma_f32_16x16x32_bf16 v[216:219], v[160:163], a[128:131], 0
    s_nop 0
    ds_read_b64_tr_b16 v[84:85], v60 offset:45056
    ds_read_b64_tr_b16 v[86:87], v60 offset:47104
    buffer_store_dwordx4 v[128:131], v15, s[32:35], s24 offen sc1
    v_mfma_f32_16x16x32_bf16 v[216:219], v[164:167], a[132:135], v[216:219]
    buffer_load_dwordx4 v62, s[20:23], s56 offen offset:2048 lds
    v_mfma_f32_16x16x32_bf16 v[216:219], v[168:171], a[136:139], v[216:219]
    s_add_u32 s57, s76, 0xd400
    buffer_store_dwordx4 v[132:135], v15, s[32:35], s25 offen sc1
    v_mfma_f32_16x16x32_bf16 v[216:219], v[172:175], a[140:143], v[216:219]
    s_nop 0
    ds_read_b64_tr_b16 v[88:89], v60 offset:57344
    ds_read_b64_tr_b16 v[90:91], v60 offset:59392
    v_mfma_f32_16x16x32_bf16 v[216:219], v[176:179], a[144:147], v[216:219]
    v_add_f32 v56, v56, v28
    v_add_f32 v57, v57, v26
    v_mfma_f32_16x16x32_bf16 v[216:219], v[180:183], a[148:151], v[216:219]
    v_lshlrev_b32 v28, 16, v27
    v_and_b32 v27, 0xffff0000, v27
    v_mfma_f32_16x16x32_bf16 v[216:219], v[184:187], a[152:155], v[216:219]
    ds_read_b64_tr_b16 v[92:93], v60 offset:61440
    ds_read_b64_tr_b16 v[94:95], v60 offset:63488
    buffer_load_dwordx4 v62, s[20:23], s57 offen offset:3072 lds
    v_mfma_f32_16x16x32_bf16 v[216:219], v[188:191], a[156:159], v[216:219]
    s_add_u32 s76, s52, 6
    v_add_f32 v58, v58, v28
    v_add_f32 v59, v59, v27
    v_mfma_f32_16x16x32_bf16 v[220:223], v[188:191], a[252:255], 0
    s_and_b32 s76, s76, 7
    v_mul_f32 v36, 0xc13504f3, v44
    v_mul_f32 v37, 0xc13504f3, v45
    v_mfma_f32_16x16x32_bf16 v[220:223], v[184:187], a[248:251], v[220:223]
    s_lshl_b32 s76, s76, 7
    v_mul_f32 v38, 0xc13504f3, v46
    v_mul_f32 v39, 0xc13504f3, v47
    v_mfma_f32_16x16x32_bf16 v[220:223], v[180:183], a[244:247], v[220:223]
    s_add_u32 s54, s76, 0x10000
    v_exp_f32 v36, v36
    v_mfma_f32_16x16x32_bf16 v[220:223], v[176:179], a[240:243], v[220:223]
    s_add_u32 m0, s77, 0x20000
    s_nop 0
    buffer_load_dwordx4 v62, s[20:23], s54 offen lds
    v_mfma_f32_16x16x32_bf16 v[220:223], v[172:175], a[172:175], v[220:223]
    s_add_u32 s55, s76, 0x11c00
    v_exp_f32 v37, v37
    v_mfma_f32_16x16x32_bf16 v[220:223], v[168:171], a[168:171], v[220:223]
    v_exp_f32 v38, v38
    v_mfma_f32_16x16x32_bf16 v[220:223], v[164:167], a[164:167], v[220:223]
    v_exp_f32 v39, v39
    v_mfma_f32_16x16x32_bf16 v[220:223], v[160:163], a[160:163], v[220:223]
    s_waitcnt vmcnt(22) lgkmcnt(0)
    s_barrier
    v_fma_f32 v36, v36, s70, s70
    v_mfma_f32_16x16x32_bf16 v[208:211], v[64:67], a[64:67], v[208:211]
    buffer_load_dwordx4 v62, s[20:23], s55 offen offset:1024 lds
    v_mfma_f32_16x16x32_bf16 v[208:211], v[68:71], a[68:71], v[208:211]
    s_add_u32 s56, s76, 0x13800
    ds_read_b64_tr_b16 v[160:161], v61 offset:8192
    ds_read_b64_tr_b16 v[162:163], v61 offset:10240
    v_mfma_f32_16x16x32_bf16 v[208:211], v[72:75], a[72:75], v[208:211]
    v_fma_f32 v37, v37, s70, s70
    v_fma_f32 v38, v38, s70, s70
    v_mfma_f32_16x16x32_bf16 v[208:211], v[76:79], a[76:79], v[208:211]
    v_fma_f32 v39, v39, s70, s70
    v_mfma_f32_16x16x32_bf16 v[208:211], v[80:83], a[80:83], v[208:211]
    s_nop 0
    ds_read_b64_tr_b16 v[164:165], v61 offset:12288
    ds_read_b64_tr_b16 v[166:167], v61 offset:14336
    v_mfma_f32_16x16x32_bf16 v[208:211], v[84:87], a[84:87], v[208:211]
    buffer_load_dwordx4 v62, s[20:23], s56 offen offset:2048 lds
    v_mfma_f32_16x16x32_bf16 v[208:211], v[88:91], a[88:91], v[208:211]
    s_add_u32 s57, s76, 0x15400
    v_rcp_f32 v36, v36
    v_mfma_f32_16x16x32_bf16 v[208:211], v[92:95], a[92:95], v[208:211]
    s_nop 0
    ds_read_b64_tr_b16 v[168:169], v61 offset:24576
    ds_read_b64_tr_b16 v[170:171], v61 offset:26624
    v_mfma_f32_16x16x32_bf16 v[212:215], v[92:95], a[124:127], v[212:215]
    v_rcp_f32 v37, v37
    v_mfma_f32_16x16x32_bf16 v[212:215], v[88:91], a[120:123], v[212:215]
    v_rcp_f32 v38, v38
    v_mfma_f32_16x16x32_bf16 v[212:215], v[84:87], a[116:119], v[212:215]
    ds_read_b64_tr_b16 v[172:173], v61 offset:28672
    ds_read_b64_tr_b16 v[174:175], v61 offset:30720
    buffer_load_dwordx4 v62, s[20:23], s57 offen offset:3072 lds
    v_mfma_f32_16x16x32_bf16 v[212:215], v[80:83], a[112:115], v[212:215]
    s_add_u32 s54, s76, 0x18000
    v_rcp_f32 v39, v39
    v_mfma_f32_16x16x32_bf16 v[212:215], v[76:79], a[108:111], v[212:215]
    s_add_u32 m0, s77, 0x21000
    v_mul_f32 v44, v44, v36
    v_mul_f32 v45, v45, v37
    v_mfma_f32_16x16x32_bf16 v[212:215], v[72:75], a[104:107], v[212:215]
    s_nop 0
    ds_read_b64_tr_b16 v[176:177], v61 offset:40960
    ds_read_b64_tr_b16 v[178:179], v61 offset:43008
    v_mfma_f32_16x16x32_bf16 v[212:215], v[68:71], a[100:103], v[212:215]
    v_mul_f32 v46, v46, v38
    v_mul_f32 v47, v47, v39
    v_mfma_f32_16x16x32_bf16 v[212:215], v[64:67], a[96:99], v[212:215]
    buffer_load_dwordx4 v62, s[20:23], s54 offen lds
    v_mfma_f32_16x16x32_bf16 v[216:219], v[64:67], a[176:179], v[216:219]
    s_add_u32 s55, s76, 0x19c00
    ds_read_b64_tr_b16 v[180:181], v61 offset:45056
    ds_read_b64_tr_b16 v[182:183], v61 offset:47104
    v_mfma_f32_16x16x32_bf16 v[216:219], v[68:71], a[180:183], v[216:219]
    v_mul_f32 v36, 0xc13504f3, v48
    v_mul_f32 v37, 0xc13504f3, v49
    v_mfma_f32_16x16x32_bf16 v[216:219], v[72:75], a[184:187], v[216:219]
    v_mul_f32 v38, 0xc13504f3, v50
    v_mul_f32 v39, 0xc13504f3, v51
    v_mfma_f32_16x16x32_bf16 v[216:219], v[76:79], a[188:191], v[216:219]
    ds_read_b64_tr_b16 v[184:185], v61 offset:57344
    ds_read_b64_tr_b16 v[186:187], v61 offset:59392
    v_mfma_f32_16x16x32_bf16 v[216:219], v[80:83], a[192:195], v[216:219]
    buffer_load_dwordx4 v62, s[20:23], s55 offen offset:1024 lds
    v_mfma_f32_16x16x32_bf16 v[216:219], v[84:87], a[196:199], v[216:219]
    s_add_u32 s56, s76, 0x1b800
    v_exp_f32 v36, v36
    v_mfma_f32_16x16x32_bf16 v[216:219], v[88:91], a[200:203], v[216:219]
    s_add_u32 s93, s52, 4
    ds_read_b64_tr_b16 v[188:189], v61 offset:61440
    ds_read_b64_tr_b16 v[190:191], v61 offset:63488
    v_mfma_f32_16x16x32_bf16 v[216:219], v[92:95], a[204:207], v[216:219]
    s_and_b32 s93, s93, 7
    v_exp_f32 v37, v37
    v_mfma_f32_16x16x32_bf16 v[220:223], v[92:95], a[236:239], v[220:223]
    s_lshl_b32 s93, s93, 17
    v_exp_f32 v38, v38
    v_mfma_f32_16x16x32_bf16 v[220:223], v[88:91], a[232:235], v[220:223]
    buffer_load_dwordx4 v62, s[20:23], s56 offen offset:2048 lds
    v_mfma_f32_16x16x32_bf16 v[220:223], v[84:87], a[228:231], v[220:223]
    s_add_u32 s57, s76, 0x1d400
    v_exp_f32 v39, v39
    v_mfma_f32_16x16x32_bf16 v[220:223], v[80:83], a[224:227], v[220:223]
    s_add_u32 s26, s93, s94
    v_fma_f32 v36, v36, s70, s70
    v_fma_f32 v37, v37, s70, s70
    v_mfma_f32_16x16x32_bf16 v[220:223], v[76:79], a[220:223], v[220:223]
    s_add_u32 s27, s26, 0x100000
    v_fma_f32 v38, v38, s70, s70
    v_fma_f32 v39, v39, s70, s70
    v_mfma_f32_16x16x32_bf16 v[220:223], v[72:75], a[216:219], v[220:223]
    s_add_u32 s94, s94, 0x200000
    v_cvt_pk_bf16_f32 v136, v208, v209
    v_cvt_pk_bf16_f32 v137, v210, v211
    v_mfma_f32_16x16x32_bf16 v[220:223], v[68:71], a[212:215], v[220:223]
    buffer_load_dwordx4 v62, s[20:23], s57 offen offset:3072 lds
    v_mfma_f32_16x16x32_bf16 v[220:223], v[64:67], a[208:211], v[220:223]
    s_waitcnt vmcnt(20) lgkmcnt(0)
    s_barrier
    v_min_u32 v136, -2, v136
    v_mfma_f32_16x16x32_bf16 v[192:195], v[160:163], a[0:3], 0
    s_add_u32 s76, s52, 7
    v_min_u32 v137, -2, v137
    v_cvt_pk_bf16_f32 v138, v212, v213
    v_mfma_f32_16x16x32_bf16 v[192:195], v[164:167], a[4:7], v[192:195]
    s_and_b32 s76, s76, 7
    ds_read_b64_tr_b16 v[64:65], v60 offset:0
    ds_read_b64_tr_b16 v[66:67], v60 offset:2048
    v_mfma_f32_16x16x32_bf16 v[192:195], v[168:171], a[8:11], v[192:195]
    s_lshl_b32 s76, s76, 7
    v_cvt_pk_bf16_f32 v139, v214, v215
    v_min_u32 v138, -2, v138
    v_mfma_f32_16x16x32_bf16 v[192:195], v[172:175], a[12:15], v[192:195]
    s_add_u32 s54, s76, 0x0
    v_min_u32 v139, -2, v139
    v_mfma_f32_16x16x32_bf16 v[192:195], v[176:179], a[16:19], v[192:195]
    s_add_u32 m0, s63, 0x2000
    ds_read_b64_tr_b16 v[68:69], v60 offset:4096
    ds_read_b64_tr_b16 v[70:71], v60 offset:6144
    buffer_load_dwordx4 v62, s[20:23], s54 offen lds
    v_mfma_f32_16x16x32_bf16 v[192:195], v[180:183], a[20:23], v[192:195]
    s_add_u32 s55, s76, 0x1c00
    v_cvt_pk_bf16_f32 v140, v216, v217
    v_cvt_pk_bf16_f32 v141, v218, v219
    v_mfma_f32_16x16x32_bf16 v[192:195], v[184:187], a[24:27], v[192:195]
    v_min_u32 v140, -2, v140
    v_min_u32 v141, -2, v141
    v_mfma_f32_16x16x32_bf16 v[192:195], v[188:191], a[28:31], v[192:195]
    ds_read_b64_tr_b16 v[72:73], v60 offset:16384
    ds_read_b64_tr_b16 v[74:75], v60 offset:18432
    v_mfma_f32_16x16x32_bf16 v[196:199], v[188:191], a[60:63], 0
    v_cvt_pk_bf16_f32 v142, v220, v221
    v_cvt_pk_bf16_f32 v143, v222, v223
    v_mfma_f32_16x16x32_bf16 v[196:199], v[184:187], a[56:59], v[196:199]
    buffer_load_dwordx4 v62, s[20:23], s55 offen offset:1024 lds
    v_mfma_f32_16x16x32_bf16 v[196:199], v[180:183], a[52:55], v[196:199]
    s_add_u32 s56, s76, 0x3800
    ds_read_b64_tr_b16 v[76:77], v60 offset:20480
    ds_read_b64_tr_b16 v[78:79], v60 offset:22528
    v_mfma_f32_16x16x32_bf16 v[196:199], v[176:179], a[48:51], v[196:199]
    v_min_u32 v142, -2, v142
    v_min_u32 v143, -2, v143
    v_mfma_f32_16x16x32_bf16 v[196:199], v[172:175], a[44:47], v[196:199]
    v_rcp_f32 v36, v36
    v_mfma_f32_16x16x32_bf16 v[196:199], v[168:171], a[40:43], v[196:199]
    ds_read_b64_tr_b16 v[80:81], v60 offset:32768
    ds_read_b64_tr_b16 v[82:83], v60 offset:34816
    s_add_u32 s88, s84, 0x200000
    v_mfma_f32_16x16x32_bf16 v[196:199], v[164:167], a[36:39], v[196:199]
    buffer_load_dwordx4 v62, s[20:23], s56 offen offset:2048 lds
    v_mfma_f32_16x16x32_bf16 v[196:199], v[160:163], a[32:35], v[196:199]
    s_add_u32 s57, s76, 0x5400
    buffer_load_dwordx4 v[104:107], v15, s[32:35], s88 offen sc1
    s_add_u32 s89, s84, 0x300000
    v_mfma_f32_16x16x32_bf16 v[200:203], v[160:163], a[128:131], 0
    s_nop 0
    ds_read_b64_tr_b16 v[84:85], v60 offset:36864
    ds_read_b64_tr_b16 v[86:87], v60 offset:38912
    buffer_load_dwordx4 v[108:111], v15, s[32:35], s89 offen sc1
    v_mfma_f32_16x16x32_bf16 v[200:203], v[164:167], a[132:135], v[200:203]
    buffer_store_dwordx4 v[136:139], v15, s[32:35], s26 offen sc1
    v_mfma_f32_16x16x32_bf16 v[200:203], v[168:171], a[136:139], v[200:203]
    buffer_store_dwordx4 v[140:143], v15, s[32:35], s27 offen sc1
    v_mfma_f32_16x16x32_bf16 v[200:203], v[172:175], a[140:143], v[200:203]
    s_nop 0
    ds_read_b64_tr_b16 v[88:89], v60 offset:49152
    ds_read_b64_tr_b16 v[90:91], v60 offset:51200
    buffer_load_dwordx4 v62, s[20:23], s57 offen offset:3072 lds
    v_mfma_f32_16x16x32_bf16 v[200:203], v[176:179], a[144:147], v[200:203]
    s_add_u32 s54, s76, 0x8000
    v_rcp_f32 v37, v37
    v_mfma_f32_16x16x32_bf16 v[200:203], v[180:183], a[148:151], v[200:203]
    s_add_u32 m0, s63, 0x3000
    v_rcp_f32 v38, v38
    v_mfma_f32_16x16x32_bf16 v[200:203], v[184:187], a[152:155], v[200:203]
    s_nop 0
    ds_read_b64_tr_b16 v[92:93], v60 offset:53248
    ds_read_b64_tr_b16 v[94:95], v60 offset:55296
    v_mfma_f32_16x16x32_bf16 v[200:203], v[188:191], a[156:159], v[200:203]
    v_rcp_f32 v39, v39
    v_mfma_f32_16x16x32_bf16 v[204:207], v[188:191], a[252:255], 0
    buffer_load_dwordx4 v62, s[20:23], s54 offen lds
    v_mfma_f32_16x16x32_bf16 v[204:207], v[184:187], a[248:251], v[204:207]
    s_add_u32 s55, s76, 0x9c00
    v_mul_f32 v48, v48, v36
    v_mul_f32 v49, v49, v37
    v_mfma_f32_16x16x32_bf16 v[204:207], v[180:183], a[244:247], v[204:207]
    v_mul_f32 v50, v50, v38
    v_mul_f32 v51, v51, v39
    v_mfma_f32_16x16x32_bf16 v[204:207], v[176:179], a[240:243], v[204:207]
    v_mul_f32 v36, 0xc13504f3, v52
    v_mul_f32 v37, 0xc13504f3, v53
    v_mfma_f32_16x16x32_bf16 v[204:207], v[172:175], a[172:175], v[204:207]
    v_mul_f32 v38, 0xc13504f3, v54
    v_mul_f32 v39, 0xc13504f3, v55
    v_mfma_f32_16x16x32_bf16 v[204:207], v[168:171], a[168:171], v[204:207]
    buffer_load_dwordx4 v62, s[20:23], s55 offen offset:1024 lds
    v_mfma_f32_16x16x32_bf16 v[204:207], v[164:167], a[164:167], v[204:207]
    s_add_u32 s56, s76, 0xb800
    v_exp_f32 v36, v36
    v_mfma_f32_16x16x32_bf16 v[204:207], v[160:163], a[160:163], v[204:207]
    s_waitcnt vmcnt(18) lgkmcnt(0)
    s_barrier
    v_mfma_f32_16x16x32_bf16 v[192:195], v[64:67], a[64:67], v[192:195]
    v_exp_f32 v37, v37
    v_mfma_f32_16x16x32_bf16 v[192:195], v[68:71], a[68:71], v[192:195]
    ds_read_b64_tr_b16 v[160:161], v61 offset:0
    ds_read_b64_tr_b16 v[162:163], v61 offset:2048
    v_mfma_f32_16x16x32_bf16 v[192:195], v[72:75], a[72:75], v[192:195]
    buffer_load_dwordx4 v62, s[20:23], s56 offen offset:2048 lds
    v_mfma_f32_16x16x32_bf16 v[192:195], v[76:79], a[76:79], v[192:195]
    s_add_u32 s57, s76, 0xd400
    v_exp_f32 v38, v38
    v_mfma_f32_16x16x32_bf16 v[192:195], v[80:83], a[80:83], v[192:195]
    s_nop 0
    ds_read_b64_tr_b16 v[164:165], v61 offset:4096
    ds_read_b64_tr_b16 v[166:167], v61 offset:6144
    v_mfma_f32_16x16x32_bf16 v[192:195], v[84:87], a[84:87], v[192:195]
    v_exp_f32 v39, v39
    v_mfma_f32_16x16x32_bf16 v[192:195], v[88:91], a[88:91], v[192:195]
    v_fma_f32 v36, v36, s70, s70
    v_fma_f32 v37, v37, s70, s70
    v_mfma_f32_16x16x32_bf16 v[192:195], v[92:95], a[92:95], v[192:195]
    ds_read_b64_tr_b16 v[168:169], v61 offset:16384
    ds_read_b64_tr_b16 v[170:171], v61 offset:18432
    buffer_load_dwordx4 v62, s[20:23], s57 offen offset:3072 lds
    v_mfma_f32_16x16x32_bf16 v[196:199], v[92:95], a[124:127], v[196:199]
    s_add_u32 s76, s52, 7
    v_fma_f32 v38, v38, s70, s70
    v_fma_f32 v39, v39, s70, s70
    v_mfma_f32_16x16x32_bf16 v[196:199], v[88:91], a[120:123], v[196:199]
    s_and_b32 s76, s76, 7
    v_rcp_f32 v36, v36
    v_mfma_f32_16x16x32_bf16 v[196:199], v[84:87], a[116:119], v[196:199]
    s_lshl_b32 s76, s76, 7
    ds_read_b64_tr_b16 v[172:173], v61 offset:20480
    ds_read_b64_tr_b16 v[174:175], v61 offset:22528
    v_mfma_f32_16x16x32_bf16 v[196:199], v[80:83], a[112:115], v[196:199]
    s_add_u32 s54, s76, 0x10000
    v_rcp_f32 v37, v37
    v_mfma_f32_16x16x32_bf16 v[196:199], v[76:79], a[108:111], v[196:199]
    s_add_u32 m0, s63, 0x12000
    s_nop 0
    buffer_load_dwordx4 v62, s[20:23], s54 offen lds
    v_mfma_f32_16x16x32_bf16 v[196:199], v[72:75], a[104:107], v[196:199]
    s_add_u32 s55, s76, 0x11c00
    ds_read_b64_tr_b16 v[176:177], v61 offset:32768
    ds_read_b64_tr_b16 v[178:179], v61 offset:34816
    v_mfma_f32_16x16x32_bf16 v[196:199], v[68:71], a[100:103], v[196:199]
    v_rcp_f32 v38, v38
    v_mfma_f32_16x16x32_bf16 v[196:199], v[64:67], a[96:99], v[196:199]
    v_rcp_f32 v39, v39
    v_mfma_f32_16x16x32_bf16 v[200:203], v[64:67], a[176:179], v[200:203]
    ds_read_b64_tr_b16 v[180:181], v61 offset:36864
    ds_read_b64_tr_b16 v[182:183], v61 offset:38912
    v_mfma_f32_16x16x32_bf16 v[200:203], v[68:71], a[180:183], v[200:203]
    buffer_load_dwordx4 v62, s[20:23], s55 offen offset:1024 lds
    v_mfma_f32_16x16x32_bf16 v[200:203], v[72:75], a[184:187], v[200:203]
    s_add_u32 s56, s76, 0x13800
    v_mul_f32 v52, v52, v36
    v_mul_f32 v53, v53, v37
    v_mfma_f32_16x16x32_bf16 v[200:203], v[76:79], a[188:191], v[200:203]
    s_nop 0
    ds_read_b64_tr_b16 v[184:185], v61 offset:49152
    ds_read_b64_tr_b16 v[186:187], v61 offset:51200
    v_mfma_f32_16x16x32_bf16 v[200:203], v[80:83], a[192:195], v[200:203]
    s_add_u32 s93, s52, 5
    v_mul_f32 v54, v54, v38
    v_mul_f32 v55, v55, v39
    v_mfma_f32_16x16x32_bf16 v[200:203], v[84:87], a[196:199], v[200:203]
    s_and_b32 s93, s93, 7
    v_mul_f32 v36, 0xc13504f3, v56
    v_mul_f32 v37, 0xc13504f3, v57
    v_mfma_f32_16x16x32_bf16 v[200:203], v[88:91], a[200:203], v[200:203]
    s_lshl_b32 s93, s93, 17
    ds_read_b64_tr_b16 v[188:189], v61 offset:53248
    ds_read_b64_tr_b16 v[190:191], v61 offset:55296
    buffer_load_dwordx4 v62, s[20:23], s56 offen offset:2048 lds
    v_mfma_f32_16x16x32_bf16 v[200:203], v[92:95], a[204:207], v[200:203]
    s_add_u32 s57, s76, 0x15400
    v_mul_f32 v38, 0xc13504f3, v58
    v_mul_f32 v39, 0xc13504f3, v59
    v_mfma_f32_16x16x32_bf16 v[204:207], v[92:95], a[236:239], v[204:207]
    s_add_u32 s24, s93, s94
    v_exp_f32 v36, v36
    v_mfma_f32_16x16x32_bf16 v[204:207], v[88:91], a[232:235], v[204:207]
    s_add_u32 s25, s24, 0x100000
    v_exp_f32 v37, v37
    v_mfma_f32_16x16x32_bf16 v[204:207], v[84:87], a[228:231], v[204:207]
    s_add_u32 s94, s94, 0x200000
    v_cvt_pk_bf16_f32 v128, v192, v193
    v_cvt_pk_bf16_f32 v129, v194, v195
    v_mfma_f32_16x16x32_bf16 v[204:207], v[80:83], a[224:227], v[204:207]
    buffer_load_dwordx4 v62, s[20:23], s57 offen offset:3072 lds
    v_mfma_f32_16x16x32_bf16 v[204:207], v[76:79], a[220:223], v[204:207]
    s_add_u32 s54, s76, 0x18000
    v_min_u32 v128, -2, v128
    v_min_u32 v129, -2, v129
    v_mfma_f32_16x16x32_bf16 v[204:207], v[72:75], a[216:219], v[204:207]
    s_add_u32 m0, s63, 0x13000
    v_cvt_pk_bf16_f32 v130, v196, v197
    v_cvt_pk_bf16_f32 v131, v198, v199
    v_mfma_f32_16x16x32_bf16 v[204:207], v[68:71], a[212:215], v[204:207]
    v_min_u32 v130, -2, v130
    v_min_u32 v131, -2, v131
    v_mfma_f32_16x16x32_bf16 v[204:207], v[64:67], a[208:211], v[204:207]
    s_waitcnt vmcnt(16) lgkmcnt(0)
    s_barrier
    v_mfma_f32_16x16x32_bf16 v[208:211], v[160:163], a[0:3], 0
    buffer_load_dwordx4 v62, s[20:23], s54 offen lds
    v_mfma_f32_16x16x32_bf16 v[208:211], v[164:167], a[4:7], v[208:211]
    s_add_u32 s55, s76, 0x19c00
    ds_read_b64_tr_b16 v[64:65], v35 offset:0
    ds_read_b64_tr_b16 v[66:67], v35 offset:2048
    v_mfma_f32_16x16x32_bf16 v[208:211], v[168:171], a[8:11], v[208:211]
L_PAD11:
    s_cbranch_execz L_PADX
    v_exp_f32 v38, v38
    v_mfma_f32_16x16x32_bf16 v[208:211], v[172:175], a[12:15], v[208:211]
    v_exp_f32 v39, v39
    v_mfma_f32_16x16x32_bf16 v[208:211], v[176:179], a[16:19], v[208:211]
    ds_read_b64_tr_b16 v[68:69], v35 offset:4096
    ds_read_b64_tr_b16 v[70:71], v35 offset:6144
    v_mfma_f32_16x16x32_bf16 v[208:211], v[180:183], a[20:23], v[208:211]
    buffer_load_dwordx4 v62, s[20:23], s55 offen offset:1024 lds
    v_mfma_f32_16x16x32_bf16 v[208:211], v[184:187], a[24:27], v[208:211]
    s_add_u32 s56, s76, 0x1b800
    v_cvt_pk_bf16_f32 v132, v200, v201
    v_cvt_pk_bf16_f32 v133, v202, v203
    v_mfma_f32_16x16x32_bf16 v[208:211], v[188:191], a[28:31], v[208:211]
    s_nop 0
    ds_read_b64_tr_b16 v[72:73], v35 offset:8192
    ds_read_b64_tr_b16 v[74:75], v35 offset:10240
    v_mfma_f32_16x16x32_bf16 v[212:215], v[188:191], a[60:63], 0
    v_min_u32 v132, -2, v132
    v_min_u32 v133, -2, v133
    v_mfma_f32_16x16x32_bf16 v[212:215], v[184:187], a[56:59], v[212:215]
    v_cvt_pk_bf16_f32 v134, v204, v205
    v_cvt_pk_bf16_f32 v135, v206, v207
    v_mfma_f32_16x16x32_bf16 v[212:215], v[180:183], a[52:55], v[212:215]
    ds_read_b64_tr_b16 v[76:77], v35 offset:12288
    ds_read_b64_tr_b16 v[78:79], v35 offset:14336
    buffer_load_dwordx4 v62, s[20:23], s56 offen offset:2048 lds
    v_mfma_f32_16x16x32_bf16 v[212:215], v[176:179], a[48:51], v[212:215]
    s_add_u32 s57, s76, 0x1d400
    v_min_u32 v134, -2, v134
    v_min_u32 v135, -2, v135
    v_mfma_f32_16x16x32_bf16 v[212:215], v[172:175], a[44:47], v[212:215]
    v_fma_f32 v36, v36, s70, s70
    v_fma_f32 v37, v37, s70, s70
    v_mfma_f32_16x16x32_bf16 v[212:215], v[168:171], a[40:43], v[212:215]
    ds_read_b64_tr_b16 v[80:81], v35 offset:16384
    ds_read_b64_tr_b16 v[82:83], v35 offset:18432
    s_add_u32 s88, s84, 0x400000
    v_mfma_f32_16x16x32_bf16 v[212:215], v[164:167], a[36:39], v[212:215]
    buffer_load_dwordx4 v[112:115], v15, s[32:35], s88 offen sc1
    s_add_u32 s89, s84, 0x500000
    v_mfma_f32_16x16x32_bf16 v[212:215], v[160:163], a[32:35], v[212:215]
    buffer_load_dwordx4 v62, s[20:23], s57 offen offset:3072 lds
    v_mfma_f32_16x16x32_bf16 v[216:219], v[160:163], a[128:131], 0
    s_add_u32 s76, s52, 8
    ds_read_b64_tr_b16 v[84:85], v35 offset:20480
    ds_read_b64_tr_b16 v[86:87], v35 offset:22528
    buffer_load_dwordx4 v[116:119], v15, s[32:35], s89 offen sc1
    v_mfma_f32_16x16x32_bf16 v[216:219], v[164:167], a[132:135], v[216:219]
    s_and_b32 s76, s76, 7
    buffer_store_dwordx4 v[128:131], v15, s[32:35], s24 offen sc1
    v_mfma_f32_16x16x32_bf16 v[216:219], v[168:171], a[136:139], v[216:219]
    s_lshl_b32 s76, s76, 7
    buffer_store_dwordx4 v[132:135], v15, s[32:35], s25 offen sc1
    v_mfma_f32_16x16x32_bf16 v[216:219], v[172:175], a[140:143], v[216:219]
    s_add_u32 s54, s76, 0x0
    ds_read_b64_tr_b16 v[88:89], v35 offset:24576
    ds_read_b64_tr_b16 v[90:91], v35 offset:26624
    v_mfma_f32_16x16x32_bf16 v[216:219], v[176:179], a[144:147], v[216:219]
    s_add_u32 m0, s63, 0x0
    s_nop 0
    buffer_load_dwordx4 v62, s[20:23], s54 offen lds
    v_mfma_f32_16x16x32_bf16 v[216:219], v[180:183], a[148:151], v[216:219]
    s_add_u32 s55, s76, 0x1c00
    v_fma_f32 v38, v38, s70, s70
    v_fma_f32 v39, v39, s70, s70
    v_mfma_f32_16x16x32_bf16 v[216:219], v[184:187], a[152:155], v[216:219]
    s_nop 0
    ds_read_b64_tr_b16 v[92:93], v35 offset:28672
    ds_read_b64_tr_b16 v[94:95], v35 offset:30720
    v_mfma_f32_16x16x32_bf16 v[216:219], v[188:191], a[156:159], v[216:219]
    v_rcp_f32 v36, v36
    v_mfma_f32_16x16x32_bf16 v[220:223], v[188:191], a[252:255], 0
    v_rcp_f32 v37, v37
    v_mfma_f32_16x16x32_bf16 v[220:223], v[184:187], a[248:251], v[220:223]
    buffer_load_dwordx4 v62, s[20:23], s55 offen offset:1024 lds
    v_mfma_f32_16x16x32_bf16 v[220:223], v[180:183], a[244:247], v[220:223]
    s_add_u32 s56, s76, 0x3800
    v_rcp_f32 v38, v38
    v_mfma_f32_16x16x32_bf16 v[220:223], v[176:179], a[240:243], v[220:223]
    v_rcp_f32 v39, v39
    v_mfma_f32_16x16x32_bf16 v[220:223], v[172:175], a[172:175], v[220:223]
    v_mul_f32 v56, v56, v36
    v_mul_f32 v57, v57, v37
    v_mfma_f32_16x16x32_bf16 v[220:223], v[168:171], a[168:171], v[220:223]
    v_mul_f32 v58, v58, v38
    v_mul_f32 v59, v59, v39
    v_mfma_f32_16x16x32_bf16 v[220:223], v[164:167], a[164:167], v[220:223]
    buffer_load_dwordx4 v62, s[20:23], s56 offen offset:2048 lds
    v_mfma_f32_16x16x32_bf16 v[220:223], v[160:163], a[160:163], v[220:223]
    s_waitcnt vmcnt(15) lgkmcnt(0)
    s_barrier
    v_mfma_f32_16x16x32_bf16 v[208:211], v[64:67], a[64:67], v[208:211]
    s_add_u32 s57, s76, 0x5400
    v_permlane16_swap_b32 v4, v6
    v_mfma_f32_16x16x32_bf16 v[208:211], v[68:71], a[68:71], v[208:211]
    s_nop 0
    ds_read_b64_tr_b16 v[160:161], v60 offset:8192
    ds_read_b64_tr_b16 v[162:163], v60 offset:10240
    v_mfma_f32_16x16x32_bf16 v[208:211], v[72:75], a[72:75], v[208:211]
    v_permlane16_swap_b32 v5, v7
    v_mfma_f32_16x16x32_bf16 v[208:211], v[76:79], a[76:79], v[208:211]
    buffer_load_dwordx4 v62, s[20:23], s57 offen offset:3072 lds
    v_mfma_f32_16x16x32_bf16 v[208:211], v[80:83], a[80:83], v[208:211]
    s_add_u32 s54, s76, 0x8000
    ds_read_b64_tr_b16 v[164:165], v60 offset:12288
    ds_read_b64_tr_b16 v[166:167], v60 offset:14336
    v_mfma_f32_16x16x32_bf16 v[208:211], v[84:87], a[84:87], v[208:211]
    s_add_u32 m0, s63, 0x1000
    v_permlane16_swap_b32 v8, v10
    v_mfma_f32_16x16x32_bf16 v[208:211], v[88:91], a[88:91], v[208:211]
    v_permlane16_swap_b32 v9, v11
    v_mfma_f32_16x16x32_bf16 v[208:211], v[92:95], a[92:95], v[208:211]
    ds_read_b64_tr_b16 v[168:169], v60 offset:24576
    ds_read_b64_tr_b16 v[170:171], v60 offset:26624
    v_mfma_f32_16x16x32_bf16 v[212:215], v[92:95], a[124:127], v[212:215]
    buffer_load_dwordx4 v62, s[20:23], s54 offen lds
    v_mfma_f32_16x16x32_bf16 v[212:215], v[88:91], a[120:123], v[212:215]
    s_add_u32 s55, s76, 0x9c00
    v_lshlrev_b32 v144, 16, v4
    v_and_b32 v145, 0xffff0000, v4
    v_mfma_f32_16x16x32_bf16 v[212:215], v[84:87], a[116:119], v[212:215]
    s_nop 0
    ds_read_b64_tr_b16 v[172:173], v60 offset:28672
    ds_read_b64_tr_b16 v[174:175], v60 offset:30720
    v_mfma_f32_16x16x32_bf16 v[212:215], v[80:83], a[112:115], v[212:215]
    v_lshlrev_b32 v146, 16, v5
    v_and_b32 v147, 0xffff0000, v5
    v_mfma_f32_16x16x32_bf16 v[212:215], v[76:79], a[108:111], v[212:215]
    v_lshlrev_b32 v148, 16, v6
    v_and_b32 v149, 0xffff0000, v6
    v_mfma_f32_16x16x32_bf16 v[212:215], v[72:75], a[104:107], v[212:215]
    ds_read_b64_tr_b16 v[176:177], v60 offset:40960
    ds_read_b64_tr_b16 v[178:179], v60 offset:43008
    buffer_load_dwordx4 v62, s[20:23], s55 offen offset:1024 lds
    v_mfma_f32_16x16x32_bf16 v[212:215], v[68:71], a[100:103], v[212:215]
    s_add_u32 s56, s76, 0xb800
    v_lshlrev_b32 v150, 16, v7
    v_and_b32 v151, 0xffff0000, v7
    v_mfma_f32_16x16x32_bf16 v[212:215], v[64:67], a[96:99], v[212:215]
    v_lshlrev_b32 v152, 16, v8
    v_and_b32 v153, 0xffff0000, v8
    v_mfma_f32_16x16x32_bf16 v[216:219], v[64:67], a[176:179], v[216:219]
    ds_read_b64_tr_b16 v[180:181], v60 offset:45056
    ds_read_b64_tr_b16 v[182:183], v60 offset:47104
    v_mfma_f32_16x16x32_bf16 v[216:219], v[68:71], a[180:183], v[216:219]
    v_lshlrev_b32 v154, 16, v9
    v_and_b32 v155, 0xffff0000, v9
    v_mfma_f32_16x16x32_bf16 v[216:219], v[72:75], a[184:187], v[216:219]
    buffer_load_dwordx4 v62, s[20:23], s56 offen offset:2048 lds
    v_mfma_f32_16x16x32_bf16 v[216:219], v[76:79], a[188:191], v[216:219]
    s_add_u32 s57, s76, 0xd400
    ds_read_b64_tr_b16 v[184:185], v60 offset:57344
    ds_read_b64_tr_b16 v[186:187], v60 offset:59392
    v_mfma_f32_16x16x32_bf16 v[216:219], v[80:83], a[192:195], v[216:219]
    s_add_u32 s93, s52, 6
    v_lshlrev_b32 v156, 16, v10
    v_and_b32 v157, 0xffff0000, v10
    v_mfma_f32_16x16x32_bf16 v[216:219], v[84:87], a[196:199], v[216:219]
    s_and_b32 s93, s93, 7
    v_lshlrev_b32 v158, 16, v11
    v_and_b32 v159, 0xffff0000, v11
    v_mfma_f32_16x16x32_bf16 v[216:219], v[88:91], a[200:203], v[216:219]
    s_lshl_b32 s93, s93, 17
    ds_read_b64_tr_b16 v[188:189], v60 offset:61440
    ds_read_b64_tr_b16 v[190:191], v60 offset:63488
    v_mfma_f32_16x16x32_bf16 v[216:219], v[92:95], a[204:207], v[216:219]
    buffer_load_dwordx4 v62, s[20:23], s57 offen offset:3072 lds
    v_mfma_f32_16x16x32_bf16 v[220:223], v[92:95], a[236:239], v[220:223]
    s_add_u32 s76, s52, 8
    s_add_u32 s26, s93, s94
    s_add_u32 s27, s26, 0x100000
    v_mfma_f32_16x16x32_bf16 v[220:223], v[88:91], a[232:235], v[220:223]
    s_and_b32 s76, s76, 7
    s_add_u32 s94, s94, 0x200000
    v_cvt_pk_bf16_f32 v136, v208, v209
    v_mfma_f32_16x16x32_bf16 v[220:223], v[84:87], a[228:231], v[220:223]
    s_lshl_b32 s76, s76, 7
    v_cvt_pk_bf16_f32 v137, v210, v211
    v_min_u32 v136, -2, v136
    v_mfma_f32_16x16x32_bf16 v[220:223], v[80:83], a[224:227], v[220:223]
    s_add_u32 s54, s76, 0x10000
    v_min_u32 v137, -2, v137
    v_cvt_pk_bf16_f32 v138, v212, v213
    v_mfma_f32_16x16x32_bf16 v[220:223], v[76:79], a[220:223], v[220:223]
    s_add_u32 m0, s63, 0x10000
    s_nop 0
    buffer_load_dwordx4 v62, s[20:23], s54 offen lds
    v_mfma_f32_16x16x32_bf16 v[220:223], v[72:75], a[216:219], v[220:223]
    s_add_u32 s55, s76, 0x11c00
    v_cvt_pk_bf16_f32 v139, v214, v215
    v_min_u32 v138, -2, v138
    v_mfma_f32_16x16x32_bf16 v[220:223], v[68:71], a[212:215], v[220:223]
    v_min_u32 v139, -2, v139
    v_bfe_u32 v3, v15, 4, 5
    v_mfma_f32_16x16x32_bf16 v[220:223], v[64:67], a[208:211], v[220:223]
    s_waitcnt vmcnt(12) lgkmcnt(0)
    s_barrier
    v_lshlrev_b32 v3, 10, v3
    v_mfma_f32_16x16x32_bf16 v[192:195], v[160:163], a[0:3], 0
    v_lshrrev_b32 v2, 9, v15
    v_lshl_add_u32 v3, v2, 4, v3
    v_mfma_f32_16x16x32_bf16 v[192:195], v[164:167], a[4:7], v[192:195]
    ds_read_b64_tr_b16 v[64:65], v61 offset:8192
    ds_read_b64_tr_b16 v[66:67], v61 offset:10240
    buffer_load_dwordx4 v62, s[20:23], s55 offen offset:1024 lds
    v_mfma_f32_16x16x32_bf16 v[192:195], v[168:171], a[8:11], v[192:195]
    s_add_u32 s56, s76, 0x13800
    v_bfe_u32 v0, v15, 6, 2
    v_lshrrev_b32 v1, 8, v15
    v_mfma_f32_16x16x32_bf16 v[192:195], v[172:175], a[12:15], v[192:195]
    v_cmp_eq_u32 vcc, v0, v1
    v_and_b32 v0, 16, v15
    v_mfma_f32_16x16x32_bf16 v[192:195], v[176:179], a[16:19], v[192:195]
    ds_read_b64_tr_b16 v[68:69], v61 offset:12288
    ds_read_b64_tr_b16 v[70:71], v61 offset:14336
    v_mfma_f32_16x16x32_bf16 v[192:195], v[180:183], a[20:23], v[192:195]
    v_cvt_pk_bf16_f32 v140, v216, v217
    v_cvt_pk_bf16_f32 v141, v218, v219
    v_mfma_f32_16x16x32_bf16 v[192:195], v[184:187], a[24:27], v[192:195]
    buffer_load_dwordx4 v62, s[20:23], s56 offen offset:2048 lds
    v_mfma_f32_16x16x32_bf16 v[192:195], v[188:191], a[28:31], v[192:195]
    s_add_u32 s57, s76, 0x15400
    ds_read_b64_tr_b16 v[72:73], v61 offset:24576
    ds_read_b64_tr_b16 v[74:75], v61 offset:26624
    v_mfma_f32_16x16x32_bf16 v[196:199], v[188:191], a[60:63], 0
    v_min_u32 v140, -2, v140
    v_min_u32 v141, -2, v141
    v_mfma_f32_16x16x32_bf16 v[196:199], v[184:187], a[56:59], v[196:199]
    v_cvt_pk_bf16_f32 v142, v220, v221
    v_cvt_pk_bf16_f32 v143, v222, v223
    v_mfma_f32_16x16x32_bf16 v[196:199], v[180:183], a[52:55], v[196:199]
    ds_read_b64_tr_b16 v[76:77], v61 offset:28672
    ds_read_b64_tr_b16 v[78:79], v61 offset:30720
    v_mfma_f32_16x16x32_bf16 v[196:199], v[176:179], a[48:51], v[196:199]
    buffer_load_dwordx4 v62, s[20:23], s57 offen offset:3072 lds
    v_mfma_f32_16x16x32_bf16 v[196:199], v[172:175], a[44:47], v[196:199]
    s_add_u32 s54, s76, 0x18000
    v_min_u32 v142, -2, v142
    v_min_u32 v143, -2, v143
    v_mfma_f32_16x16x32_bf16 v[196:199], v[168:171], a[40:43], v[196:199]
    s_add_u32 m0, s63, 0x11000
    ds_read_b64_tr_b16 v[80:81], v61 offset:40960
    ds_read_b64_tr_b16 v[82:83], v61 offset:43008
    v_mfma_f32_16x16x32_bf16 v[196:199], v[164:167], a[36:39], v[196:199]
    v_mov_b32 v1, 0x3f80
    v_lshlrev_b32 v0, v0, v1
    v_mfma_f32_16x16x32_bf16 v[196:199], v[160:163], a[32:35], v[196:199]
    v_cndmask_b32 v0, 0, v0, vcc
    v_and_b32 v1, 32, v15
    v_mfma_f32_16x16x32_bf16 v[200:203], v[160:163], a[128:131], 0
    ds_read_b64_tr_b16 v[84:85], v61 offset:45056
    ds_read_b64_tr_b16 v[86:87], v61 offset:47104
    buffer_load_dwordx4 v62, s[20:23], s54 offen lds
    v_mfma_f32_16x16x32_bf16 v[200:203], v[164:167], a[132:135], v[200:203]
    s_add_u32 s55, s76, 0x19c00
    v_cmp_eq_u32 vcc, 0, v1
    v_mov_b32 v16, 0
    v_mfma_f32_16x16x32_bf16 v[200:203], v[168:171], a[136:139], v[200:203]
    v_mov_b32 v17, 0
    v_cndmask_b32 v18, 0, v0, vcc
    v_mfma_f32_16x16x32_bf16 v[200:203], v[172:175], a[140:143], v[200:203]
    ds_read_b64_tr_b16 v[88:89], v61 offset:57344
    ds_read_b64_tr_b16 v[90:91], v61 offset:59392
    v_mfma_f32_16x16x32_bf16 v[200:203], v[176:179], a[144:147], v[200:203]
    v_mov_b32 v20, 0
    v_sub_u32 v19, v0, v18
    v_mfma_f32_16x16x32_bf16 v[200:203], v[180:183], a[148:151], v[200:203]
    buffer_load_dwordx4 v62, s[20:23], s55 offen offset:1024 lds
    v_mfma_f32_16x16x32_bf16 v[200:203], v[184:187], a[152:155], v[200:203]
    s_add_u32 s56, s76, 0x1b800
    ds_read_b64_tr_b16 v[92:93], v61 offset:61440
    ds_read_b64_tr_b16 v[94:95], v61 offset:63488
    v_mfma_f32_16x16x32_bf16 v[200:203], v[188:191], a[156:159], v[200:203]
    v_mov_b32 v21, 0
    v_mfma_f32_16x16x32_bf16 v[204:207], v[188:191], a[252:255], 0
    v_mfma_f32_16x16x32_bf16 v[204:207], v[184:187], a[248:251], v[204:207]
    v_mfma_f32_16x16x32_bf16 v[204:207], v[180:183], a[244:247], v[204:207]
    buffer_load_dwordx4 v62, s[20:23], s56 offen offset:2048 lds
    v_mfma_f32_16x16x32_bf16 v[204:207], v[176:179], a[240:243], v[204:207]
    s_add_u32 s57, s76, 0x1d400
    v_mfma_f32_16x16x32_bf16 v[204:207], v[172:175], a[172:175], v[204:207]
    v_mfma_f32_16x16x32_bf16 v[204:207], v[168:171], a[168:171], v[204:207]
    v_mfma_f32_16x16x32_bf16 v[204:207], v[164:167], a[164:167], v[204:207]
    v_mfma_f32_16x16x32_bf16 v[204:207], v[160:163], a[160:163], v[204:207]
    s_waitcnt vmcnt(7) lgkmcnt(0)
    s_barrier
    buffer_load_dwordx4 v62, s[20:23], s57 offen offset:3072 lds
    v_mfma_f32_16x16x32_bf16 v[192:195], v[64:67], a[64:67], v[192:195]
    s_add_u32 s88, s84, 0x600000
    v_mfma_f32_16x16x32_bf16 v[192:195], v[68:71], a[68:71], v[192:195]
    s_nop 0
    ds_read_b64_tr_b16 v[160:161], v60 offset:0
    ds_read_b64_tr_b16 v[162:163], v60 offset:2048
    buffer_load_dwordx4 v[120:123], v15, s[32:35], s88 offen sc1
    s_add_u32 s89, s84, 0x700000
    v_mfma_f32_16x16x32_bf16 v[192:195], v[72:75], a[72:75], v[192:195]
    buffer_load_dwordx4 v[124:127], v15, s[32:35], s89 offen sc1
    v_mfma_f32_16x16x32_bf16 v[192:195], v[76:79], a[76:79], v[192:195]
    buffer_store_dwordx4 v[136:139], v15, s[32:35], s26 offen sc1
    v_mfma_f32_16x16x32_bf16 v[192:195], v[80:83], a[80:83], v[192:195]
    s_nop 0
    ds_read_b64_tr_b16 v[164:165], v60 offset:4096
    ds_read_b64_tr_b16 v[166:167], v60 offset:6144
    buffer_store_dwordx4 v[140:143], v15, s[32:35], s27 offen sc1
    v_mfma_f32_16x16x32_bf16 v[192:195], v[84:87], a[84:87], v[192:195]
    v_mfma_f32_16x16x32_bf16 v[192:195], v[88:91], a[88:91], v[192:195]
    v_mfma_f32_16x16x32_bf16 v[192:195], v[92:95], a[92:95], v[192:195]
    s_nop 0
    ds_read_b64_tr_b16 v[168:169], v60 offset:16384
    ds_read_b64_tr_b16 v[170:171], v60 offset:18432
    v_mfma_f32_16x16x32_bf16 v[196:199], v[92:95], a[124:127], v[196:199]
    v_mfma_f32_16x16x32_bf16 v[196:199], v[88:91], a[120:123], v[196:199]
    v_mfma_f32_16x16x32_bf16 v[196:199], v[84:87], a[116:119], v[196:199]
    s_add_u32 s93, s52, 7
    ds_read_b64_tr_b16 v[172:173], v60 offset:20480
    ds_read_b64_tr_b16 v[174:175], v60 offset:22528
    v_mfma_f32_16x16x32_bf16 v[196:199], v[80:83], a[112:115], v[196:199]
    s_and_b32 s93, s93, 7
    v_mfma_f32_16x16x32_bf16 v[196:199], v[76:79], a[108:111], v[196:199]
    s_lshl_b32 s93, s93, 17
    v_mfma_f32_16x16x32_bf16 v[196:199], v[72:75], a[104:107], v[196:199]
    s_add_u32 s24, s93, s94
    ds_read_b64_tr_b16 v[176:177], v60 offset:32768
    ds_read_b64_tr_b16 v[178:179], v60 offset:34816
    v_mfma_f32_16x16x32_bf16 v[196:199], v[68:71], a[100:103], v[196:199]
    s_add_u32 s25, s24, 0x100000
    v_mfma_f32_16x16x32_bf16 v[196:199], v[64:67], a[96:99], v[196:199]
    s_add_u32 s94, s94, 0x200000
    v_cvt_pk_bf16_f32 v128, v192, v193
    v_cvt_pk_bf16_f32 v129, v194, v195
    v_mfma_f32_16x16x32_bf16 v[200:203], v[64:67], a[176:179], v[200:203]
    s_nop 0
    ds_read_b64_tr_b16 v[180:181], v60 offset:36864
    ds_read_b64_tr_b16 v[182:183], v60 offset:38912
    v_min_u32 v128, -2, v128
    v_mfma_f32_16x16x32_bf16 v[200:203], v[68:71], a[180:183], v[200:203]
    v_min_u32 v129, -2, v129
    v_mfma_f32_16x16x32_bf16 v[200:203], v[72:75], a[184:187], v[200:203]
    v_mfma_f32_16x16x32_bf16 v[200:203], v[76:79], a[188:191], v[200:203]
    s_nop 0
    ds_read_b64_tr_b16 v[184:185], v60 offset:49152
    ds_read_b64_tr_b16 v[186:187], v60 offset:51200
    v_mfma_f32_16x16x32_bf16 v[200:203], v[80:83], a[192:195], v[200:203]
    v_cvt_pk_bf16_f32 v130, v196, v197
    v_cvt_pk_bf16_f32 v131, v198, v199
    v_mfma_f32_16x16x32_bf16 v[200:203], v[84:87], a[196:199], v[200:203]
    v_min_u32 v130, -2, v130
    v_min_u32 v131, -2, v131
    v_mfma_f32_16x16x32_bf16 v[200:203], v[88:91], a[200:203], v[200:203]
    ds_read_b64_tr_b16 v[188:189], v60 offset:53248
    ds_read_b64_tr_b16 v[190:191], v60 offset:55296
    v_mfma_f32_16x16x32_bf16 v[200:203], v[92:95], a[204:207], v[200:203]
    buffer_store_dwordx4 v[128:131], v15, s[32:35], s24 offen sc1
    v_mfma_f32_16x16x32_bf16 v[204:207], v[92:95], a[236:239], v[204:207]
    v_mfma_f32_16x16x32_bf16 v[204:207], v[88:91], a[232:235], v[204:207]
    v_mfma_f32_16x16x32_bf16 v[204:207], v[84:87], a[228:231], v[204:207]
    v_mfma_f32_16x16x32_bf16 v[204:207], v[80:83], a[224:227], v[204:207]
    v_mfma_f32_16x16x32_bf16 v[204:207], v[76:79], a[220:223], v[204:207]
    v_mfma_f32_16x16x32_bf16 v[204:207], v[72:75], a[216:219], v[204:207]
    v_mfma_f32_16x16x32_bf16 v[204:207], v[68:71], a[212:215], v[204:207]
    v_mfma_f32_16x16x32_bf16 v[204:207], v[64:67], a[208:211], v[204:207]
    s_waitcnt vmcnt(5) lgkmcnt(0)
    s_barrier
    v_cvt_pk_bf16_f32 v132, v200, v201
    v_cvt_pk_bf16_f32 v133, v202, v203
    v_mfma_f32_16x16x32_bf16 v[208:211], v[160:163], a[0:3], 0
    v_min_u32 v132, -2, v132
    v_min_u32 v133, -2, v133
    v_mfma_f32_16x16x32_bf16 v[208:211], v[164:167], a[4:7], v[208:211]
    ds_read_b64_tr_b16 v[64:65], v61 offset:0
    ds_read_b64_tr_b16 v[66:67], v61 offset:2048
    v_mfma_f32_16x16x32_bf16 v[208:211], v[168:171], a[8:11], v[208:211]
    v_mfma_f32_16x16x32_bf16 v[208:211], v[172:175], a[12:15], v[208:211]
    v_mfma_f32_16x16x32_bf16 v[208:211], v[176:179], a[16:19], v[208:211]
    s_nop 0
    ds_read_b64_tr_b16 v[68:69], v61 offset:4096
    ds_read_b64_tr_b16 v[70:71], v61 offset:6144
    v_cvt_pk_bf16_f32 v134, v204, v205
    v_mfma_f32_16x16x32_bf16 v[208:211], v[180:183], a[20:23], v[208:211]
    v_cvt_pk_bf16_f32 v135, v206, v207
    v_min_u32 v134, -2, v134
    v_min_u32 v135, -2, v135
    v_mfma_f32_16x16x32_bf16 v[208:211], v[184:187], a[24:27], v[208:211]
    buffer_store_dwordx4 v[132:135], v15, s[32:35], s25 offen sc1
    v_mfma_f32_16x16x32_bf16 v[208:211], v[188:191], a[28:31], v[208:211]
    s_nop 0
    ds_read_b64_tr_b16 v[72:73], v61 offset:16384
    ds_read_b64_tr_b16 v[74:75], v61 offset:18432
    v_mfma_f32_16x16x32_bf16 v[212:215], v[188:191], a[60:63], 0
    v_mfma_f32_16x16x32_bf16 v[212:215], v[184:187], a[56:59], v[212:215]
    v_mfma_f32_16x16x32_bf16 v[212:215], v[180:183], a[52:55], v[212:215]
    s_nop 0
    ds_read_b64_tr_b16 v[76:77], v61 offset:20480
    ds_read_b64_tr_b16 v[78:79], v61 offset:22528
    v_mfma_f32_16x16x32_bf16 v[212:215], v[176:179], a[48:51], v[212:215]
    v_mfma_f32_16x16x32_bf16 v[212:215], v[172:175], a[44:47], v[212:215]
    v_mfma_f32_16x16x32_bf16 v[212:215], v[168:171], a[40:43], v[212:215]
    s_nop 0
    ds_read_b64_tr_b16 v[80:81], v61 offset:32768
    ds_read_b64_tr_b16 v[82:83], v61 offset:34816
    v_mfma_f32_16x16x32_bf16 v[212:215], v[164:167], a[36:39], v[212:215]
    s_add_u32 s88, s84, 0x800000
    v_mfma_f32_16x16x32_bf16 v[212:215], v[160:163], a[32:35], v[212:215]
    buffer_load_dwordx4 v[224:227], v15, s[32:35], s88 offen sc1
    v_mfma_f32_16x16x32_bf16 v[216:219], v[160:163], a[128:131], 0
    s_add_u32 s89, s84, 0x900000
    ds_read_b64_tr_b16 v[84:85], v61 offset:36864
    ds_read_b64_tr_b16 v[86:87], v61 offset:38912
    v_mfma_f32_16x16x32_bf16 v[216:219], v[164:167], a[132:135], v[216:219]
    buffer_load_dwordx4 v[228:231], v15, s[32:35], s89 offen sc1
    v_mfma_f32_16x16x32_bf16 v[216:219], v[168:171], a[136:139], v[216:219]
    v_mfma_f32_16x16x32_bf16 v[216:219], v[172:175], a[140:143], v[216:219]
    s_nop 0
    ds_read_b64_tr_b16 v[88:89], v61 offset:49152
    ds_read_b64_tr_b16 v[90:91], v61 offset:51200
    v_mfma_f32_16x16x32_bf16 v[216:219], v[176:179], a[144:147], v[216:219]
    v_mfma_f32_16x16x32_bf16 v[216:219], v[180:183], a[148:151], v[216:219]
    v_mfma_f32_16x16x32_bf16 v[216:219], v[184:187], a[152:155], v[216:219]
    s_nop 0
    ds_read_b64_tr_b16 v[92:93], v61 offset:53248
    ds_read_b64_tr_b16 v[94:95], v61 offset:55296
    v_mfma_f32_16x16x32_bf16 v[216:219], v[188:191], a[156:159], v[216:219]
    v_mfma_f32_16x16x32_bf16 v[220:223], v[188:191], a[252:255], 0
    v_mfma_f32_16x16x32_bf16 v[220:223], v[184:187], a[248:251], v[220:223]
    v_mfma_f32_16x16x32_bf16 v[220:223], v[180:183], a[244:247], v[220:223]
    v_mfma_f32_16x16x32_bf16 v[220:223], v[176:179], a[240:243], v[220:223]
    v_mfma_f32_16x16x32_bf16 v[220:223], v[172:175], a[172:175], v[220:223]
    v_mfma_f32_16x16x32_bf16 v[220:223], v[168:171], a[168:171], v[220:223]
    v_mfma_f32_16x16x32_bf16 v[220:223], v[164:167], a[164:167], v[220:223]
    v_mfma_f32_16x16x32_bf16 v[220:223], v[160:163], a[160:163], v[220:223]
    s_waitcnt lgkmcnt(0)
    v_mfma_f32_16x16x32_bf16 v[208:211], v[64:67], a[64:67], v[208:211]
    v_mfma_f32_16x16x32_bf16 v[208:211], v[68:71], a[68:71], v[208:211]
    v_mfma_f32_16x16x32_bf16 v[208:211], v[72:75], a[72:75], v[208:211]
    v_mfma_f32_16x16x32_bf16 v[208:211], v[76:79], a[76:79], v[208:211]
    v_mfma_f32_16x16x32_bf16 v[208:211], v[80:83], a[80:83], v[208:211]
    v_mfma_f32_16x16x32_bf16 v[208:211], v[84:87], a[84:87], v[208:211]
    v_mfma_f32_16x16x32_bf16 v[208:211], v[88:91], a[88:91], v[208:211]
    s_add_u32 s88, s84, 0xa00000
    v_mfma_f32_16x16x32_bf16 v[208:211], v[92:95], a[92:95], v[208:211]
    buffer_load_dwordx4 v[232:235], v15, s[32:35], s88 offen sc1
    v_mfma_f32_16x16x32_bf16 v[212:215], v[92:95], a[124:127], v[212:215]
    s_add_u32 s89, s84, 0xb00000
    v_mfma_f32_16x16x32_bf16 v[212:215], v[88:91], a[120:123], v[212:215]
    buffer_load_dwordx4 v[236:239], v15, s[32:35], s89 offen sc1
    v_mfma_f32_16x16x32_bf16 v[212:215], v[84:87], a[116:119], v[212:215]
    v_mfma_f32_16x16x32_bf16 v[212:215], v[80:83], a[112:115], v[212:215]
    v_mfma_f32_16x16x32_bf16 v[212:215], v[76:79], a[108:111], v[212:215]
    v_mfma_f32_16x16x32_bf16 v[212:215], v[72:75], a[104:107], v[212:215]
    v_mfma_f32_16x16x32_bf16 v[212:215], v[68:71], a[100:103], v[212:215]
    v_mfma_f32_16x16x32_bf16 v[212:215], v[64:67], a[96:99], v[212:215]
    v_mfma_f32_16x16x32_bf16 v[216:219], v[64:67], a[176:179], v[216:219]
    v_mfma_f32_16x16x32_bf16 v[216:219], v[68:71], a[180:183], v[216:219]
    v_mfma_f32_16x16x32_bf16 v[216:219], v[72:75], a[184:187], v[216:219]
    v_mfma_f32_16x16x32_bf16 v[216:219], v[76:79], a[188:191], v[216:219]
    s_mov_b32 s86, 0x40000
    v_mfma_f32_16x16x32_bf16 v[216:219], v[80:83], a[192:195], v[216:219]
    s_waitcnt vmcnt(8)
    v_max_u32 v28, v96, v97
    v_max3_u32 v28, v28, v98, v99
    v_mfma_f32_16x16x32_bf16 v[216:219], v[84:87], a[196:199], v[216:219]
    v_max3_u32 v28, v28, v100, v101
    v_max3_u32 v28, v28, v102, v103
    v_mfma_f32_16x16x32_bf16 v[216:219], v[88:91], a[200:203], v[216:219]
    v_max3_u32 v28, v28, v104, v105
    v_max3_u32 v28, v28, v106, v107
    v_mfma_f32_16x16x32_bf16 v[216:219], v[92:95], a[204:207], v[216:219]
    v_max3_u32 v28, v28, v108, v109
    v_max3_u32 v28, v28, v110, v111
    v_mfma_f32_16x16x32_bf16 v[220:223], v[92:95], a[236:239], v[220:223]
    v_max3_u32 v28, v28, v112, v113
    v_max3_u32 v28, v28, v114, v115
    v_mfma_f32_16x16x32_bf16 v[220:223], v[88:91], a[232:235], v[220:223]
    v_max3_u32 v28, v28, v116, v117
    v_max3_u32 v28, v28, v118, v119
    v_mfma_f32_16x16x32_bf16 v[220:223], v[84:87], a[228:231], v[220:223]
    v_max3_u32 v28, v28, v120, v121
    v_max3_u32 v28, v28, v122, v123
    v_mfma_f32_16x16x32_bf16 v[220:223], v[80:83], a[224:227], v[220:223]
    v_max3_u32 v28, v28, v124, v125
    v_max3_u32 v28, v28, v126, v127
    v_mfma_f32_16x16x32_bf16 v[220:223], v[76:79], a[220:223], v[220:223]
    v_cmp_eq_u32 vcc, -1, v28
    v_mfma_f32_16x16x32_bf16 v[220:223], v[72:75], a[216:219], v[220:223]
    v_mfma_f32_16x16x32_bf16 v[220:223], v[68:71], a[212:215], v[220:223]
    v_mfma_f32_16x16x32_bf16 v[220:223], v[64:67], a[208:211], v[220:223]
    s_add_u32 s88, s84, 0xc00000
    buffer_load_dwordx4 v[240:243], v15, s[32:35], s88 offen sc1
    s_add_u32 s89, s84, 0xd00000
    buffer_load_dwordx4 v[244:247], v15, s[32:35], s89 offen sc1
    s_cbranch_vccnz L_RETRY0
L_GO0:
    v_mfma_f32_16x16x32_bf16 v[208:211], v[18:21], v[96:99], v[208:211]
    v_mfma_f32_16x16x32_bf16 v[208:211], v[18:21], v[104:107], v[208:211]
    v_mfma_f32_16x16x32_bf16 v[208:211], v[18:21], v[112:115], v[208:211]
    v_mfma_f32_16x16x32_bf16 v[208:211], v[18:21], v[120:123], v[208:211]
    v_mfma_f32_16x16x32_bf16 v[212:215], v[16:19], v[96:99], v[212:215]
    v_mfma_f32_16x16x32_bf16 v[212:215], v[16:19], v[104:107], v[212:215]
    v_mfma_f32_16x16x32_bf16 v[212:215], v[16:19], v[112:115], v[212:215]
    v_mfma_f32_16x16x32_bf16 v[212:215], v[16:19], v[120:123], v[212:215]
    v_mfma_f32_16x16x32_bf16 v[216:219], v[18:21], v[100:103], v[216:219]
    v_mfma_f32_16x16x32_bf16 v[216:219], v[18:21], v[108:111], v[216:219]
    v_mfma_f32_16x16x32_bf16 v[216:219], v[18:21], v[116:119], v[216:219]
    v_mfma_f32_16x16x32_bf16 v[216:219], v[18:21], v[124:127], v[216:219]
    v_mfma_f32_16x16x32_bf16 v[220:223], v[16:19], v[100:103], v[220:223]
    v_mfma_f32_16x16x32_bf16 v[220:223], v[16:19], v[108:111], v[220:223]
    v_mfma_f32_16x16x32_bf16 v[220:223], v[16:19], v[116:119], v[220:223]
    v_mfma_f32_16x16x32_bf16 v[220:223], v[16:19], v[124:127], v[220:223]
    s_waitcnt vmcnt(4)
    v_max_u32 v28, v224, v225
    v_max3_u32 v28, v28, v226, v227
    v_max3_u32 v28, v28, v228, v229
    v_max3_u32 v28, v28, v230, v231
    v_cmp_eq_u32 vcc, -1, v28
    s_nop 1
    s_cbranch_vccnz L_RETRY1
L_GO1:
    v_mfma_f32_16x16x32_bf16 v[208:211], v[18:21], v[224:227], v[208:211]
    v_mfma_f32_16x16x32_bf16 v[212:215], v[16:19], v[224:227], v[212:215]
    v_mfma_f32_16x16x32_bf16 v[216:219], v[18:21], v[228:231], v[216:219]
    v_mfma_f32_16x16x32_bf16 v[220:223], v[16:19], v[228:231], v[220:223]
    s_waitcnt vmcnt(2)
    v_max_u32 v28, v232, v233
    v_max3_u32 v28, v28, v234, v235
    v_max3_u32 v28, v28, v236, v237
    v_max3_u32 v28, v28, v238, v239
    v_cmp_eq_u32 vcc, -1, v28
    s_nop 1
    s_cbranch_vccnz L_RETRY2
L_GO2:
    v_mfma_f32_16x16x32_bf16 v[208:211], v[18:21], v[232:235], v[208:211]
    v_mfma_f32_16x16x32_bf16 v[212:215], v[16:19], v[232:235], v[212:215]
    v_mfma_f32_16x16x32_bf16 v[216:219], v[18:21], v[236:239], v[216:219]
    v_mfma_f32_16x16x32_bf16 v[220:223], v[16:19], v[236:239], v[220:223]
    s_waitcnt vmcnt(0)
    v_max_u32 v28, v240, v241
    v_max3_u32 v28, v28, v242, v243
    v_max3_u32 v28, v28, v244, v245
    v_max3_u32 v28, v28, v246, v247
    v_cmp_eq_u32 vcc, -1, v28
    s_nop 1
    s_cbranch_vccnz L_RETRY3
L_GO3:
    v_mfma_f32_16x16x32_bf16 v[208:211], v[18:21], v[240:243], v[208:211]
    v_mfma_f32_16x16x32_bf16 v[212:215], v[16:19], v[240:243], v[212:215]
    v_mfma_f32_16x16x32_bf16 v[216:219], v[18:21], v[244:247], v[216:219]
    v_mfma_f32_16x16x32_bf16 v[220:223], v[16:19], v[244:247], v[220:223]
    s_nop 7
    v_pk_fma_f32 v[208:209], v[208:209], v[44:45], v[144:145]
    v_pk_fma_f32 v[210:211], v[210:211], v[46:47], v[146:147]
    v_pk_fma_f32 v[212:213], v[212:213], v[48:49], v[148:149]
    v_pk_fma_f32 v[214:215], v[214:215], v[50:51], v[150:151]
    v_pk_fma_f32 v[216:217], v[216:217], v[52:53], v[152:153]
    v_pk_fma_f32 v[218:219], v[218:219], v[54:55], v[154:155]
    v_pk_fma_f32 v[220:221], v[220:221], v[56:57], v[156:157]
    v_pk_fma_f32 v[222:223], v[222:223], v[58:59], v[158:159]
    v_cvt_pk_bf16_f32 v160, v208, v209
    v_cvt_pk_bf16_f32 v161, v210, v211
    v_cvt_pk_bf16_f32 v162, v212, v213
    v_cvt_pk_bf16_f32 v163, v214, v215
    v_cvt_pk_bf16_f32 v164, v216, v217
    v_cvt_pk_bf16_f32 v165, v218, v219
    v_cvt_pk_bf16_f32 v166, v220, v221
    v_cvt_pk_bf16_f32 v167, v222, v223
    v_permlane16_swap_b32 v160, v162
    v_permlane16_swap_b32 v161, v163
    v_permlane16_swap_b32 v164, v166
    v_permlane16_swap_b32 v165, v167
    buffer_store_dwordx4 v[160:163], v3, s[36:39], s91 offen
    buffer_store_dwordx4 v[164:167], v3, s[36:39], s92 offen
L_END:
    s_endpgm
L_WA:
    s_mov_b32 s86, 0x40000
L_WA_l:
    buffer_load_dword v60, off, s[48:51], s59 sc1
    s_sub_u32 s86, s86, 1
    s_waitcnt vmcnt(0)
    v_readfirstlane_b32 s78, v60
    s_nop 3
    s_cmp_ge_u32 s78, s58
    s_cbranch_scc1 L_BA
    s_cmp_gt_i32 s86, 0
    s_cbranch_scc1 L_WA_l
    s_branch L_BA
L_WB:
    s_mov_b32 s86, 0x40000
L_WB_l:
    buffer_load_dword v34, off, s[48:51], s59 sc1
    s_sub_u32 s86, s86, 1
    s_waitcnt vmcnt(0)
    v_readfirstlane_b32 s78, v34
    s_nop 3
    s_cmp_ge_u32 s78, 16
    s_cbranch_scc1 L_BB
    s_cmp_gt_i32 s86, 0
    s_cbranch_scc1 L_WB_l
    s_branch L_BB
L_MARK:
    v_mov_b32 v16, -1
    v_mov_b32 v17, s63
    ds_write_b32 v17, v16 offset:8192
    s_waitcnt lgkmcnt(0)
    s_branch L_MARKED
L_FALLBACK0:
    s_cmp_lg_u32 s69, 0
    s_cbranch_scc1 L_NOFB
    s_branch L_FALLBACK
L_RETRY0:
    v_max_u32 v28, v96, v97
    v_max3_u32 v28, v28, v98, v99
    v_max3_u32 v28, v28, v100, v101
    v_max3_u32 v28, v28, v102, v103
    v_cmp_eq_u32 vcc, -1, v28
    s_nop 3
    s_cbranch_vccz L_RN0
L_RL0:
    s_add_u32 s88, s84, 0x0
    buffer_load_dwordx4 v[96:99], v15, s[32:35], s88 offen sc1
    s_add_u32 s89, s84, 0x100000
    buffer_load_dwordx4 v[100:103], v15, s[32:35], s89 offen sc1
    s_sub_u32 s86, s86, 1
    s_waitcnt vmcnt(0)
    v_max_u32 v28, v96, v97
    v_max3_u32 v28, v28, v98, v99
    v_max3_u32 v28, v28, v100, v101
    v_max3_u32 v28, v28, v102, v103
    v_cmp_eq_u32 vcc, -1, v28
    s_cmp_le_i32 s86, 0
    s_cbranch_scc1 L_RN0
    s_nop 1
    s_cbranch_vccnz L_RL0
L_RN0:
    v_max_u32 v28, v104, v105
    v_max3_u32 v28, v28, v106, v107
    v_max3_u32 v28, v28, v108, v109
    v_max3_u32 v28, v28, v110, v111
    v_cmp_eq_u32 vcc, -1, v28
    s_nop 3
    s_cbranch_vccz L_RN1
L_RL1:
    s_add_u32 s88, s84, 0x200000
    buffer_load_dwordx4 v[104:107], v15, s[32:35], s88 offen sc1
    s_add_u32 s89, s84, 0x300000
    buffer_load_dwordx4 v[108:111], v15, s[32:35], s89 offen sc1
    s_sub_u32 s86, s86, 1
    s_waitcnt vmcnt(0)
    v_max_u32 v28, v104, v105
    v_max3_u32 v28, v28, v106, v107
    v_max3_u32 v28, v28, v108, v109
    v_max3_u32 v28, v28, v110, v111
    v_cmp_eq_u32 vcc, -1, v28
    s_cmp_le_i32 s86, 0
    s_cbranch_scc1 L_RN1
    s_nop 1
    s_cbranch_vccnz L_RL1
L_RN1:
    v_max_u32 v28, v112, v113
    v_max3_u32 v28, v28, v114, v115
    v_max3_u32 v28, v28, v116, v117
    v_max3_u32 v28, v28, v118, v119
    v_cmp_eq_u32 vcc, -1, v28
    s_nop 3
    s_cbranch_vccz L_RN2
L_RL2:
    s_add_u32 s88, s84, 0x400000
    buffer_load_dwordx4 v[112:115], v15, s[32:35], s88 offen sc1
    s_add_u32 s89, s84, 0x500000
    buffer_load_dwordx4 v[116:119], v15, s[32:35], s89 offen sc1
    s_sub_u32 s86, s86, 1
    s_waitcnt vmcnt(0)
    v_max_u32 v28, v112, v113
    v_max3_u32 v28, v28, v114, v115
    v_max3_u32 v28, v28, v116, v117
    v_max3_u32 v28, v28, v118, v119
    v_cmp_eq_u32 vcc, -1, v28
    s_cmp_le_i32 s86, 0
    s_cbranch_scc1 L_RN2
    s_nop 1
    s_cbranch_vccnz L_RL2
L_RN2:
    v_max_u32 v28, v120, v121
    v_max3_u32 v28, v28, v122, v123
    v_max3_u32 v28, v28, v124, v125
    v_max3_u32 v28, v28, v126, v127
    v_cmp_eq_u32 vcc, -1, v28
    s_nop 3
    s_cbranch_vccz L_RN3
L_RL3:
    s_add_u32 s88, s84, 0x600000
    buffer_load_dwordx4 v[120:123], v15, s[32:35], s88 offen sc1
    s_add_u32 s89, s84, 0x700000
    buffer_load_dwordx4 v[124:127], v15, s[32:35], s89 offen sc1
    s_sub_u32 s86, s86, 1
    s_waitcnt vmcnt(0)
    v_max_u32 v28, v120, v121
    v_max3_u32 v28, v28, v122, v123
    v_max3_u32 v28, v28, v124, v125
    v_max3_u32 v28, v28, v126, v127
    v_cmp_eq_u32 vcc, -1, v28
    s_cmp_le_i32 s86, 0
    s_cbranch_scc1 L_RN3
    s_nop 1
    s_cbranch_vccnz L_RL3
L_RN3:
    s_branch L_GO0
L_RETRY1:
L_RL4:
    s_add_u32 s88, s84, 0x800000
    buffer_load_dwordx4 v[224:227], v15, s[32:35], s88 offen sc1
    s_add_u32 s89, s84, 0x900000
    buffer_load_dwordx4 v[228:231], v15, s[32:35], s89 offen sc1
    s_sub_u32 s86, s86, 1
    s_waitcnt vmcnt(0)
    v_max_u32 v28, v224, v225
    v_max3_u32 v28, v28, v226, v227
    v_max3_u32 v28, v28, v228, v229
    v_max3_u32 v28, v28, v230, v231
    v_cmp_eq_u32 vcc, -1, v28
    s_cmp_le_i32 s86, 0
    s_cbranch_scc1 L_RN4
    s_nop 1
    s_cbranch_vccnz L_RL4
L_RN4:
    s_branch L_GO1
L_RETRY2:
L_RL5:
    s_add_u32 s88, s84, 0xa00000
    buffer_load_dwordx4 v[232:235], v15, s[32:35], s88 offen sc1
    s_add_u32 s89, s84, 0xb00000
    buffer_load_dwordx4 v[236:239], v15, s[32:35], s89 offen sc1
    s_sub_u32 s86, s86, 1
    s_waitcnt vmcnt(0)
    v_max_u32 v28, v232, v233
    v_max3_u32 v28, v28, v234, v235
    v_max3_u32 v28, v28, v236, v237
    v_max3_u32 v28, v28, v238, v239
    v_cmp_eq_u32 vcc, -1, v28
    s_cmp_le_i32 s86, 0
    s_cbranch_scc1 L_RN5
    s_nop 1
    s_cbranch_vccnz L_RL5
L_RN5:
    s_branch L_GO2
L_RETRY3:
L_RL6:
    s_add_u32 s88, s84, 0xc00000
    buffer_load_dwordx4 v[240:243], v15, s[32:35], s88 offen sc1
    s_add_u32 s89, s84, 0xd00000
    buffer_load_dwordx4 v[244:247], v15, s[32:35], s89 offen sc1
    s_sub_u32 s86, s86, 1
    s_waitcnt vmcnt(0)
    v_max_u32 v28, v240, v241
    v_max3_u32 v28, v28, v242, v243
    v_max3_u32 v28, v28, v244, v245
    v_max3_u32 v28, v28, v246, v247
    v_cmp_eq_u32 vcc, -1, v28
    s_cmp_le_i32 s86, 0
    s_cbranch_scc1 L_RN6
    s_nop 1
    s_cbranch_vccnz L_RL6
L_RN6:
    s_branch L_GO3
L_FALLBACK:
    s_waitcnt vmcnt(0) lgkmcnt(0)
    s_nop 7
    s_mov_b32 s69, 1
    s_mov_b32 s82, 0
    s_lshl_b32 s64, s3, 13
    s_add_u32 s65, s64, 4096
    v_mov_b32 v16, 0xff800000
    v_mov_b32 v20, 0xff800000
    v_mov_b32 v24, 0xff800000
    v_mov_b32 v28, 0xff800000
    s_mov_b32 s68, 17
L_FB_LOOP:
    s_waitcnt vmcnt(0) lgkmcnt(0)
    s_barrier
    s_cmp_lg_u32 s68, 1
    s_cbranch_scc1 L_FB_NR
    s_lshl_b32 s64, s3, 13
    s_add_u32 s65, s64, 4096
L_FB_NR:
    s_add_u32 m0, s63, 0x0
    s_nop 0
    buffer_load_dwordx4 v12, s[8:11], s64 offen lds
    buffer_load_dwordx4 v13, s[8:11], s64 offen offset:1024 lds
    buffer_load_dwordx4 v12, s[8:11], s64 offen offset:2048 lds
    buffer_load_dwordx4 v13, s[8:11], s64 offen offset:3072 lds
    s_add_u32 m0, s63, 0x1000
    s_nop 0
    buffer_load_dwordx4 v12, s[8:11], s65 offen lds
    buffer_load_dwordx4 v13, s[8:11], s65 offen offset:1024 lds
    buffer_load_dwordx4 v12, s[8:11], s65 offen offset:2048 lds
    buffer_load_dwordx4 v13, s[8:11], s65 offen offset:3072 lds
    s_waitcnt vmcnt(0)
    s_barrier
    ds_read_b128 a[144:147], v0 offset:0
    ds_read_b128 a[148:151], v1 offset:0
    ds_read_b128 a[152:155], v2 offset:0
    ds_read_b128 a[156:159], v3 offset:0
    s_waitcnt lgkmcnt(0)
    v_mfma_f32_16x16x32_bf16 v[128:131], a[144:147], v[64:67], 0
    v_mfma_f32_16x16x32_bf16 v[128:131], a[148:151], v[68:71], v[128:131]
    v_mfma_f32_16x16x32_bf16 v[128:131], a[152:155], v[72:75], v[128:131]
    v_mfma_f32_16x16x32_bf16 v[128:131], a[156:159], v[76:79], v[128:131]
    v_mfma_f32_16x16x32_bf16 v[132:135], a[144:147], v[80:83], 0
    v_mfma_f32_16x16x32_bf16 v[132:135], a[148:151], v[84:87], v[132:135]
    v_mfma_f32_16x16x32_bf16 v[132:135], a[152:155], v[88:91], v[132:135]
    v_mfma_f32_16x16x32_bf16 v[132:135], a[156:159], v[92:95], v[132:135]
    v_mfma_f32_16x16x32_bf16 v[136:139], a[144:147], v[96:99], 0
    v_mfma_f32_16x16x32_bf16 v[136:139], a[148:151], v[100:103], v[136:139]
    v_mfma_f32_16x16x32_bf16 v[136:139], a[152:155], v[104:107], v[136:139]
    v_mfma_f32_16x16x32_bf16 v[136:139], a[156:159], v[108:111], v[136:139]
    v_mfma_f32_16x16x32_bf16 v[140:143], a[144:147], v[112:115], 0
    v_mfma_f32_16x16x32_bf16 v[140:143], a[148:151], v[116:119], v[140:143]
    v_mfma_f32_16x16x32_bf16 v[140:143], a[152:155], v[120:123], v[140:143]
    v_mfma_f32_16x16x32_bf16 v[140:143], a[156:159], v[124:127], v[140:143]
    s_nop 7
    v_max3_f32 v16, v16, v128, v129
    v_max3_f32 v16, v16, v130, v131
    v_max3_f32 v20, v20, v132, v133
    v_max3_f32 v20, v20, v134, v135
    v_max3_f32 v24, v24, v136, v137
    v_max3_f32 v24, v24, v138, v139
    v_max3_f32 v28, v28, v140, v141
    v_max3_f32 v28, v28, v142, v143
    ds_read_b128 a[160:163], v0 offset:4096
    ds_read_b128 a[164:167], v1 offset:4096
    ds_read_b128 a[168:171], v2 offset:4096
    ds_read_b128 a[172:175], v3 offset:4096
    s_waitcnt lgkmcnt(0)
    v_mfma_f32_16x16x32_bf16 v[128:131], a[160:163], v[64:67], 0
    v_mfma_f32_16x16x32_bf16 v[128:131], a[164:167], v[68:71], v[128:131]
    v_mfma_f32_16x16x32_bf16 v[128:131], a[168:171], v[72:75], v[128:131]
    v_mfma_f32_16x16x32_bf16 v[128:131], a[172:175], v[76:79], v[128:131]
    v_mfma_f32_16x16x32_bf16 v[132:135], a[160:163], v[80:83], 0
    v_mfma_f32_16x16x32_bf16 v[132:135], a[164:167], v[84:87], v[132:135]
    v_mfma_f32_16x16x32_bf16 v[132:135], a[168:171], v[88:91], v[132:135]
    v_mfma_f32_16x16x32_bf16 v[132:135], a[172:175], v[92:95], v[132:135]
    v_mfma_f32_16x16x32_bf16 v[136:139], a[160:163], v[96:99], 0
    v_mfma_f32_16x16x32_bf16 v[136:139], a[164:167], v[100:103], v[136:139]
    v_mfma_f32_16x16x32_bf16 v[136:139], a[168:171], v[104:107], v[136:139]
    v_mfma_f32_16x16x32_bf16 v[136:139], a[172:175], v[108:111], v[136:139]
    v_mfma_f32_16x16x32_bf16 v[140:143], a[160:163], v[112:115], 0
    v_mfma_f32_16x16x32_bf16 v[140:143], a[164:167], v[116:119], v[140:143]
    v_mfma_f32_16x16x32_bf16 v[140:143], a[168:171], v[120:123], v[140:143]
    v_mfma_f32_16x16x32_bf16 v[140:143], a[172:175], v[124:127], v[140:143]
    s_nop 7
    v_max3_f32 v16, v16, v128, v129
    v_max3_f32 v16, v16, v130, v131
    v_max3_f32 v20, v20, v132, v133
    v_max3_f32 v20, v20, v134, v135
    v_max3_f32 v24, v24, v136, v137
    v_max3_f32 v24, v24, v138, v139
    v_max3_f32 v28, v28, v140, v141
    v_max3_f32 v28, v28, v142, v143
    ds_read_b128 a[144:147], v0 offset:16384
    ds_read_b128 a[148:151], v1 offset:16384
    ds_read_b128 a[152:155], v2 offset:16384
    ds_read_b128 a[156:159], v3 offset:16384
    s_waitcnt lgkmcnt(0)
    v_mfma_f32_16x16x32_bf16 v[128:131], a[144:147], v[64:67], 0
    v_mfma_f32_16x16x32_bf16 v[128:131], a[148:151], v[68:71], v[128:131]
    v_mfma_f32_16x16x32_bf16 v[128:131], a[152:155], v[72:75], v[128:131]
    v_mfma_f32_16x16x32_bf16 v[128:131], a[156:159], v[76:79], v[128:131]
    v_mfma_f32_16x16x32_bf16 v[132:135], a[144:147], v[80:83], 0
    v_mfma_f32_16x16x32_bf16 v[132:135], a[148:151], v[84:87], v[132:135]
    v_mfma_f32_16x16x32_bf16 v[132:135], a[152:155], v[88:91], v[132:135]
    v_mfma_f32_16x16x32_bf16 v[132:135], a[156:159], v[92:95], v[132:135]
    v_mfma_f32_16x16x32_bf16 v[136:139], a[144:147], v[96:99], 0
    v_mfma_f32_16x16x32_bf16 v[136:139], a[148:151], v[100:103], v[136:139]
    v_mfma_f32_16x16x32_bf16 v[136:139], a[152:155], v[104:107], v[136:139]
    v_mfma_f32_16x16x32_bf16 v[136:139], a[156:159], v[108:111], v[136:139]
    v_mfma_f32_16x16x32_bf16 v[140:143], a[144:147], v[112:115], 0
    v_mfma_f32_16x16x32_bf16 v[140:143], a[148:151], v[116:119], v[140:143]
    v_mfma_f32_16x16x32_bf16 v[140:143], a[152:155], v[120:123], v[140:143]
    v_mfma_f32_16x16x32_bf16 v[140:143], a[156:159], v[124:127], v[140:143]
    s_nop 7
    v_max3_f32 v16, v16, v128, v129
    v_max3_f32 v16, v16, v130, v131
    v_max3_f32 v20, v20, v132, v133
    v_max3_f32 v20, v20, v134, v135
    v_max3_f32 v24, v24, v136, v137
    v_max3_f32 v24, v24, v138, v139
    v_max3_f32 v28, v28, v140, v141
    v_max3_f32 v28, v28, v142, v143
    ds_read_b128 a[160:163], v0 offset:20480
    ds_read_b128 a[164:167], v1 offset:20480
    ds_read_b128 a[168:171], v2 offset:20480
    ds_read_b128 a[172:175], v3 offset:20480
    s_waitcnt lgkmcnt(0)
    v_mfma_f32_16x16x32_bf16 v[128:131], a[160:163], v[64:67], 0
    v_mfma_f32_16x16x32_bf16 v[128:131], a[164:167], v[68:71], v[128:131]
    v_mfma_f32_16x16x32_bf16 v[128:131], a[168:171], v[72:75], v[128:131]
    v_mfma_f32_16x16x32_bf16 v[128:131], a[172:175], v[76:79], v[128:131]
    v_mfma_f32_16x16x32_bf16 v[132:135], a[160:163], v[80:83], 0
    v_mfma_f32_16x16x32_bf16 v[132:135], a[164:167], v[84:87], v[132:135]
    v_mfma_f32_16x16x32_bf16 v[132:135], a[168:171], v[88:91], v[132:135]
    v_mfma_f32_16x16x32_bf16 v[132:135], a[172:175], v[92:95], v[132:135]
    v_mfma_f32_16x16x32_bf16 v[136:139], a[160:163], v[96:99], 0
    v_mfma_f32_16x16x32_bf16 v[136:139], a[164:167], v[100:103], v[136:139]
    v_mfma_f32_16x16x32_bf16 v[136:139], a[168:171], v[104:107], v[136:139]
    v_mfma_f32_16x16x32_bf16 v[136:139], a[172:175], v[108:111], v[136:139]
    v_mfma_f32_16x16x32_bf16 v[140:143], a[160:163], v[112:115], 0
    v_mfma_f32_16x16x32_bf16 v[140:143], a[164:167], v[116:119], v[140:143]
    v_mfma_f32_16x16x32_bf16 v[140:143], a[168:171], v[120:123], v[140:143]
    v_mfma_f32_16x16x32_bf16 v[140:143], a[172:175], v[124:127], v[140:143]
    s_nop 7
    v_max3_f32 v16, v16, v128, v129
    v_max3_f32 v16, v16, v130, v131
    v_max3_f32 v20, v20, v132, v133
    v_max3_f32 v20, v20, v134, v135
    v_max3_f32 v24, v24, v136, v137
    v_max3_f32 v24, v24, v138, v139
    v_max3_f32 v28, v28, v140, v141
    v_max3_f32 v28, v28, v142, v143
    ds_read_b128 a[144:147], v0 offset:32768
    ds_read_b128 a[148:151], v1 offset:32768
    ds_read_b128 a[152:155], v2 offset:32768
    ds_read_b128 a[156:159], v3 offset:32768
    s_waitcnt lgkmcnt(0)
    v_mfma_f32_16x16x32_bf16 v[128:131], a[144:147], v[64:67], 0
    v_mfma_f32_16x16x32_bf16 v[128:131], a[148:151], v[68:71], v[128:131]
    v_mfma_f32_16x16x32_bf16 v[128:131], a[152:155], v[72:75], v[128:131]
    v_mfma_f32_16x16x32_bf16 v[128:131], a[156:159], v[76:79], v[128:131]
    v_mfma_f32_16x16x32_bf16 v[132:135], a[144:147], v[80:83], 0
    v_mfma_f32_16x16x32_bf16 v[132:135], a[148:151], v[84:87], v[132:135]
    v_mfma_f32_16x16x32_bf16 v[132:135], a[152:155], v[88:91], v[132:135]
    v_mfma_f32_16x16x32_bf16 v[132:135], a[156:159], v[92:95], v[132:135]
    v_mfma_f32_16x16x32_bf16 v[136:139], a[144:147], v[96:99], 0
    v_mfma_f32_16x16x32_bf16 v[136:139], a[148:151], v[100:103], v[136:139]
    v_mfma_f32_16x16x32_bf16 v[136:139], a[152:155], v[104:107], v[136:139]
    v_mfma_f32_16x16x32_bf16 v[136:139], a[156:159], v[108:111], v[136:139]
    v_mfma_f32_16x16x32_bf16 v[140:143], a[144:147], v[112:115], 0
    v_mfma_f32_16x16x32_bf16 v[140:143], a[148:151], v[116:119], v[140:143]
    v_mfma_f32_16x16x32_bf16 v[140:143], a[152:155], v[120:123], v[140:143]
    v_mfma_f32_16x16x32_bf16 v[140:143], a[156:159], v[124:127], v[140:143]
    s_nop 7
    v_max3_f32 v16, v16, v128, v129
    v_max3_f32 v16, v16, v130, v131
    v_max3_f32 v20, v20, v132, v133
    v_max3_f32 v20, v20, v134, v135
    v_max3_f32 v24, v24, v136, v137
    v_max3_f32 v24, v24, v138, v139
    v_max3_f32 v28, v28, v140, v141
    v_max3_f32 v28, v28, v142, v143
    ds_read_b128 a[160:163], v0 offset:36864
    ds_read_b128 a[164:167], v1 offset:36864
    ds_read_b128 a[168:171], v2 offset:36864
    ds_read_b128 a[172:175], v3 offset:36864
    s_waitcnt lgkmcnt(0)
    v_mfma_f32_16x16x32_bf16 v[128:131], a[160:163], v[64:67], 0
    v_mfma_f32_16x16x32_bf16 v[128:131], a[164:167], v[68:71], v[128:131]
    v_mfma_f32_16x16x32_bf16 v[128:131], a[168:171], v[72:75], v[128:131]
    v_mfma_f32_16x16x32_bf16 v[128:131], a[172:175], v[76:79], v[128:131]
    v_mfma_f32_16x16x32_bf16 v[132:135], a[160:163], v[80:83], 0
    v_mfma_f32_16x16x32_bf16 v[132:135], a[164:167], v[84:87], v[132:135]
    v_mfma_f32_16x16x32_bf16 v[132:135], a[168:171], v[88:91], v[132:135]
    v_mfma_f32_16x16x32_bf16 v[132:135], a[172:175], v[92:95], v[132:135]
    v_mfma_f32_16x16x32_bf16 v[136:139], a[160:163], v[96:99], 0
    v_mfma_f32_16x16x32_bf16 v[136:139], a[164:167], v[100:103], v[136:139]
    v_mfma_f32_16x16x32_bf16 v[136:139], a[168:171], v[104:107], v[136:139]
    v_mfma_f32_16x16x32_bf16 v[136:139], a[172:175], v[108:111], v[136:139]
    v_mfma_f32_16x16x32_bf16 v[140:143], a[160:163], v[112:115], 0
    v_mfma_f32_16x16x32_bf16 v[140:143], a[164:167], v[116:119], v[140:143]
    v_mfma_f32_16x16x32_bf16 v[140:143], a[168:171], v[120:123], v[140:143]
    v_mfma_f32_16x16x32_bf16 v[140:143], a[172:175], v[124:127], v[140:143]
    s_nop 7
    v_max3_f32 v16, v16, v128, v129
    v_max3_f32 v16, v16, v130, v131
    v_max3_f32 v20, v20, v132, v133
    v_max3_f32 v20, v20, v134, v135
    v_max3_f32 v24, v24, v136, v137
    v_max3_f32 v24, v24, v138, v139
    v_max3_f32 v28, v28, v140, v141
    v_max3_f32 v28, v28, v142, v143
    ds_read_b128 a[144:147], v0 offset:49152
    ds_read_b128 a[148:151], v1 offset:49152
    ds_read_b128 a[152:155], v2 offset:49152
    ds_read_b128 a[156:159], v3 offset:49152
    s_waitcnt lgkmcnt(0)
    v_mfma_f32_16x16x32_bf16 v[128:131], a[144:147], v[64:67], 0
    v_mfma_f32_16x16x32_bf16 v[128:131], a[148:151], v[68:71], v[128:131]
    v_mfma_f32_16x16x32_bf16 v[128:131], a[152:155], v[72:75], v[128:131]
    v_mfma_f32_16x16x32_bf16 v[128:131], a[156:159], v[76:79], v[128:131]
    v_mfma_f32_16x16x32_bf16 v[132:135], a[144:147], v[80:83], 0
    v_mfma_f32_16x16x32_bf16 v[132:135], a[148:151], v[84:87], v[132:135]
    v_mfma_f32_16x16x32_bf16 v[132:135], a[152:155], v[88:91], v[132:135]
    v_mfma_f32_16x16x32_bf16 v[132:135], a[156:159], v[92:95], v[132:135]
    v_mfma_f32_16x16x32_bf16 v[136:139], a[144:147], v[96:99], 0
    v_mfma_f32_16x16x32_bf16 v[136:139], a[148:151], v[100:103], v[136:139]
    v_mfma_f32_16x16x32_bf16 v[136:139], a[152:155], v[104:107], v[136:139]
    v_mfma_f32_16x16x32_bf16 v[136:139], a[156:159], v[108:111], v[136:139]
    v_mfma_f32_16x16x32_bf16 v[140:143], a[144:147], v[112:115], 0
    v_mfma_f32_16x16x32_bf16 v[140:143], a[148:151], v[116:119], v[140:143]
    v_mfma_f32_16x16x32_bf16 v[140:143], a[152:155], v[120:123], v[140:143]
    v_mfma_f32_16x16x32_bf16 v[140:143], a[156:159], v[124:127], v[140:143]
    s_nop 7
    v_max3_f32 v16, v16, v128, v129
    v_max3_f32 v16, v16, v130, v131
    v_max3_f32 v20, v20, v132, v133
    v_max3_f32 v20, v20, v134, v135
    v_max3_f32 v24, v24, v136, v137
    v_max3_f32 v24, v24, v138, v139
    v_max3_f32 v28, v28, v140, v141
    v_max3_f32 v28, v28, v142, v143
    ds_read_b128 a[160:163], v0 offset:53248
    ds_read_b128 a[164:167], v1 offset:53248
    ds_read_b128 a[168:171], v2 offset:53248
    ds_read_b128 a[172:175], v3 offset:53248
    s_waitcnt lgkmcnt(0)
    v_mfma_f32_16x16x32_bf16 v[128:131], a[160:163], v[64:67], 0
    v_mfma_f32_16x16x32_bf16 v[128:131], a[164:167], v[68:71], v[128:131]
    v_mfma_f32_16x16x32_bf16 v[128:131], a[168:171], v[72:75], v[128:131]
    v_mfma_f32_16x16x32_bf16 v[128:131], a[172:175], v[76:79], v[128:131]
    v_mfma_f32_16x16x32_bf16 v[132:135], a[160:163], v[80:83], 0
    v_mfma_f32_16x16x32_bf16 v[132:135], a[164:167], v[84:87], v[132:135]
    v_mfma_f32_16x16x32_bf16 v[132:135], a[168:171], v[88:91], v[132:135]
    v_mfma_f32_16x16x32_bf16 v[132:135], a[172:175], v[92:95], v[132:135]
    v_mfma_f32_16x16x32_bf16 v[136:139], a[160:163], v[96:99], 0
    v_mfma_f32_16x16x32_bf16 v[136:139], a[164:167], v[100:103], v[136:139]
    v_mfma_f32_16x16x32_bf16 v[136:139], a[168:171], v[104:107], v[136:139]
    v_mfma_f32_16x16x32_bf16 v[136:139], a[172:175], v[108:111], v[136:139]
    v_mfma_f32_16x16x32_bf16 v[140:143], a[160:163], v[112:115], 0
    v_mfma_f32_16x16x32_bf16 v[140:143], a[164:167], v[116:119], v[140:143]
    v_mfma_f32_16x16x32_bf16 v[140:143], a[168:171], v[120:123], v[140:143]
    v_mfma_f32_16x16x32_bf16 v[140:143], a[172:175], v[124:127], v[140:143]
    s_nop 7
    v_max3_f32 v16, v16, v128, v129
    v_max3_f32 v16, v16, v130, v131
    v_max3_f32 v20, v20, v132, v133
    v_max3_f32 v20, v20, v134, v135
    v_max3_f32 v24, v24, v136, v137
    v_max3_f32 v24, v24, v138, v139
    v_max3_f32 v28, v28, v140, v141
    v_max3_f32 v28, v28, v142, v143
    s_add_u32 s64, s64, 0x8000
    s_add_u32 s65, s65, 0x8000
    s_sub_u32 s68, s68, 1
    s_cmp_lg_u32 s68, 0
    s_cbranch_scc1 L_FB_LOOP
    v_mov_b32 v17, v16
    v_mov_b32 v21, v20
    v_mov_b32 v25, v24
    v_mov_b32 v29, v28
    s_nop 1
    v_permlane32_swap_b32 v16, v17
    v_permlane32_swap_b32 v20, v21
    v_permlane32_swap_b32 v24, v25
    v_permlane32_swap_b32 v28, v29
    v_max_f32 v16, v16, v17
    v_max_f32 v20, v20, v21
    v_max_f32 v24, v24, v25
    v_max_f32 v28, v28, v29
    v_mov_b32 v17, v16
    v_mov_b32 v21, v20
    v_mov_b32 v25, v24
    v_mov_b32 v29, v28
    s_nop 1
    v_permlane16_swap_b32 v16, v17
    v_permlane16_swap_b32 v20, v21
    v_permlane16_swap_b32 v24, v25
    v_permlane16_swap_b32 v28, v29
    v_max_f32 v16, v16, v17
    v_max_f32 v20, v20, v21
    v_max_f32 v24, v24, v25
    v_max_f32 v28, v28, v29
    v_sub_f32 v16, 0xc1200000, v16
    v_sub_f32 v20, 0xc1200000, v20
    v_sub_f32 v24, 0xc1200000, v24
    v_sub_f32 v28, 0xc1200000, v28
    v_mov_b32 v17, v16
    v_mov_b32 v18, v16
    v_mov_b32 v19, v16
    v_mov_b32 v21, v20
    v_mov_b32 v22, v20
    v_mov_b32 v23, v20
    v_mov_b32 v25, v24
    v_mov_b32 v26, v24
    v_mov_b32 v27, v24
    v_mov_b32 v29, v28
    v_mov_b32 v30, v28
    v_mov_b32 v31, v28
    s_lshl_b32 s66, s3, 13
    s_add_u32 s67, s66, 4096
    s_add_u32 m0, s63, 0x2000
    s_nop 0
    buffer_load_dwordx4 v12, s[8:11], s64 offen lds
    buffer_load_dwordx4 v13, s[8:11], s64 offen offset:1024 lds
    buffer_load_dwordx4 v12, s[8:11], s64 offen offset:2048 lds
    buffer_load_dwordx4 v13, s[8:11], s64 offen offset:3072 lds
    s_add_u32 m0, s63, 0x3000
    s_nop 0
    buffer_load_dwordx4 v12, s[8:11], s65 offen lds
    buffer_load_dwordx4 v13, s[8:11], s65 offen offset:1024 lds
    buffer_load_dwordx4 v12, s[8:11], s65 offen offset:2048 lds
    buffer_load_dwordx4 v13, s[8:11], s65 offen offset:3072 lds
    s_add_u32 m0, s63, 0x10000
    s_nop 0
    buffer_load_dwordx4 v12, s[12:15], s66 offen lds
    buffer_load_dwordx4 v13, s[12:15], s66 offen offset:1024 lds
    buffer_load_dwordx4 v12, s[12:15], s66 offen offset:2048 lds
    buffer_load_dwordx4 v13, s[12:15], s66 offen offset:3072 lds
    s_add_u32 m0, s63, 0x11000
    s_nop 0
    buffer_load_dwordx4 v12, s[12:15], s67 offen lds
    buffer_load_dwordx4 v13, s[12:15], s67 offen offset:1024 lds
    buffer_load_dwordx4 v12, s[12:15], s67 offen offset:2048 lds
    buffer_load_dwordx4 v13, s[12:15], s67 offen offset:3072 lds
    ds_read_b128 a[144:147], v0 offset:0
    ds_read_b128 a[148:151], v1 offset:0
    ds_read_b128 a[152:155], v2 offset:0
    ds_read_b128 a[156:159], v3 offset:0
    s_waitcnt lgkmcnt(0)
    s_add_u32 s64, s64, 0x8000
    s_add_u32 s65, s65, 0x8000
    s_add_u32 s66, s66, 0x8000
    s_add_u32 s67, s67, 0x8000
    v_bfe_u32 v58, v15, 4, 2
    v_cmp_eq_u32 vcc, 1, v58
    v_mov_b32 v56, 0x44444444
    v_mov_b32 v57, 0xeeeeeeee
    v_cndmask_b32 v14, v56, v57, vcc
    v_cmp_gt_u32 vcc, 2, v58
    v_mov_b32 v56, 0x3f803f80
    v_lshrrev_b32 v57, 6, v15
    v_cndmask_b32 v59, 0, v56, vcc
    v_lshlrev_b32 v56, 8, v57
    v_and_b32 v57, 7, v57
    v_lshl_add_u32 v56, v58, 3, v56
    v_add_u32 v56, 0x10000, v56
    v_accvgpr_write_b32 a128, 0
    v_accvgpr_write_b32 a129, 0
    v_accvgpr_write_b32 a130, 0
    v_accvgpr_write_b32 a131, 0
    v_accvgpr_write_b32 a132, 0
    v_accvgpr_write_b32 a133, 0
    v_accvgpr_write_b32 a134, 0
    v_accvgpr_write_b32 a135, 0
    v_accvgpr_write_b32 a136, 0
    v_accvgpr_write_b32 a137, 0
    v_accvgpr_write_b32 a138, 0
    v_accvgpr_write_b32 a139, 0
    v_accvgpr_write_b32 a140, 0
    v_accvgpr_write_b32 a141, 0
    v_accvgpr_write_b32 a142, 0
    v_accvgpr_write_b32 a143, 0
    v_mfma_f32_16x16x32_bf16 v[32:35], a[144:147], v[64:67], v[16:19]
    ds_read_b128 a[160:163], v0 offset:4096
    v_mfma_f32_16x16x32_bf16 v[32:35], a[148:151], v[68:71], v[32:35]
    v_mfma_f32_16x16x32_bf16 v[32:35], a[152:155], v[72:75], v[32:35]
    ds_read_b128 a[164:167], v1 offset:4096
    v_mfma_f32_16x16x32_bf16 v[32:35], a[156:159], v[76:79], v[32:35]
    s_add_u32 m0, s63, 0x0
    v_mfma_f32_16x16x32_bf16 v[36:39], a[144:147], v[80:83], v[20:23]
    ds_read_b128 a[168:171], v2 offset:4096
    v_mfma_f32_16x16x32_bf16 v[36:39], a[148:151], v[84:87], v[36:39]
    s_nop 0
    v_mfma_f32_16x16x32_bf16 v[36:39], a[152:155], v[88:91], v[36:39]
    ds_read_b128 a[172:175], v3 offset:4096
    v_mfma_f32_16x16x32_bf16 v[36:39], a[156:159], v[92:95], v[36:39]
    v_exp_f32 v32, v32
    v_mfma_f32_16x16x32_bf16 v[40:43], a[144:147], v[96:99], v[24:27]
    v_exp_f32 v33, v33
    v_mfma_f32_16x16x32_bf16 v[40:43], a[148:151], v[100:103], v[40:43]
    v_exp_f32 v34, v34
    v_cvt_pk_bf16_f32 v128, v32, v33
    v_mfma_f32_16x16x32_bf16 v[40:43], a[152:155], v[104:107], v[40:43]
    v_exp_f32 v35, v35
    v_mfma_f32_16x16x32_bf16 v[40:43], a[156:159], v[108:111], v[40:43]
    v_cvt_pk_bf16_f32 v129, v34, v35
    v_exp_f32 v36, v36
    v_mfma_f32_16x16x32_bf16 v[32:35], a[144:147], v[112:115], v[28:31]
    v_exp_f32 v37, v37
    v_mfma_f32_16x16x32_bf16 v[32:35], a[148:151], v[116:119], v[32:35]
    v_exp_f32 v38, v38
    v_cvt_pk_bf16_f32 v144, v36, v37
    v_mfma_f32_16x16x32_bf16 v[32:35], a[152:155], v[120:123], v[32:35]
    v_exp_f32 v39, v39
    v_mfma_f32_16x16x32_bf16 v[32:35], a[156:159], v[124:127], v[32:35]
    s_waitcnt lgkmcnt(0)
    v_cvt_pk_bf16_f32 v145, v38, v39
    v_exp_f32 v40, v40
    v_mfma_f32_16x16x32_bf16 v[36:39], a[160:163], v[64:67], v[16:19]
    ds_read_b128 a[144:147], v0 offset:16384
    v_exp_f32 v41, v41
    v_mfma_f32_16x16x32_bf16 v[36:39], a[164:167], v[68:71], v[36:39]
    v_exp_f32 v42, v42
    v_cvt_pk_bf16_f32 v160, v40, v41
    v_mfma_f32_16x16x32_bf16 v[36:39], a[168:171], v[72:75], v[36:39]
    ds_read_b128 a[148:151], v1 offset:16384
    v_exp_f32 v43, v43
    v_mfma_f32_16x16x32_bf16 v[36:39], a[172:175], v[76:79], v[36:39]
    v_cvt_pk_bf16_f32 v161, v42, v43
    v_exp_f32 v32, v32
    v_mfma_f32_16x16x32_bf16 v[40:43], a[160:163], v[80:83], v[20:23]
    ds_read_b128 a[152:155], v2 offset:16384
    v_exp_f32 v33, v33
    v_mfma_f32_16x16x32_bf16 v[40:43], a[164:167], v[84:87], v[40:43]
    v_exp_f32 v34, v34
    v_cvt_pk_bf16_f32 v176, v32, v33
    v_mfma_f32_16x16x32_bf16 v[40:43], a[168:171], v[88:91], v[40:43]
    ds_read_b128 a[156:159], v3 offset:16384
    v_exp_f32 v35, v35
    v_mfma_f32_16x16x32_bf16 v[40:43], a[172:175], v[92:95], v[40:43]
    v_cvt_pk_bf16_f32 v177, v34, v35
    v_exp_f32 v36, v36
    v_mfma_f32_16x16x32_bf16 v[32:35], a[160:163], v[96:99], v[24:27]
    v_exp_f32 v37, v37
    v_mfma_f32_16x16x32_bf16 v[32:35], a[164:167], v[100:103], v[32:35]
    v_exp_f32 v38, v38
    v_cvt_pk_bf16_f32 v130, v36, v37
    v_mfma_f32_16x16x32_bf16 v[32:35], a[168:171], v[104:107], v[32:35]
    v_exp_f32 v39, v39
    v_mfma_f32_16x16x32_bf16 v[32:35], a[172:175], v[108:111], v[32:35]
    v_cvt_pk_bf16_f32 v131, v38, v39
    v_exp_f32 v40, v40
    v_mfma_f32_16x16x32_bf16 v[36:39], a[160:163], v[112:115], v[28:31]
    v_exp_f32 v41, v41
    v_mfma_f32_16x16x32_bf16 v[36:39], a[164:167], v[116:119], v[36:39]
    v_exp_f32 v42, v42
    v_cvt_pk_bf16_f32 v146, v40, v41
    v_mfma_f32_16x16x32_bf16 v[36:39], a[168:171], v[120:123], v[36:39]
    v_exp_f32 v43, v43
    v_mfma_f32_16x16x32_bf16 v[36:39], a[172:175], v[124:127], v[36:39]
    s_waitcnt lgkmcnt(0)
    v_cvt_pk_bf16_f32 v147, v42, v43
    v_exp_f32 v32, v32
    v_mfma_f32_16x16x32_bf16 v[40:43], a[144:147], v[64:67], v[16:19]
    ds_read_b128 a[160:163], v0 offset:20480
    v_exp_f32 v33, v33
    v_mfma_f32_16x16x32_bf16 v[40:43], a[148:151], v[68:71], v[40:43]
    v_exp_f32 v34, v34
    v_cvt_pk_bf16_f32 v162, v32, v33
    v_mfma_f32_16x16x32_bf16 v[40:43], a[152:155], v[72:75], v[40:43]
    ds_read_b128 a[164:167], v1 offset:20480
    v_exp_f32 v35, v35
    v_mfma_f32_16x16x32_bf16 v[40:43], a[156:159], v[76:79], v[40:43]
    v_cvt_pk_bf16_f32 v163, v34, v35
    v_exp_f32 v36, v36
    v_mfma_f32_16x16x32_bf16 v[32:35], a[144:147], v[80:83], v[20:23]
    ds_read_b128 a[168:171], v2 offset:20480
    v_exp_f32 v37, v37
    v_mfma_f32_16x16x32_bf16 v[32:35], a[148:151], v[84:87], v[32:35]
    v_exp_f32 v38, v38
    v_cvt_pk_bf16_f32 v178, v36, v37
    v_mfma_f32_16x16x32_bf16 v[32:35], a[152:155], v[88:91], v[32:35]
    ds_read_b128 a[172:175], v3 offset:20480
    v_exp_f32 v39, v39
    v_mfma_f32_16x16x32_bf16 v[32:35], a[156:159], v[92:95], v[32:35]
    v_cvt_pk_bf16_f32 v179, v38, v39
    v_exp_f32 v40, v40
    v_mfma_f32_16x16x32_bf16 v[36:39], a[144:147], v[96:99], v[24:27]
    v_exp_f32 v41, v41
    v_mfma_f32_16x16x32_bf16 v[36:39], a[148:151], v[100:103], v[36:39]
    v_exp_f32 v42, v42
    v_cvt_pk_bf16_f32 v132, v40, v41
    v_mfma_f32_16x16x32_bf16 v[36:39], a[152:155], v[104:107], v[36:39]
    v_exp_f32 v43, v43
    v_mfma_f32_16x16x32_bf16 v[36:39], a[156:159], v[108:111], v[36:39]
    v_cvt_pk_bf16_f32 v133, v42, v43
    v_exp_f32 v32, v32
    v_mfma_f32_16x16x32_bf16 v[40:43], a[144:147], v[112:115], v[28:31]
    v_exp_f32 v33, v33
    v_mfma_f32_16x16x32_bf16 v[40:43], a[148:151], v[116:119], v[40:43]
    v_exp_f32 v34, v34
    v_cvt_pk_bf16_f32 v148, v32, v33
    v_mfma_f32_16x16x32_bf16 v[40:43], a[152:155], v[120:123], v[40:43]
    v_exp_f32 v35, v35
    v_mfma_f32_16x16x32_bf16 v[40:43], a[156:159], v[124:127], v[40:43]
    s_waitcnt lgkmcnt(0)
    v_cvt_pk_bf16_f32 v149, v34, v35
    v_exp_f32 v36, v36
    v_mfma_f32_16x16x32_bf16 v[32:35], a[160:163], v[64:67], v[16:19]
    ds_read_b128 a[144:147], v0 offset:32768
    v_exp_f32 v37, v37
    v_mfma_f32_16x16x32_bf16 v[32:35], a[164:167], v[68:71], v[32:35]
    v_exp_f32 v38, v38
    v_cvt_pk_bf16_f32 v164, v36, v37
    v_mfma_f32_16x16x32_bf16 v[32:35], a[168:171], v[72:75], v[32:35]
    ds_read_b128 a[148:151], v1 offset:32768
    v_exp_f32 v39, v39
    v_mfma_f32_16x16x32_bf16 v[32:35], a[172:175], v[76:79], v[32:35]
    v_cvt_pk_bf16_f32 v165, v38, v39
    v_exp_f32 v40, v40
    v_mfma_f32_16x16x32_bf16 v[36:39], a[160:163], v[80:83], v[20:23]
    ds_read_b128 a[152:155], v2 offset:32768
    v_exp_f32 v41, v41
    v_mfma_f32_16x16x32_bf16 v[36:39], a[164:167], v[84:87], v[36:39]
    v_exp_f32 v42, v42
    v_cvt_pk_bf16_f32 v180, v40, v41
    v_mfma_f32_16x16x32_bf16 v[36:39], a[168:171], v[88:91], v[36:39]
    ds_read_b128 a[156:159], v3 offset:32768
    v_exp_f32 v43, v43
    v_mfma_f32_16x16x32_bf16 v[36:39], a[172:175], v[92:95], v[36:39]
    v_cvt_pk_bf16_f32 v181, v42, v43
    v_exp_f32 v32, v32
    v_mfma_f32_16x16x32_bf16 v[40:43], a[160:163], v[96:99], v[24:27]
    v_exp_f32 v33, v33
    v_mfma_f32_16x16x32_bf16 v[40:43], a[164:167], v[100:103], v[40:43]
    v_exp_f32 v34, v34
    v_cvt_pk_bf16_f32 v134, v32, v33
    v_mfma_f32_16x16x32_bf16 v[40:43], a[168:171], v[104:107], v[40:43]
    v_exp_f32 v35, v35
    v_mfma_f32_16x16x32_bf16 v[40:43], a[172:175], v[108:111], v[40:43]
    v_cvt_pk_bf16_f32 v135, v34, v35
    v_exp_f32 v36, v36
    v_mfma_f32_16x16x32_bf16 v[32:35], a[160:163], v[112:115], v[28:31]
    v_exp_f32 v37, v37
    v_mfma_f32_16x16x32_bf16 v[32:35], a[164:167], v[116:119], v[32:35]
    v_exp_f32 v38, v38
    v_cvt_pk_bf16_f32 v150, v36, v37
    v_mfma_f32_16x16x32_bf16 v[32:35], a[168:171], v[120:123], v[32:35]
    v_exp_f32 v39, v39
    v_mfma_f32_16x16x32_bf16 v[32:35], a[172:175], v[124:127], v[32:35]
    s_waitcnt lgkmcnt(0)
    v_cvt_pk_bf16_f32 v151, v38, v39
    v_exp_f32 v40, v40
    v_mfma_f32_16x16x32_bf16 v[36:39], a[144:147], v[64:67], v[16:19]
    ds_read_b128 a[160:163], v0 offset:36864
    v_exp_f32 v41, v41
    v_mfma_f32_16x16x32_bf16 v[36:39], a[148:151], v[68:71], v[36:39]
    v_exp_f32 v42, v42
    v_cvt_pk_bf16_f32 v166, v40, v41
    v_mfma_f32_16x16x32_bf16 v[36:39], a[152:155], v[72:75], v[36:39]
    ds_read_b128 a[164:167], v1 offset:36864
    v_exp_f32 v43, v43
    v_mfma_f32_16x16x32_bf16 v[36:39], a[156:159], v[76:79], v[36:39]
    v_cvt_pk_bf16_f32 v167, v42, v43
    v_exp_f32 v32, v32
    v_mfma_f32_16x16x32_bf16 v[40:43], a[144:147], v[80:83], v[20:23]
    ds_read_b128 a[168:171], v2 offset:36864
    v_exp_f32 v33, v33
    v_mfma_f32_16x16x32_bf16 v[40:43], a[148:151], v[84:87], v[40:43]
    v_exp_f32 v34, v34
    v_cvt_pk_bf16_f32 v182, v32, v33
    v_mfma_f32_16x16x32_bf16 v[40:43], a[152:155], v[88:91], v[40:43]
    ds_read_b128 a[172:175], v3 offset:36864
    v_exp_f32 v35, v35
    v_mfma_f32_16x16x32_bf16 v[40:43], a[156:159], v[92:95], v[40:43]
    v_cvt_pk_bf16_f32 v183, v34, v35
    v_exp_f32 v36, v36
    v_mfma_f32_16x16x32_bf16 v[32:35], a[144:147], v[96:99], v[24:27]
    v_exp_f32 v37, v37
    v_mfma_f32_16x16x32_bf16 v[32:35], a[148:151], v[100:103], v[32:35]
    v_exp_f32 v38, v38
    v_cvt_pk_bf16_f32 v136, v36, v37
    v_mfma_f32_16x16x32_bf16 v[32:35], a[152:155], v[104:107], v[32:35]
    v_exp_f32 v39, v39
    v_mfma_f32_16x16x32_bf16 v[32:35], a[156:159], v[108:111], v[32:35]
    v_cvt_pk_bf16_f32 v137, v38, v39
    v_exp_f32 v40, v40
    v_mfma_f32_16x16x32_bf16 v[36:39], a[144:147], v[112:115], v[28:31]
    v_exp_f32 v41, v41
    v_mfma_f32_16x16x32_bf16 v[36:39], a[148:151], v[116:119], v[36:39]
    v_exp_f32 v42, v42
    v_cvt_pk_bf16_f32 v152, v40, v41
    v_mfma_f32_16x16x32_bf16 v[36:39], a[152:155], v[120:123], v[36:39]
    v_exp_f32 v43, v43
    v_mfma_f32_16x16x32_bf16 v[36:39], a[156:159], v[124:127], v[36:39]
    s_waitcnt lgkmcnt(0)
    v_cvt_pk_bf16_f32 v153, v42, v43
    v_exp_f32 v32, v32
    v_mfma_f32_16x16x32_bf16 v[40:43], a[160:163], v[64:67], v[16:19]
    ds_read_b128 a[144:147], v0 offset:49152
    v_exp_f32 v33, v33
    v_mfma_f32_16x16x32_bf16 v[40:43], a[164:167], v[68:71], v[40:43]
    v_exp_f32 v34, v34
    v_cvt_pk_bf16_f32 v168, v32, v33
    v_mfma_f32_16x16x32_bf16 v[40:43], a[168:171], v[72:75], v[40:43]
    ds_read_b128 a[148:151], v1 offset:49152
    v_exp_f32 v35, v35
    v_mfma_f32_16x16x32_bf16 v[40:43], a[172:175], v[76:79], v[40:43]
    v_cvt_pk_bf16_f32 v169, v34, v35
    v_exp_f32 v36, v36
    v_mfma_f32_16x16x32_bf16 v[32:35], a[160:163], v[80:83], v[20:23]
    ds_read_b128 a[152:155], v2 offset:49152
    v_exp_f32 v37, v37
    v_mfma_f32_16x16x32_bf16 v[32:35], a[164:167], v[84:87], v[32:35]
    v_exp_f32 v38, v38
    v_cvt_pk_bf16_f32 v184, v36, v37
    v_mfma_f32_16x16x32_bf16 v[32:35], a[168:171], v[88:91], v[32:35]
    ds_read_b128 a[156:159], v3 offset:49152
    v_exp_f32 v39, v39
    v_mfma_f32_16x16x32_bf16 v[32:35], a[172:175], v[92:95], v[32:35]
    v_cvt_pk_bf16_f32 v185, v38, v39
    v_exp_f32 v40, v40
    v_mfma_f32_16x16x32_bf16 v[36:39], a[160:163], v[96:99], v[24:27]
    v_exp_f32 v41, v41
    v_mfma_f32_16x16x32_bf16 v[36:39], a[164:167], v[100:103], v[36:39]
    v_exp_f32 v42, v42
    v_cvt_pk_bf16_f32 v138, v40, v41
    v_mfma_f32_16x16x32_bf16 v[36:39], a[168:171], v[104:107], v[36:39]
    v_exp_f32 v43, v43
    v_mfma_f32_16x16x32_bf16 v[36:39], a[172:175], v[108:111], v[36:39]
    v_cvt_pk_bf16_f32 v139, v42, v43
    v_exp_f32 v32, v32
    v_mfma_f32_16x16x32_bf16 v[40:43], a[160:163], v[112:115], v[28:31]
    v_exp_f32 v33, v33
    v_mfma_f32_16x16x32_bf16 v[40:43], a[164:167], v[116:119], v[40:43]
    v_exp_f32 v34, v34
    v_cvt_pk_bf16_f32 v154, v32, v33
    v_mfma_f32_16x16x32_bf16 v[40:43], a[168:171], v[120:123], v[40:43]
    v_exp_f32 v35, v35
    v_mfma_f32_16x16x32_bf16 v[40:43], a[172:175], v[124:127], v[40:43]
    s_waitcnt lgkmcnt(0)
    v_cvt_pk_bf16_f32 v155, v34, v35
    v_exp_f32 v36, v36
    v_mfma_f32_16x16x32_bf16 v[32:35], a[144:147], v[64:67], v[16:19]
    ds_read_b128 a[160:163], v0 offset:53248
    v_exp_f32 v37, v37
    v_mfma_f32_16x16x32_bf16 v[32:35], a[148:151], v[68:71], v[32:35]
    v_exp_f32 v38, v38
    v_cvt_pk_bf16_f32 v170, v36, v37
    v_mfma_f32_16x16x32_bf16 v[32:35], a[152:155], v[72:75], v[32:35]
    ds_read_b128 a[164:167], v1 offset:53248
    v_exp_f32 v39, v39
    v_mfma_f32_16x16x32_bf16 v[32:35], a[156:159], v[76:79], v[32:35]
    v_cvt_pk_bf16_f32 v171, v38, v39
    v_exp_f32 v40, v40
    v_mfma_f32_16x16x32_bf16 v[36:39], a[144:147], v[80:83], v[20:23]
    ds_read_b128 a[168:171], v2 offset:53248
    v_exp_f32 v41, v41
    v_mfma_f32_16x16x32_bf16 v[36:39], a[148:151], v[84:87], v[36:39]
    v_exp_f32 v42, v42
    v_cvt_pk_bf16_f32 v186, v40, v41
    v_mfma_f32_16x16x32_bf16 v[36:39], a[152:155], v[88:91], v[36:39]
    ds_read_b128 a[172:175], v3 offset:53248
    v_exp_f32 v43, v43
    v_mfma_f32_16x16x32_bf16 v[36:39], a[156:159], v[92:95], v[36:39]
    v_cvt_pk_bf16_f32 v187, v42, v43
    v_exp_f32 v32, v32
    v_mfma_f32_16x16x32_bf16 v[40:43], a[144:147], v[96:99], v[24:27]
    v_exp_f32 v33, v33
    v_mfma_f32_16x16x32_bf16 v[40:43], a[148:151], v[100:103], v[40:43]
    v_exp_f32 v34, v34
    v_cvt_pk_bf16_f32 v140, v32, v33
    v_mfma_f32_16x16x32_bf16 v[40:43], a[152:155], v[104:107], v[40:43]
    v_exp_f32 v35, v35
    v_mfma_f32_16x16x32_bf16 v[40:43], a[156:159], v[108:111], v[40:43]
    v_cvt_pk_bf16_f32 v141, v34, v35
    v_exp_f32 v36, v36
    v_mfma_f32_16x16x32_bf16 v[32:35], a[144:147], v[112:115], v[28:31]
    v_exp_f32 v37, v37
    v_mfma_f32_16x16x32_bf16 v[32:35], a[148:151], v[116:119], v[32:35]
    v_exp_f32 v38, v38
    v_cvt_pk_bf16_f32 v156, v36, v37
    v_mfma_f32_16x16x32_bf16 v[32:35], a[152:155], v[120:123], v[32:35]
    v_exp_f32 v39, v39
    v_mfma_f32_16x16x32_bf16 v[32:35], a[156:159], v[124:127], v[32:35]
    s_waitcnt vmcnt(0) lgkmcnt(0)
    s_barrier
    v_cvt_pk_bf16_f32 v157, v38, v39
    v_exp_f32 v40, v40
    v_mfma_f32_16x16x32_bf16 v[36:39], a[160:163], v[64:67], v[16:19]
    ds_read_b128 a[144:147], v0 offset:8192
    v_exp_f32 v41, v41
    v_mfma_f32_16x16x32_bf16 v[36:39], a[164:167], v[68:71], v[36:39]
    ds_read_b128 a[148:151], v1 offset:8192
    v_exp_f32 v42, v42
    v_cvt_pk_bf16_f32 v172, v40, v41
    v_mfma_f32_16x16x32_bf16 v[36:39], a[168:171], v[72:75], v[36:39]
    ds_read_b128 a[152:155], v2 offset:8192
    v_exp_f32 v43, v43
    v_mfma_f32_16x16x32_bf16 v[36:39], a[172:175], v[76:79], v[36:39]
    ds_read_b128 a[156:159], v3 offset:8192
    v_cvt_pk_bf16_f32 v173, v42, v43
    v_exp_f32 v32, v32
    v_mfma_f32_16x16x32_bf16 v[40:43], a[160:163], v[80:83], v[20:23]
    ds_read_b64_tr_b16 a[176:177], v4 offset:0
    v_exp_f32 v33, v33
    v_mfma_f32_16x16x32_bf16 v[40:43], a[164:167], v[84:87], v[40:43]
    ds_read_b64_tr_b16 a[178:179], v4 offset:4096
    v_exp_f32 v34, v34
    v_cvt_pk_bf16_f32 v188, v32, v33
    v_mfma_f32_16x16x32_bf16 v[40:43], a[168:171], v[88:91], v[40:43]
    ds_read_b64_tr_b16 a[180:181], v4 offset:16384
    v_exp_f32 v35, v35
    v_mfma_f32_16x16x32_bf16 v[40:43], a[172:175], v[92:95], v[40:43]
    ds_read_b64_tr_b16 a[182:183], v4 offset:20480
    v_cvt_pk_bf16_f32 v189, v34, v35
    v_exp_f32 v36, v36
    v_mfma_f32_16x16x32_bf16 v[32:35], a[160:163], v[96:99], v[24:27]
    ds_read_b64_tr_b16 a[184:185], v4 offset:32768
    v_exp_f32 v37, v37
    v_mfma_f32_16x16x32_bf16 v[32:35], a[164:167], v[100:103], v[32:35]
    ds_read_b64_tr_b16 a[186:187], v4 offset:36864
    v_exp_f32 v38, v38
    v_cvt_pk_bf16_f32 v142, v36, v37
    v_mfma_f32_16x16x32_bf16 v[32:35], a[168:171], v[104:107], v[32:35]
    ds_read_b64_tr_b16 a[188:189], v4 offset:49152
    v_exp_f32 v39, v39
    v_mfma_f32_16x16x32_bf16 v[32:35], a[172:175], v[108:111], v[32:35]
    ds_read_b64_tr_b16 a[190:191], v4 offset:53248
    v_cvt_pk_bf16_f32 v143, v38, v39
    v_exp_f32 v40, v40
    v_mfma_f32_16x16x32_bf16 v[36:39], a[160:163], v[112:115], v[28:31]
    v_exp_f32 v41, v41
    v_mfma_f32_16x16x32_bf16 v[36:39], a[164:167], v[116:119], v[36:39]
    v_exp_f32 v42, v42
    v_cvt_pk_bf16_f32 v158, v40, v41
    v_mfma_f32_16x16x32_bf16 v[36:39], a[168:171], v[120:123], v[36:39]
    v_exp_f32 v43, v43
    v_mfma_f32_16x16x32_bf16 v[36:39], a[172:175], v[124:127], v[36:39]
    v_cvt_pk_bf16_f32 v159, v42, v43
    s_nop 3
    v_exp_f32 v32, v32
    v_exp_f32 v33, v33
    v_exp_f32 v34, v34
    v_exp_f32 v35, v35
    v_cvt_pk_bf16_f32 v174, v32, v33
    v_cvt_pk_bf16_f32 v175, v34, v35
    s_waitcnt lgkmcnt(0)
    s_branch L_IT1
.section .rodata,"a"
.p2align 6
.amdhsa_kernel recurrent_scan__gqa_block_cached__dense_activation_gelu__prompt_kernel
  .amdhsa_next_free_vgpr 512
  .amdhsa_next_free_sgpr 102
  .amdhsa_accum_offset 256
  .amdhsa_group_segment_fixed_size 0
  .amdhsa_kernarg_size 104
  .amdhsa_user_sgpr_count 2
  .amdhsa_user_sgpr_kernarg_segment_ptr 1
  .amdhsa_system_sgpr_workgroup_id_x 1
  .amdhsa_float_denorm_mode_32 3
.end_amdhsa_kernel
```
